```python
import torch

def _softmax(x, axis=-1):
    return torch.softmax(x, dim=axis)
def _gelu(x):
    return torch.nn.functional.gelu(x, approximate="tanh")
def _silu(x):
    return torch.nn.functional.silu(x)
def _sigmoid(x):
    return torch.sigmoid(x)
def _layernorm(x, axis=-1, eps=1e-5):
    m = x.mean(dim=axis, keepdim=True)
    v = x.var(dim=axis, keepdim=True, unbiased=False)
    return (x - m) / torch.sqrt(v + eps)
def _scatter_add(tgt, idx, src, axis=0):
    return tgt.clone().index_add_(axis, idx, src)
def _segment_sum(src, seg, n):
    out = torch.zeros((n,) + src.shape[1:], dtype=src.dtype)
    return out.index_add_(0, seg, src)
def _pad(x, pw):
    flat = tuple(v for pair in reversed(pw) for v in pair)
    return torch.nn.functional.pad(x, flat)

kernel_name = 'sequential_preLN__compressed_kv_cla__glu_gated_reglu__prompt'

def setup_inputs():

    _w = (lambda a: (lambda t: t.to(torch.bfloat16) if t.is_floating_point() else t)(torch.as_tensor(a)))
    def _A_setup():
        B, H, Sq, Sk, D, M = 1, 32, 2048, 2048, 128, 512
        Dc = 4 * D
        return {
            "x": _w((lambda *s: torch.randn(*s, dtype=torch.bfloat16) * 0.05)(B, Sq, M)),
            "c_kv": _w((lambda *s: torch.randn(*s, dtype=torch.bfloat16) * 0.4)(B, Sk, Dc)),
            "w_q": _w((lambda *s: torch.randn(*s, dtype=torch.bfloat16) * 1.6)(M, H, D) * (M ** -0.5)),
            "w_uk": _w((lambda *s: torch.randn(*s, dtype=torch.bfloat16) * 1.6)(Dc, H, D) * (Dc ** -0.5)),
            "w_uv": _w((lambda *s: torch.randn(*s, dtype=torch.bfloat16) * 0.4)(Dc, H, D) * (Dc ** -0.5)),
            "w_o": _w((lambda *s: torch.randn(*s, dtype=torch.bfloat16) * 0.4)(H, D, M) * ((H * D) ** -0.5)),
        }
    _A_in = _A_setup()

    def _B_setup():
        B, S, D, F = 1, 2048, 512, 1376
        return {
            "x": _w((lambda *s: torch.randn(*s, dtype=torch.bfloat16) * 0.05)(B, S, D)),
            "W_gate": _w((lambda *s: torch.randn(*s, dtype=torch.bfloat16) * 0.2)(D, F) * (2.0 / D) ** 0.5),
            "W_up": _w((lambda *s: torch.randn(*s, dtype=torch.bfloat16) * 0.2)(D, F) * (2.0 / D) ** 0.5),
            "W_down": _w((lambda *s: torch.randn(*s, dtype=torch.bfloat16) * 0.2)(F, D) * (1.0 / F) ** 0.5),
        }
    _B_in = _B_setup()

    return {
        "A_x": _A_in["x"],
        "A_c_kv": _A_in["c_kv"],
        "A_w_q": _A_in["w_q"],
        "A_w_uk": _A_in["w_uk"],
        "A_w_uv": _A_in["w_uv"],
        "A_w_o": _A_in["w_o"],
        "B_x": _B_in["x"],
        "B_W_gate": _B_in["W_gate"],
        "B_W_up": _B_in["W_up"],
        "B_W_down": _B_in["W_down"],
    }

def reference(A_x, A_c_kv, A_w_q, A_w_uk, A_w_uv, A_w_o, B_x, B_W_gate, B_W_up, B_W_down):
    def _A_ref(x, c_kv, w_q, w_uk, w_uv, w_o):
        B, Sq, M = x.shape[0], x.shape[1], x.shape[2]
        Sk = c_kv.shape[1]
        H, D = w_q.shape[1], w_q.shape[2]
        q = torch.einsum("bqm,mhd->bhqd", x, w_q)
        k = torch.einsum("bkc,chd->bhkd", c_kv, w_uk)
        v = torch.einsum("bkc,chd->bhkd", c_kv, w_uv)
        scores = torch.einsum("bhqd,bhkd->bhqk", q, k) * (D ** -0.5)
        off = Sk - Sq
        qi = torch.arange(Sq)[:, None]
        kj = torch.arange(Sk)[None, :]
        cmask = kj <= (qi + off)
        scores = torch.where(cmask[None, None], scores, -1e9)
        p = _softmax(scores, axis=-1)
        ctx = torch.einsum("bhqk,bhkd->bhqd", p, v)
        return torch.einsum("bhqd,hdm->bqm", ctx, w_o)

    def _B_ref(x, W_gate, W_up, W_down):
        gate = torch.einsum("bsd,df->bsf", x, W_gate)
        up = torch.einsum("bsd,df->bsf", x, W_up)
        gate = gate * (lambda x, dt: x.to(dt))(gate > 0, gate.dtype)
        h = gate * up
        return torch.einsum("bsf,fd->bsd", h, W_down)

    x = A_x
    h = x + _A_ref(_layernorm(x, axis=-1), A_c_kv, A_w_q, A_w_uk, A_w_uv, A_w_o)
    h2 = h + _B_ref(_layernorm(h, axis=-1), B_W_gate, B_W_up, B_W_down)
    return h2
```

```asm
; @launch kernel=k1_kernel grid=(256,1,1) block=(256,1,1) lds=163840
; @launch kernel=k2_kernel grid=(256,1,1) block=(256,1,1) lds=163840
; @launch kernel=k3_kernel grid=(256,1,1) block=(256,1,1) lds=69632
; @launch kernel=k45_kernel grid=(256,1,1) block=(256,1,1) lds=143360
.amdgcn_target "amdgcn-amd-amdhsa--gfx950"
.text
.globl k1_kernel
.p2align 8
.type k1_kernel,@function
k1_kernel:
s_cmp_ge_u32 s2, 256
s_cbranch_scc1 K1_END
s_load_dwordx2 s[4:5], s[0:1], 0
s_load_dwordx2 s[6:7], s[0:1], 8
s_load_dwordx2 s[8:9], s[0:1], 24
s_load_dwordx2 s[10:11], s[0:1], 32
s_load_dwordx2 s[12:13], s[0:1], 96
s_load_dwordx2 s[14:15], s[0:1], 16
v_and_b32 v1, 63, v0
v_lshrrev_b32 v2, 6, v0
s_nop 0
v_readfirstlane_b32 s36, v2
s_lshr_b32 s40, s2, 3
s_lshr_b32 s37, s40, 2
s_and_b32 s40, s40, 3
s_lshr_b32 s39, s40, 1
s_and_b32 s40, s40, 1
s_and_b32 s38, s2, 7
s_lshl_b32 s38, s38, 1
s_add_u32 s38, s38, s40
s_waitcnt lgkmcnt(0)
s_cmp_lt_u32 s2, 8
s_cbranch_scc0 CPF1_X
s_cmp_eq_u32 s36, 3
s_cbranch_scc0 CPF1_X
s_getpc_b64 s[64:65]
CPF1_P:
s_add_u32 s64, s64, k1_kernel-CPF1_P
s_addc_u32 s65, s65, ((k1_kernel-CPF1_P)>>32)&0xffffffff
s_mov_b32 s66, K1_END-k1_kernel
s_mov_b32 s67, 0x00020000
v_lshlrev_b32 v232, 7, v1
s_mov_b32 s68, 0
CPF1_L:
buffer_load_dword v233, v232, s[64:67], s68 offen
s_add_u32 s68, s68, 8192
s_cmp_lt_u32 s68, s66
s_cbranch_scc1 CPF1_L
CPF1_X:
s_mov_b32 s16, s6
s_mov_b32 s17, s7
s_mov_b32 s18, 2097152
s_mov_b32 s19, 0x00020000
s_cmp_eq_u32 s39, 0
s_cselect_b32 s20, s8, s10
s_cselect_b32 s21, s9, s11
s_mov_b32 s22, 4194304
s_mov_b32 s23, 0x00020000
s_mov_b32 s24, s4
s_mov_b32 s25, s5
s_mov_b32 s26, 2097152
s_mov_b32 s27, 0x00020000
s_add_u32 s28, s12, 0
s_addc_u32 s29, s13, 0
s_mov_b32 s30, 2097152
s_mov_b32 s31, 0x00020000
s_add_u32 s32, s12, 2097152
s_addc_u32 s33, s13, 0
s_mov_b32 s34, 33554432
s_mov_b32 s35, 0x00020000
s_mov_b32 s56, s14
s_mov_b32 s57, s15
s_mov_b32 s58, 4194304
s_mov_b32 s59, 0x00020000
s_lshl_b32 s55, s2, 2
s_add_u32 s55, s55, s36
s_lshl_b32 s55, s55, 12
v_lshlrev_b32 v22, 4, v1
v_lshrrev_b32 v200, 4, v1
v_and_b32 v201, 15, v1
s_and_b32 s63, s37, 3
s_add_u32 s40, s36, s63
s_and_b32 s40, s40, 3
s_lshl_b32 s40, s40, 8
s_lshl_b32 s63, s63, 20
v_add_u32 v202, 0, v200
v_xor_b32 v203, v202, v201
v_lshlrev_b32 v203, 4, v203
v_mul_u32_u24 v202, 1024, v202
v_add3_u32 v6, v202, v203, s40
v_add_u32 v202, 4, v200
v_xor_b32 v203, v202, v201
v_lshlrev_b32 v203, 4, v203
v_mul_u32_u24 v202, 1024, v202
v_add3_u32 v7, v202, v203, s40
v_subrev_u32 v7, 1024, v7
v_add_u32 v202, 8, v200
v_xor_b32 v203, v202, v201
v_lshlrev_b32 v203, 4, v203
v_mul_u32_u24 v202, 1024, v202
v_add3_u32 v8, v202, v203, s40
v_subrev_u32 v8, 2048, v8
v_add_u32 v202, 12, v200
v_xor_b32 v203, v202, v201
v_lshlrev_b32 v203, 4, v203
v_mul_u32_u24 v202, 1024, v202
v_add3_u32 v9, v202, v203, s40
v_subrev_u32 v9, 3072, v9
s_lshl_b32 s43, s37, 18
s_lshl_b32 s46, s36, 13
s_lshl_b32 s45, s36, 12
s_add_u32 s45, s45, 65536
v_lshrrev_b32 v200, 5, v1
v_and_b32 v201, 31, v1
s_and_b32 s40, s36, 1
s_lshl_b32 s40, s40, 2
s_lshl_b32 s41, s36, 3
v_lshrrev_b32 v204, 1, v201
v_and_b32 v205, 1, v201
v_lshlrev_b32 v205, 4, v205
s_lshl_b32 s51, s38, 9
v_add_u32 v205, s51, v205
v_add_u32 v202, 0, v200
v_and_or_b32 v203, v202, 3, s40
v_xor_b32 v203, v203, v204
v_lshl_add_u32 v203, v203, 5, v205
v_add_u32 v202, s41, v202
v_lshl_add_u32 v2, v202, 13, v203
v_add_u32 v202, 2, v200
v_and_or_b32 v203, v202, 3, s40
v_xor_b32 v203, v203, v204
v_lshl_add_u32 v203, v203, 5, v205
v_add_u32 v202, s41, v202
v_lshl_add_u32 v3, v202, 13, v203
v_subrev_u32 v3, 1024, v3
v_add_u32 v202, 4, v200
v_and_or_b32 v203, v202, 3, s40
v_xor_b32 v203, v203, v204
v_lshl_add_u32 v203, v203, 5, v205
v_add_u32 v202, s41, v202
v_lshl_add_u32 v4, v202, 13, v203
v_subrev_u32 v4, 2048, v4
v_add_u32 v202, 6, v200
v_and_or_b32 v203, v202, 3, s40
v_xor_b32 v203, v203, v204
v_lshl_add_u32 v203, v203, 5, v205
v_add_u32 v202, s41, v202
v_lshl_add_u32 v5, v202, 13, v203
v_subrev_u32 v5, 3072, v5
s_add_u32 m0, s45, 0
s_add_u32 s50, s63, 0
s_and_b32 s50, s50, 4194303
buffer_load_dwordx4 v2, s[20:23], s50 offen offset:0 nt lds
buffer_load_dwordx4 v3, s[20:23], s50 offen offset:1024 nt lds
buffer_load_dwordx4 v4, s[20:23], s50 offen offset:2048 nt lds
buffer_load_dwordx4 v5, s[20:23], s50 offen offset:3072 nt lds
s_add_u32 m0, s46, 0
s_add_u32 s49, s43, 0
buffer_load_dwordx4 v6, s[16:19], s49 offen offset:0 lds
buffer_load_dwordx4 v7, s[16:19], s49 offen offset:1024 lds
buffer_load_dwordx4 v8, s[16:19], s49 offen offset:2048 lds
buffer_load_dwordx4 v9, s[16:19], s49 offen offset:3072 lds
s_add_u32 m0, s46, 4096
s_add_u32 s49, s43, 16384
buffer_load_dwordx4 v6, s[16:19], s49 offen offset:0 lds
buffer_load_dwordx4 v7, s[16:19], s49 offen offset:1024 lds
buffer_load_dwordx4 v8, s[16:19], s49 offen offset:2048 lds
buffer_load_dwordx4 v9, s[16:19], s49 offen offset:3072 lds
s_add_u32 m0, s46, 32768
s_add_u32 s49, s43, 32768
buffer_load_dwordx4 v6, s[16:19], s49 offen offset:0 lds
buffer_load_dwordx4 v7, s[16:19], s49 offen offset:1024 lds
buffer_load_dwordx4 v8, s[16:19], s49 offen offset:2048 lds
buffer_load_dwordx4 v9, s[16:19], s49 offen offset:3072 lds
s_add_u32 m0, s46, 36864
s_add_u32 s49, s43, 49152
buffer_load_dwordx4 v6, s[16:19], s49 offen offset:0 lds
buffer_load_dwordx4 v7, s[16:19], s49 offen offset:1024 lds
buffer_load_dwordx4 v8, s[16:19], s49 offen offset:2048 lds
buffer_load_dwordx4 v9, s[16:19], s49 offen offset:3072 lds
s_add_u32 m0, s45, 16384
s_add_u32 s50, s63, 262144
s_and_b32 s50, s50, 4194303
buffer_load_dwordx4 v2, s[20:23], s50 offen offset:0 nt lds
buffer_load_dwordx4 v3, s[20:23], s50 offen offset:1024 nt lds
buffer_load_dwordx4 v4, s[20:23], s50 offen offset:2048 nt lds
buffer_load_dwordx4 v5, s[20:23], s50 offen offset:3072 nt lds
s_add_u32 m0, s45, 32768
s_add_u32 s50, s63, 524288
s_and_b32 s50, s50, 4194303
buffer_load_dwordx4 v2, s[20:23], s50 offen offset:0 nt lds
buffer_load_dwordx4 v3, s[20:23], s50 offen offset:1024 nt lds
buffer_load_dwordx4 v4, s[20:23], s50 offen offset:2048 nt lds
buffer_load_dwordx4 v5, s[20:23], s50 offen offset:3072 nt lds
s_lshl_b32 s40, s2, 3
s_lshl_b32 s41, s36, 1
s_add_u32 s48, s40, s41
s_lshl_b32 s47, s48, 10
v_lshrrev_b32 v200, 4, v1
v_and_b32 v201, 15, v1
v_lshlrev_b32 v203, 8, v201
v_add_u32 v202, 0, v200
v_xor_b32 v202, v202, v201
v_lshl_add_u32 v14, v202, 4, v203
v_add_u32 v18, 0x10000, v14
v_add_u32 v28, 0x20000, v14
v_add_u32 v202, 4, v200
v_xor_b32 v202, v202, v201
v_lshl_add_u32 v15, v202, 4, v203
v_add_u32 v19, 0x10000, v15
v_add_u32 v29, 0x20000, v15
v_add_u32 v202, 8, v200
v_xor_b32 v202, v202, v201
v_lshl_add_u32 v16, v202, 4, v203
v_add_u32 v20, 0x10000, v16
v_add_u32 v30, 0x20000, v16
v_add_u32 v202, 12, v200
v_xor_b32 v202, v202, v201
v_lshl_add_u32 v17, v202, 4, v203
v_add_u32 v21, 0x10000, v17
v_add_u32 v31, 0x20000, v17
v_lshrrev_b32 v202, 2, v201
v_and_b32 v203, 1, v200
v_lshl_or_b32 v203, v203, 2, v202
v_lshl_add_u32 v204, v200, 3, v202
v_lshlrev_b32 v204, 9, v204
v_and_b32 v205, 3, v201
v_lshl_add_u32 v204, v205, 3, v204
v_add_u32 v204, 65536, v204
s_lshl_b32 s40, s36, 2
s_add_u32 s41, s40, 0
v_xor_b32 v205, s41, v203
v_lshl_add_u32 v10, v205, 5, v204
v_add_u32 v24, 0x10000, v10
s_add_u32 s41, s40, 1
v_xor_b32 v205, s41, v203
v_lshl_add_u32 v11, v205, 5, v204
v_add_u32 v25, 0x10000, v11
s_add_u32 s41, s40, 2
v_xor_b32 v205, s41, v203
v_lshl_add_u32 v12, v205, 5, v204
v_add_u32 v26, 0x10000, v12
s_add_u32 s41, s40, 3
v_xor_b32 v205, s41, v203
v_lshl_add_u32 v13, v205, 5, v204
v_add_u32 v27, 0x10000, v13
s_lshr_b32 s40, s36, 1
s_lshl_b32 s41, s38, 1
s_add_u32 s40, s40, s41
s_lshl_b32 s40, s40, 6
s_lshl_b32 s41, s37, 3
s_add_u32 s40, s40, s41
s_lshl_b32 s44, s40, 14
s_and_b32 s40, s36, 1
s_add_u32 s41, s39, 12
s_lshl_b32 s40, s40, s41
s_add_u32 s44, s44, s40
s_mov_b32 s41, 4096
s_cmp_eq_u32 s39, 0
s_cselect_b32 s40, 0x2000, s41
v_add_u32 v23, s40, v22
s_cmp_eq_u32 s39, 0
s_cbranch_scc0 K1_V
s_waitcnt vmcnt(8)
s_barrier
ds_read_b64_tr_b16 a[0:1], v10 offset:0
ds_read_b64_tr_b16 a[2:3], v10 offset:2048
ds_read_b64_tr_b16 a[4:5], v11 offset:0
ds_read_b64_tr_b16 a[6:7], v11 offset:2048
ds_read_b64_tr_b16 a[8:9], v12 offset:0
ds_read_b64_tr_b16 a[10:11], v12 offset:2048
ds_read_b64_tr_b16 a[12:13], v13 offset:0
ds_read_b64_tr_b16 a[14:15], v13 offset:2048
ds_read_b128 v[128:131], v14 offset:0
ds_read_b128 v[132:135], v14 offset:4096
ds_read_b128 v[136:139], v14 offset:32768
ds_read_b128 v[140:143], v14 offset:36864
s_waitcnt lgkmcnt(0)
s_waitcnt vmcnt(4)
s_barrier
v_mfma_f32_16x16x32_bf16 v[32:35], a[0:3], v[128:131], 0
ds_read_b64_tr_b16 a[16:17], v10 offset:16384
ds_read_b64_tr_b16 a[18:19], v10 offset:18432
v_mfma_f32_16x16x32_bf16 v[36:39], a[4:7], v[128:131], 0
ds_read_b64_tr_b16 a[20:21], v11 offset:16384
ds_read_b64_tr_b16 a[22:23], v11 offset:18432
v_mfma_f32_16x16x32_bf16 v[40:43], a[8:11], v[128:131], 0
ds_read_b64_tr_b16 a[24:25], v12 offset:16384
ds_read_b64_tr_b16 a[26:27], v12 offset:18432
v_mfma_f32_16x16x32_bf16 v[44:47], a[12:15], v[128:131], 0
ds_read_b64_tr_b16 a[28:29], v13 offset:16384
ds_read_b64_tr_b16 a[30:31], v13 offset:18432
v_mfma_f32_16x16x32_bf16 v[48:51], a[0:3], v[132:135], 0
ds_read_b128 v[144:147], v15 offset:0
ds_read_b128 v[148:151], v15 offset:4096
v_mfma_f32_16x16x32_bf16 v[52:55], a[4:7], v[132:135], 0
ds_read_b128 v[152:155], v15 offset:32768
ds_read_b128 v[156:159], v15 offset:36864
v_mfma_f32_16x16x32_bf16 v[56:59], a[8:11], v[132:135], 0
s_add_u32 m0, s45, 49152
s_add_u32 s50, s63, 786432
v_mfma_f32_16x16x32_bf16 v[60:63], a[12:15], v[132:135], 0
s_and_b32 s50, s50, 4194303
v_mfma_f32_16x16x32_bf16 v[64:67], a[0:3], v[136:139], 0
buffer_load_dwordx4 v2, s[20:23], s50 offen offset:0 nt lds
v_mfma_f32_16x16x32_bf16 v[68:71], a[4:7], v[136:139], 0
buffer_load_dwordx4 v3, s[20:23], s50 offen offset:1024 nt lds
v_mfma_f32_16x16x32_bf16 v[72:75], a[8:11], v[136:139], 0
buffer_load_dwordx4 v4, s[20:23], s50 offen offset:2048 nt lds
v_mfma_f32_16x16x32_bf16 v[76:79], a[12:15], v[136:139], 0
buffer_load_dwordx4 v5, s[20:23], s50 offen offset:3072 nt lds
v_mfma_f32_16x16x32_bf16 v[80:83], a[0:3], v[140:143], 0
s_add_u32 m0, s45, 65536
s_add_u32 s50, s63, 1048576
v_mfma_f32_16x16x32_bf16 v[84:87], a[4:7], v[140:143], 0
s_and_b32 s50, s50, 4194303
v_mfma_f32_16x16x32_bf16 v[88:91], a[8:11], v[140:143], 0
buffer_load_dwordx4 v2, s[20:23], s50 offen offset:0 nt lds
v_mfma_f32_16x16x32_bf16 v[92:95], a[12:15], v[140:143], 0
buffer_load_dwordx4 v3, s[20:23], s50 offen offset:1024 nt lds
buffer_load_dwordx4 v4, s[20:23], s50 offen offset:2048 nt lds
buffer_load_dwordx4 v5, s[20:23], s50 offen offset:3072 nt lds
s_waitcnt lgkmcnt(0)
s_waitcnt vmcnt(8)
s_barrier
v_mfma_f32_16x16x32_bf16 v[32:35], a[16:19], v[144:147], v[32:35]
ds_read_b64_tr_b16 a[32:33], v10 offset:32768
ds_read_b64_tr_b16 a[34:35], v10 offset:34816
v_mfma_f32_16x16x32_bf16 v[36:39], a[20:23], v[144:147], v[36:39]
ds_read_b64_tr_b16 a[36:37], v11 offset:32768
ds_read_b64_tr_b16 a[38:39], v11 offset:34816
v_mfma_f32_16x16x32_bf16 v[40:43], a[24:27], v[144:147], v[40:43]
ds_read_b64_tr_b16 a[40:41], v12 offset:32768
ds_read_b64_tr_b16 a[42:43], v12 offset:34816
v_mfma_f32_16x16x32_bf16 v[44:47], a[28:31], v[144:147], v[44:47]
ds_read_b64_tr_b16 a[44:45], v13 offset:32768
ds_read_b64_tr_b16 a[46:47], v13 offset:34816
v_mfma_f32_16x16x32_bf16 v[48:51], a[16:19], v[148:151], v[48:51]
ds_read_b128 v[128:131], v16 offset:0
ds_read_b128 v[132:135], v16 offset:4096
v_mfma_f32_16x16x32_bf16 v[52:55], a[20:23], v[148:151], v[52:55]
ds_read_b128 v[136:139], v16 offset:32768
ds_read_b128 v[140:143], v16 offset:36864
v_mfma_f32_16x16x32_bf16 v[56:59], a[24:27], v[148:151], v[56:59]
s_add_u32 m0, s45, 81920
s_add_u32 s50, s63, 1310720
v_mfma_f32_16x16x32_bf16 v[60:63], a[28:31], v[148:151], v[60:63]
s_and_b32 s50, s50, 4194303
v_mfma_f32_16x16x32_bf16 v[64:67], a[16:19], v[152:155], v[64:67]
buffer_load_dwordx4 v2, s[20:23], s50 offen offset:0 nt lds
v_mfma_f32_16x16x32_bf16 v[68:71], a[20:23], v[152:155], v[68:71]
buffer_load_dwordx4 v3, s[20:23], s50 offen offset:1024 nt lds
v_mfma_f32_16x16x32_bf16 v[72:75], a[24:27], v[152:155], v[72:75]
buffer_load_dwordx4 v4, s[20:23], s50 offen offset:2048 nt lds
v_mfma_f32_16x16x32_bf16 v[76:79], a[28:31], v[152:155], v[76:79]
buffer_load_dwordx4 v5, s[20:23], s50 offen offset:3072 nt lds
v_mfma_f32_16x16x32_bf16 v[80:83], a[16:19], v[156:159], v[80:83]
s_add_u32 m0, s45, 0
s_add_u32 s50, s63, 1572864
v_mfma_f32_16x16x32_bf16 v[84:87], a[20:23], v[156:159], v[84:87]
s_and_b32 s50, s50, 4194303
v_mfma_f32_16x16x32_bf16 v[88:91], a[24:27], v[156:159], v[88:91]
buffer_load_dwordx4 v2, s[20:23], s50 offen offset:0 nt lds
v_mfma_f32_16x16x32_bf16 v[92:95], a[28:31], v[156:159], v[92:95]
buffer_load_dwordx4 v3, s[20:23], s50 offen offset:1024 nt lds
buffer_load_dwordx4 v4, s[20:23], s50 offen offset:2048 nt lds
buffer_load_dwordx4 v5, s[20:23], s50 offen offset:3072 nt lds
s_waitcnt lgkmcnt(0)
s_waitcnt vmcnt(12)
s_barrier
v_mfma_f32_16x16x32_bf16 v[32:35], a[32:35], v[128:131], v[32:35]
ds_read_b64_tr_b16 a[48:49], v10 offset:49152
ds_read_b64_tr_b16 a[50:51], v10 offset:51200
v_mfma_f32_16x16x32_bf16 v[36:39], a[36:39], v[128:131], v[36:39]
ds_read_b64_tr_b16 a[52:53], v11 offset:49152
ds_read_b64_tr_b16 a[54:55], v11 offset:51200
v_mfma_f32_16x16x32_bf16 v[40:43], a[40:43], v[128:131], v[40:43]
ds_read_b64_tr_b16 a[56:57], v12 offset:49152
ds_read_b64_tr_b16 a[58:59], v12 offset:51200
v_mfma_f32_16x16x32_bf16 v[44:47], a[44:47], v[128:131], v[44:47]
ds_read_b64_tr_b16 a[60:61], v13 offset:49152
ds_read_b64_tr_b16 a[62:63], v13 offset:51200
v_mfma_f32_16x16x32_bf16 v[48:51], a[32:35], v[132:135], v[48:51]
ds_read_b128 v[144:147], v17 offset:0
ds_read_b128 v[148:151], v17 offset:4096
v_mfma_f32_16x16x32_bf16 v[52:55], a[36:39], v[132:135], v[52:55]
ds_read_b128 v[152:155], v17 offset:32768
ds_read_b128 v[156:159], v17 offset:36864
v_mfma_f32_16x16x32_bf16 v[56:59], a[40:43], v[132:135], v[56:59]
s_add_u32 m0, s45, 16384
s_add_u32 s50, s63, 1835008
v_mfma_f32_16x16x32_bf16 v[60:63], a[44:47], v[132:135], v[60:63]
s_and_b32 s50, s50, 4194303
v_mfma_f32_16x16x32_bf16 v[64:67], a[32:35], v[136:139], v[64:67]
buffer_load_dwordx4 v2, s[20:23], s50 offen offset:0 nt lds
v_mfma_f32_16x16x32_bf16 v[68:71], a[36:39], v[136:139], v[68:71]
buffer_load_dwordx4 v3, s[20:23], s50 offen offset:1024 nt lds
v_mfma_f32_16x16x32_bf16 v[72:75], a[40:43], v[136:139], v[72:75]
buffer_load_dwordx4 v4, s[20:23], s50 offen offset:2048 nt lds
v_mfma_f32_16x16x32_bf16 v[76:79], a[44:47], v[136:139], v[76:79]
buffer_load_dwordx4 v5, s[20:23], s50 offen offset:3072 nt lds
v_mfma_f32_16x16x32_bf16 v[80:83], a[32:35], v[140:143], v[80:83]
s_add_u32 m0, s45, 32768
s_add_u32 s50, s63, 2097152
v_mfma_f32_16x16x32_bf16 v[84:87], a[36:39], v[140:143], v[84:87]
s_and_b32 s50, s50, 4194303
v_mfma_f32_16x16x32_bf16 v[88:91], a[40:43], v[140:143], v[88:91]
buffer_load_dwordx4 v2, s[20:23], s50 offen offset:0 nt lds
v_mfma_f32_16x16x32_bf16 v[92:95], a[44:47], v[140:143], v[92:95]
buffer_load_dwordx4 v3, s[20:23], s50 offen offset:1024 nt lds
buffer_load_dwordx4 v4, s[20:23], s50 offen offset:2048 nt lds
buffer_load_dwordx4 v5, s[20:23], s50 offen offset:3072 nt lds
s_waitcnt lgkmcnt(0)
s_waitcnt vmcnt(16)
s_barrier
v_mfma_f32_16x16x32_bf16 v[32:35], a[48:51], v[144:147], v[32:35]
ds_read_b64_tr_b16 a[64:65], v24 offset:0
ds_read_b64_tr_b16 a[66:67], v24 offset:2048
v_mfma_f32_16x16x32_bf16 v[36:39], a[52:55], v[144:147], v[36:39]
ds_read_b64_tr_b16 a[68:69], v25 offset:0
ds_read_b64_tr_b16 a[70:71], v25 offset:2048
v_mfma_f32_16x16x32_bf16 v[40:43], a[56:59], v[144:147], v[40:43]
ds_read_b64_tr_b16 a[72:73], v26 offset:0
ds_read_b64_tr_b16 a[74:75], v26 offset:2048
v_mfma_f32_16x16x32_bf16 v[44:47], a[60:63], v[144:147], v[44:47]
ds_read_b64_tr_b16 a[76:77], v27 offset:0
ds_read_b64_tr_b16 a[78:79], v27 offset:2048
v_mfma_f32_16x16x32_bf16 v[48:51], a[48:51], v[148:151], v[48:51]
ds_read_b128 v[128:131], v14 offset:8192
ds_read_b128 v[132:135], v14 offset:12288
v_mfma_f32_16x16x32_bf16 v[52:55], a[52:55], v[148:151], v[52:55]
ds_read_b128 v[136:139], v14 offset:40960
ds_read_b128 v[140:143], v14 offset:45056
v_mfma_f32_16x16x32_bf16 v[56:59], a[56:59], v[148:151], v[56:59]
s_add_u32 m0, s45, 49152
s_add_u32 s50, s63, 2359296
v_mfma_f32_16x16x32_bf16 v[60:63], a[60:63], v[148:151], v[60:63]
s_and_b32 s50, s50, 4194303
v_mfma_f32_16x16x32_bf16 v[64:67], a[48:51], v[152:155], v[64:67]
buffer_load_dwordx4 v2, s[20:23], s50 offen offset:0 nt lds
v_mfma_f32_16x16x32_bf16 v[68:71], a[52:55], v[152:155], v[68:71]
buffer_load_dwordx4 v3, s[20:23], s50 offen offset:1024 nt lds
v_mfma_f32_16x16x32_bf16 v[72:75], a[56:59], v[152:155], v[72:75]
buffer_load_dwordx4 v4, s[20:23], s50 offen offset:2048 nt lds
v_mfma_f32_16x16x32_bf16 v[76:79], a[60:63], v[152:155], v[76:79]
buffer_load_dwordx4 v5, s[20:23], s50 offen offset:3072 nt lds
v_mfma_f32_16x16x32_bf16 v[80:83], a[48:51], v[156:159], v[80:83]
v_mfma_f32_16x16x32_bf16 v[84:87], a[52:55], v[156:159], v[84:87]
v_mfma_f32_16x16x32_bf16 v[88:91], a[56:59], v[156:159], v[88:91]
v_mfma_f32_16x16x32_bf16 v[92:95], a[60:63], v[156:159], v[92:95]
s_waitcnt lgkmcnt(0)
s_waitcnt vmcnt(16)
s_barrier
v_mfma_f32_16x16x32_bf16 v[32:35], a[64:67], v[128:131], v[32:35]
ds_read_b64_tr_b16 a[80:81], v24 offset:16384
ds_read_b64_tr_b16 a[82:83], v24 offset:18432
v_mfma_f32_16x16x32_bf16 v[36:39], a[68:71], v[128:131], v[36:39]
ds_read_b64_tr_b16 a[84:85], v25 offset:16384
ds_read_b64_tr_b16 a[86:87], v25 offset:18432
v_mfma_f32_16x16x32_bf16 v[40:43], a[72:75], v[128:131], v[40:43]
ds_read_b64_tr_b16 a[88:89], v26 offset:16384
ds_read_b64_tr_b16 a[90:91], v26 offset:18432
v_mfma_f32_16x16x32_bf16 v[44:47], a[76:79], v[128:131], v[44:47]
ds_read_b64_tr_b16 a[92:93], v27 offset:16384
ds_read_b64_tr_b16 a[94:95], v27 offset:18432
v_mfma_f32_16x16x32_bf16 v[48:51], a[64:67], v[132:135], v[48:51]
ds_read_b128 v[144:147], v15 offset:8192
ds_read_b128 v[148:151], v15 offset:12288
v_mfma_f32_16x16x32_bf16 v[52:55], a[68:71], v[132:135], v[52:55]
ds_read_b128 v[152:155], v15 offset:40960
ds_read_b128 v[156:159], v15 offset:45056
v_mfma_f32_16x16x32_bf16 v[56:59], a[72:75], v[132:135], v[56:59]
s_add_u32 m0, s45, 65536
s_add_u32 s50, s63, 2621440
v_mfma_f32_16x16x32_bf16 v[60:63], a[76:79], v[132:135], v[60:63]
s_and_b32 s50, s50, 4194303
v_mfma_f32_16x16x32_bf16 v[64:67], a[64:67], v[136:139], v[64:67]
buffer_load_dwordx4 v2, s[20:23], s50 offen offset:0 nt lds
v_mfma_f32_16x16x32_bf16 v[68:71], a[68:71], v[136:139], v[68:71]
buffer_load_dwordx4 v3, s[20:23], s50 offen offset:1024 nt lds
v_mfma_f32_16x16x32_bf16 v[72:75], a[72:75], v[136:139], v[72:75]
buffer_load_dwordx4 v4, s[20:23], s50 offen offset:2048 nt lds
v_mfma_f32_16x16x32_bf16 v[76:79], a[76:79], v[136:139], v[76:79]
buffer_load_dwordx4 v5, s[20:23], s50 offen offset:3072 nt lds
v_mfma_f32_16x16x32_bf16 v[80:83], a[64:67], v[140:143], v[80:83]
buffer_load_dwordx4 v[192:195], v22, s[24:27], s47 offen
v_mfma_f32_16x16x32_bf16 v[84:87], a[68:71], v[140:143], v[84:87]
buffer_load_dwordx4 v[196:199], v22, s[24:27], s47 offen offset:1024
v_mfma_f32_16x16x32_bf16 v[88:91], a[72:75], v[140:143], v[88:91]
v_mfma_f32_16x16x32_bf16 v[92:95], a[76:79], v[140:143], v[92:95]
s_waitcnt lgkmcnt(0)
s_waitcnt vmcnt(18)
s_barrier
v_mfma_f32_16x16x32_bf16 v[32:35], a[80:83], v[144:147], v[32:35]
ds_read_b64_tr_b16 a[96:97], v10 offset:0
ds_read_b64_tr_b16 a[98:99], v10 offset:2048
v_mfma_f32_16x16x32_bf16 v[36:39], a[84:87], v[144:147], v[36:39]
ds_read_b64_tr_b16 a[100:101], v11 offset:0
ds_read_b64_tr_b16 a[102:103], v11 offset:2048
v_mfma_f32_16x16x32_bf16 v[40:43], a[88:91], v[144:147], v[40:43]
ds_read_b64_tr_b16 a[104:105], v12 offset:0
ds_read_b64_tr_b16 a[106:107], v12 offset:2048
v_mfma_f32_16x16x32_bf16 v[44:47], a[92:95], v[144:147], v[44:47]
ds_read_b64_tr_b16 a[108:109], v13 offset:0
ds_read_b64_tr_b16 a[110:111], v13 offset:2048
v_mfma_f32_16x16x32_bf16 v[48:51], a[80:83], v[148:151], v[48:51]
ds_read_b128 v[128:131], v16 offset:8192
ds_read_b128 v[132:135], v16 offset:12288
v_mfma_f32_16x16x32_bf16 v[52:55], a[84:87], v[148:151], v[52:55]
ds_read_b128 v[136:139], v16 offset:40960
ds_read_b128 v[140:143], v16 offset:45056
v_mfma_f32_16x16x32_bf16 v[56:59], a[88:91], v[148:151], v[56:59]
s_add_u32 m0, s45, 81920
s_add_u32 s50, s63, 2883584
v_mfma_f32_16x16x32_bf16 v[60:63], a[92:95], v[148:151], v[60:63]
s_and_b32 s50, s50, 4194303
v_mfma_f32_16x16x32_bf16 v[64:67], a[80:83], v[152:155], v[64:67]
buffer_load_dwordx4 v2, s[20:23], s50 offen offset:0 nt lds
v_mfma_f32_16x16x32_bf16 v[68:71], a[84:87], v[152:155], v[68:71]
buffer_load_dwordx4 v3, s[20:23], s50 offen offset:1024 nt lds
v_mfma_f32_16x16x32_bf16 v[72:75], a[88:91], v[152:155], v[72:75]
buffer_load_dwordx4 v4, s[20:23], s50 offen offset:2048 nt lds
v_mfma_f32_16x16x32_bf16 v[76:79], a[92:95], v[152:155], v[76:79]
buffer_load_dwordx4 v5, s[20:23], s50 offen offset:3072 nt lds
v_mfma_f32_16x16x32_bf16 v[80:83], a[80:83], v[156:159], v[80:83]
v_mfma_f32_16x16x32_bf16 v[84:87], a[84:87], v[156:159], v[84:87]
v_mfma_f32_16x16x32_bf16 v[88:91], a[88:91], v[156:159], v[88:91]
v_mfma_f32_16x16x32_bf16 v[92:95], a[92:95], v[156:159], v[92:95]
s_waitcnt lgkmcnt(0)
s_waitcnt vmcnt(18)
s_barrier
v_mfma_f32_16x16x32_bf16 v[32:35], a[96:99], v[128:131], v[32:35]
ds_read_b64_tr_b16 a[112:113], v10 offset:16384
ds_read_b64_tr_b16 a[114:115], v10 offset:18432
v_mfma_f32_16x16x32_bf16 v[36:39], a[100:103], v[128:131], v[36:39]
ds_read_b64_tr_b16 a[116:117], v11 offset:16384
ds_read_b64_tr_b16 a[118:119], v11 offset:18432
v_mfma_f32_16x16x32_bf16 v[40:43], a[104:107], v[128:131], v[40:43]
ds_read_b64_tr_b16 a[120:121], v12 offset:16384
ds_read_b64_tr_b16 a[122:123], v12 offset:18432
v_mfma_f32_16x16x32_bf16 v[44:47], a[108:111], v[128:131], v[44:47]
ds_read_b64_tr_b16 a[124:125], v13 offset:16384
ds_read_b64_tr_b16 a[126:127], v13 offset:18432
v_mfma_f32_16x16x32_bf16 v[48:51], a[96:99], v[132:135], v[48:51]
ds_read_b128 v[144:147], v17 offset:8192
ds_read_b128 v[148:151], v17 offset:12288
v_mfma_f32_16x16x32_bf16 v[52:55], a[100:103], v[132:135], v[52:55]
ds_read_b128 v[152:155], v17 offset:40960
ds_read_b128 v[156:159], v17 offset:45056
v_mfma_f32_16x16x32_bf16 v[56:59], a[104:107], v[132:135], v[56:59]
v_mfma_f32_16x16x32_bf16 v[60:63], a[108:111], v[132:135], v[60:63]
v_mfma_f32_16x16x32_bf16 v[64:67], a[96:99], v[136:139], v[64:67]
v_mfma_f32_16x16x32_bf16 v[68:71], a[100:103], v[136:139], v[68:71]
v_mfma_f32_16x16x32_bf16 v[72:75], a[104:107], v[136:139], v[72:75]
v_mfma_f32_16x16x32_bf16 v[76:79], a[108:111], v[136:139], v[76:79]
v_mfma_f32_16x16x32_bf16 v[80:83], a[96:99], v[140:143], v[80:83]
v_mfma_f32_16x16x32_bf16 v[84:87], a[100:103], v[140:143], v[84:87]
v_mfma_f32_16x16x32_bf16 v[88:91], a[104:107], v[140:143], v[88:91]
v_mfma_f32_16x16x32_bf16 v[92:95], a[108:111], v[140:143], v[92:95]
s_waitcnt lgkmcnt(0)
s_waitcnt vmcnt(14)
s_barrier
v_mfma_f32_16x16x32_bf16 v[32:35], a[112:115], v[144:147], v[32:35]
ds_read_b64_tr_b16 a[128:129], v10 offset:32768
ds_read_b64_tr_b16 a[130:131], v10 offset:34816
v_mfma_f32_16x16x32_bf16 v[36:39], a[116:119], v[144:147], v[36:39]
ds_read_b64_tr_b16 a[132:133], v11 offset:32768
ds_read_b64_tr_b16 a[134:135], v11 offset:34816
v_mfma_f32_16x16x32_bf16 v[40:43], a[120:123], v[144:147], v[40:43]
ds_read_b64_tr_b16 a[136:137], v12 offset:32768
ds_read_b64_tr_b16 a[138:139], v12 offset:34816
v_mfma_f32_16x16x32_bf16 v[44:47], a[124:127], v[144:147], v[44:47]
ds_read_b64_tr_b16 a[140:141], v13 offset:32768
ds_read_b64_tr_b16 a[142:143], v13 offset:34816
v_mfma_f32_16x16x32_bf16 v[48:51], a[112:115], v[148:151], v[48:51]
ds_read_b128 v[128:131], v14 offset:16384
ds_read_b128 v[132:135], v14 offset:20480
v_mfma_f32_16x16x32_bf16 v[52:55], a[116:119], v[148:151], v[52:55]
ds_read_b128 v[136:139], v14 offset:49152
ds_read_b128 v[140:143], v14 offset:53248
v_mfma_f32_16x16x32_bf16 v[56:59], a[120:123], v[148:151], v[56:59]
s_add_u32 m0, s46, 65536
s_add_u32 s49, s43, 65536
v_mfma_f32_16x16x32_bf16 v[60:63], a[124:127], v[148:151], v[60:63]
buffer_load_dwordx4 v6, s[16:19], s49 offen offset:0 lds
v_mfma_f32_16x16x32_bf16 v[64:67], a[112:115], v[152:155], v[64:67]
buffer_load_dwordx4 v7, s[16:19], s49 offen offset:1024 lds
v_mfma_f32_16x16x32_bf16 v[68:71], a[116:119], v[152:155], v[68:71]
buffer_load_dwordx4 v8, s[16:19], s49 offen offset:2048 lds
v_mfma_f32_16x16x32_bf16 v[72:75], a[120:123], v[152:155], v[72:75]
buffer_load_dwordx4 v9, s[16:19], s49 offen offset:3072 lds
v_mfma_f32_16x16x32_bf16 v[76:79], a[124:127], v[152:155], v[76:79]
s_add_u32 m0, s46, 69632
s_add_u32 s49, s43, 81920
v_mfma_f32_16x16x32_bf16 v[80:83], a[112:115], v[156:159], v[80:83]
buffer_load_dwordx4 v6, s[16:19], s49 offen offset:0 lds
v_mfma_f32_16x16x32_bf16 v[84:87], a[116:119], v[156:159], v[84:87]
buffer_load_dwordx4 v7, s[16:19], s49 offen offset:1024 lds
v_mfma_f32_16x16x32_bf16 v[88:91], a[120:123], v[156:159], v[88:91]
buffer_load_dwordx4 v8, s[16:19], s49 offen offset:2048 lds
v_mfma_f32_16x16x32_bf16 v[92:95], a[124:127], v[156:159], v[92:95]
buffer_load_dwordx4 v9, s[16:19], s49 offen offset:3072 lds
s_waitcnt lgkmcnt(0)
s_waitcnt vmcnt(18)
s_barrier
v_mfma_f32_16x16x32_bf16 v[32:35], a[128:131], v[128:131], v[32:35]
ds_read_b64_tr_b16 a[144:145], v10 offset:49152
ds_read_b64_tr_b16 a[146:147], v10 offset:51200
v_mfma_f32_16x16x32_bf16 v[36:39], a[132:135], v[128:131], v[36:39]
ds_read_b64_tr_b16 a[148:149], v11 offset:49152
ds_read_b64_tr_b16 a[150:151], v11 offset:51200
v_mfma_f32_16x16x32_bf16 v[40:43], a[136:139], v[128:131], v[40:43]
ds_read_b64_tr_b16 a[152:153], v12 offset:49152
ds_read_b64_tr_b16 a[154:155], v12 offset:51200
v_mfma_f32_16x16x32_bf16 v[44:47], a[140:143], v[128:131], v[44:47]
ds_read_b64_tr_b16 a[156:157], v13 offset:49152
ds_read_b64_tr_b16 a[158:159], v13 offset:51200
v_mfma_f32_16x16x32_bf16 v[48:51], a[128:131], v[132:135], v[48:51]
ds_read_b128 v[144:147], v15 offset:16384
ds_read_b128 v[148:151], v15 offset:20480
v_mfma_f32_16x16x32_bf16 v[52:55], a[132:135], v[132:135], v[52:55]
ds_read_b128 v[152:155], v15 offset:49152
ds_read_b128 v[156:159], v15 offset:53248
v_mfma_f32_16x16x32_bf16 v[56:59], a[136:139], v[132:135], v[56:59]
s_add_u32 m0, s45, 32768
s_add_u32 s50, s63, 3145728
v_mfma_f32_16x16x32_bf16 v[60:63], a[140:143], v[132:135], v[60:63]
s_and_b32 s50, s50, 4194303
v_mfma_f32_16x16x32_bf16 v[64:67], a[128:131], v[136:139], v[64:67]
buffer_load_dwordx4 v2, s[20:23], s50 offen offset:0 nt lds
v_mfma_f32_16x16x32_bf16 v[68:71], a[132:135], v[136:139], v[68:71]
buffer_load_dwordx4 v3, s[20:23], s50 offen offset:1024 nt lds
v_mfma_f32_16x16x32_bf16 v[72:75], a[136:139], v[136:139], v[72:75]
buffer_load_dwordx4 v4, s[20:23], s50 offen offset:2048 nt lds
v_mfma_f32_16x16x32_bf16 v[76:79], a[140:143], v[136:139], v[76:79]
buffer_load_dwordx4 v5, s[20:23], s50 offen offset:3072 nt lds
v_mfma_f32_16x16x32_bf16 v[80:83], a[128:131], v[140:143], v[80:83]
v_mfma_f32_16x16x32_bf16 v[84:87], a[132:135], v[140:143], v[84:87]
v_mfma_f32_16x16x32_bf16 v[88:91], a[136:139], v[140:143], v[88:91]
v_mfma_f32_16x16x32_bf16 v[92:95], a[140:143], v[140:143], v[92:95]
s_waitcnt lgkmcnt(0)
s_waitcnt vmcnt(18)
s_barrier
v_mfma_f32_16x16x32_bf16 v[32:35], a[144:147], v[144:147], v[32:35]
ds_read_b64_tr_b16 a[160:161], v24 offset:0
ds_read_b64_tr_b16 a[162:163], v24 offset:2048
v_mfma_f32_16x16x32_bf16 v[36:39], a[148:151], v[144:147], v[36:39]
ds_read_b64_tr_b16 a[164:165], v25 offset:0
ds_read_b64_tr_b16 a[166:167], v25 offset:2048
v_mfma_f32_16x16x32_bf16 v[40:43], a[152:155], v[144:147], v[40:43]
ds_read_b64_tr_b16 a[168:169], v26 offset:0
ds_read_b64_tr_b16 a[170:171], v26 offset:2048
v_mfma_f32_16x16x32_bf16 v[44:47], a[156:159], v[144:147], v[44:47]
ds_read_b64_tr_b16 a[172:173], v27 offset:0
ds_read_b64_tr_b16 a[174:175], v27 offset:2048
v_mfma_f32_16x16x32_bf16 v[48:51], a[144:147], v[148:151], v[48:51]
ds_read_b128 v[128:131], v16 offset:16384
ds_read_b128 v[132:135], v16 offset:20480
v_mfma_f32_16x16x32_bf16 v[52:55], a[148:151], v[148:151], v[52:55]
ds_read_b128 v[136:139], v16 offset:49152
ds_read_b128 v[140:143], v16 offset:53248
v_mfma_f32_16x16x32_bf16 v[56:59], a[152:155], v[148:151], v[56:59]
s_add_u32 m0, s45, 49152
s_add_u32 s50, s63, 3407872
v_mfma_f32_16x16x32_bf16 v[60:63], a[156:159], v[148:151], v[60:63]
s_and_b32 s50, s50, 4194303
v_mfma_f32_16x16x32_bf16 v[64:67], a[144:147], v[152:155], v[64:67]
buffer_load_dwordx4 v2, s[20:23], s50 offen offset:0 nt lds
v_mfma_f32_16x16x32_bf16 v[68:71], a[148:151], v[152:155], v[68:71]
buffer_load_dwordx4 v3, s[20:23], s50 offen offset:1024 nt lds
v_mfma_f32_16x16x32_bf16 v[72:75], a[152:155], v[152:155], v[72:75]
buffer_load_dwordx4 v4, s[20:23], s50 offen offset:2048 nt lds
v_mfma_f32_16x16x32_bf16 v[76:79], a[156:159], v[152:155], v[76:79]
buffer_load_dwordx4 v5, s[20:23], s50 offen offset:3072 nt lds
v_mfma_f32_16x16x32_bf16 v[80:83], a[144:147], v[156:159], v[80:83]
v_mfma_f32_16x16x32_bf16 v[84:87], a[148:151], v[156:159], v[84:87]
v_mfma_f32_16x16x32_bf16 v[88:91], a[152:155], v[156:159], v[88:91]
v_mfma_f32_16x16x32_bf16 v[92:95], a[156:159], v[156:159], v[92:95]
s_waitcnt lgkmcnt(0)
s_waitcnt vmcnt(16)
s_barrier
v_mfma_f32_16x16x32_bf16 v[32:35], a[160:163], v[128:131], v[32:35]
ds_read_b64_tr_b16 a[176:177], v24 offset:16384
ds_read_b64_tr_b16 a[178:179], v24 offset:18432
v_mfma_f32_16x16x32_bf16 v[36:39], a[164:167], v[128:131], v[36:39]
ds_read_b64_tr_b16 a[180:181], v25 offset:16384
ds_read_b64_tr_b16 a[182:183], v25 offset:18432
v_mfma_f32_16x16x32_bf16 v[40:43], a[168:171], v[128:131], v[40:43]
ds_read_b64_tr_b16 a[184:185], v26 offset:16384
ds_read_b64_tr_b16 a[186:187], v26 offset:18432
v_mfma_f32_16x16x32_bf16 v[44:47], a[172:175], v[128:131], v[44:47]
ds_read_b64_tr_b16 a[188:189], v27 offset:16384
ds_read_b64_tr_b16 a[190:191], v27 offset:18432
v_mfma_f32_16x16x32_bf16 v[48:51], a[160:163], v[132:135], v[48:51]
ds_read_b128 v[144:147], v17 offset:16384
ds_read_b128 v[148:151], v17 offset:20480
v_mfma_f32_16x16x32_bf16 v[52:55], a[164:167], v[132:135], v[52:55]
ds_read_b128 v[152:155], v17 offset:49152
ds_read_b128 v[156:159], v17 offset:53248
v_mfma_f32_16x16x32_bf16 v[56:59], a[168:171], v[132:135], v[56:59]
s_add_u32 m0, s45, 65536
s_add_u32 s50, s63, 3670016
v_mfma_f32_16x16x32_bf16 v[60:63], a[172:175], v[132:135], v[60:63]
s_and_b32 s50, s50, 4194303
v_mfma_f32_16x16x32_bf16 v[64:67], a[160:163], v[136:139], v[64:67]
buffer_load_dwordx4 v2, s[20:23], s50 offen offset:0 nt lds
v_mfma_f32_16x16x32_bf16 v[68:71], a[164:167], v[136:139], v[68:71]
buffer_load_dwordx4 v3, s[20:23], s50 offen offset:1024 nt lds
v_mfma_f32_16x16x32_bf16 v[72:75], a[168:171], v[136:139], v[72:75]
buffer_load_dwordx4 v4, s[20:23], s50 offen offset:2048 nt lds
v_mfma_f32_16x16x32_bf16 v[76:79], a[172:175], v[136:139], v[76:79]
buffer_load_dwordx4 v5, s[20:23], s50 offen offset:3072 nt lds
v_mfma_f32_16x16x32_bf16 v[80:83], a[160:163], v[140:143], v[80:83]
v_mfma_f32_16x16x32_bf16 v[84:87], a[164:167], v[140:143], v[84:87]
v_mfma_f32_16x16x32_bf16 v[88:91], a[168:171], v[140:143], v[88:91]
v_mfma_f32_16x16x32_bf16 v[92:95], a[172:175], v[140:143], v[92:95]
s_waitcnt lgkmcnt(0)
s_waitcnt vmcnt(8)
s_barrier
v_mfma_f32_16x16x32_bf16 v[32:35], a[176:179], v[144:147], v[32:35]
ds_read_b64_tr_b16 a[192:193], v10 offset:32768
ds_read_b64_tr_b16 a[194:195], v10 offset:34816
v_mfma_f32_16x16x32_bf16 v[36:39], a[180:183], v[144:147], v[36:39]
ds_read_b64_tr_b16 a[196:197], v11 offset:32768
ds_read_b64_tr_b16 a[198:199], v11 offset:34816
v_mfma_f32_16x16x32_bf16 v[40:43], a[184:187], v[144:147], v[40:43]
ds_read_b64_tr_b16 a[200:201], v12 offset:32768
ds_read_b64_tr_b16 a[202:203], v12 offset:34816
v_mfma_f32_16x16x32_bf16 v[44:47], a[188:191], v[144:147], v[44:47]
ds_read_b64_tr_b16 a[204:205], v13 offset:32768
ds_read_b64_tr_b16 a[206:207], v13 offset:34816
v_mfma_f32_16x16x32_bf16 v[48:51], a[176:179], v[148:151], v[48:51]
ds_read_b128 v[128:131], v14 offset:24576
ds_read_b128 v[132:135], v14 offset:28672
v_mfma_f32_16x16x32_bf16 v[52:55], a[180:183], v[148:151], v[52:55]
ds_read_b128 v[136:139], v14 offset:57344
ds_read_b128 v[140:143], v14 offset:61440
v_mfma_f32_16x16x32_bf16 v[56:59], a[184:187], v[148:151], v[56:59]
s_add_u32 m0, s45, 81920
s_add_u32 s50, s63, 3932160
v_mfma_f32_16x16x32_bf16 v[60:63], a[188:191], v[148:151], v[60:63]
s_and_b32 s50, s50, 4194303
v_mfma_f32_16x16x32_bf16 v[64:67], a[176:179], v[152:155], v[64:67]
buffer_load_dwordx4 v2, s[20:23], s50 offen offset:0 nt lds
v_mfma_f32_16x16x32_bf16 v[68:71], a[180:183], v[152:155], v[68:71]
buffer_load_dwordx4 v3, s[20:23], s50 offen offset:1024 nt lds
v_mfma_f32_16x16x32_bf16 v[72:75], a[184:187], v[152:155], v[72:75]
buffer_load_dwordx4 v4, s[20:23], s50 offen offset:2048 nt lds
v_mfma_f32_16x16x32_bf16 v[76:79], a[188:191], v[152:155], v[76:79]
buffer_load_dwordx4 v5, s[20:23], s50 offen offset:3072 nt lds
v_mfma_f32_16x16x32_bf16 v[80:83], a[176:179], v[156:159], v[80:83]
v_mfma_f32_16x16x32_bf16 v[84:87], a[180:183], v[156:159], v[84:87]
v_mfma_f32_16x16x32_bf16 v[88:91], a[184:187], v[156:159], v[88:91]
v_mfma_f32_16x16x32_bf16 v[92:95], a[188:191], v[156:159], v[92:95]
s_waitcnt lgkmcnt(0)
s_waitcnt vmcnt(8)
s_barrier
v_mfma_f32_16x16x32_bf16 v[32:35], a[192:195], v[128:131], v[32:35]
ds_read_b64_tr_b16 a[208:209], v10 offset:49152
ds_read_b64_tr_b16 a[210:211], v10 offset:51200
v_mfma_f32_16x16x32_bf16 v[36:39], a[196:199], v[128:131], v[36:39]
ds_read_b64_tr_b16 a[212:213], v11 offset:49152
ds_read_b64_tr_b16 a[214:215], v11 offset:51200
v_mfma_f32_16x16x32_bf16 v[40:43], a[200:203], v[128:131], v[40:43]
ds_read_b64_tr_b16 a[216:217], v12 offset:49152
ds_read_b64_tr_b16 a[218:219], v12 offset:51200
v_mfma_f32_16x16x32_bf16 v[44:47], a[204:207], v[128:131], v[44:47]
ds_read_b64_tr_b16 a[220:221], v13 offset:49152
ds_read_b64_tr_b16 a[222:223], v13 offset:51200
v_mfma_f32_16x16x32_bf16 v[48:51], a[192:195], v[132:135], v[48:51]
ds_read_b128 v[144:147], v15 offset:24576
ds_read_b128 v[148:151], v15 offset:28672
v_mfma_f32_16x16x32_bf16 v[52:55], a[196:199], v[132:135], v[52:55]
ds_read_b128 v[152:155], v15 offset:57344
ds_read_b128 v[156:159], v15 offset:61440
v_mfma_f32_16x16x32_bf16 v[56:59], a[200:203], v[132:135], v[56:59]
v_mfma_f32_16x16x32_bf16 v[60:63], a[204:207], v[132:135], v[60:63]
v_mfma_f32_16x16x32_bf16 v[64:67], a[192:195], v[136:139], v[64:67]
v_mfma_f32_16x16x32_bf16 v[68:71], a[196:199], v[136:139], v[68:71]
v_mfma_f32_16x16x32_bf16 v[72:75], a[200:203], v[136:139], v[72:75]
v_mfma_f32_16x16x32_bf16 v[76:79], a[204:207], v[136:139], v[76:79]
v_mfma_f32_16x16x32_bf16 v[80:83], a[192:195], v[140:143], v[80:83]
v_mfma_f32_16x16x32_bf16 v[84:87], a[196:199], v[140:143], v[84:87]
v_mfma_f32_16x16x32_bf16 v[88:91], a[200:203], v[140:143], v[88:91]
v_mfma_f32_16x16x32_bf16 v[92:95], a[204:207], v[140:143], v[92:95]
s_waitcnt lgkmcnt(0)
s_waitcnt vmcnt(4)
s_barrier
v_mfma_f32_16x16x32_bf16 v[32:35], a[208:211], v[144:147], v[32:35]
ds_read_b64_tr_b16 a[224:225], v24 offset:0
ds_read_b64_tr_b16 a[226:227], v24 offset:2048
v_mfma_f32_16x16x32_bf16 v[36:39], a[212:215], v[144:147], v[36:39]
ds_read_b64_tr_b16 a[228:229], v25 offset:0
ds_read_b64_tr_b16 a[230:231], v25 offset:2048
v_mfma_f32_16x16x32_bf16 v[40:43], a[216:219], v[144:147], v[40:43]
ds_read_b64_tr_b16 a[232:233], v26 offset:0
ds_read_b64_tr_b16 a[234:235], v26 offset:2048
v_mfma_f32_16x16x32_bf16 v[44:47], a[220:223], v[144:147], v[44:47]
ds_read_b64_tr_b16 a[236:237], v27 offset:0
ds_read_b64_tr_b16 a[238:239], v27 offset:2048
v_mfma_f32_16x16x32_bf16 v[48:51], a[208:211], v[148:151], v[48:51]
ds_read_b128 v[128:131], v16 offset:24576
ds_read_b128 v[132:135], v16 offset:28672
v_mfma_f32_16x16x32_bf16 v[52:55], a[212:215], v[148:151], v[52:55]
ds_read_b128 v[136:139], v16 offset:57344
ds_read_b128 v[140:143], v16 offset:61440
v_mfma_f32_16x16x32_bf16 v[56:59], a[216:219], v[148:151], v[56:59]
v_mfma_f32_16x16x32_bf16 v[60:63], a[220:223], v[148:151], v[60:63]
v_mfma_f32_16x16x32_bf16 v[64:67], a[208:211], v[152:155], v[64:67]
v_mfma_f32_16x16x32_bf16 v[68:71], a[212:215], v[152:155], v[68:71]
v_mfma_f32_16x16x32_bf16 v[72:75], a[216:219], v[152:155], v[72:75]
v_mfma_f32_16x16x32_bf16 v[76:79], a[220:223], v[152:155], v[76:79]
v_mfma_f32_16x16x32_bf16 v[80:83], a[208:211], v[156:159], v[80:83]
v_mfma_f32_16x16x32_bf16 v[84:87], a[212:215], v[156:159], v[84:87]
v_mfma_f32_16x16x32_bf16 v[88:91], a[216:219], v[156:159], v[88:91]
v_mfma_f32_16x16x32_bf16 v[92:95], a[220:223], v[156:159], v[92:95]
s_waitcnt lgkmcnt(0)
s_waitcnt vmcnt(0)
s_barrier
v_mfma_f32_16x16x32_bf16 v[32:35], a[224:227], v[128:131], v[32:35]
ds_read_b64_tr_b16 a[240:241], v24 offset:16384
ds_read_b64_tr_b16 a[242:243], v24 offset:18432
v_mfma_f32_16x16x32_bf16 v[36:39], a[228:231], v[128:131], v[36:39]
ds_read_b64_tr_b16 a[244:245], v25 offset:16384
ds_read_b64_tr_b16 a[246:247], v25 offset:18432
v_mfma_f32_16x16x32_bf16 v[40:43], a[232:235], v[128:131], v[40:43]
ds_read_b64_tr_b16 a[248:249], v26 offset:16384
ds_read_b64_tr_b16 a[250:251], v26 offset:18432
v_mfma_f32_16x16x32_bf16 v[44:47], a[236:239], v[128:131], v[44:47]
ds_read_b64_tr_b16 a[252:253], v27 offset:16384
ds_read_b64_tr_b16 a[254:255], v27 offset:18432
v_mfma_f32_16x16x32_bf16 v[48:51], a[224:227], v[132:135], v[48:51]
ds_read_b128 v[144:147], v17 offset:24576
ds_read_b128 v[148:151], v17 offset:28672
v_mfma_f32_16x16x32_bf16 v[52:55], a[228:231], v[132:135], v[52:55]
ds_read_b128 v[152:155], v17 offset:57344
ds_read_b128 v[156:159], v17 offset:61440
v_mfma_f32_16x16x32_bf16 v[56:59], a[232:235], v[132:135], v[56:59]
s_add_u32 m0, s46, 98304
s_add_u32 s49, s43, 98304
v_mfma_f32_16x16x32_bf16 v[60:63], a[236:239], v[132:135], v[60:63]
buffer_load_dwordx4 v6, s[16:19], s49 offen offset:0 lds
v_mfma_f32_16x16x32_bf16 v[64:67], a[224:227], v[136:139], v[64:67]
buffer_load_dwordx4 v7, s[16:19], s49 offen offset:1024 lds
v_mfma_f32_16x16x32_bf16 v[68:71], a[228:231], v[136:139], v[68:71]
buffer_load_dwordx4 v8, s[16:19], s49 offen offset:2048 lds
v_mfma_f32_16x16x32_bf16 v[72:75], a[232:235], v[136:139], v[72:75]
buffer_load_dwordx4 v9, s[16:19], s49 offen offset:3072 lds
v_mfma_f32_16x16x32_bf16 v[76:79], a[236:239], v[136:139], v[76:79]
s_add_u32 m0, s46, 102400
s_add_u32 s49, s43, 114688
v_mfma_f32_16x16x32_bf16 v[80:83], a[224:227], v[140:143], v[80:83]
buffer_load_dwordx4 v6, s[16:19], s49 offen offset:0 lds
v_mfma_f32_16x16x32_bf16 v[84:87], a[228:231], v[140:143], v[84:87]
buffer_load_dwordx4 v7, s[16:19], s49 offen offset:1024 lds
v_mfma_f32_16x16x32_bf16 v[88:91], a[232:235], v[140:143], v[88:91]
buffer_load_dwordx4 v8, s[16:19], s49 offen offset:2048 lds
v_mfma_f32_16x16x32_bf16 v[92:95], a[236:239], v[140:143], v[92:95]
buffer_load_dwordx4 v9, s[16:19], s49 offen offset:3072 lds
s_waitcnt lgkmcnt(0)
s_barrier
v_mfma_f32_16x16x32_bf16 v[32:35], a[240:243], v[144:147], v[32:35]
v_mfma_f32_16x16x32_bf16 v[36:39], a[244:247], v[144:147], v[36:39]
s_add_u32 m0, s46, 131072
s_add_u32 s49, s43, 131072
v_mfma_f32_16x16x32_bf16 v[40:43], a[248:251], v[144:147], v[40:43]
buffer_load_dwordx4 v6, s[16:19], s49 offen offset:0 lds
v_mfma_f32_16x16x32_bf16 v[44:47], a[252:255], v[144:147], v[44:47]
buffer_load_dwordx4 v7, s[16:19], s49 offen offset:1024 lds
v_mfma_f32_16x16x32_bf16 v[48:51], a[240:243], v[148:151], v[48:51]
buffer_load_dwordx4 v8, s[16:19], s49 offen offset:2048 lds
v_mfma_f32_16x16x32_bf16 v[52:55], a[244:247], v[148:151], v[52:55]
buffer_load_dwordx4 v9, s[16:19], s49 offen offset:3072 lds
v_mfma_f32_16x16x32_bf16 v[56:59], a[248:251], v[148:151], v[56:59]
s_add_u32 m0, s46, 135168
s_add_u32 s49, s43, 147456
v_mfma_f32_16x16x32_bf16 v[60:63], a[252:255], v[148:151], v[60:63]
buffer_load_dwordx4 v6, s[16:19], s49 offen offset:0 lds
v_mfma_f32_16x16x32_bf16 v[64:67], a[240:243], v[152:155], v[64:67]
buffer_load_dwordx4 v7, s[16:19], s49 offen offset:1024 lds
v_mfma_f32_16x16x32_bf16 v[68:71], a[244:247], v[152:155], v[68:71]
buffer_load_dwordx4 v8, s[16:19], s49 offen offset:2048 lds
v_mfma_f32_16x16x32_bf16 v[72:75], a[248:251], v[152:155], v[72:75]
buffer_load_dwordx4 v9, s[16:19], s49 offen offset:3072 lds
v_mfma_f32_16x16x32_bf16 v[76:79], a[252:255], v[152:155], v[76:79]
v_mfma_f32_16x16x32_bf16 v[80:83], a[240:243], v[156:159], v[80:83]
v_mfma_f32_16x16x32_bf16 v[84:87], a[244:247], v[156:159], v[84:87]
v_mfma_f32_16x16x32_bf16 v[88:91], a[248:251], v[156:159], v[88:91]
v_mfma_f32_16x16x32_bf16 v[92:95], a[252:255], v[156:159], v[92:95]
s_waitcnt lgkmcnt(0)
s_waitcnt vmcnt(32)
s_barrier
s_cmp_lt_u32 s2, 8
s_cbranch_scc0 CPF2_X
s_cmp_eq_u32 s36, 3
s_cbranch_scc0 CPF2_X
s_getpc_b64 s[64:65]
CPF2_P:
s_add_u32 s64, s64, K1_END-CPF2_P
s_addc_u32 s65, s65, ((K1_END-CPF2_P)>>32)&0xffffffff
s_mov_b32 s66, TEXT_END-K1_END
s_mov_b32 s67, 0x00020000
v_lshlrev_b32 v232, 7, v1
s_mov_b32 s68, 0
CPF2_L:
buffer_load_dword v233, v232, s[64:67], s68 offen
s_add_u32 s68, s68, 8192
s_cmp_lt_u32 s68, s66
s_cbranch_scc1 CPF2_L
CPF2_X:
ds_read_b128 v[128:131], v18 offset:0
ds_read_b128 v[132:135], v18 offset:4096
ds_read_b128 v[136:139], v19 offset:0
ds_read_b128 v[140:143], v19 offset:4096
s_waitcnt lgkmcnt(2)
v_mfma_f32_16x16x32_bf16 v[96:99], a[0:3], v[128:131], 0
ds_read_b128 v[144:147], v20 offset:0
ds_read_b128 v[148:151], v20 offset:4096
v_mfma_f32_16x16x32_bf16 v[100:103], a[4:7], v[128:131], 0
s_add_u32 m0, s46, 0
s_add_u32 s49, s43, 163840
v_mfma_f32_16x16x32_bf16 v[104:107], a[8:11], v[128:131], 0
buffer_load_dwordx4 v6, s[16:19], s49 offen offset:0 lds
v_mfma_f32_16x16x32_bf16 v[108:111], a[12:15], v[128:131], 0
v_mfma_f32_16x16x32_bf16 v[112:115], a[0:3], v[132:135], 0
v_mfma_f32_16x16x32_bf16 v[116:119], a[4:7], v[132:135], 0
v_mfma_f32_16x16x32_bf16 v[120:123], a[8:11], v[132:135], 0
v_mfma_f32_16x16x32_bf16 v[124:127], a[12:15], v[132:135], 0
s_waitcnt lgkmcnt(2)
v_mfma_f32_16x16x32_bf16 v[96:99], a[16:19], v[136:139], v[96:99]
ds_read_b128 v[128:131], v21 offset:0
ds_read_b128 v[132:135], v21 offset:4096
v_mfma_f32_16x16x32_bf16 v[100:103], a[20:23], v[136:139], v[100:103]
s_add_u32 s53, s44, 0
v_mfma_f32_16x16x32_bf16 v[104:107], a[24:27], v[136:139], v[104:107]
v_cvt_pk_bf16_f32 v160, v32, v33
v_cvt_pk_bf16_f32 v161, v34, v35
v_mfma_f32_16x16x32_bf16 v[108:111], a[28:31], v[136:139], v[108:111]
v_cvt_pk_bf16_f32 v162, v36, v37
v_cvt_pk_bf16_f32 v163, v38, v39
v_mfma_f32_16x16x32_bf16 v[112:115], a[16:19], v[140:143], v[112:115]
buffer_store_dwordx4 v[160:163], v22, s[32:35], s53 offen offset:0 sc0 sc1
v_mfma_f32_16x16x32_bf16 v[116:119], a[20:23], v[140:143], v[116:119]
buffer_load_dwordx4 v7, s[16:19], s49 offen offset:1024 lds
v_mfma_f32_16x16x32_bf16 v[120:123], a[24:27], v[140:143], v[120:123]
v_mfma_f32_16x16x32_bf16 v[124:127], a[28:31], v[140:143], v[124:127]
s_waitcnt lgkmcnt(2)
v_mfma_f32_16x16x32_bf16 v[96:99], a[32:35], v[144:147], v[96:99]
ds_read_b128 v[136:139], v18 offset:8192
ds_read_b128 v[140:143], v18 offset:12288
v_mfma_f32_16x16x32_bf16 v[100:103], a[36:39], v[144:147], v[100:103]
v_mfma_f32_16x16x32_bf16 v[104:107], a[40:43], v[144:147], v[104:107]
v_mfma_f32_16x16x32_bf16 v[108:111], a[44:47], v[144:147], v[108:111]
v_mfma_f32_16x16x32_bf16 v[112:115], a[32:35], v[148:151], v[112:115]
v_mfma_f32_16x16x32_bf16 v[116:119], a[36:39], v[148:151], v[116:119]
v_cvt_pk_bf16_f32 v164, v40, v41
v_cvt_pk_bf16_f32 v165, v42, v43
v_mfma_f32_16x16x32_bf16 v[120:123], a[40:43], v[148:151], v[120:123]
v_cvt_pk_bf16_f32 v166, v44, v45
v_cvt_pk_bf16_f32 v167, v46, v47
v_mfma_f32_16x16x32_bf16 v[124:127], a[44:47], v[148:151], v[124:127]
s_waitcnt lgkmcnt(2)
v_mfma_f32_16x16x32_bf16 v[96:99], a[48:51], v[128:131], v[96:99]
ds_read_b128 v[144:147], v19 offset:8192
ds_read_b128 v[148:151], v19 offset:12288
v_mfma_f32_16x16x32_bf16 v[100:103], a[52:55], v[128:131], v[100:103]
buffer_load_dwordx4 v8, s[16:19], s49 offen offset:2048 lds
v_mfma_f32_16x16x32_bf16 v[104:107], a[56:59], v[128:131], v[104:107]
buffer_store_dwordx4 v[164:167], v22, s[32:35], s53 offen offset:1024 sc0 sc1
v_mfma_f32_16x16x32_bf16 v[108:111], a[60:63], v[128:131], v[108:111]
v_mfma_f32_16x16x32_bf16 v[112:115], a[48:51], v[132:135], v[112:115]
v_mfma_f32_16x16x32_bf16 v[116:119], a[52:55], v[132:135], v[116:119]
v_mfma_f32_16x16x32_bf16 v[120:123], a[56:59], v[132:135], v[120:123]
v_lshlrev_b32 v208, 16, v192
v_mfma_f32_16x16x32_bf16 v[124:127], a[60:63], v[132:135], v[124:127]
s_waitcnt lgkmcnt(2)
v_and_b32 v209, 0xffff0000, v192
v_mfma_f32_16x16x32_bf16 v[96:99], a[64:67], v[136:139], v[96:99]
ds_read_b128 v[128:131], v20 offset:8192
ds_read_b128 v[132:135], v20 offset:12288
v_mfma_f32_16x16x32_bf16 v[100:103], a[68:71], v[136:139], v[100:103]
v_cvt_pk_bf16_f32 v168, v48, v49
v_cvt_pk_bf16_f32 v169, v50, v51
v_mfma_f32_16x16x32_bf16 v[104:107], a[72:75], v[136:139], v[104:107]
v_cvt_pk_bf16_f32 v170, v52, v53
v_cvt_pk_bf16_f32 v171, v54, v55
v_mfma_f32_16x16x32_bf16 v[108:111], a[76:79], v[136:139], v[108:111]
buffer_store_dwordx4 v[168:171], v23, s[32:35], s53 offen offset:0 sc0 sc1
v_mfma_f32_16x16x32_bf16 v[112:115], a[64:67], v[140:143], v[112:115]
v_lshlrev_b32 v210, 16, v193
v_mfma_f32_16x16x32_bf16 v[116:119], a[68:71], v[140:143], v[116:119]
buffer_load_dwordx4 v9, s[16:19], s49 offen offset:3072 lds
v_mfma_f32_16x16x32_bf16 v[120:123], a[72:75], v[140:143], v[120:123]
v_and_b32 v211, 0xffff0000, v193
v_mfma_f32_16x16x32_bf16 v[124:127], a[76:79], v[140:143], v[124:127]
s_waitcnt lgkmcnt(2)
v_lshlrev_b32 v212, 16, v194
v_mfma_f32_16x16x32_bf16 v[96:99], a[80:83], v[144:147], v[96:99]
ds_read_b128 v[136:139], v21 offset:8192
ds_read_b128 v[140:143], v21 offset:12288
v_mfma_f32_16x16x32_bf16 v[100:103], a[84:87], v[144:147], v[100:103]
v_and_b32 v213, 0xffff0000, v194
v_mfma_f32_16x16x32_bf16 v[104:107], a[88:91], v[144:147], v[104:107]
v_lshlrev_b32 v214, 16, v195
v_mfma_f32_16x16x32_bf16 v[108:111], a[92:95], v[144:147], v[108:111]
v_cvt_pk_bf16_f32 v172, v56, v57
v_cvt_pk_bf16_f32 v173, v58, v59
v_mfma_f32_16x16x32_bf16 v[112:115], a[80:83], v[148:151], v[112:115]
v_cvt_pk_bf16_f32 v174, v60, v61
v_cvt_pk_bf16_f32 v175, v62, v63
v_mfma_f32_16x16x32_bf16 v[116:119], a[84:87], v[148:151], v[116:119]
buffer_store_dwordx4 v[172:175], v23, s[32:35], s53 offen offset:1024 sc0 sc1
v_mfma_f32_16x16x32_bf16 v[120:123], a[88:91], v[148:151], v[120:123]
v_and_b32 v215, 0xffff0000, v195
v_mfma_f32_16x16x32_bf16 v[124:127], a[92:95], v[148:151], v[124:127]
s_waitcnt lgkmcnt(2)
v_lshlrev_b32 v216, 16, v196
v_mfma_f32_16x16x32_bf16 v[96:99], a[96:99], v[128:131], v[96:99]
ds_read_b128 v[144:147], v18 offset:16384
ds_read_b128 v[148:151], v18 offset:20480
v_mfma_f32_16x16x32_bf16 v[100:103], a[100:103], v[128:131], v[100:103]
s_add_u32 m0, s46, 4096
s_add_u32 s49, s43, 180224
v_mfma_f32_16x16x32_bf16 v[104:107], a[104:107], v[128:131], v[104:107]
buffer_load_dwordx4 v6, s[16:19], s49 offen offset:0 lds
v_mfma_f32_16x16x32_bf16 v[108:111], a[108:111], v[128:131], v[108:111]
v_and_b32 v217, 0xffff0000, v196
v_mfma_f32_16x16x32_bf16 v[112:115], a[96:99], v[132:135], v[112:115]
v_lshlrev_b32 v218, 16, v197
v_mfma_f32_16x16x32_bf16 v[116:119], a[100:103], v[132:135], v[116:119]
v_and_b32 v219, 0xffff0000, v197
v_mfma_f32_16x16x32_bf16 v[120:123], a[104:107], v[132:135], v[120:123]
s_add_u32 s54, s44, 16384
v_lshlrev_b32 v220, 16, v198
v_mfma_f32_16x16x32_bf16 v[124:127], a[108:111], v[132:135], v[124:127]
s_waitcnt lgkmcnt(2)
v_cvt_pk_bf16_f32 v176, v64, v65
v_mfma_f32_16x16x32_bf16 v[96:99], a[112:115], v[136:139], v[96:99]
ds_read_b128 v[128:131], v19 offset:16384
ds_read_b128 v[132:135], v19 offset:20480
v_mfma_f32_16x16x32_bf16 v[100:103], a[116:119], v[136:139], v[100:103]
v_cvt_pk_bf16_f32 v177, v66, v67
v_cvt_pk_bf16_f32 v178, v68, v69
v_mfma_f32_16x16x32_bf16 v[104:107], a[120:123], v[136:139], v[104:107]
v_cvt_pk_bf16_f32 v179, v70, v71
v_and_b32 v221, 0xffff0000, v198
v_mfma_f32_16x16x32_bf16 v[108:111], a[124:127], v[136:139], v[108:111]
buffer_store_dwordx4 v[176:179], v22, s[32:35], s54 offen offset:0 sc0 sc1
v_mfma_f32_16x16x32_bf16 v[112:115], a[112:115], v[140:143], v[112:115]
v_lshlrev_b32 v222, 16, v199
v_mfma_f32_16x16x32_bf16 v[116:119], a[116:119], v[140:143], v[116:119]
buffer_load_dwordx4 v7, s[16:19], s49 offen offset:1024 lds
v_mfma_f32_16x16x32_bf16 v[120:123], a[120:123], v[140:143], v[120:123]
v_and_b32 v223, 0xffff0000, v199
v_mfma_f32_16x16x32_bf16 v[124:127], a[124:127], v[140:143], v[124:127]
s_waitcnt lgkmcnt(2)
v_add_f32 v200, v208, v209
v_mfma_f32_16x16x32_bf16 v[96:99], a[128:131], v[144:147], v[96:99]
ds_read_b128 v[136:139], v20 offset:16384
ds_read_b128 v[140:143], v20 offset:20480
v_mfma_f32_16x16x32_bf16 v[100:103], a[132:135], v[144:147], v[100:103]
v_add_f32 v200, v200, v210
v_mfma_f32_16x16x32_bf16 v[104:107], a[136:139], v[144:147], v[104:107]
v_cvt_pk_bf16_f32 v180, v72, v73
v_cvt_pk_bf16_f32 v181, v74, v75
v_mfma_f32_16x16x32_bf16 v[108:111], a[140:143], v[144:147], v[108:111]
v_cvt_pk_bf16_f32 v182, v76, v77
v_cvt_pk_bf16_f32 v183, v78, v79
v_mfma_f32_16x16x32_bf16 v[112:115], a[128:131], v[148:151], v[112:115]
buffer_store_dwordx4 v[180:183], v22, s[32:35], s54 offen offset:1024 sc0 sc1
v_mfma_f32_16x16x32_bf16 v[116:119], a[132:135], v[148:151], v[116:119]
v_add_f32 v200, v200, v211
v_mfma_f32_16x16x32_bf16 v[120:123], a[136:139], v[148:151], v[120:123]
v_add_f32 v200, v200, v212
v_mfma_f32_16x16x32_bf16 v[124:127], a[140:143], v[148:151], v[124:127]
s_waitcnt lgkmcnt(2)
v_add_f32 v200, v200, v213
v_mfma_f32_16x16x32_bf16 v[96:99], a[144:147], v[128:131], v[96:99]
ds_read_b128 v[144:147], v21 offset:16384
ds_read_b128 v[148:151], v21 offset:20480
v_mfma_f32_16x16x32_bf16 v[100:103], a[148:151], v[128:131], v[100:103]
buffer_load_dwordx4 v8, s[16:19], s49 offen offset:2048 lds
v_mfma_f32_16x16x32_bf16 v[104:107], a[152:155], v[128:131], v[104:107]
v_add_f32 v200, v200, v214
v_mfma_f32_16x16x32_bf16 v[108:111], a[156:159], v[128:131], v[108:111]
v_add_f32 v200, v200, v215
v_mfma_f32_16x16x32_bf16 v[112:115], a[144:147], v[132:135], v[112:115]
v_mfma_f32_16x16x32_bf16 v[116:119], a[148:151], v[132:135], v[116:119]
v_cvt_pk_bf16_f32 v184, v80, v81
v_cvt_pk_bf16_f32 v185, v82, v83
v_mfma_f32_16x16x32_bf16 v[120:123], a[152:155], v[132:135], v[120:123]
v_cvt_pk_bf16_f32 v186, v84, v85
v_cvt_pk_bf16_f32 v187, v86, v87
v_mfma_f32_16x16x32_bf16 v[124:127], a[156:159], v[132:135], v[124:127]
s_waitcnt lgkmcnt(2)
v_add_f32_dpp v200, v200, v200 row_ror:8 row_mask:0xf bank_mask:0xf
v_mfma_f32_16x16x32_bf16 v[96:99], a[160:163], v[136:139], v[96:99]
ds_read_b128 v[128:131], v18 offset:24576
ds_read_b128 v[132:135], v18 offset:28672
v_mfma_f32_16x16x32_bf16 v[100:103], a[164:167], v[136:139], v[100:103]
buffer_store_dwordx4 v[184:187], v23, s[32:35], s54 offen offset:0 sc0 sc1
v_mfma_f32_16x16x32_bf16 v[104:107], a[168:171], v[136:139], v[104:107]
v_add_f32_dpp v200, v200, v200 row_ror:4 row_mask:0xf bank_mask:0xf
v_mfma_f32_16x16x32_bf16 v[108:111], a[172:175], v[136:139], v[108:111]
v_mfma_f32_16x16x32_bf16 v[112:115], a[160:163], v[140:143], v[112:115]
v_mfma_f32_16x16x32_bf16 v[116:119], a[164:167], v[140:143], v[116:119]
buffer_load_dwordx4 v9, s[16:19], s49 offen offset:3072 lds
v_mfma_f32_16x16x32_bf16 v[120:123], a[168:171], v[140:143], v[120:123]
v_add_f32_dpp v200, v200, v200 row_ror:2 row_mask:0xf bank_mask:0xf
v_mfma_f32_16x16x32_bf16 v[124:127], a[172:175], v[140:143], v[124:127]
s_waitcnt lgkmcnt(2)
v_mfma_f32_16x16x32_bf16 v[96:99], a[176:179], v[144:147], v[96:99]
ds_read_b128 v[136:139], v19 offset:24576
ds_read_b128 v[140:143], v19 offset:28672
v_mfma_f32_16x16x32_bf16 v[100:103], a[180:183], v[144:147], v[100:103]
v_cvt_pk_bf16_f32 v188, v88, v89
v_cvt_pk_bf16_f32 v189, v90, v91
v_mfma_f32_16x16x32_bf16 v[104:107], a[184:187], v[144:147], v[104:107]
v_cvt_pk_bf16_f32 v190, v92, v93
v_cvt_pk_bf16_f32 v191, v94, v95
v_mfma_f32_16x16x32_bf16 v[108:111], a[188:191], v[144:147], v[108:111]
buffer_store_dwordx4 v[188:191], v23, s[32:35], s54 offen offset:1024 sc0 sc1
v_mfma_f32_16x16x32_bf16 v[112:115], a[176:179], v[148:151], v[112:115]
v_add_f32_dpp v200, v200, v200 row_ror:1 row_mask:0xf bank_mask:0xf
v_mfma_f32_16x16x32_bf16 v[116:119], a[180:183], v[148:151], v[116:119]
v_mov_b32 v202, v200
v_mfma_f32_16x16x32_bf16 v[120:123], a[184:187], v[148:151], v[120:123]
v_mfma_f32_16x16x32_bf16 v[124:127], a[188:191], v[148:151], v[124:127]
s_waitcnt lgkmcnt(2)
v_mfma_f32_16x16x32_bf16 v[96:99], a[192:195], v[128:131], v[96:99]
ds_read_b128 v[144:147], v20 offset:24576
ds_read_b128 v[148:151], v20 offset:28672
v_mfma_f32_16x16x32_bf16 v[100:103], a[196:199], v[128:131], v[100:103]
v_permlane16_swap_b32 v200, v202
v_mfma_f32_16x16x32_bf16 v[104:107], a[200:203], v[128:131], v[104:107]
v_mfma_f32_16x16x32_bf16 v[108:111], a[204:207], v[128:131], v[108:111]
v_mfma_f32_16x16x32_bf16 v[112:115], a[192:195], v[132:135], v[112:115]
v_add_f32 v200, v200, v202
v_mfma_f32_16x16x32_bf16 v[116:119], a[196:199], v[132:135], v[116:119]
v_mov_b32 v202, v200
v_mfma_f32_16x16x32_bf16 v[120:123], a[200:203], v[132:135], v[120:123]
v_mfma_f32_16x16x32_bf16 v[124:127], a[204:207], v[132:135], v[124:127]
s_waitcnt lgkmcnt(2)
v_mfma_f32_16x16x32_bf16 v[96:99], a[208:211], v[136:139], v[96:99]
ds_read_b128 v[128:131], v21 offset:24576
ds_read_b128 v[132:135], v21 offset:28672
v_mfma_f32_16x16x32_bf16 v[100:103], a[212:215], v[136:139], v[100:103]
v_permlane32_swap_b32 v200, v202
v_mfma_f32_16x16x32_bf16 v[104:107], a[216:219], v[136:139], v[104:107]
v_mfma_f32_16x16x32_bf16 v[108:111], a[220:223], v[136:139], v[108:111]
s_waitcnt vmcnt(24)
v_mfma_f32_16x16x32_bf16 v[112:115], a[208:211], v[140:143], v[112:115]
v_add_f32 v200, v200, v202
s_barrier
v_mfma_f32_16x16x32_bf16 v[116:119], a[212:215], v[140:143], v[116:119]
v_mul_f32 v200, 0x3b000000, v200
v_mfma_f32_16x16x32_bf16 v[120:123], a[216:219], v[140:143], v[120:123]
v_sub_f32 v208, v208, v200
v_mfma_f32_16x16x32_bf16 v[124:127], a[220:223], v[140:143], v[124:127]
s_waitcnt lgkmcnt(2)
v_sub_f32 v209, v209, v200
v_mfma_f32_16x16x32_bf16 v[96:99], a[224:227], v[144:147], v[96:99]
ds_read_b128 v[136:139], v18 offset:32768
ds_read_b128 v[140:143], v18 offset:36864
v_mfma_f32_16x16x32_bf16 v[100:103], a[228:231], v[144:147], v[100:103]
v_sub_f32 v210, v210, v200
v_mfma_f32_16x16x32_bf16 v[104:107], a[232:235], v[144:147], v[104:107]
v_sub_f32 v211, v211, v200
v_mfma_f32_16x16x32_bf16 v[108:111], a[236:239], v[144:147], v[108:111]
v_sub_f32 v212, v212, v200
v_mfma_f32_16x16x32_bf16 v[112:115], a[224:227], v[148:151], v[112:115]
v_sub_f32 v213, v213, v200
v_mfma_f32_16x16x32_bf16 v[116:119], a[228:231], v[148:151], v[116:119]
v_sub_f32 v214, v214, v200
v_mfma_f32_16x16x32_bf16 v[120:123], a[232:235], v[148:151], v[120:123]
v_sub_f32 v215, v215, v200
v_mfma_f32_16x16x32_bf16 v[124:127], a[236:239], v[148:151], v[124:127]
s_waitcnt lgkmcnt(2)
v_mul_f32 v200, v208, v208
v_mfma_f32_16x16x32_bf16 v[96:99], a[240:243], v[128:131], v[96:99]
ds_read_b128 v[144:147], v19 offset:32768
ds_read_b128 v[148:151], v19 offset:36864
v_mfma_f32_16x16x32_bf16 v[100:103], a[244:247], v[128:131], v[100:103]
v_fmac_f32 v200, v209, v209
v_mfma_f32_16x16x32_bf16 v[104:107], a[248:251], v[128:131], v[104:107]
v_fmac_f32 v200, v210, v210
v_mfma_f32_16x16x32_bf16 v[108:111], a[252:255], v[128:131], v[108:111]
v_fmac_f32 v200, v211, v211
v_mfma_f32_16x16x32_bf16 v[112:115], a[240:243], v[132:135], v[112:115]
v_fmac_f32 v200, v212, v212
v_mfma_f32_16x16x32_bf16 v[116:119], a[244:247], v[132:135], v[116:119]
v_fmac_f32 v200, v213, v213
v_mfma_f32_16x16x32_bf16 v[120:123], a[248:251], v[132:135], v[120:123]
v_fmac_f32 v200, v214, v214
v_mfma_f32_16x16x32_bf16 v[124:127], a[252:255], v[132:135], v[124:127]
s_waitcnt lgkmcnt(2)
v_fmac_f32 v200, v215, v215
v_mfma_f32_16x16x32_bf16 v[32:35], a[0:3], v[136:139], 0
ds_read_b128 v[128:131], v20 offset:32768
ds_read_b128 v[132:135], v20 offset:36864
v_mfma_f32_16x16x32_bf16 v[36:39], a[4:7], v[136:139], 0
s_add_u32 m0, s46, 32768
s_add_u32 s49, s43, 196608
v_mfma_f32_16x16x32_bf16 v[40:43], a[8:11], v[136:139], 0
buffer_load_dwordx4 v6, s[16:19], s49 offen offset:0 lds
v_mfma_f32_16x16x32_bf16 v[44:47], a[12:15], v[136:139], 0
v_add_f32_dpp v200, v200, v200 row_ror:8 row_mask:0xf bank_mask:0xf
v_mfma_f32_16x16x32_bf16 v[48:51], a[0:3], v[140:143], 0
v_mfma_f32_16x16x32_bf16 v[52:55], a[4:7], v[140:143], 0
v_mfma_f32_16x16x32_bf16 v[56:59], a[8:11], v[140:143], 0
v_add_f32_dpp v200, v200, v200 row_ror:4 row_mask:0xf bank_mask:0xf
v_mfma_f32_16x16x32_bf16 v[60:63], a[12:15], v[140:143], 0
s_waitcnt lgkmcnt(2)
v_mfma_f32_16x16x32_bf16 v[32:35], a[16:19], v[144:147], v[32:35]
ds_read_b128 v[136:139], v21 offset:32768
ds_read_b128 v[140:143], v21 offset:36864
v_mfma_f32_16x16x32_bf16 v[36:39], a[20:23], v[144:147], v[36:39]
s_add_u32 s53, s44, 32768
v_add_f32_dpp v200, v200, v200 row_ror:2 row_mask:0xf bank_mask:0xf
v_mfma_f32_16x16x32_bf16 v[40:43], a[24:27], v[144:147], v[40:43]
v_cvt_pk_bf16_f32 v176, v96, v97
v_cvt_pk_bf16_f32 v177, v98, v99
v_mfma_f32_16x16x32_bf16 v[44:47], a[28:31], v[144:147], v[44:47]
v_cvt_pk_bf16_f32 v178, v100, v101
v_cvt_pk_bf16_f32 v179, v102, v103
v_mfma_f32_16x16x32_bf16 v[48:51], a[16:19], v[148:151], v[48:51]
buffer_store_dwordx4 v[176:179], v22, s[32:35], s53 offen offset:0 sc0 sc1
v_mfma_f32_16x16x32_bf16 v[52:55], a[20:23], v[148:151], v[52:55]
buffer_load_dwordx4 v7, s[16:19], s49 offen offset:1024 lds
v_mfma_f32_16x16x32_bf16 v[56:59], a[24:27], v[148:151], v[56:59]
v_add_f32_dpp v200, v200, v200 row_ror:1 row_mask:0xf bank_mask:0xf
v_mfma_f32_16x16x32_bf16 v[60:63], a[28:31], v[148:151], v[60:63]
s_waitcnt lgkmcnt(2)
v_mov_b32 v202, v200
v_mfma_f32_16x16x32_bf16 v[32:35], a[32:35], v[128:131], v[32:35]
ds_read_b128 v[144:147], v18 offset:40960
ds_read_b128 v[148:151], v18 offset:45056
v_mfma_f32_16x16x32_bf16 v[36:39], a[36:39], v[128:131], v[36:39]
v_mfma_f32_16x16x32_bf16 v[40:43], a[40:43], v[128:131], v[40:43]
v_permlane16_swap_b32 v200, v202
v_mfma_f32_16x16x32_bf16 v[44:47], a[44:47], v[128:131], v[44:47]
v_mfma_f32_16x16x32_bf16 v[48:51], a[32:35], v[132:135], v[48:51]
v_mfma_f32_16x16x32_bf16 v[52:55], a[36:39], v[132:135], v[52:55]
v_add_f32 v200, v200, v202
v_mfma_f32_16x16x32_bf16 v[56:59], a[40:43], v[132:135], v[56:59]
v_mov_b32 v202, v200
v_mfma_f32_16x16x32_bf16 v[60:63], a[44:47], v[132:135], v[60:63]
s_waitcnt lgkmcnt(2)
v_mfma_f32_16x16x32_bf16 v[32:35], a[48:51], v[136:139], v[32:35]
ds_read_b128 v[128:131], v19 offset:40960
ds_read_b128 v[132:135], v19 offset:45056
v_mfma_f32_16x16x32_bf16 v[36:39], a[52:55], v[136:139], v[36:39]
buffer_load_dwordx4 v8, s[16:19], s49 offen offset:2048 lds
v_mfma_f32_16x16x32_bf16 v[40:43], a[56:59], v[136:139], v[40:43]
v_permlane32_swap_b32 v200, v202
v_mfma_f32_16x16x32_bf16 v[44:47], a[60:63], v[136:139], v[44:47]
v_mfma_f32_16x16x32_bf16 v[48:51], a[48:51], v[140:143], v[48:51]
v_mfma_f32_16x16x32_bf16 v[52:55], a[52:55], v[140:143], v[52:55]
v_add_f32 v200, v200, v202
v_mfma_f32_16x16x32_bf16 v[56:59], a[56:59], v[140:143], v[56:59]
v_mov_b32 v203, 0x3727c5ac
v_mfma_f32_16x16x32_bf16 v[60:63], a[60:63], v[140:143], v[60:63]
s_waitcnt lgkmcnt(2)
v_fmac_f32 v203, 0x3b000000, v200
v_mfma_f32_16x16x32_bf16 v[32:35], a[64:67], v[144:147], v[32:35]
ds_read_b128 v[136:139], v20 offset:40960
ds_read_b128 v[140:143], v20 offset:45056
v_mfma_f32_16x16x32_bf16 v[36:39], a[68:71], v[144:147], v[36:39]
v_cvt_pk_bf16_f32 v180, v104, v105
v_cvt_pk_bf16_f32 v181, v106, v107
v_mfma_f32_16x16x32_bf16 v[40:43], a[72:75], v[144:147], v[40:43]
v_cvt_pk_bf16_f32 v182, v108, v109
v_cvt_pk_bf16_f32 v183, v110, v111
v_mfma_f32_16x16x32_bf16 v[44:47], a[76:79], v[144:147], v[44:47]
buffer_store_dwordx4 v[180:183], v22, s[32:35], s53 offen offset:1024 sc0 sc1
v_mfma_f32_16x16x32_bf16 v[48:51], a[64:67], v[148:151], v[48:51]
v_rsq_f32 v200, v203
v_mfma_f32_16x16x32_bf16 v[52:55], a[68:71], v[148:151], v[52:55]
buffer_load_dwordx4 v9, s[16:19], s49 offen offset:3072 lds
v_mfma_f32_16x16x32_bf16 v[56:59], a[72:75], v[148:151], v[56:59]
v_mul_f32 v200, 0x3e0293ee, v200
v_mfma_f32_16x16x32_bf16 v[60:63], a[76:79], v[148:151], v[60:63]
s_waitcnt lgkmcnt(2)
v_mul_f32 v208, v208, v200
v_mfma_f32_16x16x32_bf16 v[32:35], a[80:83], v[128:131], v[32:35]
ds_read_b128 v[144:147], v21 offset:40960
ds_read_b128 v[148:151], v21 offset:45056
v_mfma_f32_16x16x32_bf16 v[36:39], a[84:87], v[128:131], v[36:39]
v_mul_f32 v209, v209, v200
v_mfma_f32_16x16x32_bf16 v[40:43], a[88:91], v[128:131], v[40:43]
v_mul_f32 v210, v210, v200
v_mfma_f32_16x16x32_bf16 v[44:47], a[92:95], v[128:131], v[44:47]
v_mul_f32 v211, v211, v200
v_mfma_f32_16x16x32_bf16 v[48:51], a[80:83], v[132:135], v[48:51]
v_mul_f32 v212, v212, v200
v_mfma_f32_16x16x32_bf16 v[52:55], a[84:87], v[132:135], v[52:55]
v_mul_f32 v213, v213, v200
v_mfma_f32_16x16x32_bf16 v[56:59], a[88:91], v[132:135], v[56:59]
v_mul_f32 v214, v214, v200
v_mfma_f32_16x16x32_bf16 v[60:63], a[92:95], v[132:135], v[60:63]
s_waitcnt lgkmcnt(2)
v_mul_f32 v215, v215, v200
v_mfma_f32_16x16x32_bf16 v[32:35], a[96:99], v[136:139], v[32:35]
ds_read_b128 v[128:131], v18 offset:49152
ds_read_b128 v[132:135], v18 offset:53248
v_mfma_f32_16x16x32_bf16 v[36:39], a[100:103], v[136:139], v[36:39]
s_add_u32 m0, s46, 36864
s_add_u32 s49, s43, 212992
v_mfma_f32_16x16x32_bf16 v[40:43], a[104:107], v[136:139], v[40:43]
buffer_load_dwordx4 v6, s[16:19], s49 offen offset:0 lds
v_mfma_f32_16x16x32_bf16 v[44:47], a[108:111], v[136:139], v[44:47]
v_cvt_pk_bf16_f32 v192, v208, v209
v_mfma_f32_16x16x32_bf16 v[48:51], a[96:99], v[140:143], v[48:51]
v_cvt_pk_bf16_f32 v193, v210, v211
v_mfma_f32_16x16x32_bf16 v[52:55], a[100:103], v[140:143], v[52:55]
v_cvt_pk_bf16_f32 v194, v212, v213
v_mfma_f32_16x16x32_bf16 v[56:59], a[104:107], v[140:143], v[56:59]
v_cvt_pk_bf16_f32 v184, v112, v113
v_cvt_pk_bf16_f32 v185, v114, v115
v_mfma_f32_16x16x32_bf16 v[60:63], a[108:111], v[140:143], v[60:63]
s_waitcnt lgkmcnt(2)
v_cvt_pk_bf16_f32 v186, v116, v117
v_mfma_f32_16x16x32_bf16 v[32:35], a[112:115], v[144:147], v[32:35]
ds_read_b128 v[136:139], v19 offset:49152
ds_read_b128 v[140:143], v19 offset:53248
v_mfma_f32_16x16x32_bf16 v[36:39], a[116:119], v[144:147], v[36:39]
v_cvt_pk_bf16_f32 v187, v118, v119
v_cvt_pk_bf16_f32 v195, v214, v215
v_mfma_f32_16x16x32_bf16 v[40:43], a[120:123], v[144:147], v[40:43]
buffer_store_dwordx4 v[184:187], v23, s[32:35], s53 offen offset:0 sc0 sc1
v_mfma_f32_16x16x32_bf16 v[44:47], a[124:127], v[144:147], v[44:47]
v_add_f32 v201, v216, v217
v_mfma_f32_16x16x32_bf16 v[48:51], a[112:115], v[148:151], v[48:51]
v_add_f32 v201, v201, v218
v_mfma_f32_16x16x32_bf16 v[52:55], a[116:119], v[148:151], v[52:55]
buffer_load_dwordx4 v7, s[16:19], s49 offen offset:1024 lds
v_mfma_f32_16x16x32_bf16 v[56:59], a[120:123], v[148:151], v[56:59]
v_add_f32 v201, v201, v219
v_mfma_f32_16x16x32_bf16 v[60:63], a[124:127], v[148:151], v[60:63]
s_waitcnt lgkmcnt(2)
v_add_f32 v201, v201, v220
v_mfma_f32_16x16x32_bf16 v[32:35], a[128:131], v[128:131], v[32:35]
ds_read_b128 v[144:147], v20 offset:49152
ds_read_b128 v[148:151], v20 offset:53248
v_mfma_f32_16x16x32_bf16 v[36:39], a[132:135], v[128:131], v[36:39]
v_add_f32 v201, v201, v221
v_mfma_f32_16x16x32_bf16 v[40:43], a[136:139], v[128:131], v[40:43]
v_add_f32 v201, v201, v222
v_mfma_f32_16x16x32_bf16 v[44:47], a[140:143], v[128:131], v[44:47]
v_add_f32 v201, v201, v223
v_mfma_f32_16x16x32_bf16 v[48:51], a[128:131], v[132:135], v[48:51]
v_mfma_f32_16x16x32_bf16 v[52:55], a[132:135], v[132:135], v[52:55]
v_mfma_f32_16x16x32_bf16 v[56:59], a[136:139], v[132:135], v[56:59]
v_add_f32_dpp v201, v201, v201 row_ror:8 row_mask:0xf bank_mask:0xf
v_mfma_f32_16x16x32_bf16 v[60:63], a[140:143], v[132:135], v[60:63]
s_waitcnt lgkmcnt(2)
v_mfma_f32_16x16x32_bf16 v[32:35], a[144:147], v[136:139], v[32:35]
ds_read_b128 v[128:131], v21 offset:49152
ds_read_b128 v[132:135], v21 offset:53248
v_mfma_f32_16x16x32_bf16 v[36:39], a[148:151], v[136:139], v[36:39]
buffer_load_dwordx4 v8, s[16:19], s49 offen offset:2048 lds
v_mfma_f32_16x16x32_bf16 v[40:43], a[152:155], v[136:139], v[40:43]
v_add_f32_dpp v201, v201, v201 row_ror:4 row_mask:0xf bank_mask:0xf
v_mfma_f32_16x16x32_bf16 v[44:47], a[156:159], v[136:139], v[44:47]
v_mfma_f32_16x16x32_bf16 v[48:51], a[144:147], v[140:143], v[48:51]
v_cvt_pk_bf16_f32 v188, v120, v121
v_cvt_pk_bf16_f32 v189, v122, v123
v_mfma_f32_16x16x32_bf16 v[52:55], a[148:151], v[140:143], v[52:55]
v_cvt_pk_bf16_f32 v190, v124, v125
v_cvt_pk_bf16_f32 v191, v126, v127
v_mfma_f32_16x16x32_bf16 v[56:59], a[152:155], v[140:143], v[56:59]
buffer_store_dwordx4 v[188:191], v23, s[32:35], s53 offen offset:1024 sc0 sc1
v_mfma_f32_16x16x32_bf16 v[60:63], a[156:159], v[140:143], v[60:63]
s_waitcnt lgkmcnt(2)
v_add_f32_dpp v201, v201, v201 row_ror:2 row_mask:0xf bank_mask:0xf
v_mfma_f32_16x16x32_bf16 v[32:35], a[160:163], v[144:147], v[32:35]
ds_read_b128 v[136:139], v18 offset:57344
ds_read_b128 v[140:143], v18 offset:61440
v_mfma_f32_16x16x32_bf16 v[36:39], a[164:167], v[144:147], v[36:39]
v_mfma_f32_16x16x32_bf16 v[40:43], a[168:171], v[144:147], v[40:43]
v_add_f32_dpp v201, v201, v201 row_ror:1 row_mask:0xf bank_mask:0xf
v_mfma_f32_16x16x32_bf16 v[44:47], a[172:175], v[144:147], v[44:47]
v_mov_b32 v202, v201
v_mfma_f32_16x16x32_bf16 v[48:51], a[160:163], v[148:151], v[48:51]
v_mfma_f32_16x16x32_bf16 v[52:55], a[164:167], v[148:151], v[52:55]
buffer_load_dwordx4 v9, s[16:19], s49 offen offset:3072 lds
v_mfma_f32_16x16x32_bf16 v[56:59], a[168:171], v[148:151], v[56:59]
v_permlane16_swap_b32 v201, v202
v_mfma_f32_16x16x32_bf16 v[60:63], a[172:175], v[148:151], v[60:63]
s_waitcnt lgkmcnt(2)
v_mfma_f32_16x16x32_bf16 v[32:35], a[176:179], v[128:131], v[32:35]
ds_read_b128 v[144:147], v19 offset:57344
ds_read_b128 v[148:151], v19 offset:61440
v_mfma_f32_16x16x32_bf16 v[36:39], a[180:183], v[128:131], v[36:39]
v_add_f32 v201, v201, v202
v_mfma_f32_16x16x32_bf16 v[40:43], a[184:187], v[128:131], v[40:43]
v_mov_b32 v202, v201
v_mfma_f32_16x16x32_bf16 v[44:47], a[188:191], v[128:131], v[44:47]
v_mfma_f32_16x16x32_bf16 v[48:51], a[176:179], v[132:135], v[48:51]
v_mfma_f32_16x16x32_bf16 v[52:55], a[180:183], v[132:135], v[52:55]
v_permlane32_swap_b32 v201, v202
v_mfma_f32_16x16x32_bf16 v[56:59], a[184:187], v[132:135], v[56:59]
v_mfma_f32_16x16x32_bf16 v[60:63], a[188:191], v[132:135], v[60:63]
s_waitcnt lgkmcnt(2)
v_mfma_f32_16x16x32_bf16 v[32:35], a[192:195], v[136:139], v[32:35]
ds_read_b128 v[128:131], v20 offset:57344
ds_read_b128 v[132:135], v20 offset:61440
v_mfma_f32_16x16x32_bf16 v[36:39], a[196:199], v[136:139], v[36:39]
v_add_f32 v201, v201, v202
v_mfma_f32_16x16x32_bf16 v[40:43], a[200:203], v[136:139], v[40:43]
v_mul_f32 v201, 0x3b000000, v201
v_mfma_f32_16x16x32_bf16 v[44:47], a[204:207], v[136:139], v[44:47]
v_sub_f32 v216, v216, v201
v_mfma_f32_16x16x32_bf16 v[48:51], a[192:195], v[140:143], v[48:51]
v_sub_f32 v217, v217, v201
v_mfma_f32_16x16x32_bf16 v[52:55], a[196:199], v[140:143], v[52:55]
v_sub_f32 v218, v218, v201
v_mfma_f32_16x16x32_bf16 v[56:59], a[200:203], v[140:143], v[56:59]
v_sub_f32 v219, v219, v201
v_mfma_f32_16x16x32_bf16 v[60:63], a[204:207], v[140:143], v[60:63]
s_waitcnt lgkmcnt(2)
v_sub_f32 v220, v220, v201
v_mfma_f32_16x16x32_bf16 v[32:35], a[208:211], v[144:147], v[32:35]
ds_read_b128 v[136:139], v21 offset:57344
ds_read_b128 v[140:143], v21 offset:61440
v_mfma_f32_16x16x32_bf16 v[36:39], a[212:215], v[144:147], v[36:39]
v_sub_f32 v221, v221, v201
v_mfma_f32_16x16x32_bf16 v[40:43], a[216:219], v[144:147], v[40:43]
v_sub_f32 v222, v222, v201
v_mfma_f32_16x16x32_bf16 v[44:47], a[220:223], v[144:147], v[44:47]
v_sub_f32 v223, v223, v201
s_waitcnt vmcnt(28)
v_mfma_f32_16x16x32_bf16 v[48:51], a[208:211], v[148:151], v[48:51]
v_mul_f32 v201, v216, v216
s_barrier
v_mfma_f32_16x16x32_bf16 v[52:55], a[212:215], v[148:151], v[52:55]
v_fmac_f32 v201, v217, v217
v_mfma_f32_16x16x32_bf16 v[56:59], a[216:219], v[148:151], v[56:59]
v_fmac_f32 v201, v218, v218
v_mfma_f32_16x16x32_bf16 v[60:63], a[220:223], v[148:151], v[60:63]
s_waitcnt lgkmcnt(2)
v_fmac_f32 v201, v219, v219
v_mfma_f32_16x16x32_bf16 v[32:35], a[224:227], v[128:131], v[32:35]
ds_read_b128 v[144:147], v28 offset:0
ds_read_b128 v[148:151], v28 offset:4096
v_mfma_f32_16x16x32_bf16 v[36:39], a[228:231], v[128:131], v[36:39]
v_fmac_f32 v201, v220, v220
v_mfma_f32_16x16x32_bf16 v[40:43], a[232:235], v[128:131], v[40:43]
v_fmac_f32 v201, v221, v221
v_mfma_f32_16x16x32_bf16 v[44:47], a[236:239], v[128:131], v[44:47]
v_fmac_f32 v201, v222, v222
v_mfma_f32_16x16x32_bf16 v[48:51], a[224:227], v[132:135], v[48:51]
v_fmac_f32 v201, v223, v223
v_mfma_f32_16x16x32_bf16 v[52:55], a[228:231], v[132:135], v[52:55]
v_mfma_f32_16x16x32_bf16 v[56:59], a[232:235], v[132:135], v[56:59]
v_mfma_f32_16x16x32_bf16 v[60:63], a[236:239], v[132:135], v[60:63]
s_waitcnt lgkmcnt(2)
v_add_f32_dpp v201, v201, v201 row_ror:8 row_mask:0xf bank_mask:0xf
v_mfma_f32_16x16x32_bf16 v[32:35], a[240:243], v[136:139], v[32:35]
ds_read_b128 v[128:131], v29 offset:0
ds_read_b128 v[132:135], v29 offset:4096
v_mfma_f32_16x16x32_bf16 v[36:39], a[244:247], v[136:139], v[36:39]
v_mfma_f32_16x16x32_bf16 v[40:43], a[248:251], v[136:139], v[40:43]
v_add_f32_dpp v201, v201, v201 row_ror:4 row_mask:0xf bank_mask:0xf
v_mfma_f32_16x16x32_bf16 v[44:47], a[252:255], v[136:139], v[44:47]
v_mfma_f32_16x16x32_bf16 v[48:51], a[240:243], v[140:143], v[48:51]
v_mfma_f32_16x16x32_bf16 v[52:55], a[244:247], v[140:143], v[52:55]
v_add_f32_dpp v201, v201, v201 row_ror:2 row_mask:0xf bank_mask:0xf
v_mfma_f32_16x16x32_bf16 v[56:59], a[248:251], v[140:143], v[56:59]
v_mfma_f32_16x16x32_bf16 v[60:63], a[252:255], v[140:143], v[60:63]
s_waitcnt lgkmcnt(2)
v_mfma_f32_16x16x32_bf16 v[64:67], a[0:3], v[144:147], 0
ds_read_b128 v[136:139], v30 offset:0
ds_read_b128 v[140:143], v30 offset:4096
v_mfma_f32_16x16x32_bf16 v[68:71], a[4:7], v[144:147], 0
s_add_u32 m0, s46, 65536
s_add_u32 s49, s43, 229376
v_mfma_f32_16x16x32_bf16 v[72:75], a[8:11], v[144:147], 0
buffer_load_dwordx4 v6, s[16:19], s49 offen offset:0 lds
v_mfma_f32_16x16x32_bf16 v[76:79], a[12:15], v[144:147], 0
v_add_f32_dpp v201, v201, v201 row_ror:1 row_mask:0xf bank_mask:0xf
v_mfma_f32_16x16x32_bf16 v[80:83], a[0:3], v[148:151], 0
v_mov_b32 v202, v201
v_mfma_f32_16x16x32_bf16 v[84:87], a[4:7], v[148:151], 0
v_mfma_f32_16x16x32_bf16 v[88:91], a[8:11], v[148:151], 0
v_mfma_f32_16x16x32_bf16 v[92:95], a[12:15], v[148:151], 0
s_waitcnt lgkmcnt(2)
v_permlane16_swap_b32 v201, v202
v_mfma_f32_16x16x32_bf16 v[64:67], a[16:19], v[128:131], v[64:67]
ds_read_b128 v[144:147], v31 offset:0
ds_read_b128 v[148:151], v31 offset:4096
v_mfma_f32_16x16x32_bf16 v[68:71], a[20:23], v[128:131], v[68:71]
s_add_u32 s54, s44, 49152
v_mfma_f32_16x16x32_bf16 v[72:75], a[24:27], v[128:131], v[72:75]
v_cvt_pk_bf16_f32 v160, v32, v33
v_cvt_pk_bf16_f32 v161, v34, v35
v_mfma_f32_16x16x32_bf16 v[76:79], a[28:31], v[128:131], v[76:79]
v_cvt_pk_bf16_f32 v162, v36, v37
v_cvt_pk_bf16_f32 v163, v38, v39
v_mfma_f32_16x16x32_bf16 v[80:83], a[16:19], v[132:135], v[80:83]
buffer_store_dwordx4 v[160:163], v22, s[32:35], s54 offen offset:0 sc0 sc1
v_mfma_f32_16x16x32_bf16 v[84:87], a[20:23], v[132:135], v[84:87]
buffer_load_dwordx4 v7, s[16:19], s49 offen offset:1024 lds
v_mfma_f32_16x16x32_bf16 v[88:91], a[24:27], v[132:135], v[88:91]
v_add_f32 v201, v201, v202
v_mfma_f32_16x16x32_bf16 v[92:95], a[28:31], v[132:135], v[92:95]
s_waitcnt lgkmcnt(2)
v_mov_b32 v202, v201
v_mfma_f32_16x16x32_bf16 v[64:67], a[32:35], v[136:139], v[64:67]
ds_read_b128 v[128:131], v28 offset:8192
ds_read_b128 v[132:135], v28 offset:12288
v_mfma_f32_16x16x32_bf16 v[68:71], a[36:39], v[136:139], v[68:71]
v_mfma_f32_16x16x32_bf16 v[72:75], a[40:43], v[136:139], v[72:75]
v_permlane32_swap_b32 v201, v202
v_mfma_f32_16x16x32_bf16 v[76:79], a[44:47], v[136:139], v[76:79]
v_mfma_f32_16x16x32_bf16 v[80:83], a[32:35], v[140:143], v[80:83]
v_mfma_f32_16x16x32_bf16 v[84:87], a[36:39], v[140:143], v[84:87]
v_add_f32 v201, v201, v202
v_mfma_f32_16x16x32_bf16 v[88:91], a[40:43], v[140:143], v[88:91]
v_mov_b32 v203, 0x3727c5ac
v_mfma_f32_16x16x32_bf16 v[92:95], a[44:47], v[140:143], v[92:95]
s_waitcnt lgkmcnt(2)
v_fmac_f32 v203, 0x3b000000, v201
v_mfma_f32_16x16x32_bf16 v[64:67], a[48:51], v[144:147], v[64:67]
ds_read_b128 v[136:139], v29 offset:8192
ds_read_b128 v[140:143], v29 offset:12288
v_mfma_f32_16x16x32_bf16 v[68:71], a[52:55], v[144:147], v[68:71]
buffer_load_dwordx4 v8, s[16:19], s49 offen offset:2048 lds
v_mfma_f32_16x16x32_bf16 v[72:75], a[56:59], v[144:147], v[72:75]
v_rsq_f32 v201, v203
v_mfma_f32_16x16x32_bf16 v[76:79], a[60:63], v[144:147], v[76:79]
v_mfma_f32_16x16x32_bf16 v[80:83], a[48:51], v[148:151], v[80:83]
v_mul_f32 v201, 0x3e0293ee, v201
v_mfma_f32_16x16x32_bf16 v[84:87], a[52:55], v[148:151], v[84:87]
v_mul_f32 v216, v216, v201
v_mfma_f32_16x16x32_bf16 v[88:91], a[56:59], v[148:151], v[88:91]
v_mul_f32 v217, v217, v201
v_mfma_f32_16x16x32_bf16 v[92:95], a[60:63], v[148:151], v[92:95]
s_waitcnt lgkmcnt(2)
v_mul_f32 v218, v218, v201
v_mfma_f32_16x16x32_bf16 v[64:67], a[64:67], v[128:131], v[64:67]
ds_read_b128 v[144:147], v30 offset:8192
ds_read_b128 v[148:151], v30 offset:12288
v_mfma_f32_16x16x32_bf16 v[68:71], a[68:71], v[128:131], v[68:71]
v_cvt_pk_bf16_f32 v164, v40, v41
v_cvt_pk_bf16_f32 v165, v42, v43
v_mfma_f32_16x16x32_bf16 v[72:75], a[72:75], v[128:131], v[72:75]
v_cvt_pk_bf16_f32 v166, v44, v45
v_cvt_pk_bf16_f32 v167, v46, v47
v_mfma_f32_16x16x32_bf16 v[76:79], a[76:79], v[128:131], v[76:79]
buffer_store_dwordx4 v[164:167], v22, s[32:35], s54 offen offset:1024 sc0 sc1
v_mfma_f32_16x16x32_bf16 v[80:83], a[64:67], v[132:135], v[80:83]
v_mul_f32 v219, v219, v201
v_mfma_f32_16x16x32_bf16 v[84:87], a[68:71], v[132:135], v[84:87]
buffer_load_dwordx4 v9, s[16:19], s49 offen offset:3072 lds
v_mfma_f32_16x16x32_bf16 v[88:91], a[72:75], v[132:135], v[88:91]
v_mul_f32 v220, v220, v201
v_mfma_f32_16x16x32_bf16 v[92:95], a[76:79], v[132:135], v[92:95]
s_waitcnt lgkmcnt(2)
v_mul_f32 v221, v221, v201
v_mfma_f32_16x16x32_bf16 v[64:67], a[80:83], v[136:139], v[64:67]
ds_read_b128 v[128:131], v31 offset:8192
ds_read_b128 v[132:135], v31 offset:12288
v_mfma_f32_16x16x32_bf16 v[68:71], a[84:87], v[136:139], v[68:71]
v_mul_f32 v222, v222, v201
v_mfma_f32_16x16x32_bf16 v[72:75], a[88:91], v[136:139], v[72:75]
v_mul_f32 v223, v223, v201
v_mfma_f32_16x16x32_bf16 v[76:79], a[92:95], v[136:139], v[76:79]
v_cvt_pk_bf16_f32 v196, v216, v217
v_mfma_f32_16x16x32_bf16 v[80:83], a[80:83], v[140:143], v[80:83]
v_cvt_pk_bf16_f32 v197, v218, v219
v_mfma_f32_16x16x32_bf16 v[84:87], a[84:87], v[140:143], v[84:87]
v_cvt_pk_bf16_f32 v198, v220, v221
v_mfma_f32_16x16x32_bf16 v[88:91], a[88:91], v[140:143], v[88:91]
v_cvt_pk_bf16_f32 v199, v222, v223
v_mfma_f32_16x16x32_bf16 v[92:95], a[92:95], v[140:143], v[92:95]
s_waitcnt lgkmcnt(2)
v_lshrrev_b32 v204, 2, v1
v_mfma_f32_16x16x32_bf16 v[64:67], a[96:99], v[144:147], v[64:67]
ds_read_b128 v[136:139], v28 offset:16384
ds_read_b128 v[140:143], v28 offset:20480
v_mfma_f32_16x16x32_bf16 v[68:71], a[100:103], v[144:147], v[68:71]
s_add_u32 m0, s46, 69632
s_add_u32 s49, s43, 245760
v_mfma_f32_16x16x32_bf16 v[72:75], a[104:107], v[144:147], v[72:75]
buffer_load_dwordx4 v6, s[16:19], s49 offen offset:0 lds
v_mfma_f32_16x16x32_bf16 v[76:79], a[108:111], v[144:147], v[76:79]
v_lshlrev_b32 v204, 10, v204
v_mfma_f32_16x16x32_bf16 v[80:83], a[96:99], v[148:151], v[80:83]
v_and_b32 v205, 3, v1
v_mfma_f32_16x16x32_bf16 v[84:87], a[100:103], v[148:151], v[84:87]
v_lshl_add_u32 v204, v205, 8, v204
v_mfma_f32_16x16x32_bf16 v[88:91], a[104:107], v[148:151], v[88:91]
v_cvt_pk_bf16_f32 v168, v48, v49
v_cvt_pk_bf16_f32 v169, v50, v51
v_mfma_f32_16x16x32_bf16 v[92:95], a[108:111], v[148:151], v[92:95]
s_waitcnt lgkmcnt(2)
v_cvt_pk_bf16_f32 v170, v52, v53
v_mfma_f32_16x16x32_bf16 v[64:67], a[112:115], v[128:131], v[64:67]
ds_read_b128 v[144:147], v29 offset:16384
ds_read_b128 v[148:151], v29 offset:20480
v_mfma_f32_16x16x32_bf16 v[68:71], a[116:119], v[128:131], v[68:71]
v_cvt_pk_bf16_f32 v171, v54, v55
s_lshr_b32 s51, s48, 4
v_mfma_f32_16x16x32_bf16 v[72:75], a[120:123], v[128:131], v[72:75]
buffer_store_dwordx4 v[168:171], v23, s[32:35], s54 offen offset:0 sc0 sc1
v_mfma_f32_16x16x32_bf16 v[76:79], a[124:127], v[128:131], v[76:79]
s_lshl_b32 s51, s51, 14
v_mfma_f32_16x16x32_bf16 v[80:83], a[112:115], v[132:135], v[80:83]
s_and_b32 s52, s48, 15
v_mfma_f32_16x16x32_bf16 v[84:87], a[116:119], v[132:135], v[84:87]
buffer_load_dwordx4 v7, s[16:19], s49 offen offset:1024 lds
v_mfma_f32_16x16x32_bf16 v[88:91], a[120:123], v[132:135], v[88:91]
s_lshl_b32 s52, s52, 4
v_mfma_f32_16x16x32_bf16 v[92:95], a[124:127], v[132:135], v[92:95]
s_waitcnt lgkmcnt(2)
s_add_u32 s51, s51, s52
v_mfma_f32_16x16x32_bf16 v[64:67], a[128:131], v[136:139], v[64:67]
ds_read_b128 v[128:131], v30 offset:16384
ds_read_b128 v[132:135], v30 offset:20480
v_mfma_f32_16x16x32_bf16 v[68:71], a[132:135], v[136:139], v[68:71]
buffer_store_dwordx4 v[192:195], v204, s[28:31], s51 offen sc0 sc1
v_mfma_f32_16x16x32_bf16 v[72:75], a[136:139], v[136:139], v[72:75]
v_mfma_f32_16x16x32_bf16 v[76:79], a[140:143], v[136:139], v[76:79]
buffer_store_dwordx4 v[196:199], v204, s[28:31], s51 offen offset:16 sc0 sc1
v_mfma_f32_16x16x32_bf16 v[80:83], a[128:131], v[140:143], v[80:83]
v_mfma_f32_16x16x32_bf16 v[84:87], a[132:135], v[140:143], v[84:87]
v_mfma_f32_16x16x32_bf16 v[88:91], a[136:139], v[140:143], v[88:91]
v_mfma_f32_16x16x32_bf16 v[92:95], a[140:143], v[140:143], v[92:95]
s_waitcnt lgkmcnt(2)
v_mfma_f32_16x16x32_bf16 v[64:67], a[144:147], v[144:147], v[64:67]
ds_read_b128 v[136:139], v31 offset:16384
ds_read_b128 v[140:143], v31 offset:20480
v_mfma_f32_16x16x32_bf16 v[68:71], a[148:151], v[144:147], v[68:71]
buffer_load_dwordx4 v8, s[16:19], s49 offen offset:2048 lds
v_mfma_f32_16x16x32_bf16 v[72:75], a[152:155], v[144:147], v[72:75]
v_mfma_f32_16x16x32_bf16 v[76:79], a[156:159], v[144:147], v[76:79]
v_mfma_f32_16x16x32_bf16 v[80:83], a[144:147], v[148:151], v[80:83]
v_cvt_pk_bf16_f32 v172, v56, v57
v_cvt_pk_bf16_f32 v173, v58, v59
v_mfma_f32_16x16x32_bf16 v[84:87], a[148:151], v[148:151], v[84:87]
v_cvt_pk_bf16_f32 v174, v60, v61
v_cvt_pk_bf16_f32 v175, v62, v63
v_mfma_f32_16x16x32_bf16 v[88:91], a[152:155], v[148:151], v[88:91]
buffer_store_dwordx4 v[172:175], v23, s[32:35], s54 offen offset:1024 sc0 sc1
v_mfma_f32_16x16x32_bf16 v[92:95], a[156:159], v[148:151], v[92:95]
s_waitcnt lgkmcnt(2)
v_mfma_f32_16x16x32_bf16 v[64:67], a[160:163], v[128:131], v[64:67]
ds_read_b128 v[144:147], v28 offset:24576
ds_read_b128 v[148:151], v28 offset:28672
v_mfma_f32_16x16x32_bf16 v[68:71], a[164:167], v[128:131], v[68:71]
v_mfma_f32_16x16x32_bf16 v[72:75], a[168:171], v[128:131], v[72:75]
v_mfma_f32_16x16x32_bf16 v[76:79], a[172:175], v[128:131], v[76:79]
v_mfma_f32_16x16x32_bf16 v[80:83], a[160:163], v[132:135], v[80:83]
v_mfma_f32_16x16x32_bf16 v[84:87], a[164:167], v[132:135], v[84:87]
buffer_load_dwordx4 v9, s[16:19], s49 offen offset:3072 lds
v_mfma_f32_16x16x32_bf16 v[88:91], a[168:171], v[132:135], v[88:91]
v_mfma_f32_16x16x32_bf16 v[92:95], a[172:175], v[132:135], v[92:95]
s_waitcnt lgkmcnt(2)
v_mfma_f32_16x16x32_bf16 v[64:67], a[176:179], v[136:139], v[64:67]
ds_read_b128 v[128:131], v29 offset:24576
ds_read_b128 v[132:135], v29 offset:28672
v_mfma_f32_16x16x32_bf16 v[68:71], a[180:183], v[136:139], v[68:71]
v_mfma_f32_16x16x32_bf16 v[72:75], a[184:187], v[136:139], v[72:75]
v_mfma_f32_16x16x32_bf16 v[76:79], a[188:191], v[136:139], v[76:79]
v_mfma_f32_16x16x32_bf16 v[80:83], a[176:179], v[140:143], v[80:83]
v_mfma_f32_16x16x32_bf16 v[84:87], a[180:183], v[140:143], v[84:87]
v_mfma_f32_16x16x32_bf16 v[88:91], a[184:187], v[140:143], v[88:91]
v_mfma_f32_16x16x32_bf16 v[92:95], a[188:191], v[140:143], v[92:95]
s_waitcnt lgkmcnt(2)
v_mfma_f32_16x16x32_bf16 v[64:67], a[192:195], v[144:147], v[64:67]
ds_read_b128 v[136:139], v30 offset:24576
ds_read_b128 v[140:143], v30 offset:28672
v_mfma_f32_16x16x32_bf16 v[68:71], a[196:199], v[144:147], v[68:71]
v_mfma_f32_16x16x32_bf16 v[72:75], a[200:203], v[144:147], v[72:75]
v_mfma_f32_16x16x32_bf16 v[76:79], a[204:207], v[144:147], v[76:79]
v_mfma_f32_16x16x32_bf16 v[80:83], a[192:195], v[148:151], v[80:83]
v_mfma_f32_16x16x32_bf16 v[84:87], a[196:199], v[148:151], v[84:87]
v_mfma_f32_16x16x32_bf16 v[88:91], a[200:203], v[148:151], v[88:91]
v_mfma_f32_16x16x32_bf16 v[92:95], a[204:207], v[148:151], v[92:95]
s_waitcnt lgkmcnt(2)
v_mfma_f32_16x16x32_bf16 v[64:67], a[208:211], v[128:131], v[64:67]
ds_read_b128 v[144:147], v31 offset:24576
ds_read_b128 v[148:151], v31 offset:28672
v_mfma_f32_16x16x32_bf16 v[68:71], a[212:215], v[128:131], v[68:71]
v_mfma_f32_16x16x32_bf16 v[72:75], a[216:219], v[128:131], v[72:75]
v_mfma_f32_16x16x32_bf16 v[76:79], a[220:223], v[128:131], v[76:79]
s_waitcnt vmcnt(27)
v_mfma_f32_16x16x32_bf16 v[80:83], a[208:211], v[132:135], v[80:83]
s_barrier
v_mfma_f32_16x16x32_bf16 v[84:87], a[212:215], v[132:135], v[84:87]
v_mfma_f32_16x16x32_bf16 v[88:91], a[216:219], v[132:135], v[88:91]
v_mfma_f32_16x16x32_bf16 v[92:95], a[220:223], v[132:135], v[92:95]
s_waitcnt lgkmcnt(2)
v_mfma_f32_16x16x32_bf16 v[64:67], a[224:227], v[136:139], v[64:67]
ds_read_b128 v[128:131], v14 offset:0
ds_read_b128 v[132:135], v14 offset:4096
v_mfma_f32_16x16x32_bf16 v[68:71], a[228:231], v[136:139], v[68:71]
v_mfma_f32_16x16x32_bf16 v[72:75], a[232:235], v[136:139], v[72:75]
v_mfma_f32_16x16x32_bf16 v[76:79], a[236:239], v[136:139], v[76:79]
v_mfma_f32_16x16x32_bf16 v[80:83], a[224:227], v[140:143], v[80:83]
v_mfma_f32_16x16x32_bf16 v[84:87], a[228:231], v[140:143], v[84:87]
v_mfma_f32_16x16x32_bf16 v[88:91], a[232:235], v[140:143], v[88:91]
v_mfma_f32_16x16x32_bf16 v[92:95], a[236:239], v[140:143], v[92:95]
s_waitcnt lgkmcnt(2)
v_mfma_f32_16x16x32_bf16 v[64:67], a[240:243], v[144:147], v[64:67]
ds_read_b128 v[136:139], v15 offset:0
ds_read_b128 v[140:143], v15 offset:4096
v_mfma_f32_16x16x32_bf16 v[68:71], a[244:247], v[144:147], v[68:71]
v_mfma_f32_16x16x32_bf16 v[72:75], a[248:251], v[144:147], v[72:75]
v_mfma_f32_16x16x32_bf16 v[76:79], a[252:255], v[144:147], v[76:79]
v_mfma_f32_16x16x32_bf16 v[80:83], a[240:243], v[148:151], v[80:83]
v_mfma_f32_16x16x32_bf16 v[84:87], a[244:247], v[148:151], v[84:87]
v_mfma_f32_16x16x32_bf16 v[88:91], a[248:251], v[148:151], v[88:91]
v_mfma_f32_16x16x32_bf16 v[92:95], a[252:255], v[148:151], v[92:95]
s_waitcnt lgkmcnt(2)
v_mfma_f32_16x16x32_bf16 v[96:99], a[0:3], v[128:131], 0
ds_read_b128 v[144:147], v16 offset:0
ds_read_b128 v[148:151], v16 offset:4096
v_mfma_f32_16x16x32_bf16 v[100:103], a[4:7], v[128:131], 0
v_mfma_f32_16x16x32_bf16 v[104:107], a[8:11], v[128:131], 0
v_mfma_f32_16x16x32_bf16 v[108:111], a[12:15], v[128:131], 0
v_mfma_f32_16x16x32_bf16 v[112:115], a[0:3], v[132:135], 0
v_mfma_f32_16x16x32_bf16 v[116:119], a[4:7], v[132:135], 0
v_mfma_f32_16x16x32_bf16 v[120:123], a[8:11], v[132:135], 0
v_mfma_f32_16x16x32_bf16 v[124:127], a[12:15], v[132:135], 0
s_waitcnt lgkmcnt(2)
v_mfma_f32_16x16x32_bf16 v[96:99], a[16:19], v[136:139], v[96:99]
ds_read_b128 v[128:131], v17 offset:0
ds_read_b128 v[132:135], v17 offset:4096
v_mfma_f32_16x16x32_bf16 v[100:103], a[20:23], v[136:139], v[100:103]
s_add_u32 s53, s44, 65536
v_mfma_f32_16x16x32_bf16 v[104:107], a[24:27], v[136:139], v[104:107]
v_cvt_pk_bf16_f32 v176, v64, v65
v_cvt_pk_bf16_f32 v177, v66, v67
v_mfma_f32_16x16x32_bf16 v[108:111], a[28:31], v[136:139], v[108:111]
v_cvt_pk_bf16_f32 v178, v68, v69
v_cvt_pk_bf16_f32 v179, v70, v71
v_mfma_f32_16x16x32_bf16 v[112:115], a[16:19], v[140:143], v[112:115]
buffer_store_dwordx4 v[176:179], v22, s[32:35], s53 offen offset:0 sc0 sc1
v_mfma_f32_16x16x32_bf16 v[116:119], a[20:23], v[140:143], v[116:119]
v_mfma_f32_16x16x32_bf16 v[120:123], a[24:27], v[140:143], v[120:123]
v_mfma_f32_16x16x32_bf16 v[124:127], a[28:31], v[140:143], v[124:127]
s_waitcnt lgkmcnt(2)
v_mfma_f32_16x16x32_bf16 v[96:99], a[32:35], v[144:147], v[96:99]
ds_read_b128 v[136:139], v14 offset:8192
ds_read_b128 v[140:143], v14 offset:12288
v_mfma_f32_16x16x32_bf16 v[100:103], a[36:39], v[144:147], v[100:103]
v_mfma_f32_16x16x32_bf16 v[104:107], a[40:43], v[144:147], v[104:107]
v_mfma_f32_16x16x32_bf16 v[108:111], a[44:47], v[144:147], v[108:111]
v_mfma_f32_16x16x32_bf16 v[112:115], a[32:35], v[148:151], v[112:115]
v_mfma_f32_16x16x32_bf16 v[116:119], a[36:39], v[148:151], v[116:119]
v_mfma_f32_16x16x32_bf16 v[120:123], a[40:43], v[148:151], v[120:123]
v_mfma_f32_16x16x32_bf16 v[124:127], a[44:47], v[148:151], v[124:127]
s_waitcnt lgkmcnt(2)
v_mfma_f32_16x16x32_bf16 v[96:99], a[48:51], v[128:131], v[96:99]
ds_read_b128 v[144:147], v15 offset:8192
ds_read_b128 v[148:151], v15 offset:12288
v_mfma_f32_16x16x32_bf16 v[100:103], a[52:55], v[128:131], v[100:103]
v_mfma_f32_16x16x32_bf16 v[104:107], a[56:59], v[128:131], v[104:107]
v_mfma_f32_16x16x32_bf16 v[108:111], a[60:63], v[128:131], v[108:111]
v_mfma_f32_16x16x32_bf16 v[112:115], a[48:51], v[132:135], v[112:115]
v_mfma_f32_16x16x32_bf16 v[116:119], a[52:55], v[132:135], v[116:119]
v_mfma_f32_16x16x32_bf16 v[120:123], a[56:59], v[132:135], v[120:123]
v_mfma_f32_16x16x32_bf16 v[124:127], a[60:63], v[132:135], v[124:127]
s_waitcnt lgkmcnt(2)
v_mfma_f32_16x16x32_bf16 v[96:99], a[64:67], v[136:139], v[96:99]
ds_read_b128 v[128:131], v16 offset:8192
ds_read_b128 v[132:135], v16 offset:12288
v_mfma_f32_16x16x32_bf16 v[100:103], a[68:71], v[136:139], v[100:103]
v_cvt_pk_bf16_f32 v180, v72, v73
v_cvt_pk_bf16_f32 v181, v74, v75
v_mfma_f32_16x16x32_bf16 v[104:107], a[72:75], v[136:139], v[104:107]
v_cvt_pk_bf16_f32 v182, v76, v77
v_cvt_pk_bf16_f32 v183, v78, v79
v_mfma_f32_16x16x32_bf16 v[108:111], a[76:79], v[136:139], v[108:111]
buffer_store_dwordx4 v[180:183], v22, s[32:35], s53 offen offset:1024 sc0 sc1
v_mfma_f32_16x16x32_bf16 v[112:115], a[64:67], v[140:143], v[112:115]
v_mfma_f32_16x16x32_bf16 v[116:119], a[68:71], v[140:143], v[116:119]
v_mfma_f32_16x16x32_bf16 v[120:123], a[72:75], v[140:143], v[120:123]
v_mfma_f32_16x16x32_bf16 v[124:127], a[76:79], v[140:143], v[124:127]
s_waitcnt lgkmcnt(2)
v_mfma_f32_16x16x32_bf16 v[96:99], a[80:83], v[144:147], v[96:99]
ds_read_b128 v[136:139], v17 offset:8192
ds_read_b128 v[140:143], v17 offset:12288
v_mfma_f32_16x16x32_bf16 v[100:103], a[84:87], v[144:147], v[100:103]
v_mfma_f32_16x16x32_bf16 v[104:107], a[88:91], v[144:147], v[104:107]
v_mfma_f32_16x16x32_bf16 v[108:111], a[92:95], v[144:147], v[108:111]
v_mfma_f32_16x16x32_bf16 v[112:115], a[80:83], v[148:151], v[112:115]
v_mfma_f32_16x16x32_bf16 v[116:119], a[84:87], v[148:151], v[116:119]
v_mfma_f32_16x16x32_bf16 v[120:123], a[88:91], v[148:151], v[120:123]
v_mfma_f32_16x16x32_bf16 v[124:127], a[92:95], v[148:151], v[124:127]
s_waitcnt lgkmcnt(2)
v_mfma_f32_16x16x32_bf16 v[96:99], a[96:99], v[128:131], v[96:99]
ds_read_b128 v[144:147], v14 offset:16384
ds_read_b128 v[148:151], v14 offset:20480
v_mfma_f32_16x16x32_bf16 v[100:103], a[100:103], v[128:131], v[100:103]
v_mfma_f32_16x16x32_bf16 v[104:107], a[104:107], v[128:131], v[104:107]
v_mfma_f32_16x16x32_bf16 v[108:111], a[108:111], v[128:131], v[108:111]
v_mfma_f32_16x16x32_bf16 v[112:115], a[96:99], v[132:135], v[112:115]
v_mfma_f32_16x16x32_bf16 v[116:119], a[100:103], v[132:135], v[116:119]
v_mfma_f32_16x16x32_bf16 v[120:123], a[104:107], v[132:135], v[120:123]
v_cvt_pk_bf16_f32 v184, v80, v81
v_cvt_pk_bf16_f32 v185, v82, v83
v_mfma_f32_16x16x32_bf16 v[124:127], a[108:111], v[132:135], v[124:127]
s_waitcnt lgkmcnt(2)
v_cvt_pk_bf16_f32 v186, v84, v85
v_mfma_f32_16x16x32_bf16 v[96:99], a[112:115], v[136:139], v[96:99]
ds_read_b128 v[128:131], v15 offset:16384
ds_read_b128 v[132:135], v15 offset:20480
v_mfma_f32_16x16x32_bf16 v[100:103], a[116:119], v[136:139], v[100:103]
v_cvt_pk_bf16_f32 v187, v86, v87
v_mfma_f32_16x16x32_bf16 v[104:107], a[120:123], v[136:139], v[104:107]
buffer_store_dwordx4 v[184:187], v23, s[32:35], s53 offen offset:0 sc0 sc1
v_mfma_f32_16x16x32_bf16 v[108:111], a[124:127], v[136:139], v[108:111]
v_mfma_f32_16x16x32_bf16 v[112:115], a[112:115], v[140:143], v[112:115]
v_mfma_f32_16x16x32_bf16 v[116:119], a[116:119], v[140:143], v[116:119]
v_mfma_f32_16x16x32_bf16 v[120:123], a[120:123], v[140:143], v[120:123]
v_mfma_f32_16x16x32_bf16 v[124:127], a[124:127], v[140:143], v[124:127]
s_waitcnt lgkmcnt(2)
v_mfma_f32_16x16x32_bf16 v[96:99], a[128:131], v[144:147], v[96:99]
ds_read_b128 v[136:139], v16 offset:16384
ds_read_b128 v[140:143], v16 offset:20480
v_mfma_f32_16x16x32_bf16 v[100:103], a[132:135], v[144:147], v[100:103]
v_mfma_f32_16x16x32_bf16 v[104:107], a[136:139], v[144:147], v[104:107]
v_mfma_f32_16x16x32_bf16 v[108:111], a[140:143], v[144:147], v[108:111]
v_mfma_f32_16x16x32_bf16 v[112:115], a[128:131], v[148:151], v[112:115]
v_mfma_f32_16x16x32_bf16 v[116:119], a[132:135], v[148:151], v[116:119]
v_mfma_f32_16x16x32_bf16 v[120:123], a[136:139], v[148:151], v[120:123]
v_mfma_f32_16x16x32_bf16 v[124:127], a[140:143], v[148:151], v[124:127]
s_waitcnt lgkmcnt(2)
v_mfma_f32_16x16x32_bf16 v[96:99], a[144:147], v[128:131], v[96:99]
ds_read_b128 v[144:147], v17 offset:16384
ds_read_b128 v[148:151], v17 offset:20480
v_mfma_f32_16x16x32_bf16 v[100:103], a[148:151], v[128:131], v[100:103]
v_mfma_f32_16x16x32_bf16 v[104:107], a[152:155], v[128:131], v[104:107]
v_mfma_f32_16x16x32_bf16 v[108:111], a[156:159], v[128:131], v[108:111]
v_mfma_f32_16x16x32_bf16 v[112:115], a[144:147], v[132:135], v[112:115]
v_cvt_pk_bf16_f32 v188, v88, v89
v_cvt_pk_bf16_f32 v189, v90, v91
v_mfma_f32_16x16x32_bf16 v[116:119], a[148:151], v[132:135], v[116:119]
v_cvt_pk_bf16_f32 v190, v92, v93
v_cvt_pk_bf16_f32 v191, v94, v95
v_mfma_f32_16x16x32_bf16 v[120:123], a[152:155], v[132:135], v[120:123]
buffer_store_dwordx4 v[188:191], v23, s[32:35], s53 offen offset:1024 sc0 sc1
v_mfma_f32_16x16x32_bf16 v[124:127], a[156:159], v[132:135], v[124:127]
s_waitcnt lgkmcnt(2)
v_mfma_f32_16x16x32_bf16 v[96:99], a[160:163], v[136:139], v[96:99]
ds_read_b128 v[128:131], v14 offset:24576
ds_read_b128 v[132:135], v14 offset:28672
v_mfma_f32_16x16x32_bf16 v[100:103], a[164:167], v[136:139], v[100:103]
v_mfma_f32_16x16x32_bf16 v[104:107], a[168:171], v[136:139], v[104:107]
v_mfma_f32_16x16x32_bf16 v[108:111], a[172:175], v[136:139], v[108:111]
v_mfma_f32_16x16x32_bf16 v[112:115], a[160:163], v[140:143], v[112:115]
v_mfma_f32_16x16x32_bf16 v[116:119], a[164:167], v[140:143], v[116:119]
v_mfma_f32_16x16x32_bf16 v[120:123], a[168:171], v[140:143], v[120:123]
v_mfma_f32_16x16x32_bf16 v[124:127], a[172:175], v[140:143], v[124:127]
s_waitcnt lgkmcnt(2)
v_mfma_f32_16x16x32_bf16 v[96:99], a[176:179], v[144:147], v[96:99]
ds_read_b128 v[136:139], v15 offset:24576
ds_read_b128 v[140:143], v15 offset:28672
v_mfma_f32_16x16x32_bf16 v[100:103], a[180:183], v[144:147], v[100:103]
v_mfma_f32_16x16x32_bf16 v[104:107], a[184:187], v[144:147], v[104:107]
v_mfma_f32_16x16x32_bf16 v[108:111], a[188:191], v[144:147], v[108:111]
v_mfma_f32_16x16x32_bf16 v[112:115], a[176:179], v[148:151], v[112:115]
v_mfma_f32_16x16x32_bf16 v[116:119], a[180:183], v[148:151], v[116:119]
v_mfma_f32_16x16x32_bf16 v[120:123], a[184:187], v[148:151], v[120:123]
v_mfma_f32_16x16x32_bf16 v[124:127], a[188:191], v[148:151], v[124:127]
s_waitcnt lgkmcnt(2)
v_mfma_f32_16x16x32_bf16 v[96:99], a[192:195], v[128:131], v[96:99]
ds_read_b128 v[144:147], v16 offset:24576
ds_read_b128 v[148:151], v16 offset:28672
v_mfma_f32_16x16x32_bf16 v[100:103], a[196:199], v[128:131], v[100:103]
v_mfma_f32_16x16x32_bf16 v[104:107], a[200:203], v[128:131], v[104:107]
v_mfma_f32_16x16x32_bf16 v[108:111], a[204:207], v[128:131], v[108:111]
v_mfma_f32_16x16x32_bf16 v[112:115], a[192:195], v[132:135], v[112:115]
v_mfma_f32_16x16x32_bf16 v[116:119], a[196:199], v[132:135], v[116:119]
v_mfma_f32_16x16x32_bf16 v[120:123], a[200:203], v[132:135], v[120:123]
v_mfma_f32_16x16x32_bf16 v[124:127], a[204:207], v[132:135], v[124:127]
s_waitcnt lgkmcnt(2)
v_mfma_f32_16x16x32_bf16 v[96:99], a[208:211], v[136:139], v[96:99]
ds_read_b128 v[128:131], v17 offset:24576
ds_read_b128 v[132:135], v17 offset:28672
v_mfma_f32_16x16x32_bf16 v[100:103], a[212:215], v[136:139], v[100:103]
v_mfma_f32_16x16x32_bf16 v[104:107], a[216:219], v[136:139], v[104:107]
v_mfma_f32_16x16x32_bf16 v[108:111], a[220:223], v[136:139], v[108:111]
s_waitcnt vmcnt(18)
v_mfma_f32_16x16x32_bf16 v[112:115], a[208:211], v[140:143], v[112:115]
s_barrier
v_mfma_f32_16x16x32_bf16 v[116:119], a[212:215], v[140:143], v[116:119]
v_mfma_f32_16x16x32_bf16 v[120:123], a[216:219], v[140:143], v[120:123]
v_mfma_f32_16x16x32_bf16 v[124:127], a[220:223], v[140:143], v[124:127]
s_waitcnt lgkmcnt(2)
v_mfma_f32_16x16x32_bf16 v[96:99], a[224:227], v[144:147], v[96:99]
ds_read_b128 v[136:139], v14 offset:32768
ds_read_b128 v[140:143], v14 offset:36864
v_mfma_f32_16x16x32_bf16 v[100:103], a[228:231], v[144:147], v[100:103]
v_mfma_f32_16x16x32_bf16 v[104:107], a[232:235], v[144:147], v[104:107]
v_mfma_f32_16x16x32_bf16 v[108:111], a[236:239], v[144:147], v[108:111]
v_mfma_f32_16x16x32_bf16 v[112:115], a[224:227], v[148:151], v[112:115]
v_mfma_f32_16x16x32_bf16 v[116:119], a[228:231], v[148:151], v[116:119]
v_mfma_f32_16x16x32_bf16 v[120:123], a[232:235], v[148:151], v[120:123]
v_mfma_f32_16x16x32_bf16 v[124:127], a[236:239], v[148:151], v[124:127]
s_waitcnt lgkmcnt(2)
v_mfma_f32_16x16x32_bf16 v[96:99], a[240:243], v[128:131], v[96:99]
ds_read_b128 v[144:147], v15 offset:32768
ds_read_b128 v[148:151], v15 offset:36864
v_mfma_f32_16x16x32_bf16 v[100:103], a[244:247], v[128:131], v[100:103]
v_mfma_f32_16x16x32_bf16 v[104:107], a[248:251], v[128:131], v[104:107]
v_mfma_f32_16x16x32_bf16 v[108:111], a[252:255], v[128:131], v[108:111]
v_mfma_f32_16x16x32_bf16 v[112:115], a[240:243], v[132:135], v[112:115]
v_mfma_f32_16x16x32_bf16 v[116:119], a[244:247], v[132:135], v[116:119]
v_mfma_f32_16x16x32_bf16 v[120:123], a[248:251], v[132:135], v[120:123]
v_mfma_f32_16x16x32_bf16 v[124:127], a[252:255], v[132:135], v[124:127]
s_waitcnt lgkmcnt(2)
v_mfma_f32_16x16x32_bf16 v[32:35], a[0:3], v[136:139], 0
ds_read_b128 v[128:131], v16 offset:32768
ds_read_b128 v[132:135], v16 offset:36864
v_mfma_f32_16x16x32_bf16 v[36:39], a[4:7], v[136:139], 0
v_mfma_f32_16x16x32_bf16 v[40:43], a[8:11], v[136:139], 0
v_mfma_f32_16x16x32_bf16 v[44:47], a[12:15], v[136:139], 0
v_mfma_f32_16x16x32_bf16 v[48:51], a[0:3], v[140:143], 0
v_mfma_f32_16x16x32_bf16 v[52:55], a[4:7], v[140:143], 0
v_mfma_f32_16x16x32_bf16 v[56:59], a[8:11], v[140:143], 0
v_mfma_f32_16x16x32_bf16 v[60:63], a[12:15], v[140:143], 0
s_waitcnt lgkmcnt(2)
v_mfma_f32_16x16x32_bf16 v[32:35], a[16:19], v[144:147], v[32:35]
ds_read_b128 v[136:139], v17 offset:32768
ds_read_b128 v[140:143], v17 offset:36864
v_mfma_f32_16x16x32_bf16 v[36:39], a[20:23], v[144:147], v[36:39]
s_add_u32 s54, s44, 81920
v_mfma_f32_16x16x32_bf16 v[40:43], a[24:27], v[144:147], v[40:43]
v_cvt_pk_bf16_f32 v160, v96, v97
v_cvt_pk_bf16_f32 v161, v98, v99
v_mfma_f32_16x16x32_bf16 v[44:47], a[28:31], v[144:147], v[44:47]
v_cvt_pk_bf16_f32 v162, v100, v101
v_cvt_pk_bf16_f32 v163, v102, v103
v_mfma_f32_16x16x32_bf16 v[48:51], a[16:19], v[148:151], v[48:51]
buffer_store_dwordx4 v[160:163], v22, s[32:35], s54 offen offset:0 sc0 sc1
v_mfma_f32_16x16x32_bf16 v[52:55], a[20:23], v[148:151], v[52:55]
v_mfma_f32_16x16x32_bf16 v[56:59], a[24:27], v[148:151], v[56:59]
v_mfma_f32_16x16x32_bf16 v[60:63], a[28:31], v[148:151], v[60:63]
s_waitcnt lgkmcnt(2)
v_mfma_f32_16x16x32_bf16 v[32:35], a[32:35], v[128:131], v[32:35]
ds_read_b128 v[144:147], v14 offset:40960
ds_read_b128 v[148:151], v14 offset:45056
v_mfma_f32_16x16x32_bf16 v[36:39], a[36:39], v[128:131], v[36:39]
v_mfma_f32_16x16x32_bf16 v[40:43], a[40:43], v[128:131], v[40:43]
v_mfma_f32_16x16x32_bf16 v[44:47], a[44:47], v[128:131], v[44:47]
v_mfma_f32_16x16x32_bf16 v[48:51], a[32:35], v[132:135], v[48:51]
v_mfma_f32_16x16x32_bf16 v[52:55], a[36:39], v[132:135], v[52:55]
v_mfma_f32_16x16x32_bf16 v[56:59], a[40:43], v[132:135], v[56:59]
v_mfma_f32_16x16x32_bf16 v[60:63], a[44:47], v[132:135], v[60:63]
s_waitcnt lgkmcnt(2)
v_mfma_f32_16x16x32_bf16 v[32:35], a[48:51], v[136:139], v[32:35]
ds_read_b128 v[128:131], v15 offset:40960
ds_read_b128 v[132:135], v15 offset:45056
v_mfma_f32_16x16x32_bf16 v[36:39], a[52:55], v[136:139], v[36:39]
v_mfma_f32_16x16x32_bf16 v[40:43], a[56:59], v[136:139], v[40:43]
v_mfma_f32_16x16x32_bf16 v[44:47], a[60:63], v[136:139], v[44:47]
v_mfma_f32_16x16x32_bf16 v[48:51], a[48:51], v[140:143], v[48:51]
v_mfma_f32_16x16x32_bf16 v[52:55], a[52:55], v[140:143], v[52:55]
v_mfma_f32_16x16x32_bf16 v[56:59], a[56:59], v[140:143], v[56:59]
v_mfma_f32_16x16x32_bf16 v[60:63], a[60:63], v[140:143], v[60:63]
s_waitcnt lgkmcnt(2)
v_mfma_f32_16x16x32_bf16 v[32:35], a[64:67], v[144:147], v[32:35]
ds_read_b128 v[136:139], v16 offset:40960
ds_read_b128 v[140:143], v16 offset:45056
v_mfma_f32_16x16x32_bf16 v[36:39], a[68:71], v[144:147], v[36:39]
v_cvt_pk_bf16_f32 v164, v104, v105
v_cvt_pk_bf16_f32 v165, v106, v107
v_mfma_f32_16x16x32_bf16 v[40:43], a[72:75], v[144:147], v[40:43]
v_cvt_pk_bf16_f32 v166, v108, v109
v_cvt_pk_bf16_f32 v167, v110, v111
v_mfma_f32_16x16x32_bf16 v[44:47], a[76:79], v[144:147], v[44:47]
buffer_store_dwordx4 v[164:167], v22, s[32:35], s54 offen offset:1024 sc0 sc1
v_mfma_f32_16x16x32_bf16 v[48:51], a[64:67], v[148:151], v[48:51]
v_mfma_f32_16x16x32_bf16 v[52:55], a[68:71], v[148:151], v[52:55]
v_mfma_f32_16x16x32_bf16 v[56:59], a[72:75], v[148:151], v[56:59]
v_mfma_f32_16x16x32_bf16 v[60:63], a[76:79], v[148:151], v[60:63]
s_waitcnt lgkmcnt(2)
v_mfma_f32_16x16x32_bf16 v[32:35], a[80:83], v[128:131], v[32:35]
ds_read_b128 v[144:147], v17 offset:40960
ds_read_b128 v[148:151], v17 offset:45056
v_mfma_f32_16x16x32_bf16 v[36:39], a[84:87], v[128:131], v[36:39]
v_mfma_f32_16x16x32_bf16 v[40:43], a[88:91], v[128:131], v[40:43]
v_mfma_f32_16x16x32_bf16 v[44:47], a[92:95], v[128:131], v[44:47]
v_mfma_f32_16x16x32_bf16 v[48:51], a[80:83], v[132:135], v[48:51]
v_mfma_f32_16x16x32_bf16 v[52:55], a[84:87], v[132:135], v[52:55]
v_mfma_f32_16x16x32_bf16 v[56:59], a[88:91], v[132:135], v[56:59]
v_mfma_f32_16x16x32_bf16 v[60:63], a[92:95], v[132:135], v[60:63]
s_waitcnt lgkmcnt(2)
v_mfma_f32_16x16x32_bf16 v[32:35], a[96:99], v[136:139], v[32:35]
ds_read_b128 v[128:131], v14 offset:49152
ds_read_b128 v[132:135], v14 offset:53248
v_mfma_f32_16x16x32_bf16 v[36:39], a[100:103], v[136:139], v[36:39]
v_mfma_f32_16x16x32_bf16 v[40:43], a[104:107], v[136:139], v[40:43]
v_mfma_f32_16x16x32_bf16 v[44:47], a[108:111], v[136:139], v[44:47]
v_mfma_f32_16x16x32_bf16 v[48:51], a[96:99], v[140:143], v[48:51]
v_mfma_f32_16x16x32_bf16 v[52:55], a[100:103], v[140:143], v[52:55]
v_mfma_f32_16x16x32_bf16 v[56:59], a[104:107], v[140:143], v[56:59]
v_cvt_pk_bf16_f32 v168, v112, v113
v_cvt_pk_bf16_f32 v169, v114, v115
v_mfma_f32_16x16x32_bf16 v[60:63], a[108:111], v[140:143], v[60:63]
s_waitcnt lgkmcnt(2)
v_cvt_pk_bf16_f32 v170, v116, v117
v_mfma_f32_16x16x32_bf16 v[32:35], a[112:115], v[144:147], v[32:35]
ds_read_b128 v[136:139], v15 offset:49152
ds_read_b128 v[140:143], v15 offset:53248
v_mfma_f32_16x16x32_bf16 v[36:39], a[116:119], v[144:147], v[36:39]
v_cvt_pk_bf16_f32 v171, v118, v119
v_mfma_f32_16x16x32_bf16 v[40:43], a[120:123], v[144:147], v[40:43]
buffer_store_dwordx4 v[168:171], v23, s[32:35], s54 offen offset:0 sc0 sc1
v_mfma_f32_16x16x32_bf16 v[44:47], a[124:127], v[144:147], v[44:47]
v_mfma_f32_16x16x32_bf16 v[48:51], a[112:115], v[148:151], v[48:51]
buffer_load_dwordx4 v[224:227], v22, s[56:59], s55 offen offset:0
v_mfma_f32_16x16x32_bf16 v[52:55], a[116:119], v[148:151], v[52:55]
v_mfma_f32_16x16x32_bf16 v[56:59], a[120:123], v[148:151], v[56:59]
v_mfma_f32_16x16x32_bf16 v[60:63], a[124:127], v[148:151], v[60:63]
s_waitcnt lgkmcnt(2)
v_mfma_f32_16x16x32_bf16 v[32:35], a[128:131], v[128:131], v[32:35]
ds_read_b128 v[144:147], v16 offset:49152
ds_read_b128 v[148:151], v16 offset:53248
v_mfma_f32_16x16x32_bf16 v[36:39], a[132:135], v[128:131], v[36:39]
v_mfma_f32_16x16x32_bf16 v[40:43], a[136:139], v[128:131], v[40:43]
v_mfma_f32_16x16x32_bf16 v[44:47], a[140:143], v[128:131], v[44:47]
v_mfma_f32_16x16x32_bf16 v[48:51], a[128:131], v[132:135], v[48:51]
v_mfma_f32_16x16x32_bf16 v[52:55], a[132:135], v[132:135], v[52:55]
buffer_load_dwordx4 v[224:227], v22, s[56:59], s55 offen offset:1024
v_mfma_f32_16x16x32_bf16 v[56:59], a[136:139], v[132:135], v[56:59]
v_mfma_f32_16x16x32_bf16 v[60:63], a[140:143], v[132:135], v[60:63]
s_waitcnt lgkmcnt(2)
v_mfma_f32_16x16x32_bf16 v[32:35], a[144:147], v[136:139], v[32:35]
ds_read_b128 v[128:131], v17 offset:49152
ds_read_b128 v[132:135], v17 offset:53248
v_mfma_f32_16x16x32_bf16 v[36:39], a[148:151], v[136:139], v[36:39]
v_mfma_f32_16x16x32_bf16 v[40:43], a[152:155], v[136:139], v[40:43]
v_mfma_f32_16x16x32_bf16 v[44:47], a[156:159], v[136:139], v[44:47]
v_mfma_f32_16x16x32_bf16 v[48:51], a[144:147], v[140:143], v[48:51]
v_cvt_pk_bf16_f32 v172, v120, v121
v_cvt_pk_bf16_f32 v173, v122, v123
v_mfma_f32_16x16x32_bf16 v[52:55], a[148:151], v[140:143], v[52:55]
v_cvt_pk_bf16_f32 v174, v124, v125
v_cvt_pk_bf16_f32 v175, v126, v127
v_mfma_f32_16x16x32_bf16 v[56:59], a[152:155], v[140:143], v[56:59]
buffer_store_dwordx4 v[172:175], v23, s[32:35], s54 offen offset:1024 sc0 sc1
v_mfma_f32_16x16x32_bf16 v[60:63], a[156:159], v[140:143], v[60:63]
s_waitcnt lgkmcnt(2)
v_mfma_f32_16x16x32_bf16 v[32:35], a[160:163], v[144:147], v[32:35]
ds_read_b128 v[136:139], v14 offset:57344
ds_read_b128 v[140:143], v14 offset:61440
v_mfma_f32_16x16x32_bf16 v[36:39], a[164:167], v[144:147], v[36:39]
buffer_load_dwordx4 v[224:227], v22, s[56:59], s55 offen offset:2048
v_mfma_f32_16x16x32_bf16 v[40:43], a[168:171], v[144:147], v[40:43]
v_mfma_f32_16x16x32_bf16 v[44:47], a[172:175], v[144:147], v[44:47]
v_mfma_f32_16x16x32_bf16 v[48:51], a[160:163], v[148:151], v[48:51]
v_mfma_f32_16x16x32_bf16 v[52:55], a[164:167], v[148:151], v[52:55]
v_mfma_f32_16x16x32_bf16 v[56:59], a[168:171], v[148:151], v[56:59]
v_mfma_f32_16x16x32_bf16 v[60:63], a[172:175], v[148:151], v[60:63]
s_waitcnt lgkmcnt(2)
v_mfma_f32_16x16x32_bf16 v[32:35], a[176:179], v[128:131], v[32:35]
ds_read_b128 v[144:147], v15 offset:57344
ds_read_b128 v[148:151], v15 offset:61440
v_mfma_f32_16x16x32_bf16 v[36:39], a[180:183], v[128:131], v[36:39]
buffer_load_dwordx4 v[224:227], v22, s[56:59], s55 offen offset:3072
v_mfma_f32_16x16x32_bf16 v[40:43], a[184:187], v[128:131], v[40:43]
v_mfma_f32_16x16x32_bf16 v[44:47], a[188:191], v[128:131], v[44:47]
v_mfma_f32_16x16x32_bf16 v[48:51], a[176:179], v[132:135], v[48:51]
v_mfma_f32_16x16x32_bf16 v[52:55], a[180:183], v[132:135], v[52:55]
v_mfma_f32_16x16x32_bf16 v[56:59], a[184:187], v[132:135], v[56:59]
v_mfma_f32_16x16x32_bf16 v[60:63], a[188:191], v[132:135], v[60:63]
s_waitcnt lgkmcnt(2)
v_mfma_f32_16x16x32_bf16 v[32:35], a[192:195], v[136:139], v[32:35]
ds_read_b128 v[128:131], v16 offset:57344
ds_read_b128 v[132:135], v16 offset:61440
v_mfma_f32_16x16x32_bf16 v[36:39], a[196:199], v[136:139], v[36:39]
v_mfma_f32_16x16x32_bf16 v[40:43], a[200:203], v[136:139], v[40:43]
v_mfma_f32_16x16x32_bf16 v[44:47], a[204:207], v[136:139], v[44:47]
v_mfma_f32_16x16x32_bf16 v[48:51], a[192:195], v[140:143], v[48:51]
v_mfma_f32_16x16x32_bf16 v[52:55], a[196:199], v[140:143], v[52:55]
v_mfma_f32_16x16x32_bf16 v[56:59], a[200:203], v[140:143], v[56:59]
v_mfma_f32_16x16x32_bf16 v[60:63], a[204:207], v[140:143], v[60:63]
s_waitcnt lgkmcnt(2)
v_mfma_f32_16x16x32_bf16 v[32:35], a[208:211], v[144:147], v[32:35]
ds_read_b128 v[136:139], v17 offset:57344
ds_read_b128 v[140:143], v17 offset:61440
v_mfma_f32_16x16x32_bf16 v[36:39], a[212:215], v[144:147], v[36:39]
v_mfma_f32_16x16x32_bf16 v[40:43], a[216:219], v[144:147], v[40:43]
v_mfma_f32_16x16x32_bf16 v[44:47], a[220:223], v[144:147], v[44:47]
s_waitcnt vmcnt(12)
v_mfma_f32_16x16x32_bf16 v[48:51], a[208:211], v[148:151], v[48:51]
s_barrier
v_mfma_f32_16x16x32_bf16 v[52:55], a[212:215], v[148:151], v[52:55]
v_mfma_f32_16x16x32_bf16 v[56:59], a[216:219], v[148:151], v[56:59]
v_mfma_f32_16x16x32_bf16 v[60:63], a[220:223], v[148:151], v[60:63]
s_waitcnt lgkmcnt(2)
v_mfma_f32_16x16x32_bf16 v[32:35], a[224:227], v[128:131], v[32:35]
ds_read_b128 v[144:147], v18 offset:0
ds_read_b128 v[148:151], v18 offset:4096
v_mfma_f32_16x16x32_bf16 v[36:39], a[228:231], v[128:131], v[36:39]
v_mfma_f32_16x16x32_bf16 v[40:43], a[232:235], v[128:131], v[40:43]
v_mfma_f32_16x16x32_bf16 v[44:47], a[236:239], v[128:131], v[44:47]
v_mfma_f32_16x16x32_bf16 v[48:51], a[224:227], v[132:135], v[48:51]
v_mfma_f32_16x16x32_bf16 v[52:55], a[228:231], v[132:135], v[52:55]
v_mfma_f32_16x16x32_bf16 v[56:59], a[232:235], v[132:135], v[56:59]
v_mfma_f32_16x16x32_bf16 v[60:63], a[236:239], v[132:135], v[60:63]
s_waitcnt lgkmcnt(2)
v_mfma_f32_16x16x32_bf16 v[32:35], a[240:243], v[136:139], v[32:35]
ds_read_b128 v[128:131], v19 offset:0
ds_read_b128 v[132:135], v19 offset:4096
v_mfma_f32_16x16x32_bf16 v[36:39], a[244:247], v[136:139], v[36:39]
v_mfma_f32_16x16x32_bf16 v[40:43], a[248:251], v[136:139], v[40:43]
v_mfma_f32_16x16x32_bf16 v[44:47], a[252:255], v[136:139], v[44:47]
v_mfma_f32_16x16x32_bf16 v[48:51], a[240:243], v[140:143], v[48:51]
v_mfma_f32_16x16x32_bf16 v[52:55], a[244:247], v[140:143], v[52:55]
v_mfma_f32_16x16x32_bf16 v[56:59], a[248:251], v[140:143], v[56:59]
v_mfma_f32_16x16x32_bf16 v[60:63], a[252:255], v[140:143], v[60:63]
s_waitcnt lgkmcnt(2)
v_mfma_f32_16x16x32_bf16 v[64:67], a[0:3], v[144:147], 0
ds_read_b128 v[136:139], v20 offset:0
ds_read_b128 v[140:143], v20 offset:4096
v_mfma_f32_16x16x32_bf16 v[68:71], a[4:7], v[144:147], 0
v_mfma_f32_16x16x32_bf16 v[72:75], a[8:11], v[144:147], 0
v_mfma_f32_16x16x32_bf16 v[76:79], a[12:15], v[144:147], 0
v_mfma_f32_16x16x32_bf16 v[80:83], a[0:3], v[148:151], 0
v_mfma_f32_16x16x32_bf16 v[84:87], a[4:7], v[148:151], 0
v_mfma_f32_16x16x32_bf16 v[88:91], a[8:11], v[148:151], 0
v_mfma_f32_16x16x32_bf16 v[92:95], a[12:15], v[148:151], 0
s_waitcnt lgkmcnt(2)
v_mfma_f32_16x16x32_bf16 v[64:67], a[16:19], v[128:131], v[64:67]
ds_read_b128 v[144:147], v21 offset:0
ds_read_b128 v[148:151], v21 offset:4096
v_mfma_f32_16x16x32_bf16 v[68:71], a[20:23], v[128:131], v[68:71]
s_add_u32 s53, s44, 98304
v_mfma_f32_16x16x32_bf16 v[72:75], a[24:27], v[128:131], v[72:75]
v_cvt_pk_bf16_f32 v176, v32, v33
v_cvt_pk_bf16_f32 v177, v34, v35
v_mfma_f32_16x16x32_bf16 v[76:79], a[28:31], v[128:131], v[76:79]
v_cvt_pk_bf16_f32 v178, v36, v37
v_cvt_pk_bf16_f32 v179, v38, v39
v_mfma_f32_16x16x32_bf16 v[80:83], a[16:19], v[132:135], v[80:83]
buffer_store_dwordx4 v[176:179], v22, s[32:35], s53 offen offset:0 sc0 sc1
v_mfma_f32_16x16x32_bf16 v[84:87], a[20:23], v[132:135], v[84:87]
v_mfma_f32_16x16x32_bf16 v[88:91], a[24:27], v[132:135], v[88:91]
v_mfma_f32_16x16x32_bf16 v[92:95], a[28:31], v[132:135], v[92:95]
s_waitcnt lgkmcnt(2)
v_mfma_f32_16x16x32_bf16 v[64:67], a[32:35], v[136:139], v[64:67]
ds_read_b128 v[128:131], v18 offset:8192
ds_read_b128 v[132:135], v18 offset:12288
v_mfma_f32_16x16x32_bf16 v[68:71], a[36:39], v[136:139], v[68:71]
v_mfma_f32_16x16x32_bf16 v[72:75], a[40:43], v[136:139], v[72:75]
v_mfma_f32_16x16x32_bf16 v[76:79], a[44:47], v[136:139], v[76:79]
v_mfma_f32_16x16x32_bf16 v[80:83], a[32:35], v[140:143], v[80:83]
v_mfma_f32_16x16x32_bf16 v[84:87], a[36:39], v[140:143], v[84:87]
v_mfma_f32_16x16x32_bf16 v[88:91], a[40:43], v[140:143], v[88:91]
v_mfma_f32_16x16x32_bf16 v[92:95], a[44:47], v[140:143], v[92:95]
s_waitcnt lgkmcnt(2)
v_mfma_f32_16x16x32_bf16 v[64:67], a[48:51], v[144:147], v[64:67]
ds_read_b128 v[136:139], v19 offset:8192
ds_read_b128 v[140:143], v19 offset:12288
v_mfma_f32_16x16x32_bf16 v[68:71], a[52:55], v[144:147], v[68:71]
v_mfma_f32_16x16x32_bf16 v[72:75], a[56:59], v[144:147], v[72:75]
v_mfma_f32_16x16x32_bf16 v[76:79], a[60:63], v[144:147], v[76:79]
v_mfma_f32_16x16x32_bf16 v[80:83], a[48:51], v[148:151], v[80:83]
v_mfma_f32_16x16x32_bf16 v[84:87], a[52:55], v[148:151], v[84:87]
v_mfma_f32_16x16x32_bf16 v[88:91], a[56:59], v[148:151], v[88:91]
v_mfma_f32_16x16x32_bf16 v[92:95], a[60:63], v[148:151], v[92:95]
s_waitcnt lgkmcnt(2)
v_mfma_f32_16x16x32_bf16 v[64:67], a[64:67], v[128:131], v[64:67]
ds_read_b128 v[144:147], v20 offset:8192
ds_read_b128 v[148:151], v20 offset:12288
v_mfma_f32_16x16x32_bf16 v[68:71], a[68:71], v[128:131], v[68:71]
v_cvt_pk_bf16_f32 v180, v40, v41
v_cvt_pk_bf16_f32 v181, v42, v43
v_mfma_f32_16x16x32_bf16 v[72:75], a[72:75], v[128:131], v[72:75]
v_cvt_pk_bf16_f32 v182, v44, v45
v_cvt_pk_bf16_f32 v183, v46, v47
v_mfma_f32_16x16x32_bf16 v[76:79], a[76:79], v[128:131], v[76:79]
buffer_store_dwordx4 v[180:183], v22, s[32:35], s53 offen offset:1024 sc0 sc1
v_mfma_f32_16x16x32_bf16 v[80:83], a[64:67], v[132:135], v[80:83]
v_mfma_f32_16x16x32_bf16 v[84:87], a[68:71], v[132:135], v[84:87]
v_mfma_f32_16x16x32_bf16 v[88:91], a[72:75], v[132:135], v[88:91]
v_mfma_f32_16x16x32_bf16 v[92:95], a[76:79], v[132:135], v[92:95]
s_waitcnt lgkmcnt(2)
v_mfma_f32_16x16x32_bf16 v[64:67], a[80:83], v[136:139], v[64:67]
ds_read_b128 v[128:131], v21 offset:8192
ds_read_b128 v[132:135], v21 offset:12288
v_mfma_f32_16x16x32_bf16 v[68:71], a[84:87], v[136:139], v[68:71]
v_mfma_f32_16x16x32_bf16 v[72:75], a[88:91], v[136:139], v[72:75]
v_mfma_f32_16x16x32_bf16 v[76:79], a[92:95], v[136:139], v[76:79]
v_mfma_f32_16x16x32_bf16 v[80:83], a[80:83], v[140:143], v[80:83]
v_mfma_f32_16x16x32_bf16 v[84:87], a[84:87], v[140:143], v[84:87]
v_mfma_f32_16x16x32_bf16 v[88:91], a[88:91], v[140:143], v[88:91]
v_mfma_f32_16x16x32_bf16 v[92:95], a[92:95], v[140:143], v[92:95]
s_waitcnt lgkmcnt(2)
v_mfma_f32_16x16x32_bf16 v[64:67], a[96:99], v[144:147], v[64:67]
ds_read_b128 v[136:139], v18 offset:16384
ds_read_b128 v[140:143], v18 offset:20480
v_mfma_f32_16x16x32_bf16 v[68:71], a[100:103], v[144:147], v[68:71]
v_mfma_f32_16x16x32_bf16 v[72:75], a[104:107], v[144:147], v[72:75]
v_mfma_f32_16x16x32_bf16 v[76:79], a[108:111], v[144:147], v[76:79]
v_mfma_f32_16x16x32_bf16 v[80:83], a[96:99], v[148:151], v[80:83]
v_mfma_f32_16x16x32_bf16 v[84:87], a[100:103], v[148:151], v[84:87]
v_mfma_f32_16x16x32_bf16 v[88:91], a[104:107], v[148:151], v[88:91]
v_cvt_pk_bf16_f32 v184, v48, v49
v_cvt_pk_bf16_f32 v185, v50, v51
v_mfma_f32_16x16x32_bf16 v[92:95], a[108:111], v[148:151], v[92:95]
s_waitcnt lgkmcnt(2)
v_cvt_pk_bf16_f32 v186, v52, v53
v_mfma_f32_16x16x32_bf16 v[64:67], a[112:115], v[128:131], v[64:67]
ds_read_b128 v[144:147], v19 offset:16384
ds_read_b128 v[148:151], v19 offset:20480
v_mfma_f32_16x16x32_bf16 v[68:71], a[116:119], v[128:131], v[68:71]
v_cvt_pk_bf16_f32 v187, v54, v55
v_mfma_f32_16x16x32_bf16 v[72:75], a[120:123], v[128:131], v[72:75]
buffer_store_dwordx4 v[184:187], v23, s[32:35], s53 offen offset:0 sc0 sc1
v_mfma_f32_16x16x32_bf16 v[76:79], a[124:127], v[128:131], v[76:79]
v_mfma_f32_16x16x32_bf16 v[80:83], a[112:115], v[132:135], v[80:83]
v_mfma_f32_16x16x32_bf16 v[84:87], a[116:119], v[132:135], v[84:87]
v_mfma_f32_16x16x32_bf16 v[88:91], a[120:123], v[132:135], v[88:91]
v_mfma_f32_16x16x32_bf16 v[92:95], a[124:127], v[132:135], v[92:95]
s_waitcnt lgkmcnt(2)
v_mfma_f32_16x16x32_bf16 v[64:67], a[128:131], v[136:139], v[64:67]
ds_read_b128 v[128:131], v20 offset:16384
ds_read_b128 v[132:135], v20 offset:20480
v_mfma_f32_16x16x32_bf16 v[68:71], a[132:135], v[136:139], v[68:71]
v_mfma_f32_16x16x32_bf16 v[72:75], a[136:139], v[136:139], v[72:75]
v_mfma_f32_16x16x32_bf16 v[76:79], a[140:143], v[136:139], v[76:79]
v_mfma_f32_16x16x32_bf16 v[80:83], a[128:131], v[140:143], v[80:83]
v_mfma_f32_16x16x32_bf16 v[84:87], a[132:135], v[140:143], v[84:87]
v_mfma_f32_16x16x32_bf16 v[88:91], a[136:139], v[140:143], v[88:91]
v_mfma_f32_16x16x32_bf16 v[92:95], a[140:143], v[140:143], v[92:95]
s_waitcnt lgkmcnt(2)
v_mfma_f32_16x16x32_bf16 v[64:67], a[144:147], v[144:147], v[64:67]
ds_read_b128 v[136:139], v21 offset:16384
ds_read_b128 v[140:143], v21 offset:20480
v_mfma_f32_16x16x32_bf16 v[68:71], a[148:151], v[144:147], v[68:71]
v_mfma_f32_16x16x32_bf16 v[72:75], a[152:155], v[144:147], v[72:75]
v_mfma_f32_16x16x32_bf16 v[76:79], a[156:159], v[144:147], v[76:79]
v_mfma_f32_16x16x32_bf16 v[80:83], a[144:147], v[148:151], v[80:83]
v_cvt_pk_bf16_f32 v188, v56, v57
v_cvt_pk_bf16_f32 v189, v58, v59
v_mfma_f32_16x16x32_bf16 v[84:87], a[148:151], v[148:151], v[84:87]
v_cvt_pk_bf16_f32 v190, v60, v61
v_cvt_pk_bf16_f32 v191, v62, v63
v_mfma_f32_16x16x32_bf16 v[88:91], a[152:155], v[148:151], v[88:91]
buffer_store_dwordx4 v[188:191], v23, s[32:35], s53 offen offset:1024 sc0 sc1
v_mfma_f32_16x16x32_bf16 v[92:95], a[156:159], v[148:151], v[92:95]
s_waitcnt lgkmcnt(2)
v_mfma_f32_16x16x32_bf16 v[64:67], a[160:163], v[128:131], v[64:67]
ds_read_b128 v[144:147], v18 offset:24576
ds_read_b128 v[148:151], v18 offset:28672
v_mfma_f32_16x16x32_bf16 v[68:71], a[164:167], v[128:131], v[68:71]
v_mfma_f32_16x16x32_bf16 v[72:75], a[168:171], v[128:131], v[72:75]
v_mfma_f32_16x16x32_bf16 v[76:79], a[172:175], v[128:131], v[76:79]
v_mfma_f32_16x16x32_bf16 v[80:83], a[160:163], v[132:135], v[80:83]
v_mfma_f32_16x16x32_bf16 v[84:87], a[164:167], v[132:135], v[84:87]
v_mfma_f32_16x16x32_bf16 v[88:91], a[168:171], v[132:135], v[88:91]
v_mfma_f32_16x16x32_bf16 v[92:95], a[172:175], v[132:135], v[92:95]
s_waitcnt lgkmcnt(2)
v_mfma_f32_16x16x32_bf16 v[64:67], a[176:179], v[136:139], v[64:67]
ds_read_b128 v[128:131], v19 offset:24576
ds_read_b128 v[132:135], v19 offset:28672
v_mfma_f32_16x16x32_bf16 v[68:71], a[180:183], v[136:139], v[68:71]
v_mfma_f32_16x16x32_bf16 v[72:75], a[184:187], v[136:139], v[72:75]
v_mfma_f32_16x16x32_bf16 v[76:79], a[188:191], v[136:139], v[76:79]
v_mfma_f32_16x16x32_bf16 v[80:83], a[176:179], v[140:143], v[80:83]
v_mfma_f32_16x16x32_bf16 v[84:87], a[180:183], v[140:143], v[84:87]
v_mfma_f32_16x16x32_bf16 v[88:91], a[184:187], v[140:143], v[88:91]
v_mfma_f32_16x16x32_bf16 v[92:95], a[188:191], v[140:143], v[92:95]
s_waitcnt lgkmcnt(2)
v_mfma_f32_16x16x32_bf16 v[64:67], a[192:195], v[144:147], v[64:67]
ds_read_b128 v[136:139], v20 offset:24576
ds_read_b128 v[140:143], v20 offset:28672
v_mfma_f32_16x16x32_bf16 v[68:71], a[196:199], v[144:147], v[68:71]
v_mfma_f32_16x16x32_bf16 v[72:75], a[200:203], v[144:147], v[72:75]
v_mfma_f32_16x16x32_bf16 v[76:79], a[204:207], v[144:147], v[76:79]
v_mfma_f32_16x16x32_bf16 v[80:83], a[192:195], v[148:151], v[80:83]
v_mfma_f32_16x16x32_bf16 v[84:87], a[196:199], v[148:151], v[84:87]
v_mfma_f32_16x16x32_bf16 v[88:91], a[200:203], v[148:151], v[88:91]
v_mfma_f32_16x16x32_bf16 v[92:95], a[204:207], v[148:151], v[92:95]
s_waitcnt lgkmcnt(2)
v_mfma_f32_16x16x32_bf16 v[64:67], a[208:211], v[128:131], v[64:67]
ds_read_b128 v[144:147], v21 offset:24576
ds_read_b128 v[148:151], v21 offset:28672
v_mfma_f32_16x16x32_bf16 v[68:71], a[212:215], v[128:131], v[68:71]
v_mfma_f32_16x16x32_bf16 v[72:75], a[216:219], v[128:131], v[72:75]
v_mfma_f32_16x16x32_bf16 v[76:79], a[220:223], v[128:131], v[76:79]
v_mfma_f32_16x16x32_bf16 v[80:83], a[208:211], v[132:135], v[80:83]
v_mfma_f32_16x16x32_bf16 v[84:87], a[212:215], v[132:135], v[84:87]
v_mfma_f32_16x16x32_bf16 v[88:91], a[216:219], v[132:135], v[88:91]
v_mfma_f32_16x16x32_bf16 v[92:95], a[220:223], v[132:135], v[92:95]
s_waitcnt lgkmcnt(2)
v_mfma_f32_16x16x32_bf16 v[64:67], a[224:227], v[136:139], v[64:67]
v_mfma_f32_16x16x32_bf16 v[68:71], a[228:231], v[136:139], v[68:71]
v_mfma_f32_16x16x32_bf16 v[72:75], a[232:235], v[136:139], v[72:75]
v_mfma_f32_16x16x32_bf16 v[76:79], a[236:239], v[136:139], v[76:79]
v_mfma_f32_16x16x32_bf16 v[80:83], a[224:227], v[140:143], v[80:83]
v_mfma_f32_16x16x32_bf16 v[84:87], a[228:231], v[140:143], v[84:87]
v_mfma_f32_16x16x32_bf16 v[88:91], a[232:235], v[140:143], v[88:91]
v_mfma_f32_16x16x32_bf16 v[92:95], a[236:239], v[140:143], v[92:95]
s_waitcnt lgkmcnt(0)
v_mfma_f32_16x16x32_bf16 v[64:67], a[240:243], v[144:147], v[64:67]
v_mfma_f32_16x16x32_bf16 v[68:71], a[244:247], v[144:147], v[68:71]
v_mfma_f32_16x16x32_bf16 v[72:75], a[248:251], v[144:147], v[72:75]
v_mfma_f32_16x16x32_bf16 v[76:79], a[252:255], v[144:147], v[76:79]
v_mfma_f32_16x16x32_bf16 v[80:83], a[240:243], v[148:151], v[80:83]
v_mfma_f32_16x16x32_bf16 v[84:87], a[244:247], v[148:151], v[84:87]
v_mfma_f32_16x16x32_bf16 v[88:91], a[248:251], v[148:151], v[88:91]
v_mfma_f32_16x16x32_bf16 v[92:95], a[252:255], v[148:151], v[92:95]
s_nop 7
s_nop 1
s_add_u32 s53, s44, 114688
v_cvt_pk_bf16_f32 v176, v64, v65
v_cvt_pk_bf16_f32 v177, v66, v67
v_cvt_pk_bf16_f32 v178, v68, v69
v_cvt_pk_bf16_f32 v179, v70, v71
buffer_store_dwordx4 v[176:179], v22, s[32:35], s53 offen offset:0 sc0 sc1
v_cvt_pk_bf16_f32 v180, v72, v73
v_cvt_pk_bf16_f32 v181, v74, v75
v_cvt_pk_bf16_f32 v182, v76, v77
v_cvt_pk_bf16_f32 v183, v78, v79
buffer_store_dwordx4 v[180:183], v22, s[32:35], s53 offen offset:1024 sc0 sc1
v_cvt_pk_bf16_f32 v184, v80, v81
v_cvt_pk_bf16_f32 v185, v82, v83
v_cvt_pk_bf16_f32 v186, v84, v85
v_cvt_pk_bf16_f32 v187, v86, v87
buffer_store_dwordx4 v[184:187], v23, s[32:35], s53 offen offset:0 sc0 sc1
v_cvt_pk_bf16_f32 v188, v88, v89
v_cvt_pk_bf16_f32 v189, v90, v91
v_cvt_pk_bf16_f32 v190, v92, v93
v_cvt_pk_bf16_f32 v191, v94, v95
buffer_store_dwordx4 v[188:191], v23, s[32:35], s53 offen offset:1024 sc0 sc1
s_endpgm
K1_V:
s_waitcnt vmcnt(8)
s_barrier
ds_read_b64_tr_b16 a[0:1], v10 offset:0
ds_read_b64_tr_b16 a[2:3], v10 offset:2048
ds_read_b64_tr_b16 a[4:5], v11 offset:0
ds_read_b64_tr_b16 a[6:7], v11 offset:2048
ds_read_b64_tr_b16 a[8:9], v12 offset:0
ds_read_b64_tr_b16 a[10:11], v12 offset:2048
ds_read_b64_tr_b16 a[12:13], v13 offset:0
ds_read_b64_tr_b16 a[14:15], v13 offset:2048
ds_read_b128 v[128:131], v14 offset:0
ds_read_b128 v[132:135], v14 offset:4096
ds_read_b128 v[136:139], v14 offset:32768
ds_read_b128 v[140:143], v14 offset:36864
s_waitcnt lgkmcnt(0)
s_waitcnt vmcnt(4)
s_barrier
v_mfma_f32_16x16x32_bf16 v[32:35], v[128:131], a[0:3], 0
ds_read_b64_tr_b16 a[16:17], v10 offset:16384
ds_read_b64_tr_b16 a[18:19], v10 offset:18432
v_mfma_f32_16x16x32_bf16 v[36:39], v[128:131], a[4:7], 0
ds_read_b64_tr_b16 a[20:21], v11 offset:16384
ds_read_b64_tr_b16 a[22:23], v11 offset:18432
v_mfma_f32_16x16x32_bf16 v[40:43], v[128:131], a[8:11], 0
ds_read_b64_tr_b16 a[24:25], v12 offset:16384
ds_read_b64_tr_b16 a[26:27], v12 offset:18432
v_mfma_f32_16x16x32_bf16 v[44:47], v[128:131], a[12:15], 0
ds_read_b64_tr_b16 a[28:29], v13 offset:16384
ds_read_b64_tr_b16 a[30:31], v13 offset:18432
v_mfma_f32_16x16x32_bf16 v[48:51], v[132:135], a[0:3], 0
ds_read_b128 v[144:147], v15 offset:0
ds_read_b128 v[148:151], v15 offset:4096
v_mfma_f32_16x16x32_bf16 v[52:55], v[132:135], a[4:7], 0
ds_read_b128 v[152:155], v15 offset:32768
ds_read_b128 v[156:159], v15 offset:36864
v_mfma_f32_16x16x32_bf16 v[56:59], v[132:135], a[8:11], 0
s_add_u32 m0, s45, 49152
s_add_u32 s50, s63, 786432
v_mfma_f32_16x16x32_bf16 v[60:63], v[132:135], a[12:15], 0
s_and_b32 s50, s50, 4194303
v_mfma_f32_16x16x32_bf16 v[64:67], v[136:139], a[0:3], 0
buffer_load_dwordx4 v2, s[20:23], s50 offen offset:0 nt lds
v_mfma_f32_16x16x32_bf16 v[68:71], v[136:139], a[4:7], 0
buffer_load_dwordx4 v3, s[20:23], s50 offen offset:1024 nt lds
v_mfma_f32_16x16x32_bf16 v[72:75], v[136:139], a[8:11], 0
buffer_load_dwordx4 v4, s[20:23], s50 offen offset:2048 nt lds
v_mfma_f32_16x16x32_bf16 v[76:79], v[136:139], a[12:15], 0
buffer_load_dwordx4 v5, s[20:23], s50 offen offset:3072 nt lds
v_mfma_f32_16x16x32_bf16 v[80:83], v[140:143], a[0:3], 0
s_add_u32 m0, s45, 65536
s_add_u32 s50, s63, 1048576
v_mfma_f32_16x16x32_bf16 v[84:87], v[140:143], a[4:7], 0
s_and_b32 s50, s50, 4194303
v_mfma_f32_16x16x32_bf16 v[88:91], v[140:143], a[8:11], 0
buffer_load_dwordx4 v2, s[20:23], s50 offen offset:0 nt lds
v_mfma_f32_16x16x32_bf16 v[92:95], v[140:143], a[12:15], 0
buffer_load_dwordx4 v3, s[20:23], s50 offen offset:1024 nt lds
buffer_load_dwordx4 v4, s[20:23], s50 offen offset:2048 nt lds
buffer_load_dwordx4 v5, s[20:23], s50 offen offset:3072 nt lds
s_waitcnt lgkmcnt(0)
s_waitcnt vmcnt(8)
s_barrier
v_mfma_f32_16x16x32_bf16 v[32:35], v[144:147], a[16:19], v[32:35]
ds_read_b64_tr_b16 a[32:33], v10 offset:32768
ds_read_b64_tr_b16 a[34:35], v10 offset:34816
v_mfma_f32_16x16x32_bf16 v[36:39], v[144:147], a[20:23], v[36:39]
ds_read_b64_tr_b16 a[36:37], v11 offset:32768
ds_read_b64_tr_b16 a[38:39], v11 offset:34816
v_mfma_f32_16x16x32_bf16 v[40:43], v[144:147], a[24:27], v[40:43]
ds_read_b64_tr_b16 a[40:41], v12 offset:32768
ds_read_b64_tr_b16 a[42:43], v12 offset:34816
v_mfma_f32_16x16x32_bf16 v[44:47], v[144:147], a[28:31], v[44:47]
ds_read_b64_tr_b16 a[44:45], v13 offset:32768
ds_read_b64_tr_b16 a[46:47], v13 offset:34816
v_mfma_f32_16x16x32_bf16 v[48:51], v[148:151], a[16:19], v[48:51]
ds_read_b128 v[128:131], v16 offset:0
ds_read_b128 v[132:135], v16 offset:4096
v_mfma_f32_16x16x32_bf16 v[52:55], v[148:151], a[20:23], v[52:55]
ds_read_b128 v[136:139], v16 offset:32768
ds_read_b128 v[140:143], v16 offset:36864
v_mfma_f32_16x16x32_bf16 v[56:59], v[148:151], a[24:27], v[56:59]
s_add_u32 m0, s45, 81920
s_add_u32 s50, s63, 1310720
v_mfma_f32_16x16x32_bf16 v[60:63], v[148:151], a[28:31], v[60:63]
s_and_b32 s50, s50, 4194303
v_mfma_f32_16x16x32_bf16 v[64:67], v[152:155], a[16:19], v[64:67]
buffer_load_dwordx4 v2, s[20:23], s50 offen offset:0 nt lds
v_mfma_f32_16x16x32_bf16 v[68:71], v[152:155], a[20:23], v[68:71]
buffer_load_dwordx4 v3, s[20:23], s50 offen offset:1024 nt lds
v_mfma_f32_16x16x32_bf16 v[72:75], v[152:155], a[24:27], v[72:75]
buffer_load_dwordx4 v4, s[20:23], s50 offen offset:2048 nt lds
v_mfma_f32_16x16x32_bf16 v[76:79], v[152:155], a[28:31], v[76:79]
buffer_load_dwordx4 v5, s[20:23], s50 offen offset:3072 nt lds
v_mfma_f32_16x16x32_bf16 v[80:83], v[156:159], a[16:19], v[80:83]
s_add_u32 m0, s45, 0
s_add_u32 s50, s63, 1572864
v_mfma_f32_16x16x32_bf16 v[84:87], v[156:159], a[20:23], v[84:87]
s_and_b32 s50, s50, 4194303
v_mfma_f32_16x16x32_bf16 v[88:91], v[156:159], a[24:27], v[88:91]
buffer_load_dwordx4 v2, s[20:23], s50 offen offset:0 nt lds
v_mfma_f32_16x16x32_bf16 v[92:95], v[156:159], a[28:31], v[92:95]
buffer_load_dwordx4 v3, s[20:23], s50 offen offset:1024 nt lds
buffer_load_dwordx4 v4, s[20:23], s50 offen offset:2048 nt lds
buffer_load_dwordx4 v5, s[20:23], s50 offen offset:3072 nt lds
s_waitcnt lgkmcnt(0)
s_waitcnt vmcnt(12)
s_barrier
v_mfma_f32_16x16x32_bf16 v[32:35], v[128:131], a[32:35], v[32:35]
ds_read_b64_tr_b16 a[48:49], v10 offset:49152
ds_read_b64_tr_b16 a[50:51], v10 offset:51200
v_mfma_f32_16x16x32_bf16 v[36:39], v[128:131], a[36:39], v[36:39]
ds_read_b64_tr_b16 a[52:53], v11 offset:49152
ds_read_b64_tr_b16 a[54:55], v11 offset:51200
v_mfma_f32_16x16x32_bf16 v[40:43], v[128:131], a[40:43], v[40:43]
ds_read_b64_tr_b16 a[56:57], v12 offset:49152
ds_read_b64_tr_b16 a[58:59], v12 offset:51200
v_mfma_f32_16x16x32_bf16 v[44:47], v[128:131], a[44:47], v[44:47]
ds_read_b64_tr_b16 a[60:61], v13 offset:49152
ds_read_b64_tr_b16 a[62:63], v13 offset:51200
v_mfma_f32_16x16x32_bf16 v[48:51], v[132:135], a[32:35], v[48:51]
ds_read_b128 v[144:147], v17 offset:0
ds_read_b128 v[148:151], v17 offset:4096
v_mfma_f32_16x16x32_bf16 v[52:55], v[132:135], a[36:39], v[52:55]
ds_read_b128 v[152:155], v17 offset:32768
ds_read_b128 v[156:159], v17 offset:36864
v_mfma_f32_16x16x32_bf16 v[56:59], v[132:135], a[40:43], v[56:59]
s_add_u32 m0, s45, 16384
s_add_u32 s50, s63, 1835008
v_mfma_f32_16x16x32_bf16 v[60:63], v[132:135], a[44:47], v[60:63]
s_and_b32 s50, s50, 4194303
v_mfma_f32_16x16x32_bf16 v[64:67], v[136:139], a[32:35], v[64:67]
buffer_load_dwordx4 v2, s[20:23], s50 offen offset:0 nt lds
v_mfma_f32_16x16x32_bf16 v[68:71], v[136:139], a[36:39], v[68:71]
buffer_load_dwordx4 v3, s[20:23], s50 offen offset:1024 nt lds
v_mfma_f32_16x16x32_bf16 v[72:75], v[136:139], a[40:43], v[72:75]
buffer_load_dwordx4 v4, s[20:23], s50 offen offset:2048 nt lds
v_mfma_f32_16x16x32_bf16 v[76:79], v[136:139], a[44:47], v[76:79]
buffer_load_dwordx4 v5, s[20:23], s50 offen offset:3072 nt lds
v_mfma_f32_16x16x32_bf16 v[80:83], v[140:143], a[32:35], v[80:83]
s_add_u32 m0, s45, 32768
s_add_u32 s50, s63, 2097152
v_mfma_f32_16x16x32_bf16 v[84:87], v[140:143], a[36:39], v[84:87]
s_and_b32 s50, s50, 4194303
v_mfma_f32_16x16x32_bf16 v[88:91], v[140:143], a[40:43], v[88:91]
buffer_load_dwordx4 v2, s[20:23], s50 offen offset:0 nt lds
v_mfma_f32_16x16x32_bf16 v[92:95], v[140:143], a[44:47], v[92:95]
buffer_load_dwordx4 v3, s[20:23], s50 offen offset:1024 nt lds
buffer_load_dwordx4 v4, s[20:23], s50 offen offset:2048 nt lds
buffer_load_dwordx4 v5, s[20:23], s50 offen offset:3072 nt lds
s_waitcnt lgkmcnt(0)
s_waitcnt vmcnt(16)
s_barrier
v_mfma_f32_16x16x32_bf16 v[32:35], v[144:147], a[48:51], v[32:35]
ds_read_b64_tr_b16 a[64:65], v24 offset:0
ds_read_b64_tr_b16 a[66:67], v24 offset:2048
v_mfma_f32_16x16x32_bf16 v[36:39], v[144:147], a[52:55], v[36:39]
ds_read_b64_tr_b16 a[68:69], v25 offset:0
ds_read_b64_tr_b16 a[70:71], v25 offset:2048
v_mfma_f32_16x16x32_bf16 v[40:43], v[144:147], a[56:59], v[40:43]
ds_read_b64_tr_b16 a[72:73], v26 offset:0
ds_read_b64_tr_b16 a[74:75], v26 offset:2048
v_mfma_f32_16x16x32_bf16 v[44:47], v[144:147], a[60:63], v[44:47]
ds_read_b64_tr_b16 a[76:77], v27 offset:0
ds_read_b64_tr_b16 a[78:79], v27 offset:2048
v_mfma_f32_16x16x32_bf16 v[48:51], v[148:151], a[48:51], v[48:51]
ds_read_b128 v[128:131], v14 offset:8192
ds_read_b128 v[132:135], v14 offset:12288
v_mfma_f32_16x16x32_bf16 v[52:55], v[148:151], a[52:55], v[52:55]
ds_read_b128 v[136:139], v14 offset:40960
ds_read_b128 v[140:143], v14 offset:45056
v_mfma_f32_16x16x32_bf16 v[56:59], v[148:151], a[56:59], v[56:59]
s_add_u32 m0, s45, 49152
s_add_u32 s50, s63, 2359296
v_mfma_f32_16x16x32_bf16 v[60:63], v[148:151], a[60:63], v[60:63]
s_and_b32 s50, s50, 4194303
v_mfma_f32_16x16x32_bf16 v[64:67], v[152:155], a[48:51], v[64:67]
buffer_load_dwordx4 v2, s[20:23], s50 offen offset:0 nt lds
v_mfma_f32_16x16x32_bf16 v[68:71], v[152:155], a[52:55], v[68:71]
buffer_load_dwordx4 v3, s[20:23], s50 offen offset:1024 nt lds
v_mfma_f32_16x16x32_bf16 v[72:75], v[152:155], a[56:59], v[72:75]
buffer_load_dwordx4 v4, s[20:23], s50 offen offset:2048 nt lds
v_mfma_f32_16x16x32_bf16 v[76:79], v[152:155], a[60:63], v[76:79]
buffer_load_dwordx4 v5, s[20:23], s50 offen offset:3072 nt lds
v_mfma_f32_16x16x32_bf16 v[80:83], v[156:159], a[48:51], v[80:83]
v_mfma_f32_16x16x32_bf16 v[84:87], v[156:159], a[52:55], v[84:87]
v_mfma_f32_16x16x32_bf16 v[88:91], v[156:159], a[56:59], v[88:91]
v_mfma_f32_16x16x32_bf16 v[92:95], v[156:159], a[60:63], v[92:95]
s_waitcnt lgkmcnt(0)
s_waitcnt vmcnt(16)
s_barrier
v_mfma_f32_16x16x32_bf16 v[32:35], v[128:131], a[64:67], v[32:35]
ds_read_b64_tr_b16 a[80:81], v24 offset:16384
ds_read_b64_tr_b16 a[82:83], v24 offset:18432
v_mfma_f32_16x16x32_bf16 v[36:39], v[128:131], a[68:71], v[36:39]
ds_read_b64_tr_b16 a[84:85], v25 offset:16384
ds_read_b64_tr_b16 a[86:87], v25 offset:18432
v_mfma_f32_16x16x32_bf16 v[40:43], v[128:131], a[72:75], v[40:43]
ds_read_b64_tr_b16 a[88:89], v26 offset:16384
ds_read_b64_tr_b16 a[90:91], v26 offset:18432
v_mfma_f32_16x16x32_bf16 v[44:47], v[128:131], a[76:79], v[44:47]
ds_read_b64_tr_b16 a[92:93], v27 offset:16384
ds_read_b64_tr_b16 a[94:95], v27 offset:18432
v_mfma_f32_16x16x32_bf16 v[48:51], v[132:135], a[64:67], v[48:51]
ds_read_b128 v[144:147], v15 offset:8192
ds_read_b128 v[148:151], v15 offset:12288
v_mfma_f32_16x16x32_bf16 v[52:55], v[132:135], a[68:71], v[52:55]
ds_read_b128 v[152:155], v15 offset:40960
ds_read_b128 v[156:159], v15 offset:45056
v_mfma_f32_16x16x32_bf16 v[56:59], v[132:135], a[72:75], v[56:59]
s_add_u32 m0, s45, 65536
s_add_u32 s50, s63, 2621440
v_mfma_f32_16x16x32_bf16 v[60:63], v[132:135], a[76:79], v[60:63]
s_and_b32 s50, s50, 4194303
v_mfma_f32_16x16x32_bf16 v[64:67], v[136:139], a[64:67], v[64:67]
buffer_load_dwordx4 v2, s[20:23], s50 offen offset:0 nt lds
v_mfma_f32_16x16x32_bf16 v[68:71], v[136:139], a[68:71], v[68:71]
buffer_load_dwordx4 v3, s[20:23], s50 offen offset:1024 nt lds
v_mfma_f32_16x16x32_bf16 v[72:75], v[136:139], a[72:75], v[72:75]
buffer_load_dwordx4 v4, s[20:23], s50 offen offset:2048 nt lds
v_mfma_f32_16x16x32_bf16 v[76:79], v[136:139], a[76:79], v[76:79]
buffer_load_dwordx4 v5, s[20:23], s50 offen offset:3072 nt lds
v_mfma_f32_16x16x32_bf16 v[80:83], v[140:143], a[64:67], v[80:83]
buffer_load_dwordx4 v[192:195], v22, s[24:27], s47 offen
v_mfma_f32_16x16x32_bf16 v[84:87], v[140:143], a[68:71], v[84:87]
buffer_load_dwordx4 v[196:199], v22, s[24:27], s47 offen offset:1024
v_mfma_f32_16x16x32_bf16 v[88:91], v[140:143], a[72:75], v[88:91]
v_mfma_f32_16x16x32_bf16 v[92:95], v[140:143], a[76:79], v[92:95]
s_waitcnt lgkmcnt(0)
s_waitcnt vmcnt(18)
s_barrier
v_mfma_f32_16x16x32_bf16 v[32:35], v[144:147], a[80:83], v[32:35]
ds_read_b64_tr_b16 a[96:97], v10 offset:0
ds_read_b64_tr_b16 a[98:99], v10 offset:2048
v_mfma_f32_16x16x32_bf16 v[36:39], v[144:147], a[84:87], v[36:39]
ds_read_b64_tr_b16 a[100:101], v11 offset:0
ds_read_b64_tr_b16 a[102:103], v11 offset:2048
v_mfma_f32_16x16x32_bf16 v[40:43], v[144:147], a[88:91], v[40:43]
ds_read_b64_tr_b16 a[104:105], v12 offset:0
ds_read_b64_tr_b16 a[106:107], v12 offset:2048
v_mfma_f32_16x16x32_bf16 v[44:47], v[144:147], a[92:95], v[44:47]
ds_read_b64_tr_b16 a[108:109], v13 offset:0
ds_read_b64_tr_b16 a[110:111], v13 offset:2048
v_mfma_f32_16x16x32_bf16 v[48:51], v[148:151], a[80:83], v[48:51]
ds_read_b128 v[128:131], v16 offset:8192
ds_read_b128 v[132:135], v16 offset:12288
v_mfma_f32_16x16x32_bf16 v[52:55], v[148:151], a[84:87], v[52:55]
ds_read_b128 v[136:139], v16 offset:40960
ds_read_b128 v[140:143], v16 offset:45056
v_mfma_f32_16x16x32_bf16 v[56:59], v[148:151], a[88:91], v[56:59]
s_add_u32 m0, s45, 81920
s_add_u32 s50, s63, 2883584
v_mfma_f32_16x16x32_bf16 v[60:63], v[148:151], a[92:95], v[60:63]
s_and_b32 s50, s50, 4194303
v_mfma_f32_16x16x32_bf16 v[64:67], v[152:155], a[80:83], v[64:67]
buffer_load_dwordx4 v2, s[20:23], s50 offen offset:0 nt lds
v_mfma_f32_16x16x32_bf16 v[68:71], v[152:155], a[84:87], v[68:71]
buffer_load_dwordx4 v3, s[20:23], s50 offen offset:1024 nt lds
v_mfma_f32_16x16x32_bf16 v[72:75], v[152:155], a[88:91], v[72:75]
buffer_load_dwordx4 v4, s[20:23], s50 offen offset:2048 nt lds
v_mfma_f32_16x16x32_bf16 v[76:79], v[152:155], a[92:95], v[76:79]
buffer_load_dwordx4 v5, s[20:23], s50 offen offset:3072 nt lds
v_mfma_f32_16x16x32_bf16 v[80:83], v[156:159], a[80:83], v[80:83]
v_mfma_f32_16x16x32_bf16 v[84:87], v[156:159], a[84:87], v[84:87]
v_mfma_f32_16x16x32_bf16 v[88:91], v[156:159], a[88:91], v[88:91]
v_mfma_f32_16x16x32_bf16 v[92:95], v[156:159], a[92:95], v[92:95]
s_waitcnt lgkmcnt(0)
s_waitcnt vmcnt(18)
s_barrier
v_mfma_f32_16x16x32_bf16 v[32:35], v[128:131], a[96:99], v[32:35]
ds_read_b64_tr_b16 a[112:113], v10 offset:16384
ds_read_b64_tr_b16 a[114:115], v10 offset:18432
v_mfma_f32_16x16x32_bf16 v[36:39], v[128:131], a[100:103], v[36:39]
ds_read_b64_tr_b16 a[116:117], v11 offset:16384
ds_read_b64_tr_b16 a[118:119], v11 offset:18432
v_mfma_f32_16x16x32_bf16 v[40:43], v[128:131], a[104:107], v[40:43]
ds_read_b64_tr_b16 a[120:121], v12 offset:16384
ds_read_b64_tr_b16 a[122:123], v12 offset:18432
v_mfma_f32_16x16x32_bf16 v[44:47], v[128:131], a[108:111], v[44:47]
ds_read_b64_tr_b16 a[124:125], v13 offset:16384
ds_read_b64_tr_b16 a[126:127], v13 offset:18432
v_mfma_f32_16x16x32_bf16 v[48:51], v[132:135], a[96:99], v[48:51]
ds_read_b128 v[144:147], v17 offset:8192
ds_read_b128 v[148:151], v17 offset:12288
v_mfma_f32_16x16x32_bf16 v[52:55], v[132:135], a[100:103], v[52:55]
ds_read_b128 v[152:155], v17 offset:40960
ds_read_b128 v[156:159], v17 offset:45056
v_mfma_f32_16x16x32_bf16 v[56:59], v[132:135], a[104:107], v[56:59]
v_mfma_f32_16x16x32_bf16 v[60:63], v[132:135], a[108:111], v[60:63]
v_mfma_f32_16x16x32_bf16 v[64:67], v[136:139], a[96:99], v[64:67]
v_mfma_f32_16x16x32_bf16 v[68:71], v[136:139], a[100:103], v[68:71]
v_mfma_f32_16x16x32_bf16 v[72:75], v[136:139], a[104:107], v[72:75]
v_mfma_f32_16x16x32_bf16 v[76:79], v[136:139], a[108:111], v[76:79]
v_mfma_f32_16x16x32_bf16 v[80:83], v[140:143], a[96:99], v[80:83]
v_mfma_f32_16x16x32_bf16 v[84:87], v[140:143], a[100:103], v[84:87]
v_mfma_f32_16x16x32_bf16 v[88:91], v[140:143], a[104:107], v[88:91]
v_mfma_f32_16x16x32_bf16 v[92:95], v[140:143], a[108:111], v[92:95]
s_waitcnt lgkmcnt(0)
s_waitcnt vmcnt(14)
s_barrier
v_mfma_f32_16x16x32_bf16 v[32:35], v[144:147], a[112:115], v[32:35]
ds_read_b64_tr_b16 a[128:129], v10 offset:32768
ds_read_b64_tr_b16 a[130:131], v10 offset:34816
v_mfma_f32_16x16x32_bf16 v[36:39], v[144:147], a[116:119], v[36:39]
ds_read_b64_tr_b16 a[132:133], v11 offset:32768
ds_read_b64_tr_b16 a[134:135], v11 offset:34816
v_mfma_f32_16x16x32_bf16 v[40:43], v[144:147], a[120:123], v[40:43]
ds_read_b64_tr_b16 a[136:137], v12 offset:32768
ds_read_b64_tr_b16 a[138:139], v12 offset:34816
v_mfma_f32_16x16x32_bf16 v[44:47], v[144:147], a[124:127], v[44:47]
ds_read_b64_tr_b16 a[140:141], v13 offset:32768
ds_read_b64_tr_b16 a[142:143], v13 offset:34816
v_mfma_f32_16x16x32_bf16 v[48:51], v[148:151], a[112:115], v[48:51]
ds_read_b128 v[128:131], v14 offset:16384
ds_read_b128 v[132:135], v14 offset:20480
v_mfma_f32_16x16x32_bf16 v[52:55], v[148:151], a[116:119], v[52:55]
ds_read_b128 v[136:139], v14 offset:49152
ds_read_b128 v[140:143], v14 offset:53248
v_mfma_f32_16x16x32_bf16 v[56:59], v[148:151], a[120:123], v[56:59]
s_add_u32 m0, s46, 65536
s_add_u32 s49, s43, 65536
v_mfma_f32_16x16x32_bf16 v[60:63], v[148:151], a[124:127], v[60:63]
buffer_load_dwordx4 v6, s[16:19], s49 offen offset:0 lds
v_mfma_f32_16x16x32_bf16 v[64:67], v[152:155], a[112:115], v[64:67]
buffer_load_dwordx4 v7, s[16:19], s49 offen offset:1024 lds
v_mfma_f32_16x16x32_bf16 v[68:71], v[152:155], a[116:119], v[68:71]
buffer_load_dwordx4 v8, s[16:19], s49 offen offset:2048 lds
v_mfma_f32_16x16x32_bf16 v[72:75], v[152:155], a[120:123], v[72:75]
buffer_load_dwordx4 v9, s[16:19], s49 offen offset:3072 lds
v_mfma_f32_16x16x32_bf16 v[76:79], v[152:155], a[124:127], v[76:79]
s_add_u32 m0, s46, 69632
s_add_u32 s49, s43, 81920
v_mfma_f32_16x16x32_bf16 v[80:83], v[156:159], a[112:115], v[80:83]
buffer_load_dwordx4 v6, s[16:19], s49 offen offset:0 lds
v_mfma_f32_16x16x32_bf16 v[84:87], v[156:159], a[116:119], v[84:87]
buffer_load_dwordx4 v7, s[16:19], s49 offen offset:1024 lds
v_mfma_f32_16x16x32_bf16 v[88:91], v[156:159], a[120:123], v[88:91]
buffer_load_dwordx4 v8, s[16:19], s49 offen offset:2048 lds
v_mfma_f32_16x16x32_bf16 v[92:95], v[156:159], a[124:127], v[92:95]
buffer_load_dwordx4 v9, s[16:19], s49 offen offset:3072 lds
s_waitcnt lgkmcnt(0)
s_waitcnt vmcnt(18)
s_barrier
v_mfma_f32_16x16x32_bf16 v[32:35], v[128:131], a[128:131], v[32:35]
ds_read_b64_tr_b16 a[144:145], v10 offset:49152
ds_read_b64_tr_b16 a[146:147], v10 offset:51200
v_mfma_f32_16x16x32_bf16 v[36:39], v[128:131], a[132:135], v[36:39]
ds_read_b64_tr_b16 a[148:149], v11 offset:49152
ds_read_b64_tr_b16 a[150:151], v11 offset:51200
v_mfma_f32_16x16x32_bf16 v[40:43], v[128:131], a[136:139], v[40:43]
ds_read_b64_tr_b16 a[152:153], v12 offset:49152
ds_read_b64_tr_b16 a[154:155], v12 offset:51200
v_mfma_f32_16x16x32_bf16 v[44:47], v[128:131], a[140:143], v[44:47]
ds_read_b64_tr_b16 a[156:157], v13 offset:49152
ds_read_b64_tr_b16 a[158:159], v13 offset:51200
v_mfma_f32_16x16x32_bf16 v[48:51], v[132:135], a[128:131], v[48:51]
ds_read_b128 v[144:147], v15 offset:16384
ds_read_b128 v[148:151], v15 offset:20480
v_mfma_f32_16x16x32_bf16 v[52:55], v[132:135], a[132:135], v[52:55]
ds_read_b128 v[152:155], v15 offset:49152
ds_read_b128 v[156:159], v15 offset:53248
v_mfma_f32_16x16x32_bf16 v[56:59], v[132:135], a[136:139], v[56:59]
s_add_u32 m0, s45, 32768
s_add_u32 s50, s63, 3145728
v_mfma_f32_16x16x32_bf16 v[60:63], v[132:135], a[140:143], v[60:63]
s_and_b32 s50, s50, 4194303
v_mfma_f32_16x16x32_bf16 v[64:67], v[136:139], a[128:131], v[64:67]
buffer_load_dwordx4 v2, s[20:23], s50 offen offset:0 nt lds
v_mfma_f32_16x16x32_bf16 v[68:71], v[136:139], a[132:135], v[68:71]
buffer_load_dwordx4 v3, s[20:23], s50 offen offset:1024 nt lds
v_mfma_f32_16x16x32_bf16 v[72:75], v[136:139], a[136:139], v[72:75]
buffer_load_dwordx4 v4, s[20:23], s50 offen offset:2048 nt lds
v_mfma_f32_16x16x32_bf16 v[76:79], v[136:139], a[140:143], v[76:79]
buffer_load_dwordx4 v5, s[20:23], s50 offen offset:3072 nt lds
v_mfma_f32_16x16x32_bf16 v[80:83], v[140:143], a[128:131], v[80:83]
v_mfma_f32_16x16x32_bf16 v[84:87], v[140:143], a[132:135], v[84:87]
v_mfma_f32_16x16x32_bf16 v[88:91], v[140:143], a[136:139], v[88:91]
v_mfma_f32_16x16x32_bf16 v[92:95], v[140:143], a[140:143], v[92:95]
s_waitcnt lgkmcnt(0)
s_waitcnt vmcnt(18)
s_barrier
v_mfma_f32_16x16x32_bf16 v[32:35], v[144:147], a[144:147], v[32:35]
ds_read_b64_tr_b16 a[160:161], v24 offset:0
ds_read_b64_tr_b16 a[162:163], v24 offset:2048
v_mfma_f32_16x16x32_bf16 v[36:39], v[144:147], a[148:151], v[36:39]
ds_read_b64_tr_b16 a[164:165], v25 offset:0
ds_read_b64_tr_b16 a[166:167], v25 offset:2048
v_mfma_f32_16x16x32_bf16 v[40:43], v[144:147], a[152:155], v[40:43]
ds_read_b64_tr_b16 a[168:169], v26 offset:0
ds_read_b64_tr_b16 a[170:171], v26 offset:2048
v_mfma_f32_16x16x32_bf16 v[44:47], v[144:147], a[156:159], v[44:47]
ds_read_b64_tr_b16 a[172:173], v27 offset:0
ds_read_b64_tr_b16 a[174:175], v27 offset:2048
v_mfma_f32_16x16x32_bf16 v[48:51], v[148:151], a[144:147], v[48:51]
ds_read_b128 v[128:131], v16 offset:16384
ds_read_b128 v[132:135], v16 offset:20480
v_mfma_f32_16x16x32_bf16 v[52:55], v[148:151], a[148:151], v[52:55]
ds_read_b128 v[136:139], v16 offset:49152
ds_read_b128 v[140:143], v16 offset:53248
v_mfma_f32_16x16x32_bf16 v[56:59], v[148:151], a[152:155], v[56:59]
s_add_u32 m0, s45, 49152
s_add_u32 s50, s63, 3407872
v_mfma_f32_16x16x32_bf16 v[60:63], v[148:151], a[156:159], v[60:63]
s_and_b32 s50, s50, 4194303
v_mfma_f32_16x16x32_bf16 v[64:67], v[152:155], a[144:147], v[64:67]
buffer_load_dwordx4 v2, s[20:23], s50 offen offset:0 nt lds
v_mfma_f32_16x16x32_bf16 v[68:71], v[152:155], a[148:151], v[68:71]
buffer_load_dwordx4 v3, s[20:23], s50 offen offset:1024 nt lds
v_mfma_f32_16x16x32_bf16 v[72:75], v[152:155], a[152:155], v[72:75]
buffer_load_dwordx4 v4, s[20:23], s50 offen offset:2048 nt lds
v_mfma_f32_16x16x32_bf16 v[76:79], v[152:155], a[156:159], v[76:79]
buffer_load_dwordx4 v5, s[20:23], s50 offen offset:3072 nt lds
v_mfma_f32_16x16x32_bf16 v[80:83], v[156:159], a[144:147], v[80:83]
v_mfma_f32_16x16x32_bf16 v[84:87], v[156:159], a[148:151], v[84:87]
v_mfma_f32_16x16x32_bf16 v[88:91], v[156:159], a[152:155], v[88:91]
v_mfma_f32_16x16x32_bf16 v[92:95], v[156:159], a[156:159], v[92:95]
s_waitcnt lgkmcnt(0)
s_waitcnt vmcnt(16)
s_barrier
v_mfma_f32_16x16x32_bf16 v[32:35], v[128:131], a[160:163], v[32:35]
ds_read_b64_tr_b16 a[176:177], v24 offset:16384
ds_read_b64_tr_b16 a[178:179], v24 offset:18432
v_mfma_f32_16x16x32_bf16 v[36:39], v[128:131], a[164:167], v[36:39]
ds_read_b64_tr_b16 a[180:181], v25 offset:16384
ds_read_b64_tr_b16 a[182:183], v25 offset:18432
v_mfma_f32_16x16x32_bf16 v[40:43], v[128:131], a[168:171], v[40:43]
ds_read_b64_tr_b16 a[184:185], v26 offset:16384
ds_read_b64_tr_b16 a[186:187], v26 offset:18432
v_mfma_f32_16x16x32_bf16 v[44:47], v[128:131], a[172:175], v[44:47]
ds_read_b64_tr_b16 a[188:189], v27 offset:16384
ds_read_b64_tr_b16 a[190:191], v27 offset:18432
v_mfma_f32_16x16x32_bf16 v[48:51], v[132:135], a[160:163], v[48:51]
ds_read_b128 v[144:147], v17 offset:16384
ds_read_b128 v[148:151], v17 offset:20480
v_mfma_f32_16x16x32_bf16 v[52:55], v[132:135], a[164:167], v[52:55]
ds_read_b128 v[152:155], v17 offset:49152
ds_read_b128 v[156:159], v17 offset:53248
v_mfma_f32_16x16x32_bf16 v[56:59], v[132:135], a[168:171], v[56:59]
s_add_u32 m0, s45, 65536
s_add_u32 s50, s63, 3670016
v_mfma_f32_16x16x32_bf16 v[60:63], v[132:135], a[172:175], v[60:63]
s_and_b32 s50, s50, 4194303
v_mfma_f32_16x16x32_bf16 v[64:67], v[136:139], a[160:163], v[64:67]
buffer_load_dwordx4 v2, s[20:23], s50 offen offset:0 nt lds
v_mfma_f32_16x16x32_bf16 v[68:71], v[136:139], a[164:167], v[68:71]
buffer_load_dwordx4 v3, s[20:23], s50 offen offset:1024 nt lds
v_mfma_f32_16x16x32_bf16 v[72:75], v[136:139], a[168:171], v[72:75]
buffer_load_dwordx4 v4, s[20:23], s50 offen offset:2048 nt lds
v_mfma_f32_16x16x32_bf16 v[76:79], v[136:139], a[172:175], v[76:79]
buffer_load_dwordx4 v5, s[20:23], s50 offen offset:3072 nt lds
v_mfma_f32_16x16x32_bf16 v[80:83], v[140:143], a[160:163], v[80:83]
v_mfma_f32_16x16x32_bf16 v[84:87], v[140:143], a[164:167], v[84:87]
v_mfma_f32_16x16x32_bf16 v[88:91], v[140:143], a[168:171], v[88:91]
v_mfma_f32_16x16x32_bf16 v[92:95], v[140:143], a[172:175], v[92:95]
s_waitcnt lgkmcnt(0)
s_waitcnt vmcnt(8)
s_barrier
v_mfma_f32_16x16x32_bf16 v[32:35], v[144:147], a[176:179], v[32:35]
ds_read_b64_tr_b16 a[192:193], v10 offset:32768
ds_read_b64_tr_b16 a[194:195], v10 offset:34816
v_mfma_f32_16x16x32_bf16 v[36:39], v[144:147], a[180:183], v[36:39]
ds_read_b64_tr_b16 a[196:197], v11 offset:32768
ds_read_b64_tr_b16 a[198:199], v11 offset:34816
v_mfma_f32_16x16x32_bf16 v[40:43], v[144:147], a[184:187], v[40:43]
ds_read_b64_tr_b16 a[200:201], v12 offset:32768
ds_read_b64_tr_b16 a[202:203], v12 offset:34816
v_mfma_f32_16x16x32_bf16 v[44:47], v[144:147], a[188:191], v[44:47]
ds_read_b64_tr_b16 a[204:205], v13 offset:32768
ds_read_b64_tr_b16 a[206:207], v13 offset:34816
v_mfma_f32_16x16x32_bf16 v[48:51], v[148:151], a[176:179], v[48:51]
ds_read_b128 v[128:131], v14 offset:24576
ds_read_b128 v[132:135], v14 offset:28672
v_mfma_f32_16x16x32_bf16 v[52:55], v[148:151], a[180:183], v[52:55]
ds_read_b128 v[136:139], v14 offset:57344
ds_read_b128 v[140:143], v14 offset:61440
v_mfma_f32_16x16x32_bf16 v[56:59], v[148:151], a[184:187], v[56:59]
s_add_u32 m0, s45, 81920
s_add_u32 s50, s63, 3932160
v_mfma_f32_16x16x32_bf16 v[60:63], v[148:151], a[188:191], v[60:63]
s_and_b32 s50, s50, 4194303
v_mfma_f32_16x16x32_bf16 v[64:67], v[152:155], a[176:179], v[64:67]
buffer_load_dwordx4 v2, s[20:23], s50 offen offset:0 nt lds
v_mfma_f32_16x16x32_bf16 v[68:71], v[152:155], a[180:183], v[68:71]
buffer_load_dwordx4 v3, s[20:23], s50 offen offset:1024 nt lds
v_mfma_f32_16x16x32_bf16 v[72:75], v[152:155], a[184:187], v[72:75]
buffer_load_dwordx4 v4, s[20:23], s50 offen offset:2048 nt lds
v_mfma_f32_16x16x32_bf16 v[76:79], v[152:155], a[188:191], v[76:79]
buffer_load_dwordx4 v5, s[20:23], s50 offen offset:3072 nt lds
v_mfma_f32_16x16x32_bf16 v[80:83], v[156:159], a[176:179], v[80:83]
v_mfma_f32_16x16x32_bf16 v[84:87], v[156:159], a[180:183], v[84:87]
v_mfma_f32_16x16x32_bf16 v[88:91], v[156:159], a[184:187], v[88:91]
v_mfma_f32_16x16x32_bf16 v[92:95], v[156:159], a[188:191], v[92:95]
s_waitcnt lgkmcnt(0)
s_waitcnt vmcnt(8)
s_barrier
v_mfma_f32_16x16x32_bf16 v[32:35], v[128:131], a[192:195], v[32:35]
ds_read_b64_tr_b16 a[208:209], v10 offset:49152
ds_read_b64_tr_b16 a[210:211], v10 offset:51200
v_mfma_f32_16x16x32_bf16 v[36:39], v[128:131], a[196:199], v[36:39]
ds_read_b64_tr_b16 a[212:213], v11 offset:49152
ds_read_b64_tr_b16 a[214:215], v11 offset:51200
v_mfma_f32_16x16x32_bf16 v[40:43], v[128:131], a[200:203], v[40:43]
ds_read_b64_tr_b16 a[216:217], v12 offset:49152
ds_read_b64_tr_b16 a[218:219], v12 offset:51200
v_mfma_f32_16x16x32_bf16 v[44:47], v[128:131], a[204:207], v[44:47]
ds_read_b64_tr_b16 a[220:221], v13 offset:49152
ds_read_b64_tr_b16 a[222:223], v13 offset:51200
v_mfma_f32_16x16x32_bf16 v[48:51], v[132:135], a[192:195], v[48:51]
ds_read_b128 v[144:147], v15 offset:24576
ds_read_b128 v[148:151], v15 offset:28672
v_mfma_f32_16x16x32_bf16 v[52:55], v[132:135], a[196:199], v[52:55]
ds_read_b128 v[152:155], v15 offset:57344
ds_read_b128 v[156:159], v15 offset:61440
v_mfma_f32_16x16x32_bf16 v[56:59], v[132:135], a[200:203], v[56:59]
v_mfma_f32_16x16x32_bf16 v[60:63], v[132:135], a[204:207], v[60:63]
v_mfma_f32_16x16x32_bf16 v[64:67], v[136:139], a[192:195], v[64:67]
v_mfma_f32_16x16x32_bf16 v[68:71], v[136:139], a[196:199], v[68:71]
v_mfma_f32_16x16x32_bf16 v[72:75], v[136:139], a[200:203], v[72:75]
v_mfma_f32_16x16x32_bf16 v[76:79], v[136:139], a[204:207], v[76:79]
v_mfma_f32_16x16x32_bf16 v[80:83], v[140:143], a[192:195], v[80:83]
v_mfma_f32_16x16x32_bf16 v[84:87], v[140:143], a[196:199], v[84:87]
v_mfma_f32_16x16x32_bf16 v[88:91], v[140:143], a[200:203], v[88:91]
v_mfma_f32_16x16x32_bf16 v[92:95], v[140:143], a[204:207], v[92:95]
s_waitcnt lgkmcnt(0)
s_waitcnt vmcnt(4)
s_barrier
v_mfma_f32_16x16x32_bf16 v[32:35], v[144:147], a[208:211], v[32:35]
ds_read_b64_tr_b16 a[224:225], v24 offset:0
ds_read_b64_tr_b16 a[226:227], v24 offset:2048
v_mfma_f32_16x16x32_bf16 v[36:39], v[144:147], a[212:215], v[36:39]
ds_read_b64_tr_b16 a[228:229], v25 offset:0
ds_read_b64_tr_b16 a[230:231], v25 offset:2048
v_mfma_f32_16x16x32_bf16 v[40:43], v[144:147], a[216:219], v[40:43]
ds_read_b64_tr_b16 a[232:233], v26 offset:0
ds_read_b64_tr_b16 a[234:235], v26 offset:2048
v_mfma_f32_16x16x32_bf16 v[44:47], v[144:147], a[220:223], v[44:47]
ds_read_b64_tr_b16 a[236:237], v27 offset:0
ds_read_b64_tr_b16 a[238:239], v27 offset:2048
v_mfma_f32_16x16x32_bf16 v[48:51], v[148:151], a[208:211], v[48:51]
ds_read_b128 v[128:131], v16 offset:24576
ds_read_b128 v[132:135], v16 offset:28672
v_mfma_f32_16x16x32_bf16 v[52:55], v[148:151], a[212:215], v[52:55]
ds_read_b128 v[136:139], v16 offset:57344
ds_read_b128 v[140:143], v16 offset:61440
v_mfma_f32_16x16x32_bf16 v[56:59], v[148:151], a[216:219], v[56:59]
v_mfma_f32_16x16x32_bf16 v[60:63], v[148:151], a[220:223], v[60:63]
v_mfma_f32_16x16x32_bf16 v[64:67], v[152:155], a[208:211], v[64:67]
v_mfma_f32_16x16x32_bf16 v[68:71], v[152:155], a[212:215], v[68:71]
v_mfma_f32_16x16x32_bf16 v[72:75], v[152:155], a[216:219], v[72:75]
v_mfma_f32_16x16x32_bf16 v[76:79], v[152:155], a[220:223], v[76:79]
v_mfma_f32_16x16x32_bf16 v[80:83], v[156:159], a[208:211], v[80:83]
v_mfma_f32_16x16x32_bf16 v[84:87], v[156:159], a[212:215], v[84:87]
v_mfma_f32_16x16x32_bf16 v[88:91], v[156:159], a[216:219], v[88:91]
v_mfma_f32_16x16x32_bf16 v[92:95], v[156:159], a[220:223], v[92:95]
s_waitcnt lgkmcnt(0)
s_waitcnt vmcnt(0)
s_barrier
v_mfma_f32_16x16x32_bf16 v[32:35], v[128:131], a[224:227], v[32:35]
ds_read_b64_tr_b16 a[240:241], v24 offset:16384
ds_read_b64_tr_b16 a[242:243], v24 offset:18432
v_mfma_f32_16x16x32_bf16 v[36:39], v[128:131], a[228:231], v[36:39]
ds_read_b64_tr_b16 a[244:245], v25 offset:16384
ds_read_b64_tr_b16 a[246:247], v25 offset:18432
v_mfma_f32_16x16x32_bf16 v[40:43], v[128:131], a[232:235], v[40:43]
ds_read_b64_tr_b16 a[248:249], v26 offset:16384
ds_read_b64_tr_b16 a[250:251], v26 offset:18432
v_mfma_f32_16x16x32_bf16 v[44:47], v[128:131], a[236:239], v[44:47]
ds_read_b64_tr_b16 a[252:253], v27 offset:16384
ds_read_b64_tr_b16 a[254:255], v27 offset:18432
v_mfma_f32_16x16x32_bf16 v[48:51], v[132:135], a[224:227], v[48:51]
ds_read_b128 v[144:147], v17 offset:24576
ds_read_b128 v[148:151], v17 offset:28672
v_mfma_f32_16x16x32_bf16 v[52:55], v[132:135], a[228:231], v[52:55]
ds_read_b128 v[152:155], v17 offset:57344
ds_read_b128 v[156:159], v17 offset:61440
v_mfma_f32_16x16x32_bf16 v[56:59], v[132:135], a[232:235], v[56:59]
s_add_u32 m0, s46, 98304
s_add_u32 s49, s43, 98304
v_mfma_f32_16x16x32_bf16 v[60:63], v[132:135], a[236:239], v[60:63]
buffer_load_dwordx4 v6, s[16:19], s49 offen offset:0 lds
v_mfma_f32_16x16x32_bf16 v[64:67], v[136:139], a[224:227], v[64:67]
buffer_load_dwordx4 v7, s[16:19], s49 offen offset:1024 lds
v_mfma_f32_16x16x32_bf16 v[68:71], v[136:139], a[228:231], v[68:71]
buffer_load_dwordx4 v8, s[16:19], s49 offen offset:2048 lds
v_mfma_f32_16x16x32_bf16 v[72:75], v[136:139], a[232:235], v[72:75]
buffer_load_dwordx4 v9, s[16:19], s49 offen offset:3072 lds
v_mfma_f32_16x16x32_bf16 v[76:79], v[136:139], a[236:239], v[76:79]
s_add_u32 m0, s46, 102400
s_add_u32 s49, s43, 114688
v_mfma_f32_16x16x32_bf16 v[80:83], v[140:143], a[224:227], v[80:83]
buffer_load_dwordx4 v6, s[16:19], s49 offen offset:0 lds
v_mfma_f32_16x16x32_bf16 v[84:87], v[140:143], a[228:231], v[84:87]
buffer_load_dwordx4 v7, s[16:19], s49 offen offset:1024 lds
v_mfma_f32_16x16x32_bf16 v[88:91], v[140:143], a[232:235], v[88:91]
buffer_load_dwordx4 v8, s[16:19], s49 offen offset:2048 lds
v_mfma_f32_16x16x32_bf16 v[92:95], v[140:143], a[236:239], v[92:95]
buffer_load_dwordx4 v9, s[16:19], s49 offen offset:3072 lds
s_waitcnt lgkmcnt(0)
s_barrier
v_mfma_f32_16x16x32_bf16 v[32:35], v[144:147], a[240:243], v[32:35]
v_mfma_f32_16x16x32_bf16 v[36:39], v[144:147], a[244:247], v[36:39]
s_add_u32 m0, s46, 131072
s_add_u32 s49, s43, 131072
v_mfma_f32_16x16x32_bf16 v[40:43], v[144:147], a[248:251], v[40:43]
buffer_load_dwordx4 v6, s[16:19], s49 offen offset:0 lds
v_mfma_f32_16x16x32_bf16 v[44:47], v[144:147], a[252:255], v[44:47]
buffer_load_dwordx4 v7, s[16:19], s49 offen offset:1024 lds
v_mfma_f32_16x16x32_bf16 v[48:51], v[148:151], a[240:243], v[48:51]
buffer_load_dwordx4 v8, s[16:19], s49 offen offset:2048 lds
v_mfma_f32_16x16x32_bf16 v[52:55], v[148:151], a[244:247], v[52:55]
buffer_load_dwordx4 v9, s[16:19], s49 offen offset:3072 lds
v_mfma_f32_16x16x32_bf16 v[56:59], v[148:151], a[248:251], v[56:59]
s_add_u32 m0, s46, 135168
s_add_u32 s49, s43, 147456
v_mfma_f32_16x16x32_bf16 v[60:63], v[148:151], a[252:255], v[60:63]
buffer_load_dwordx4 v6, s[16:19], s49 offen offset:0 lds
v_mfma_f32_16x16x32_bf16 v[64:67], v[152:155], a[240:243], v[64:67]
buffer_load_dwordx4 v7, s[16:19], s49 offen offset:1024 lds
v_mfma_f32_16x16x32_bf16 v[68:71], v[152:155], a[244:247], v[68:71]
buffer_load_dwordx4 v8, s[16:19], s49 offen offset:2048 lds
v_mfma_f32_16x16x32_bf16 v[72:75], v[152:155], a[248:251], v[72:75]
buffer_load_dwordx4 v9, s[16:19], s49 offen offset:3072 lds
v_mfma_f32_16x16x32_bf16 v[76:79], v[152:155], a[252:255], v[76:79]
v_mfma_f32_16x16x32_bf16 v[80:83], v[156:159], a[240:243], v[80:83]
v_mfma_f32_16x16x32_bf16 v[84:87], v[156:159], a[244:247], v[84:87]
v_mfma_f32_16x16x32_bf16 v[88:91], v[156:159], a[248:251], v[88:91]
v_mfma_f32_16x16x32_bf16 v[92:95], v[156:159], a[252:255], v[92:95]
s_waitcnt lgkmcnt(0)
s_waitcnt vmcnt(32)
s_barrier
s_cmp_lt_u32 s2, 8
s_cbranch_scc0 CPF3_X
s_cmp_eq_u32 s36, 3
s_cbranch_scc0 CPF3_X
s_getpc_b64 s[64:65]
CPF3_P:
s_add_u32 s64, s64, K1_END-CPF3_P
s_addc_u32 s65, s65, ((K1_END-CPF3_P)>>32)&0xffffffff
s_mov_b32 s66, TEXT_END-K1_END
s_mov_b32 s67, 0x00020000
v_lshlrev_b32 v232, 7, v1
s_mov_b32 s68, 0
CPF3_L:
buffer_load_dword v233, v232, s[64:67], s68 offen
s_add_u32 s68, s68, 8192
s_cmp_lt_u32 s68, s66
s_cbranch_scc1 CPF3_L
CPF3_X:
ds_read_b128 v[128:131], v18 offset:0
ds_read_b128 v[132:135], v18 offset:4096
ds_read_b128 v[136:139], v19 offset:0
ds_read_b128 v[140:143], v19 offset:4096
s_waitcnt lgkmcnt(2)
v_mfma_f32_16x16x32_bf16 v[96:99], v[128:131], a[0:3], 0
ds_read_b128 v[144:147], v20 offset:0
ds_read_b128 v[148:151], v20 offset:4096
v_mfma_f32_16x16x32_bf16 v[100:103], v[128:131], a[4:7], 0
s_add_u32 m0, s46, 0
s_add_u32 s49, s43, 163840
v_mfma_f32_16x16x32_bf16 v[104:107], v[128:131], a[8:11], 0
buffer_load_dwordx4 v6, s[16:19], s49 offen offset:0 lds
v_mfma_f32_16x16x32_bf16 v[108:111], v[128:131], a[12:15], 0
v_mfma_f32_16x16x32_bf16 v[112:115], v[132:135], a[0:3], 0
v_mfma_f32_16x16x32_bf16 v[116:119], v[132:135], a[4:7], 0
v_mfma_f32_16x16x32_bf16 v[120:123], v[132:135], a[8:11], 0
v_mfma_f32_16x16x32_bf16 v[124:127], v[132:135], a[12:15], 0
s_waitcnt lgkmcnt(2)
v_mfma_f32_16x16x32_bf16 v[96:99], v[136:139], a[16:19], v[96:99]
ds_read_b128 v[128:131], v21 offset:0
ds_read_b128 v[132:135], v21 offset:4096
v_mfma_f32_16x16x32_bf16 v[100:103], v[136:139], a[20:23], v[100:103]
s_add_u32 s53, s44, 0
v_mfma_f32_16x16x32_bf16 v[104:107], v[136:139], a[24:27], v[104:107]
v_cvt_pk_bf16_f32 v160, v32, v33
v_cvt_pk_bf16_f32 v161, v34, v35
v_mfma_f32_16x16x32_bf16 v[108:111], v[136:139], a[28:31], v[108:111]
v_cvt_pk_bf16_f32 v162, v48, v49
v_cvt_pk_bf16_f32 v163, v50, v51
v_mfma_f32_16x16x32_bf16 v[112:115], v[140:143], a[16:19], v[112:115]
buffer_store_dwordx4 v[160:163], v22, s[32:35], s53 offen offset:2048 sc0 sc1
v_mfma_f32_16x16x32_bf16 v[116:119], v[140:143], a[20:23], v[116:119]
buffer_load_dwordx4 v7, s[16:19], s49 offen offset:1024 lds
v_mfma_f32_16x16x32_bf16 v[120:123], v[140:143], a[24:27], v[120:123]
v_mfma_f32_16x16x32_bf16 v[124:127], v[140:143], a[28:31], v[124:127]
s_waitcnt lgkmcnt(2)
v_mfma_f32_16x16x32_bf16 v[96:99], v[144:147], a[32:35], v[96:99]
ds_read_b128 v[136:139], v18 offset:8192
ds_read_b128 v[140:143], v18 offset:12288
v_mfma_f32_16x16x32_bf16 v[100:103], v[144:147], a[36:39], v[100:103]
v_mfma_f32_16x16x32_bf16 v[104:107], v[144:147], a[40:43], v[104:107]
v_mfma_f32_16x16x32_bf16 v[108:111], v[144:147], a[44:47], v[108:111]
v_mfma_f32_16x16x32_bf16 v[112:115], v[148:151], a[32:35], v[112:115]
v_mfma_f32_16x16x32_bf16 v[116:119], v[148:151], a[36:39], v[116:119]
v_cvt_pk_bf16_f32 v164, v36, v37
v_cvt_pk_bf16_f32 v165, v38, v39
v_mfma_f32_16x16x32_bf16 v[120:123], v[148:151], a[40:43], v[120:123]
v_cvt_pk_bf16_f32 v166, v52, v53
v_cvt_pk_bf16_f32 v167, v54, v55
v_mfma_f32_16x16x32_bf16 v[124:127], v[148:151], a[44:47], v[124:127]
s_waitcnt lgkmcnt(2)
v_mfma_f32_16x16x32_bf16 v[96:99], v[128:131], a[48:51], v[96:99]
ds_read_b128 v[144:147], v19 offset:8192
ds_read_b128 v[148:151], v19 offset:12288
v_mfma_f32_16x16x32_bf16 v[100:103], v[128:131], a[52:55], v[100:103]
buffer_load_dwordx4 v8, s[16:19], s49 offen offset:2048 lds
v_mfma_f32_16x16x32_bf16 v[104:107], v[128:131], a[56:59], v[104:107]
buffer_store_dwordx4 v[164:167], v22, s[32:35], s53 offen offset:3072 sc0 sc1
v_mfma_f32_16x16x32_bf16 v[108:111], v[128:131], a[60:63], v[108:111]
v_mfma_f32_16x16x32_bf16 v[112:115], v[132:135], a[48:51], v[112:115]
v_mfma_f32_16x16x32_bf16 v[116:119], v[132:135], a[52:55], v[116:119]
v_mfma_f32_16x16x32_bf16 v[120:123], v[132:135], a[56:59], v[120:123]
v_lshlrev_b32 v208, 16, v192
v_mfma_f32_16x16x32_bf16 v[124:127], v[132:135], a[60:63], v[124:127]
s_waitcnt lgkmcnt(2)
v_and_b32 v209, 0xffff0000, v192
v_mfma_f32_16x16x32_bf16 v[96:99], v[136:139], a[64:67], v[96:99]
ds_read_b128 v[128:131], v20 offset:8192
ds_read_b128 v[132:135], v20 offset:12288
v_mfma_f32_16x16x32_bf16 v[100:103], v[136:139], a[68:71], v[100:103]
v_cvt_pk_bf16_f32 v168, v40, v41
v_cvt_pk_bf16_f32 v169, v42, v43
v_mfma_f32_16x16x32_bf16 v[104:107], v[136:139], a[72:75], v[104:107]
v_cvt_pk_bf16_f32 v170, v56, v57
v_cvt_pk_bf16_f32 v171, v58, v59
v_mfma_f32_16x16x32_bf16 v[108:111], v[136:139], a[76:79], v[108:111]
buffer_store_dwordx4 v[168:171], v23, s[32:35], s53 offen offset:2048 sc0 sc1
v_mfma_f32_16x16x32_bf16 v[112:115], v[140:143], a[64:67], v[112:115]
v_lshlrev_b32 v210, 16, v193
v_mfma_f32_16x16x32_bf16 v[116:119], v[140:143], a[68:71], v[116:119]
buffer_load_dwordx4 v9, s[16:19], s49 offen offset:3072 lds
v_mfma_f32_16x16x32_bf16 v[120:123], v[140:143], a[72:75], v[120:123]
v_and_b32 v211, 0xffff0000, v193
v_mfma_f32_16x16x32_bf16 v[124:127], v[140:143], a[76:79], v[124:127]
s_waitcnt lgkmcnt(2)
v_lshlrev_b32 v212, 16, v194
v_mfma_f32_16x16x32_bf16 v[96:99], v[144:147], a[80:83], v[96:99]
ds_read_b128 v[136:139], v21 offset:8192
ds_read_b128 v[140:143], v21 offset:12288
v_mfma_f32_16x16x32_bf16 v[100:103], v[144:147], a[84:87], v[100:103]
v_and_b32 v213, 0xffff0000, v194
v_mfma_f32_16x16x32_bf16 v[104:107], v[144:147], a[88:91], v[104:107]
v_lshlrev_b32 v214, 16, v195
v_mfma_f32_16x16x32_bf16 v[108:111], v[144:147], a[92:95], v[108:111]
v_cvt_pk_bf16_f32 v172, v44, v45
v_cvt_pk_bf16_f32 v173, v46, v47
v_mfma_f32_16x16x32_bf16 v[112:115], v[148:151], a[80:83], v[112:115]
v_cvt_pk_bf16_f32 v174, v60, v61
v_cvt_pk_bf16_f32 v175, v62, v63
v_mfma_f32_16x16x32_bf16 v[116:119], v[148:151], a[84:87], v[116:119]
buffer_store_dwordx4 v[172:175], v23, s[32:35], s53 offen offset:3072 sc0 sc1
v_mfma_f32_16x16x32_bf16 v[120:123], v[148:151], a[88:91], v[120:123]
v_and_b32 v215, 0xffff0000, v195
v_mfma_f32_16x16x32_bf16 v[124:127], v[148:151], a[92:95], v[124:127]
s_waitcnt lgkmcnt(2)
v_lshlrev_b32 v216, 16, v196
v_mfma_f32_16x16x32_bf16 v[96:99], v[128:131], a[96:99], v[96:99]
ds_read_b128 v[144:147], v18 offset:16384
ds_read_b128 v[148:151], v18 offset:20480
v_mfma_f32_16x16x32_bf16 v[100:103], v[128:131], a[100:103], v[100:103]
s_add_u32 m0, s46, 4096
s_add_u32 s49, s43, 180224
v_mfma_f32_16x16x32_bf16 v[104:107], v[128:131], a[104:107], v[104:107]
buffer_load_dwordx4 v6, s[16:19], s49 offen offset:0 lds
v_mfma_f32_16x16x32_bf16 v[108:111], v[128:131], a[108:111], v[108:111]
v_and_b32 v217, 0xffff0000, v196
v_mfma_f32_16x16x32_bf16 v[112:115], v[132:135], a[96:99], v[112:115]
v_lshlrev_b32 v218, 16, v197
v_mfma_f32_16x16x32_bf16 v[116:119], v[132:135], a[100:103], v[116:119]
v_and_b32 v219, 0xffff0000, v197
v_mfma_f32_16x16x32_bf16 v[120:123], v[132:135], a[104:107], v[120:123]
s_add_u32 s54, s44, 16384
v_lshlrev_b32 v220, 16, v198
v_mfma_f32_16x16x32_bf16 v[124:127], v[132:135], a[108:111], v[124:127]
s_waitcnt lgkmcnt(2)
v_cvt_pk_bf16_f32 v176, v64, v65
v_mfma_f32_16x16x32_bf16 v[96:99], v[136:139], a[112:115], v[96:99]
ds_read_b128 v[128:131], v19 offset:16384
ds_read_b128 v[132:135], v19 offset:20480
v_mfma_f32_16x16x32_bf16 v[100:103], v[136:139], a[116:119], v[100:103]
v_cvt_pk_bf16_f32 v177, v66, v67
v_cvt_pk_bf16_f32 v178, v80, v81
v_mfma_f32_16x16x32_bf16 v[104:107], v[136:139], a[120:123], v[104:107]
v_cvt_pk_bf16_f32 v179, v82, v83
v_and_b32 v221, 0xffff0000, v198
v_mfma_f32_16x16x32_bf16 v[108:111], v[136:139], a[124:127], v[108:111]
buffer_store_dwordx4 v[176:179], v22, s[32:35], s54 offen offset:2048 sc0 sc1
v_mfma_f32_16x16x32_bf16 v[112:115], v[140:143], a[112:115], v[112:115]
v_lshlrev_b32 v222, 16, v199
v_mfma_f32_16x16x32_bf16 v[116:119], v[140:143], a[116:119], v[116:119]
buffer_load_dwordx4 v7, s[16:19], s49 offen offset:1024 lds
v_mfma_f32_16x16x32_bf16 v[120:123], v[140:143], a[120:123], v[120:123]
v_and_b32 v223, 0xffff0000, v199
v_mfma_f32_16x16x32_bf16 v[124:127], v[140:143], a[124:127], v[124:127]
s_waitcnt lgkmcnt(2)
v_add_f32 v200, v208, v209
v_mfma_f32_16x16x32_bf16 v[96:99], v[144:147], a[128:131], v[96:99]
ds_read_b128 v[136:139], v20 offset:16384
ds_read_b128 v[140:143], v20 offset:20480
v_mfma_f32_16x16x32_bf16 v[100:103], v[144:147], a[132:135], v[100:103]
v_add_f32 v200, v200, v210
v_mfma_f32_16x16x32_bf16 v[104:107], v[144:147], a[136:139], v[104:107]
v_cvt_pk_bf16_f32 v180, v68, v69
v_cvt_pk_bf16_f32 v181, v70, v71
v_mfma_f32_16x16x32_bf16 v[108:111], v[144:147], a[140:143], v[108:111]
v_cvt_pk_bf16_f32 v182, v84, v85
v_cvt_pk_bf16_f32 v183, v86, v87
v_mfma_f32_16x16x32_bf16 v[112:115], v[148:151], a[128:131], v[112:115]
buffer_store_dwordx4 v[180:183], v22, s[32:35], s54 offen offset:3072 sc0 sc1
v_mfma_f32_16x16x32_bf16 v[116:119], v[148:151], a[132:135], v[116:119]
v_add_f32 v200, v200, v211
v_mfma_f32_16x16x32_bf16 v[120:123], v[148:151], a[136:139], v[120:123]
v_add_f32 v200, v200, v212
v_mfma_f32_16x16x32_bf16 v[124:127], v[148:151], a[140:143], v[124:127]
s_waitcnt lgkmcnt(2)
v_add_f32 v200, v200, v213
v_mfma_f32_16x16x32_bf16 v[96:99], v[128:131], a[144:147], v[96:99]
ds_read_b128 v[144:147], v21 offset:16384
ds_read_b128 v[148:151], v21 offset:20480
v_mfma_f32_16x16x32_bf16 v[100:103], v[128:131], a[148:151], v[100:103]
buffer_load_dwordx4 v8, s[16:19], s49 offen offset:2048 lds
v_mfma_f32_16x16x32_bf16 v[104:107], v[128:131], a[152:155], v[104:107]
v_add_f32 v200, v200, v214
v_mfma_f32_16x16x32_bf16 v[108:111], v[128:131], a[156:159], v[108:111]
v_add_f32 v200, v200, v215
v_mfma_f32_16x16x32_bf16 v[112:115], v[132:135], a[144:147], v[112:115]
v_mfma_f32_16x16x32_bf16 v[116:119], v[132:135], a[148:151], v[116:119]
v_cvt_pk_bf16_f32 v184, v72, v73
v_cvt_pk_bf16_f32 v185, v74, v75
v_mfma_f32_16x16x32_bf16 v[120:123], v[132:135], a[152:155], v[120:123]
v_cvt_pk_bf16_f32 v186, v88, v89
v_cvt_pk_bf16_f32 v187, v90, v91
v_mfma_f32_16x16x32_bf16 v[124:127], v[132:135], a[156:159], v[124:127]
s_waitcnt lgkmcnt(2)
v_add_f32_dpp v200, v200, v200 row_ror:8 row_mask:0xf bank_mask:0xf
v_mfma_f32_16x16x32_bf16 v[96:99], v[136:139], a[160:163], v[96:99]
ds_read_b128 v[128:131], v18 offset:24576
ds_read_b128 v[132:135], v18 offset:28672
v_mfma_f32_16x16x32_bf16 v[100:103], v[136:139], a[164:167], v[100:103]
buffer_store_dwordx4 v[184:187], v23, s[32:35], s54 offen offset:2048 sc0 sc1
v_mfma_f32_16x16x32_bf16 v[104:107], v[136:139], a[168:171], v[104:107]
v_add_f32_dpp v200, v200, v200 row_ror:4 row_mask:0xf bank_mask:0xf
v_mfma_f32_16x16x32_bf16 v[108:111], v[136:139], a[172:175], v[108:111]
v_mfma_f32_16x16x32_bf16 v[112:115], v[140:143], a[160:163], v[112:115]
v_mfma_f32_16x16x32_bf16 v[116:119], v[140:143], a[164:167], v[116:119]
buffer_load_dwordx4 v9, s[16:19], s49 offen offset:3072 lds
v_mfma_f32_16x16x32_bf16 v[120:123], v[140:143], a[168:171], v[120:123]
v_add_f32_dpp v200, v200, v200 row_ror:2 row_mask:0xf bank_mask:0xf
v_mfma_f32_16x16x32_bf16 v[124:127], v[140:143], a[172:175], v[124:127]
s_waitcnt lgkmcnt(2)
v_mfma_f32_16x16x32_bf16 v[96:99], v[144:147], a[176:179], v[96:99]
ds_read_b128 v[136:139], v19 offset:24576
ds_read_b128 v[140:143], v19 offset:28672
v_mfma_f32_16x16x32_bf16 v[100:103], v[144:147], a[180:183], v[100:103]
v_cvt_pk_bf16_f32 v188, v76, v77
v_cvt_pk_bf16_f32 v189, v78, v79
v_mfma_f32_16x16x32_bf16 v[104:107], v[144:147], a[184:187], v[104:107]
v_cvt_pk_bf16_f32 v190, v92, v93
v_cvt_pk_bf16_f32 v191, v94, v95
v_mfma_f32_16x16x32_bf16 v[108:111], v[144:147], a[188:191], v[108:111]
buffer_store_dwordx4 v[188:191], v23, s[32:35], s54 offen offset:3072 sc0 sc1
v_mfma_f32_16x16x32_bf16 v[112:115], v[148:151], a[176:179], v[112:115]
v_add_f32_dpp v200, v200, v200 row_ror:1 row_mask:0xf bank_mask:0xf
v_mfma_f32_16x16x32_bf16 v[116:119], v[148:151], a[180:183], v[116:119]
v_mov_b32 v202, v200
v_mfma_f32_16x16x32_bf16 v[120:123], v[148:151], a[184:187], v[120:123]
v_mfma_f32_16x16x32_bf16 v[124:127], v[148:151], a[188:191], v[124:127]
s_waitcnt lgkmcnt(2)
v_mfma_f32_16x16x32_bf16 v[96:99], v[128:131], a[192:195], v[96:99]
ds_read_b128 v[144:147], v20 offset:24576
ds_read_b128 v[148:151], v20 offset:28672
v_mfma_f32_16x16x32_bf16 v[100:103], v[128:131], a[196:199], v[100:103]
v_permlane16_swap_b32 v200, v202
v_mfma_f32_16x16x32_bf16 v[104:107], v[128:131], a[200:203], v[104:107]
v_mfma_f32_16x16x32_bf16 v[108:111], v[128:131], a[204:207], v[108:111]
v_mfma_f32_16x16x32_bf16 v[112:115], v[132:135], a[192:195], v[112:115]
v_add_f32 v200, v200, v202
v_mfma_f32_16x16x32_bf16 v[116:119], v[132:135], a[196:199], v[116:119]
v_mov_b32 v202, v200
v_mfma_f32_16x16x32_bf16 v[120:123], v[132:135], a[200:203], v[120:123]
v_mfma_f32_16x16x32_bf16 v[124:127], v[132:135], a[204:207], v[124:127]
s_waitcnt lgkmcnt(2)
v_mfma_f32_16x16x32_bf16 v[96:99], v[136:139], a[208:211], v[96:99]
ds_read_b128 v[128:131], v21 offset:24576
ds_read_b128 v[132:135], v21 offset:28672
v_mfma_f32_16x16x32_bf16 v[100:103], v[136:139], a[212:215], v[100:103]
v_permlane32_swap_b32 v200, v202
v_mfma_f32_16x16x32_bf16 v[104:107], v[136:139], a[216:219], v[104:107]
v_mfma_f32_16x16x32_bf16 v[108:111], v[136:139], a[220:223], v[108:111]
s_waitcnt vmcnt(24)
v_mfma_f32_16x16x32_bf16 v[112:115], v[140:143], a[208:211], v[112:115]
v_add_f32 v200, v200, v202
s_barrier
v_mfma_f32_16x16x32_bf16 v[116:119], v[140:143], a[212:215], v[116:119]
v_mul_f32 v200, 0x3b000000, v200
v_mfma_f32_16x16x32_bf16 v[120:123], v[140:143], a[216:219], v[120:123]
v_sub_f32 v208, v208, v200
v_mfma_f32_16x16x32_bf16 v[124:127], v[140:143], a[220:223], v[124:127]
s_waitcnt lgkmcnt(2)
v_sub_f32 v209, v209, v200
v_mfma_f32_16x16x32_bf16 v[96:99], v[144:147], a[224:227], v[96:99]
ds_read_b128 v[136:139], v18 offset:32768
ds_read_b128 v[140:143], v18 offset:36864
v_mfma_f32_16x16x32_bf16 v[100:103], v[144:147], a[228:231], v[100:103]
v_sub_f32 v210, v210, v200
v_mfma_f32_16x16x32_bf16 v[104:107], v[144:147], a[232:235], v[104:107]
v_sub_f32 v211, v211, v200
v_mfma_f32_16x16x32_bf16 v[108:111], v[144:147], a[236:239], v[108:111]
v_sub_f32 v212, v212, v200
v_mfma_f32_16x16x32_bf16 v[112:115], v[148:151], a[224:227], v[112:115]
v_sub_f32 v213, v213, v200
v_mfma_f32_16x16x32_bf16 v[116:119], v[148:151], a[228:231], v[116:119]
v_sub_f32 v214, v214, v200
v_mfma_f32_16x16x32_bf16 v[120:123], v[148:151], a[232:235], v[120:123]
v_sub_f32 v215, v215, v200
v_mfma_f32_16x16x32_bf16 v[124:127], v[148:151], a[236:239], v[124:127]
s_waitcnt lgkmcnt(2)
v_mul_f32 v200, v208, v208
v_mfma_f32_16x16x32_bf16 v[96:99], v[128:131], a[240:243], v[96:99]
ds_read_b128 v[144:147], v19 offset:32768
ds_read_b128 v[148:151], v19 offset:36864
v_mfma_f32_16x16x32_bf16 v[100:103], v[128:131], a[244:247], v[100:103]
v_fmac_f32 v200, v209, v209
v_mfma_f32_16x16x32_bf16 v[104:107], v[128:131], a[248:251], v[104:107]
v_fmac_f32 v200, v210, v210
v_mfma_f32_16x16x32_bf16 v[108:111], v[128:131], a[252:255], v[108:111]
v_fmac_f32 v200, v211, v211
v_mfma_f32_16x16x32_bf16 v[112:115], v[132:135], a[240:243], v[112:115]
v_fmac_f32 v200, v212, v212
v_mfma_f32_16x16x32_bf16 v[116:119], v[132:135], a[244:247], v[116:119]
v_fmac_f32 v200, v213, v213
v_mfma_f32_16x16x32_bf16 v[120:123], v[132:135], a[248:251], v[120:123]
v_fmac_f32 v200, v214, v214
v_mfma_f32_16x16x32_bf16 v[124:127], v[132:135], a[252:255], v[124:127]
s_waitcnt lgkmcnt(2)
v_fmac_f32 v200, v215, v215
v_mfma_f32_16x16x32_bf16 v[32:35], v[136:139], a[0:3], 0
ds_read_b128 v[128:131], v20 offset:32768
ds_read_b128 v[132:135], v20 offset:36864
v_mfma_f32_16x16x32_bf16 v[36:39], v[136:139], a[4:7], 0
s_add_u32 m0, s46, 32768
s_add_u32 s49, s43, 196608
v_mfma_f32_16x16x32_bf16 v[40:43], v[136:139], a[8:11], 0
buffer_load_dwordx4 v6, s[16:19], s49 offen offset:0 lds
v_mfma_f32_16x16x32_bf16 v[44:47], v[136:139], a[12:15], 0
v_add_f32_dpp v200, v200, v200 row_ror:8 row_mask:0xf bank_mask:0xf
v_mfma_f32_16x16x32_bf16 v[48:51], v[140:143], a[0:3], 0
v_mfma_f32_16x16x32_bf16 v[52:55], v[140:143], a[4:7], 0
v_mfma_f32_16x16x32_bf16 v[56:59], v[140:143], a[8:11], 0
v_add_f32_dpp v200, v200, v200 row_ror:4 row_mask:0xf bank_mask:0xf
v_mfma_f32_16x16x32_bf16 v[60:63], v[140:143], a[12:15], 0
s_waitcnt lgkmcnt(2)
v_mfma_f32_16x16x32_bf16 v[32:35], v[144:147], a[16:19], v[32:35]
ds_read_b128 v[136:139], v21 offset:32768
ds_read_b128 v[140:143], v21 offset:36864
v_mfma_f32_16x16x32_bf16 v[36:39], v[144:147], a[20:23], v[36:39]
s_add_u32 s53, s44, 32768
v_add_f32_dpp v200, v200, v200 row_ror:2 row_mask:0xf bank_mask:0xf
v_mfma_f32_16x16x32_bf16 v[40:43], v[144:147], a[24:27], v[40:43]
v_cvt_pk_bf16_f32 v176, v96, v97
v_cvt_pk_bf16_f32 v177, v98, v99
v_mfma_f32_16x16x32_bf16 v[44:47], v[144:147], a[28:31], v[44:47]
v_cvt_pk_bf16_f32 v178, v112, v113
v_cvt_pk_bf16_f32 v179, v114, v115
v_mfma_f32_16x16x32_bf16 v[48:51], v[148:151], a[16:19], v[48:51]
buffer_store_dwordx4 v[176:179], v22, s[32:35], s53 offen offset:2048 sc0 sc1
v_mfma_f32_16x16x32_bf16 v[52:55], v[148:151], a[20:23], v[52:55]
buffer_load_dwordx4 v7, s[16:19], s49 offen offset:1024 lds
v_mfma_f32_16x16x32_bf16 v[56:59], v[148:151], a[24:27], v[56:59]
v_add_f32_dpp v200, v200, v200 row_ror:1 row_mask:0xf bank_mask:0xf
v_mfma_f32_16x16x32_bf16 v[60:63], v[148:151], a[28:31], v[60:63]
s_waitcnt lgkmcnt(2)
v_mov_b32 v202, v200
v_mfma_f32_16x16x32_bf16 v[32:35], v[128:131], a[32:35], v[32:35]
ds_read_b128 v[144:147], v18 offset:40960
ds_read_b128 v[148:151], v18 offset:45056
v_mfma_f32_16x16x32_bf16 v[36:39], v[128:131], a[36:39], v[36:39]
v_mfma_f32_16x16x32_bf16 v[40:43], v[128:131], a[40:43], v[40:43]
v_permlane16_swap_b32 v200, v202
v_mfma_f32_16x16x32_bf16 v[44:47], v[128:131], a[44:47], v[44:47]
v_mfma_f32_16x16x32_bf16 v[48:51], v[132:135], a[32:35], v[48:51]
v_mfma_f32_16x16x32_bf16 v[52:55], v[132:135], a[36:39], v[52:55]
v_add_f32 v200, v200, v202
v_mfma_f32_16x16x32_bf16 v[56:59], v[132:135], a[40:43], v[56:59]
v_mov_b32 v202, v200
v_mfma_f32_16x16x32_bf16 v[60:63], v[132:135], a[44:47], v[60:63]
s_waitcnt lgkmcnt(2)
v_mfma_f32_16x16x32_bf16 v[32:35], v[136:139], a[48:51], v[32:35]
ds_read_b128 v[128:131], v19 offset:40960
ds_read_b128 v[132:135], v19 offset:45056
v_mfma_f32_16x16x32_bf16 v[36:39], v[136:139], a[52:55], v[36:39]
buffer_load_dwordx4 v8, s[16:19], s49 offen offset:2048 lds
v_mfma_f32_16x16x32_bf16 v[40:43], v[136:139], a[56:59], v[40:43]
v_permlane32_swap_b32 v200, v202
v_mfma_f32_16x16x32_bf16 v[44:47], v[136:139], a[60:63], v[44:47]
v_mfma_f32_16x16x32_bf16 v[48:51], v[140:143], a[48:51], v[48:51]
v_mfma_f32_16x16x32_bf16 v[52:55], v[140:143], a[52:55], v[52:55]
v_add_f32 v200, v200, v202
v_mfma_f32_16x16x32_bf16 v[56:59], v[140:143], a[56:59], v[56:59]
v_mov_b32 v203, 0x3727c5ac
v_mfma_f32_16x16x32_bf16 v[60:63], v[140:143], a[60:63], v[60:63]
s_waitcnt lgkmcnt(2)
v_fmac_f32 v203, 0x3b000000, v200
v_mfma_f32_16x16x32_bf16 v[32:35], v[144:147], a[64:67], v[32:35]
ds_read_b128 v[136:139], v20 offset:40960
ds_read_b128 v[140:143], v20 offset:45056
v_mfma_f32_16x16x32_bf16 v[36:39], v[144:147], a[68:71], v[36:39]
v_cvt_pk_bf16_f32 v180, v100, v101
v_cvt_pk_bf16_f32 v181, v102, v103
v_mfma_f32_16x16x32_bf16 v[40:43], v[144:147], a[72:75], v[40:43]
v_cvt_pk_bf16_f32 v182, v116, v117
v_cvt_pk_bf16_f32 v183, v118, v119
v_mfma_f32_16x16x32_bf16 v[44:47], v[144:147], a[76:79], v[44:47]
buffer_store_dwordx4 v[180:183], v22, s[32:35], s53 offen offset:3072 sc0 sc1
v_mfma_f32_16x16x32_bf16 v[48:51], v[148:151], a[64:67], v[48:51]
v_rsq_f32 v200, v203
v_mfma_f32_16x16x32_bf16 v[52:55], v[148:151], a[68:71], v[52:55]
buffer_load_dwordx4 v9, s[16:19], s49 offen offset:3072 lds
v_mfma_f32_16x16x32_bf16 v[56:59], v[148:151], a[72:75], v[56:59]
v_mul_f32 v200, 0x3e0293ee, v200
v_mfma_f32_16x16x32_bf16 v[60:63], v[148:151], a[76:79], v[60:63]
s_waitcnt lgkmcnt(2)
v_mul_f32 v208, v208, v200
v_mfma_f32_16x16x32_bf16 v[32:35], v[128:131], a[80:83], v[32:35]
ds_read_b128 v[144:147], v21 offset:40960
ds_read_b128 v[148:151], v21 offset:45056
v_mfma_f32_16x16x32_bf16 v[36:39], v[128:131], a[84:87], v[36:39]
v_mul_f32 v209, v209, v200
v_mfma_f32_16x16x32_bf16 v[40:43], v[128:131], a[88:91], v[40:43]
v_mul_f32 v210, v210, v200
v_mfma_f32_16x16x32_bf16 v[44:47], v[128:131], a[92:95], v[44:47]
v_mul_f32 v211, v211, v200
v_mfma_f32_16x16x32_bf16 v[48:51], v[132:135], a[80:83], v[48:51]
v_mul_f32 v212, v212, v200
v_mfma_f32_16x16x32_bf16 v[52:55], v[132:135], a[84:87], v[52:55]
v_mul_f32 v213, v213, v200
v_mfma_f32_16x16x32_bf16 v[56:59], v[132:135], a[88:91], v[56:59]
v_mul_f32 v214, v214, v200
v_mfma_f32_16x16x32_bf16 v[60:63], v[132:135], a[92:95], v[60:63]
s_waitcnt lgkmcnt(2)
v_mul_f32 v215, v215, v200
v_mfma_f32_16x16x32_bf16 v[32:35], v[136:139], a[96:99], v[32:35]
ds_read_b128 v[128:131], v18 offset:49152
ds_read_b128 v[132:135], v18 offset:53248
v_mfma_f32_16x16x32_bf16 v[36:39], v[136:139], a[100:103], v[36:39]
s_add_u32 m0, s46, 36864
s_add_u32 s49, s43, 212992
v_mfma_f32_16x16x32_bf16 v[40:43], v[136:139], a[104:107], v[40:43]
buffer_load_dwordx4 v6, s[16:19], s49 offen offset:0 lds
v_mfma_f32_16x16x32_bf16 v[44:47], v[136:139], a[108:111], v[44:47]
v_cvt_pk_bf16_f32 v192, v208, v209
v_mfma_f32_16x16x32_bf16 v[48:51], v[140:143], a[96:99], v[48:51]
v_cvt_pk_bf16_f32 v193, v210, v211
v_mfma_f32_16x16x32_bf16 v[52:55], v[140:143], a[100:103], v[52:55]
v_cvt_pk_bf16_f32 v194, v212, v213
v_mfma_f32_16x16x32_bf16 v[56:59], v[140:143], a[104:107], v[56:59]
v_cvt_pk_bf16_f32 v184, v104, v105
v_cvt_pk_bf16_f32 v185, v106, v107
v_mfma_f32_16x16x32_bf16 v[60:63], v[140:143], a[108:111], v[60:63]
s_waitcnt lgkmcnt(2)
v_cvt_pk_bf16_f32 v186, v120, v121
v_mfma_f32_16x16x32_bf16 v[32:35], v[144:147], a[112:115], v[32:35]
ds_read_b128 v[136:139], v19 offset:49152
ds_read_b128 v[140:143], v19 offset:53248
v_mfma_f32_16x16x32_bf16 v[36:39], v[144:147], a[116:119], v[36:39]
v_cvt_pk_bf16_f32 v187, v122, v123
v_cvt_pk_bf16_f32 v195, v214, v215
v_mfma_f32_16x16x32_bf16 v[40:43], v[144:147], a[120:123], v[40:43]
buffer_store_dwordx4 v[184:187], v23, s[32:35], s53 offen offset:2048 sc0 sc1
v_mfma_f32_16x16x32_bf16 v[44:47], v[144:147], a[124:127], v[44:47]
v_add_f32 v201, v216, v217
v_mfma_f32_16x16x32_bf16 v[48:51], v[148:151], a[112:115], v[48:51]
v_add_f32 v201, v201, v218
v_mfma_f32_16x16x32_bf16 v[52:55], v[148:151], a[116:119], v[52:55]
buffer_load_dwordx4 v7, s[16:19], s49 offen offset:1024 lds
v_mfma_f32_16x16x32_bf16 v[56:59], v[148:151], a[120:123], v[56:59]
v_add_f32 v201, v201, v219
v_mfma_f32_16x16x32_bf16 v[60:63], v[148:151], a[124:127], v[60:63]
s_waitcnt lgkmcnt(2)
v_add_f32 v201, v201, v220
v_mfma_f32_16x16x32_bf16 v[32:35], v[128:131], a[128:131], v[32:35]
ds_read_b128 v[144:147], v20 offset:49152
ds_read_b128 v[148:151], v20 offset:53248
v_mfma_f32_16x16x32_bf16 v[36:39], v[128:131], a[132:135], v[36:39]
v_add_f32 v201, v201, v221
v_mfma_f32_16x16x32_bf16 v[40:43], v[128:131], a[136:139], v[40:43]
v_add_f32 v201, v201, v222
v_mfma_f32_16x16x32_bf16 v[44:47], v[128:131], a[140:143], v[44:47]
v_add_f32 v201, v201, v223
v_mfma_f32_16x16x32_bf16 v[48:51], v[132:135], a[128:131], v[48:51]
v_mfma_f32_16x16x32_bf16 v[52:55], v[132:135], a[132:135], v[52:55]
v_mfma_f32_16x16x32_bf16 v[56:59], v[132:135], a[136:139], v[56:59]
v_add_f32_dpp v201, v201, v201 row_ror:8 row_mask:0xf bank_mask:0xf
v_mfma_f32_16x16x32_bf16 v[60:63], v[132:135], a[140:143], v[60:63]
s_waitcnt lgkmcnt(2)
v_mfma_f32_16x16x32_bf16 v[32:35], v[136:139], a[144:147], v[32:35]
ds_read_b128 v[128:131], v21 offset:49152
ds_read_b128 v[132:135], v21 offset:53248
v_mfma_f32_16x16x32_bf16 v[36:39], v[136:139], a[148:151], v[36:39]
buffer_load_dwordx4 v8, s[16:19], s49 offen offset:2048 lds
v_mfma_f32_16x16x32_bf16 v[40:43], v[136:139], a[152:155], v[40:43]
v_add_f32_dpp v201, v201, v201 row_ror:4 row_mask:0xf bank_mask:0xf
v_mfma_f32_16x16x32_bf16 v[44:47], v[136:139], a[156:159], v[44:47]
v_mfma_f32_16x16x32_bf16 v[48:51], v[140:143], a[144:147], v[48:51]
v_cvt_pk_bf16_f32 v188, v108, v109
v_cvt_pk_bf16_f32 v189, v110, v111
v_mfma_f32_16x16x32_bf16 v[52:55], v[140:143], a[148:151], v[52:55]
v_cvt_pk_bf16_f32 v190, v124, v125
v_cvt_pk_bf16_f32 v191, v126, v127
v_mfma_f32_16x16x32_bf16 v[56:59], v[140:143], a[152:155], v[56:59]
buffer_store_dwordx4 v[188:191], v23, s[32:35], s53 offen offset:3072 sc0 sc1
v_mfma_f32_16x16x32_bf16 v[60:63], v[140:143], a[156:159], v[60:63]
s_waitcnt lgkmcnt(2)
v_add_f32_dpp v201, v201, v201 row_ror:2 row_mask:0xf bank_mask:0xf
v_mfma_f32_16x16x32_bf16 v[32:35], v[144:147], a[160:163], v[32:35]
ds_read_b128 v[136:139], v18 offset:57344
ds_read_b128 v[140:143], v18 offset:61440
v_mfma_f32_16x16x32_bf16 v[36:39], v[144:147], a[164:167], v[36:39]
v_mfma_f32_16x16x32_bf16 v[40:43], v[144:147], a[168:171], v[40:43]
v_add_f32_dpp v201, v201, v201 row_ror:1 row_mask:0xf bank_mask:0xf
v_mfma_f32_16x16x32_bf16 v[44:47], v[144:147], a[172:175], v[44:47]
v_mov_b32 v202, v201
v_mfma_f32_16x16x32_bf16 v[48:51], v[148:151], a[160:163], v[48:51]
v_mfma_f32_16x16x32_bf16 v[52:55], v[148:151], a[164:167], v[52:55]
buffer_load_dwordx4 v9, s[16:19], s49 offen offset:3072 lds
v_mfma_f32_16x16x32_bf16 v[56:59], v[148:151], a[168:171], v[56:59]
v_permlane16_swap_b32 v201, v202
v_mfma_f32_16x16x32_bf16 v[60:63], v[148:151], a[172:175], v[60:63]
s_waitcnt lgkmcnt(2)
v_mfma_f32_16x16x32_bf16 v[32:35], v[128:131], a[176:179], v[32:35]
ds_read_b128 v[144:147], v19 offset:57344
ds_read_b128 v[148:151], v19 offset:61440
v_mfma_f32_16x16x32_bf16 v[36:39], v[128:131], a[180:183], v[36:39]
v_add_f32 v201, v201, v202
v_mfma_f32_16x16x32_bf16 v[40:43], v[128:131], a[184:187], v[40:43]
v_mov_b32 v202, v201
v_mfma_f32_16x16x32_bf16 v[44:47], v[128:131], a[188:191], v[44:47]
v_mfma_f32_16x16x32_bf16 v[48:51], v[132:135], a[176:179], v[48:51]
v_mfma_f32_16x16x32_bf16 v[52:55], v[132:135], a[180:183], v[52:55]
v_permlane32_swap_b32 v201, v202
v_mfma_f32_16x16x32_bf16 v[56:59], v[132:135], a[184:187], v[56:59]
v_mfma_f32_16x16x32_bf16 v[60:63], v[132:135], a[188:191], v[60:63]
s_waitcnt lgkmcnt(2)
v_mfma_f32_16x16x32_bf16 v[32:35], v[136:139], a[192:195], v[32:35]
ds_read_b128 v[128:131], v20 offset:57344
ds_read_b128 v[132:135], v20 offset:61440
v_mfma_f32_16x16x32_bf16 v[36:39], v[136:139], a[196:199], v[36:39]
v_add_f32 v201, v201, v202
v_mfma_f32_16x16x32_bf16 v[40:43], v[136:139], a[200:203], v[40:43]
v_mul_f32 v201, 0x3b000000, v201
v_mfma_f32_16x16x32_bf16 v[44:47], v[136:139], a[204:207], v[44:47]
v_sub_f32 v216, v216, v201
v_mfma_f32_16x16x32_bf16 v[48:51], v[140:143], a[192:195], v[48:51]
v_sub_f32 v217, v217, v201
v_mfma_f32_16x16x32_bf16 v[52:55], v[140:143], a[196:199], v[52:55]
v_sub_f32 v218, v218, v201
v_mfma_f32_16x16x32_bf16 v[56:59], v[140:143], a[200:203], v[56:59]
v_sub_f32 v219, v219, v201
v_mfma_f32_16x16x32_bf16 v[60:63], v[140:143], a[204:207], v[60:63]
s_waitcnt lgkmcnt(2)
v_sub_f32 v220, v220, v201
v_mfma_f32_16x16x32_bf16 v[32:35], v[144:147], a[208:211], v[32:35]
ds_read_b128 v[136:139], v21 offset:57344
ds_read_b128 v[140:143], v21 offset:61440
v_mfma_f32_16x16x32_bf16 v[36:39], v[144:147], a[212:215], v[36:39]
v_sub_f32 v221, v221, v201
v_mfma_f32_16x16x32_bf16 v[40:43], v[144:147], a[216:219], v[40:43]
v_sub_f32 v222, v222, v201
v_mfma_f32_16x16x32_bf16 v[44:47], v[144:147], a[220:223], v[44:47]
v_sub_f32 v223, v223, v201
s_waitcnt vmcnt(28)
v_mfma_f32_16x16x32_bf16 v[48:51], v[148:151], a[208:211], v[48:51]
v_mul_f32 v201, v216, v216
s_barrier
v_mfma_f32_16x16x32_bf16 v[52:55], v[148:151], a[212:215], v[52:55]
v_fmac_f32 v201, v217, v217
v_mfma_f32_16x16x32_bf16 v[56:59], v[148:151], a[216:219], v[56:59]
v_fmac_f32 v201, v218, v218
v_mfma_f32_16x16x32_bf16 v[60:63], v[148:151], a[220:223], v[60:63]
s_waitcnt lgkmcnt(2)
v_fmac_f32 v201, v219, v219
v_mfma_f32_16x16x32_bf16 v[32:35], v[128:131], a[224:227], v[32:35]
ds_read_b128 v[144:147], v28 offset:0
ds_read_b128 v[148:151], v28 offset:4096
v_mfma_f32_16x16x32_bf16 v[36:39], v[128:131], a[228:231], v[36:39]
v_fmac_f32 v201, v220, v220
v_mfma_f32_16x16x32_bf16 v[40:43], v[128:131], a[232:235], v[40:43]
v_fmac_f32 v201, v221, v221
v_mfma_f32_16x16x32_bf16 v[44:47], v[128:131], a[236:239], v[44:47]
v_fmac_f32 v201, v222, v222
v_mfma_f32_16x16x32_bf16 v[48:51], v[132:135], a[224:227], v[48:51]
v_fmac_f32 v201, v223, v223
v_mfma_f32_16x16x32_bf16 v[52:55], v[132:135], a[228:231], v[52:55]
v_mfma_f32_16x16x32_bf16 v[56:59], v[132:135], a[232:235], v[56:59]
v_mfma_f32_16x16x32_bf16 v[60:63], v[132:135], a[236:239], v[60:63]
s_waitcnt lgkmcnt(2)
v_add_f32_dpp v201, v201, v201 row_ror:8 row_mask:0xf bank_mask:0xf
v_mfma_f32_16x16x32_bf16 v[32:35], v[136:139], a[240:243], v[32:35]
ds_read_b128 v[128:131], v29 offset:0
ds_read_b128 v[132:135], v29 offset:4096
v_mfma_f32_16x16x32_bf16 v[36:39], v[136:139], a[244:247], v[36:39]
v_mfma_f32_16x16x32_bf16 v[40:43], v[136:139], a[248:251], v[40:43]
v_add_f32_dpp v201, v201, v201 row_ror:4 row_mask:0xf bank_mask:0xf
v_mfma_f32_16x16x32_bf16 v[44:47], v[136:139], a[252:255], v[44:47]
v_mfma_f32_16x16x32_bf16 v[48:51], v[140:143], a[240:243], v[48:51]
v_mfma_f32_16x16x32_bf16 v[52:55], v[140:143], a[244:247], v[52:55]
v_add_f32_dpp v201, v201, v201 row_ror:2 row_mask:0xf bank_mask:0xf
v_mfma_f32_16x16x32_bf16 v[56:59], v[140:143], a[248:251], v[56:59]
v_mfma_f32_16x16x32_bf16 v[60:63], v[140:143], a[252:255], v[60:63]
s_waitcnt lgkmcnt(2)
v_mfma_f32_16x16x32_bf16 v[64:67], v[144:147], a[0:3], 0
ds_read_b128 v[136:139], v30 offset:0
ds_read_b128 v[140:143], v30 offset:4096
v_mfma_f32_16x16x32_bf16 v[68:71], v[144:147], a[4:7], 0
s_add_u32 m0, s46, 65536
s_add_u32 s49, s43, 229376
v_mfma_f32_16x16x32_bf16 v[72:75], v[144:147], a[8:11], 0
buffer_load_dwordx4 v6, s[16:19], s49 offen offset:0 lds
v_mfma_f32_16x16x32_bf16 v[76:79], v[144:147], a[12:15], 0
v_add_f32_dpp v201, v201, v201 row_ror:1 row_mask:0xf bank_mask:0xf
v_mfma_f32_16x16x32_bf16 v[80:83], v[148:151], a[0:3], 0
v_mov_b32 v202, v201
v_mfma_f32_16x16x32_bf16 v[84:87], v[148:151], a[4:7], 0
v_mfma_f32_16x16x32_bf16 v[88:91], v[148:151], a[8:11], 0
v_mfma_f32_16x16x32_bf16 v[92:95], v[148:151], a[12:15], 0
s_waitcnt lgkmcnt(2)
v_permlane16_swap_b32 v201, v202
v_mfma_f32_16x16x32_bf16 v[64:67], v[128:131], a[16:19], v[64:67]
ds_read_b128 v[144:147], v31 offset:0
ds_read_b128 v[148:151], v31 offset:4096
v_mfma_f32_16x16x32_bf16 v[68:71], v[128:131], a[20:23], v[68:71]
s_add_u32 s54, s44, 49152
v_mfma_f32_16x16x32_bf16 v[72:75], v[128:131], a[24:27], v[72:75]
v_cvt_pk_bf16_f32 v160, v32, v33
v_cvt_pk_bf16_f32 v161, v34, v35
v_mfma_f32_16x16x32_bf16 v[76:79], v[128:131], a[28:31], v[76:79]
v_cvt_pk_bf16_f32 v162, v48, v49
v_cvt_pk_bf16_f32 v163, v50, v51
v_mfma_f32_16x16x32_bf16 v[80:83], v[132:135], a[16:19], v[80:83]
buffer_store_dwordx4 v[160:163], v22, s[32:35], s54 offen offset:2048 sc0 sc1
v_mfma_f32_16x16x32_bf16 v[84:87], v[132:135], a[20:23], v[84:87]
buffer_load_dwordx4 v7, s[16:19], s49 offen offset:1024 lds
v_mfma_f32_16x16x32_bf16 v[88:91], v[132:135], a[24:27], v[88:91]
v_add_f32 v201, v201, v202
v_mfma_f32_16x16x32_bf16 v[92:95], v[132:135], a[28:31], v[92:95]
s_waitcnt lgkmcnt(2)
v_mov_b32 v202, v201
v_mfma_f32_16x16x32_bf16 v[64:67], v[136:139], a[32:35], v[64:67]
ds_read_b128 v[128:131], v28 offset:8192
ds_read_b128 v[132:135], v28 offset:12288
v_mfma_f32_16x16x32_bf16 v[68:71], v[136:139], a[36:39], v[68:71]
v_mfma_f32_16x16x32_bf16 v[72:75], v[136:139], a[40:43], v[72:75]
v_permlane32_swap_b32 v201, v202
v_mfma_f32_16x16x32_bf16 v[76:79], v[136:139], a[44:47], v[76:79]
v_mfma_f32_16x16x32_bf16 v[80:83], v[140:143], a[32:35], v[80:83]
v_mfma_f32_16x16x32_bf16 v[84:87], v[140:143], a[36:39], v[84:87]
v_add_f32 v201, v201, v202
v_mfma_f32_16x16x32_bf16 v[88:91], v[140:143], a[40:43], v[88:91]
v_mov_b32 v203, 0x3727c5ac
v_mfma_f32_16x16x32_bf16 v[92:95], v[140:143], a[44:47], v[92:95]
s_waitcnt lgkmcnt(2)
v_fmac_f32 v203, 0x3b000000, v201
v_mfma_f32_16x16x32_bf16 v[64:67], v[144:147], a[48:51], v[64:67]
ds_read_b128 v[136:139], v29 offset:8192
ds_read_b128 v[140:143], v29 offset:12288
v_mfma_f32_16x16x32_bf16 v[68:71], v[144:147], a[52:55], v[68:71]
buffer_load_dwordx4 v8, s[16:19], s49 offen offset:2048 lds
v_mfma_f32_16x16x32_bf16 v[72:75], v[144:147], a[56:59], v[72:75]
v_rsq_f32 v201, v203
v_mfma_f32_16x16x32_bf16 v[76:79], v[144:147], a[60:63], v[76:79]
v_mfma_f32_16x16x32_bf16 v[80:83], v[148:151], a[48:51], v[80:83]
v_mul_f32 v201, 0x3e0293ee, v201
v_mfma_f32_16x16x32_bf16 v[84:87], v[148:151], a[52:55], v[84:87]
v_mul_f32 v216, v216, v201
v_mfma_f32_16x16x32_bf16 v[88:91], v[148:151], a[56:59], v[88:91]
v_mul_f32 v217, v217, v201
v_mfma_f32_16x16x32_bf16 v[92:95], v[148:151], a[60:63], v[92:95]
s_waitcnt lgkmcnt(2)
v_mul_f32 v218, v218, v201
v_mfma_f32_16x16x32_bf16 v[64:67], v[128:131], a[64:67], v[64:67]
ds_read_b128 v[144:147], v30 offset:8192
ds_read_b128 v[148:151], v30 offset:12288
v_mfma_f32_16x16x32_bf16 v[68:71], v[128:131], a[68:71], v[68:71]
v_cvt_pk_bf16_f32 v164, v36, v37
v_cvt_pk_bf16_f32 v165, v38, v39
v_mfma_f32_16x16x32_bf16 v[72:75], v[128:131], a[72:75], v[72:75]
v_cvt_pk_bf16_f32 v166, v52, v53
v_cvt_pk_bf16_f32 v167, v54, v55
v_mfma_f32_16x16x32_bf16 v[76:79], v[128:131], a[76:79], v[76:79]
buffer_store_dwordx4 v[164:167], v22, s[32:35], s54 offen offset:3072 sc0 sc1
v_mfma_f32_16x16x32_bf16 v[80:83], v[132:135], a[64:67], v[80:83]
v_mul_f32 v219, v219, v201
v_mfma_f32_16x16x32_bf16 v[84:87], v[132:135], a[68:71], v[84:87]
buffer_load_dwordx4 v9, s[16:19], s49 offen offset:3072 lds
v_mfma_f32_16x16x32_bf16 v[88:91], v[132:135], a[72:75], v[88:91]
v_mul_f32 v220, v220, v201
v_mfma_f32_16x16x32_bf16 v[92:95], v[132:135], a[76:79], v[92:95]
s_waitcnt lgkmcnt(2)
v_mul_f32 v221, v221, v201
v_mfma_f32_16x16x32_bf16 v[64:67], v[136:139], a[80:83], v[64:67]
ds_read_b128 v[128:131], v31 offset:8192
ds_read_b128 v[132:135], v31 offset:12288
v_mfma_f32_16x16x32_bf16 v[68:71], v[136:139], a[84:87], v[68:71]
v_mul_f32 v222, v222, v201
v_mfma_f32_16x16x32_bf16 v[72:75], v[136:139], a[88:91], v[72:75]
v_mul_f32 v223, v223, v201
v_mfma_f32_16x16x32_bf16 v[76:79], v[136:139], a[92:95], v[76:79]
v_cvt_pk_bf16_f32 v196, v216, v217
v_mfma_f32_16x16x32_bf16 v[80:83], v[140:143], a[80:83], v[80:83]
v_cvt_pk_bf16_f32 v197, v218, v219
v_mfma_f32_16x16x32_bf16 v[84:87], v[140:143], a[84:87], v[84:87]
v_cvt_pk_bf16_f32 v198, v220, v221
v_mfma_f32_16x16x32_bf16 v[88:91], v[140:143], a[88:91], v[88:91]
v_cvt_pk_bf16_f32 v199, v222, v223
v_mfma_f32_16x16x32_bf16 v[92:95], v[140:143], a[92:95], v[92:95]
s_waitcnt lgkmcnt(2)
v_lshrrev_b32 v204, 2, v1
v_mfma_f32_16x16x32_bf16 v[64:67], v[144:147], a[96:99], v[64:67]
ds_read_b128 v[136:139], v28 offset:16384
ds_read_b128 v[140:143], v28 offset:20480
v_mfma_f32_16x16x32_bf16 v[68:71], v[144:147], a[100:103], v[68:71]
s_add_u32 m0, s46, 69632
s_add_u32 s49, s43, 245760
v_mfma_f32_16x16x32_bf16 v[72:75], v[144:147], a[104:107], v[72:75]
buffer_load_dwordx4 v6, s[16:19], s49 offen offset:0 lds
v_mfma_f32_16x16x32_bf16 v[76:79], v[144:147], a[108:111], v[76:79]
v_lshlrev_b32 v204, 10, v204
v_mfma_f32_16x16x32_bf16 v[80:83], v[148:151], a[96:99], v[80:83]
v_and_b32 v205, 3, v1
v_mfma_f32_16x16x32_bf16 v[84:87], v[148:151], a[100:103], v[84:87]
v_lshl_add_u32 v204, v205, 8, v204
v_mfma_f32_16x16x32_bf16 v[88:91], v[148:151], a[104:107], v[88:91]
v_cvt_pk_bf16_f32 v168, v40, v41
v_cvt_pk_bf16_f32 v169, v42, v43
v_mfma_f32_16x16x32_bf16 v[92:95], v[148:151], a[108:111], v[92:95]
s_waitcnt lgkmcnt(2)
v_cvt_pk_bf16_f32 v170, v56, v57
v_mfma_f32_16x16x32_bf16 v[64:67], v[128:131], a[112:115], v[64:67]
ds_read_b128 v[144:147], v29 offset:16384
ds_read_b128 v[148:151], v29 offset:20480
v_mfma_f32_16x16x32_bf16 v[68:71], v[128:131], a[116:119], v[68:71]
v_cvt_pk_bf16_f32 v171, v58, v59
s_lshr_b32 s51, s48, 4
v_mfma_f32_16x16x32_bf16 v[72:75], v[128:131], a[120:123], v[72:75]
buffer_store_dwordx4 v[168:171], v23, s[32:35], s54 offen offset:2048 sc0 sc1
v_mfma_f32_16x16x32_bf16 v[76:79], v[128:131], a[124:127], v[76:79]
s_lshl_b32 s51, s51, 14
v_mfma_f32_16x16x32_bf16 v[80:83], v[132:135], a[112:115], v[80:83]
s_and_b32 s52, s48, 15
v_mfma_f32_16x16x32_bf16 v[84:87], v[132:135], a[116:119], v[84:87]
buffer_load_dwordx4 v7, s[16:19], s49 offen offset:1024 lds
v_mfma_f32_16x16x32_bf16 v[88:91], v[132:135], a[120:123], v[88:91]
s_lshl_b32 s52, s52, 4
v_mfma_f32_16x16x32_bf16 v[92:95], v[132:135], a[124:127], v[92:95]
s_waitcnt lgkmcnt(2)
s_add_u32 s51, s51, s52
v_mfma_f32_16x16x32_bf16 v[64:67], v[136:139], a[128:131], v[64:67]
ds_read_b128 v[128:131], v30 offset:16384
ds_read_b128 v[132:135], v30 offset:20480
v_mfma_f32_16x16x32_bf16 v[68:71], v[136:139], a[132:135], v[68:71]
buffer_store_dwordx4 v[192:195], v204, s[28:31], s51 offen sc0 sc1
v_mfma_f32_16x16x32_bf16 v[72:75], v[136:139], a[136:139], v[72:75]
v_mfma_f32_16x16x32_bf16 v[76:79], v[136:139], a[140:143], v[76:79]
buffer_store_dwordx4 v[196:199], v204, s[28:31], s51 offen offset:16 sc0 sc1
v_mfma_f32_16x16x32_bf16 v[80:83], v[140:143], a[128:131], v[80:83]
v_mfma_f32_16x16x32_bf16 v[84:87], v[140:143], a[132:135], v[84:87]
v_mfma_f32_16x16x32_bf16 v[88:91], v[140:143], a[136:139], v[88:91]
v_mfma_f32_16x16x32_bf16 v[92:95], v[140:143], a[140:143], v[92:95]
s_waitcnt lgkmcnt(2)
v_mfma_f32_16x16x32_bf16 v[64:67], v[144:147], a[144:147], v[64:67]
ds_read_b128 v[136:139], v31 offset:16384
ds_read_b128 v[140:143], v31 offset:20480
v_mfma_f32_16x16x32_bf16 v[68:71], v[144:147], a[148:151], v[68:71]
buffer_load_dwordx4 v8, s[16:19], s49 offen offset:2048 lds
v_mfma_f32_16x16x32_bf16 v[72:75], v[144:147], a[152:155], v[72:75]
v_mfma_f32_16x16x32_bf16 v[76:79], v[144:147], a[156:159], v[76:79]
v_mfma_f32_16x16x32_bf16 v[80:83], v[148:151], a[144:147], v[80:83]
v_cvt_pk_bf16_f32 v172, v44, v45
v_cvt_pk_bf16_f32 v173, v46, v47
v_mfma_f32_16x16x32_bf16 v[84:87], v[148:151], a[148:151], v[84:87]
v_cvt_pk_bf16_f32 v174, v60, v61
v_cvt_pk_bf16_f32 v175, v62, v63
v_mfma_f32_16x16x32_bf16 v[88:91], v[148:151], a[152:155], v[88:91]
buffer_store_dwordx4 v[172:175], v23, s[32:35], s54 offen offset:3072 sc0 sc1
v_mfma_f32_16x16x32_bf16 v[92:95], v[148:151], a[156:159], v[92:95]
s_waitcnt lgkmcnt(2)
v_mfma_f32_16x16x32_bf16 v[64:67], v[128:131], a[160:163], v[64:67]
ds_read_b128 v[144:147], v28 offset:24576
ds_read_b128 v[148:151], v28 offset:28672
v_mfma_f32_16x16x32_bf16 v[68:71], v[128:131], a[164:167], v[68:71]
v_mfma_f32_16x16x32_bf16 v[72:75], v[128:131], a[168:171], v[72:75]
v_mfma_f32_16x16x32_bf16 v[76:79], v[128:131], a[172:175], v[76:79]
v_mfma_f32_16x16x32_bf16 v[80:83], v[132:135], a[160:163], v[80:83]
v_mfma_f32_16x16x32_bf16 v[84:87], v[132:135], a[164:167], v[84:87]
buffer_load_dwordx4 v9, s[16:19], s49 offen offset:3072 lds
v_mfma_f32_16x16x32_bf16 v[88:91], v[132:135], a[168:171], v[88:91]
v_mfma_f32_16x16x32_bf16 v[92:95], v[132:135], a[172:175], v[92:95]
s_waitcnt lgkmcnt(2)
v_mfma_f32_16x16x32_bf16 v[64:67], v[136:139], a[176:179], v[64:67]
ds_read_b128 v[128:131], v29 offset:24576
ds_read_b128 v[132:135], v29 offset:28672
v_mfma_f32_16x16x32_bf16 v[68:71], v[136:139], a[180:183], v[68:71]
v_mfma_f32_16x16x32_bf16 v[72:75], v[136:139], a[184:187], v[72:75]
v_mfma_f32_16x16x32_bf16 v[76:79], v[136:139], a[188:191], v[76:79]
v_mfma_f32_16x16x32_bf16 v[80:83], v[140:143], a[176:179], v[80:83]
v_mfma_f32_16x16x32_bf16 v[84:87], v[140:143], a[180:183], v[84:87]
v_mfma_f32_16x16x32_bf16 v[88:91], v[140:143], a[184:187], v[88:91]
v_mfma_f32_16x16x32_bf16 v[92:95], v[140:143], a[188:191], v[92:95]
s_waitcnt lgkmcnt(2)
v_mfma_f32_16x16x32_bf16 v[64:67], v[144:147], a[192:195], v[64:67]
ds_read_b128 v[136:139], v30 offset:24576
ds_read_b128 v[140:143], v30 offset:28672
v_mfma_f32_16x16x32_bf16 v[68:71], v[144:147], a[196:199], v[68:71]
v_mfma_f32_16x16x32_bf16 v[72:75], v[144:147], a[200:203], v[72:75]
v_mfma_f32_16x16x32_bf16 v[76:79], v[144:147], a[204:207], v[76:79]
v_mfma_f32_16x16x32_bf16 v[80:83], v[148:151], a[192:195], v[80:83]
v_mfma_f32_16x16x32_bf16 v[84:87], v[148:151], a[196:199], v[84:87]
v_mfma_f32_16x16x32_bf16 v[88:91], v[148:151], a[200:203], v[88:91]
v_mfma_f32_16x16x32_bf16 v[92:95], v[148:151], a[204:207], v[92:95]
s_waitcnt lgkmcnt(2)
v_mfma_f32_16x16x32_bf16 v[64:67], v[128:131], a[208:211], v[64:67]
ds_read_b128 v[144:147], v31 offset:24576
ds_read_b128 v[148:151], v31 offset:28672
v_mfma_f32_16x16x32_bf16 v[68:71], v[128:131], a[212:215], v[68:71]
v_mfma_f32_16x16x32_bf16 v[72:75], v[128:131], a[216:219], v[72:75]
v_mfma_f32_16x16x32_bf16 v[76:79], v[128:131], a[220:223], v[76:79]
s_waitcnt vmcnt(27)
v_mfma_f32_16x16x32_bf16 v[80:83], v[132:135], a[208:211], v[80:83]
s_barrier
v_mfma_f32_16x16x32_bf16 v[84:87], v[132:135], a[212:215], v[84:87]
v_mfma_f32_16x16x32_bf16 v[88:91], v[132:135], a[216:219], v[88:91]
v_mfma_f32_16x16x32_bf16 v[92:95], v[132:135], a[220:223], v[92:95]
s_waitcnt lgkmcnt(2)
v_mfma_f32_16x16x32_bf16 v[64:67], v[136:139], a[224:227], v[64:67]
ds_read_b128 v[128:131], v14 offset:0
ds_read_b128 v[132:135], v14 offset:4096
v_mfma_f32_16x16x32_bf16 v[68:71], v[136:139], a[228:231], v[68:71]
v_mfma_f32_16x16x32_bf16 v[72:75], v[136:139], a[232:235], v[72:75]
v_mfma_f32_16x16x32_bf16 v[76:79], v[136:139], a[236:239], v[76:79]
v_mfma_f32_16x16x32_bf16 v[80:83], v[140:143], a[224:227], v[80:83]
v_mfma_f32_16x16x32_bf16 v[84:87], v[140:143], a[228:231], v[84:87]
v_mfma_f32_16x16x32_bf16 v[88:91], v[140:143], a[232:235], v[88:91]
v_mfma_f32_16x16x32_bf16 v[92:95], v[140:143], a[236:239], v[92:95]
s_waitcnt lgkmcnt(2)
v_mfma_f32_16x16x32_bf16 v[64:67], v[144:147], a[240:243], v[64:67]
ds_read_b128 v[136:139], v15 offset:0
ds_read_b128 v[140:143], v15 offset:4096
v_mfma_f32_16x16x32_bf16 v[68:71], v[144:147], a[244:247], v[68:71]
v_mfma_f32_16x16x32_bf16 v[72:75], v[144:147], a[248:251], v[72:75]
v_mfma_f32_16x16x32_bf16 v[76:79], v[144:147], a[252:255], v[76:79]
v_mfma_f32_16x16x32_bf16 v[80:83], v[148:151], a[240:243], v[80:83]
v_mfma_f32_16x16x32_bf16 v[84:87], v[148:151], a[244:247], v[84:87]
v_mfma_f32_16x16x32_bf16 v[88:91], v[148:151], a[248:251], v[88:91]
v_mfma_f32_16x16x32_bf16 v[92:95], v[148:151], a[252:255], v[92:95]
s_waitcnt lgkmcnt(2)
v_mfma_f32_16x16x32_bf16 v[96:99], v[128:131], a[0:3], 0
ds_read_b128 v[144:147], v16 offset:0
ds_read_b128 v[148:151], v16 offset:4096
v_mfma_f32_16x16x32_bf16 v[100:103], v[128:131], a[4:7], 0
v_mfma_f32_16x16x32_bf16 v[104:107], v[128:131], a[8:11], 0
v_mfma_f32_16x16x32_bf16 v[108:111], v[128:131], a[12:15], 0
v_mfma_f32_16x16x32_bf16 v[112:115], v[132:135], a[0:3], 0
v_mfma_f32_16x16x32_bf16 v[116:119], v[132:135], a[4:7], 0
v_mfma_f32_16x16x32_bf16 v[120:123], v[132:135], a[8:11], 0
v_mfma_f32_16x16x32_bf16 v[124:127], v[132:135], a[12:15], 0
s_waitcnt lgkmcnt(2)
v_mfma_f32_16x16x32_bf16 v[96:99], v[136:139], a[16:19], v[96:99]
ds_read_b128 v[128:131], v17 offset:0
ds_read_b128 v[132:135], v17 offset:4096
v_mfma_f32_16x16x32_bf16 v[100:103], v[136:139], a[20:23], v[100:103]
s_add_u32 s53, s44, 65536
v_mfma_f32_16x16x32_bf16 v[104:107], v[136:139], a[24:27], v[104:107]
v_cvt_pk_bf16_f32 v176, v64, v65
v_cvt_pk_bf16_f32 v177, v66, v67
v_mfma_f32_16x16x32_bf16 v[108:111], v[136:139], a[28:31], v[108:111]
v_cvt_pk_bf16_f32 v178, v80, v81
v_cvt_pk_bf16_f32 v179, v82, v83
v_mfma_f32_16x16x32_bf16 v[112:115], v[140:143], a[16:19], v[112:115]
buffer_store_dwordx4 v[176:179], v22, s[32:35], s53 offen offset:2048 sc0 sc1
v_mfma_f32_16x16x32_bf16 v[116:119], v[140:143], a[20:23], v[116:119]
v_mfma_f32_16x16x32_bf16 v[120:123], v[140:143], a[24:27], v[120:123]
v_mfma_f32_16x16x32_bf16 v[124:127], v[140:143], a[28:31], v[124:127]
s_waitcnt lgkmcnt(2)
v_mfma_f32_16x16x32_bf16 v[96:99], v[144:147], a[32:35], v[96:99]
ds_read_b128 v[136:139], v14 offset:8192
ds_read_b128 v[140:143], v14 offset:12288
v_mfma_f32_16x16x32_bf16 v[100:103], v[144:147], a[36:39], v[100:103]
v_mfma_f32_16x16x32_bf16 v[104:107], v[144:147], a[40:43], v[104:107]
v_mfma_f32_16x16x32_bf16 v[108:111], v[144:147], a[44:47], v[108:111]
v_mfma_f32_16x16x32_bf16 v[112:115], v[148:151], a[32:35], v[112:115]
v_mfma_f32_16x16x32_bf16 v[116:119], v[148:151], a[36:39], v[116:119]
v_mfma_f32_16x16x32_bf16 v[120:123], v[148:151], a[40:43], v[120:123]
v_mfma_f32_16x16x32_bf16 v[124:127], v[148:151], a[44:47], v[124:127]
s_waitcnt lgkmcnt(2)
v_mfma_f32_16x16x32_bf16 v[96:99], v[128:131], a[48:51], v[96:99]
ds_read_b128 v[144:147], v15 offset:8192
ds_read_b128 v[148:151], v15 offset:12288
v_mfma_f32_16x16x32_bf16 v[100:103], v[128:131], a[52:55], v[100:103]
v_mfma_f32_16x16x32_bf16 v[104:107], v[128:131], a[56:59], v[104:107]
v_mfma_f32_16x16x32_bf16 v[108:111], v[128:131], a[60:63], v[108:111]
v_mfma_f32_16x16x32_bf16 v[112:115], v[132:135], a[48:51], v[112:115]
v_mfma_f32_16x16x32_bf16 v[116:119], v[132:135], a[52:55], v[116:119]
v_mfma_f32_16x16x32_bf16 v[120:123], v[132:135], a[56:59], v[120:123]
v_mfma_f32_16x16x32_bf16 v[124:127], v[132:135], a[60:63], v[124:127]
s_waitcnt lgkmcnt(2)
v_mfma_f32_16x16x32_bf16 v[96:99], v[136:139], a[64:67], v[96:99]
ds_read_b128 v[128:131], v16 offset:8192
ds_read_b128 v[132:135], v16 offset:12288
v_mfma_f32_16x16x32_bf16 v[100:103], v[136:139], a[68:71], v[100:103]
v_cvt_pk_bf16_f32 v180, v68, v69
v_cvt_pk_bf16_f32 v181, v70, v71
v_mfma_f32_16x16x32_bf16 v[104:107], v[136:139], a[72:75], v[104:107]
v_cvt_pk_bf16_f32 v182, v84, v85
v_cvt_pk_bf16_f32 v183, v86, v87
v_mfma_f32_16x16x32_bf16 v[108:111], v[136:139], a[76:79], v[108:111]
buffer_store_dwordx4 v[180:183], v22, s[32:35], s53 offen offset:3072 sc0 sc1
v_mfma_f32_16x16x32_bf16 v[112:115], v[140:143], a[64:67], v[112:115]
v_mfma_f32_16x16x32_bf16 v[116:119], v[140:143], a[68:71], v[116:119]
v_mfma_f32_16x16x32_bf16 v[120:123], v[140:143], a[72:75], v[120:123]
v_mfma_f32_16x16x32_bf16 v[124:127], v[140:143], a[76:79], v[124:127]
s_waitcnt lgkmcnt(2)
v_mfma_f32_16x16x32_bf16 v[96:99], v[144:147], a[80:83], v[96:99]
ds_read_b128 v[136:139], v17 offset:8192
ds_read_b128 v[140:143], v17 offset:12288
v_mfma_f32_16x16x32_bf16 v[100:103], v[144:147], a[84:87], v[100:103]
v_mfma_f32_16x16x32_bf16 v[104:107], v[144:147], a[88:91], v[104:107]
v_mfma_f32_16x16x32_bf16 v[108:111], v[144:147], a[92:95], v[108:111]
v_mfma_f32_16x16x32_bf16 v[112:115], v[148:151], a[80:83], v[112:115]
v_mfma_f32_16x16x32_bf16 v[116:119], v[148:151], a[84:87], v[116:119]
v_mfma_f32_16x16x32_bf16 v[120:123], v[148:151], a[88:91], v[120:123]
v_mfma_f32_16x16x32_bf16 v[124:127], v[148:151], a[92:95], v[124:127]
s_waitcnt lgkmcnt(2)
v_mfma_f32_16x16x32_bf16 v[96:99], v[128:131], a[96:99], v[96:99]
ds_read_b128 v[144:147], v14 offset:16384
ds_read_b128 v[148:151], v14 offset:20480
v_mfma_f32_16x16x32_bf16 v[100:103], v[128:131], a[100:103], v[100:103]
v_mfma_f32_16x16x32_bf16 v[104:107], v[128:131], a[104:107], v[104:107]
v_mfma_f32_16x16x32_bf16 v[108:111], v[128:131], a[108:111], v[108:111]
v_mfma_f32_16x16x32_bf16 v[112:115], v[132:135], a[96:99], v[112:115]
v_mfma_f32_16x16x32_bf16 v[116:119], v[132:135], a[100:103], v[116:119]
v_mfma_f32_16x16x32_bf16 v[120:123], v[132:135], a[104:107], v[120:123]
v_cvt_pk_bf16_f32 v184, v72, v73
v_cvt_pk_bf16_f32 v185, v74, v75
v_mfma_f32_16x16x32_bf16 v[124:127], v[132:135], a[108:111], v[124:127]
s_waitcnt lgkmcnt(2)
v_cvt_pk_bf16_f32 v186, v88, v89
v_mfma_f32_16x16x32_bf16 v[96:99], v[136:139], a[112:115], v[96:99]
ds_read_b128 v[128:131], v15 offset:16384
ds_read_b128 v[132:135], v15 offset:20480
v_mfma_f32_16x16x32_bf16 v[100:103], v[136:139], a[116:119], v[100:103]
v_cvt_pk_bf16_f32 v187, v90, v91
v_mfma_f32_16x16x32_bf16 v[104:107], v[136:139], a[120:123], v[104:107]
buffer_store_dwordx4 v[184:187], v23, s[32:35], s53 offen offset:2048 sc0 sc1
v_mfma_f32_16x16x32_bf16 v[108:111], v[136:139], a[124:127], v[108:111]
v_mfma_f32_16x16x32_bf16 v[112:115], v[140:143], a[112:115], v[112:115]
v_mfma_f32_16x16x32_bf16 v[116:119], v[140:143], a[116:119], v[116:119]
v_mfma_f32_16x16x32_bf16 v[120:123], v[140:143], a[120:123], v[120:123]
v_mfma_f32_16x16x32_bf16 v[124:127], v[140:143], a[124:127], v[124:127]
s_waitcnt lgkmcnt(2)
v_mfma_f32_16x16x32_bf16 v[96:99], v[144:147], a[128:131], v[96:99]
ds_read_b128 v[136:139], v16 offset:16384
ds_read_b128 v[140:143], v16 offset:20480
v_mfma_f32_16x16x32_bf16 v[100:103], v[144:147], a[132:135], v[100:103]
v_mfma_f32_16x16x32_bf16 v[104:107], v[144:147], a[136:139], v[104:107]
v_mfma_f32_16x16x32_bf16 v[108:111], v[144:147], a[140:143], v[108:111]
v_mfma_f32_16x16x32_bf16 v[112:115], v[148:151], a[128:131], v[112:115]
v_mfma_f32_16x16x32_bf16 v[116:119], v[148:151], a[132:135], v[116:119]
v_mfma_f32_16x16x32_bf16 v[120:123], v[148:151], a[136:139], v[120:123]
v_mfma_f32_16x16x32_bf16 v[124:127], v[148:151], a[140:143], v[124:127]
s_waitcnt lgkmcnt(2)
v_mfma_f32_16x16x32_bf16 v[96:99], v[128:131], a[144:147], v[96:99]
ds_read_b128 v[144:147], v17 offset:16384
ds_read_b128 v[148:151], v17 offset:20480
v_mfma_f32_16x16x32_bf16 v[100:103], v[128:131], a[148:151], v[100:103]
v_mfma_f32_16x16x32_bf16 v[104:107], v[128:131], a[152:155], v[104:107]
v_mfma_f32_16x16x32_bf16 v[108:111], v[128:131], a[156:159], v[108:111]
v_mfma_f32_16x16x32_bf16 v[112:115], v[132:135], a[144:147], v[112:115]
v_cvt_pk_bf16_f32 v188, v76, v77
v_cvt_pk_bf16_f32 v189, v78, v79
v_mfma_f32_16x16x32_bf16 v[116:119], v[132:135], a[148:151], v[116:119]
v_cvt_pk_bf16_f32 v190, v92, v93
v_cvt_pk_bf16_f32 v191, v94, v95
v_mfma_f32_16x16x32_bf16 v[120:123], v[132:135], a[152:155], v[120:123]
buffer_store_dwordx4 v[188:191], v23, s[32:35], s53 offen offset:3072 sc0 sc1
v_mfma_f32_16x16x32_bf16 v[124:127], v[132:135], a[156:159], v[124:127]
s_waitcnt lgkmcnt(2)
v_mfma_f32_16x16x32_bf16 v[96:99], v[136:139], a[160:163], v[96:99]
ds_read_b128 v[128:131], v14 offset:24576
ds_read_b128 v[132:135], v14 offset:28672
v_mfma_f32_16x16x32_bf16 v[100:103], v[136:139], a[164:167], v[100:103]
v_mfma_f32_16x16x32_bf16 v[104:107], v[136:139], a[168:171], v[104:107]
v_mfma_f32_16x16x32_bf16 v[108:111], v[136:139], a[172:175], v[108:111]
v_mfma_f32_16x16x32_bf16 v[112:115], v[140:143], a[160:163], v[112:115]
v_mfma_f32_16x16x32_bf16 v[116:119], v[140:143], a[164:167], v[116:119]
v_mfma_f32_16x16x32_bf16 v[120:123], v[140:143], a[168:171], v[120:123]
v_mfma_f32_16x16x32_bf16 v[124:127], v[140:143], a[172:175], v[124:127]
s_waitcnt lgkmcnt(2)
v_mfma_f32_16x16x32_bf16 v[96:99], v[144:147], a[176:179], v[96:99]
ds_read_b128 v[136:139], v15 offset:24576
ds_read_b128 v[140:143], v15 offset:28672
v_mfma_f32_16x16x32_bf16 v[100:103], v[144:147], a[180:183], v[100:103]
v_mfma_f32_16x16x32_bf16 v[104:107], v[144:147], a[184:187], v[104:107]
v_mfma_f32_16x16x32_bf16 v[108:111], v[144:147], a[188:191], v[108:111]
v_mfma_f32_16x16x32_bf16 v[112:115], v[148:151], a[176:179], v[112:115]
v_mfma_f32_16x16x32_bf16 v[116:119], v[148:151], a[180:183], v[116:119]
v_mfma_f32_16x16x32_bf16 v[120:123], v[148:151], a[184:187], v[120:123]
v_mfma_f32_16x16x32_bf16 v[124:127], v[148:151], a[188:191], v[124:127]
s_waitcnt lgkmcnt(2)
v_mfma_f32_16x16x32_bf16 v[96:99], v[128:131], a[192:195], v[96:99]
ds_read_b128 v[144:147], v16 offset:24576
ds_read_b128 v[148:151], v16 offset:28672
v_mfma_f32_16x16x32_bf16 v[100:103], v[128:131], a[196:199], v[100:103]
v_mfma_f32_16x16x32_bf16 v[104:107], v[128:131], a[200:203], v[104:107]
v_mfma_f32_16x16x32_bf16 v[108:111], v[128:131], a[204:207], v[108:111]
v_mfma_f32_16x16x32_bf16 v[112:115], v[132:135], a[192:195], v[112:115]
v_mfma_f32_16x16x32_bf16 v[116:119], v[132:135], a[196:199], v[116:119]
v_mfma_f32_16x16x32_bf16 v[120:123], v[132:135], a[200:203], v[120:123]
v_mfma_f32_16x16x32_bf16 v[124:127], v[132:135], a[204:207], v[124:127]
s_waitcnt lgkmcnt(2)
v_mfma_f32_16x16x32_bf16 v[96:99], v[136:139], a[208:211], v[96:99]
ds_read_b128 v[128:131], v17 offset:24576
ds_read_b128 v[132:135], v17 offset:28672
v_mfma_f32_16x16x32_bf16 v[100:103], v[136:139], a[212:215], v[100:103]
v_mfma_f32_16x16x32_bf16 v[104:107], v[136:139], a[216:219], v[104:107]
v_mfma_f32_16x16x32_bf16 v[108:111], v[136:139], a[220:223], v[108:111]
s_waitcnt vmcnt(18)
v_mfma_f32_16x16x32_bf16 v[112:115], v[140:143], a[208:211], v[112:115]
s_barrier
v_mfma_f32_16x16x32_bf16 v[116:119], v[140:143], a[212:215], v[116:119]
v_mfma_f32_16x16x32_bf16 v[120:123], v[140:143], a[216:219], v[120:123]
v_mfma_f32_16x16x32_bf16 v[124:127], v[140:143], a[220:223], v[124:127]
s_waitcnt lgkmcnt(2)
v_mfma_f32_16x16x32_bf16 v[96:99], v[144:147], a[224:227], v[96:99]
ds_read_b128 v[136:139], v14 offset:32768
ds_read_b128 v[140:143], v14 offset:36864
v_mfma_f32_16x16x32_bf16 v[100:103], v[144:147], a[228:231], v[100:103]
v_mfma_f32_16x16x32_bf16 v[104:107], v[144:147], a[232:235], v[104:107]
v_mfma_f32_16x16x32_bf16 v[108:111], v[144:147], a[236:239], v[108:111]
v_mfma_f32_16x16x32_bf16 v[112:115], v[148:151], a[224:227], v[112:115]
v_mfma_f32_16x16x32_bf16 v[116:119], v[148:151], a[228:231], v[116:119]
v_mfma_f32_16x16x32_bf16 v[120:123], v[148:151], a[232:235], v[120:123]
v_mfma_f32_16x16x32_bf16 v[124:127], v[148:151], a[236:239], v[124:127]
s_waitcnt lgkmcnt(2)
v_mfma_f32_16x16x32_bf16 v[96:99], v[128:131], a[240:243], v[96:99]
ds_read_b128 v[144:147], v15 offset:32768
ds_read_b128 v[148:151], v15 offset:36864
v_mfma_f32_16x16x32_bf16 v[100:103], v[128:131], a[244:247], v[100:103]
v_mfma_f32_16x16x32_bf16 v[104:107], v[128:131], a[248:251], v[104:107]
v_mfma_f32_16x16x32_bf16 v[108:111], v[128:131], a[252:255], v[108:111]
v_mfma_f32_16x16x32_bf16 v[112:115], v[132:135], a[240:243], v[112:115]
v_mfma_f32_16x16x32_bf16 v[116:119], v[132:135], a[244:247], v[116:119]
v_mfma_f32_16x16x32_bf16 v[120:123], v[132:135], a[248:251], v[120:123]
v_mfma_f32_16x16x32_bf16 v[124:127], v[132:135], a[252:255], v[124:127]
s_waitcnt lgkmcnt(2)
v_mfma_f32_16x16x32_bf16 v[32:35], v[136:139], a[0:3], 0
ds_read_b128 v[128:131], v16 offset:32768
ds_read_b128 v[132:135], v16 offset:36864
v_mfma_f32_16x16x32_bf16 v[36:39], v[136:139], a[4:7], 0
v_mfma_f32_16x16x32_bf16 v[40:43], v[136:139], a[8:11], 0
v_mfma_f32_16x16x32_bf16 v[44:47], v[136:139], a[12:15], 0
v_mfma_f32_16x16x32_bf16 v[48:51], v[140:143], a[0:3], 0
v_mfma_f32_16x16x32_bf16 v[52:55], v[140:143], a[4:7], 0
v_mfma_f32_16x16x32_bf16 v[56:59], v[140:143], a[8:11], 0
v_mfma_f32_16x16x32_bf16 v[60:63], v[140:143], a[12:15], 0
s_waitcnt lgkmcnt(2)
v_mfma_f32_16x16x32_bf16 v[32:35], v[144:147], a[16:19], v[32:35]
ds_read_b128 v[136:139], v17 offset:32768
ds_read_b128 v[140:143], v17 offset:36864
v_mfma_f32_16x16x32_bf16 v[36:39], v[144:147], a[20:23], v[36:39]
s_add_u32 s54, s44, 81920
v_mfma_f32_16x16x32_bf16 v[40:43], v[144:147], a[24:27], v[40:43]
v_cvt_pk_bf16_f32 v160, v96, v97
v_cvt_pk_bf16_f32 v161, v98, v99
v_mfma_f32_16x16x32_bf16 v[44:47], v[144:147], a[28:31], v[44:47]
v_cvt_pk_bf16_f32 v162, v112, v113
v_cvt_pk_bf16_f32 v163, v114, v115
v_mfma_f32_16x16x32_bf16 v[48:51], v[148:151], a[16:19], v[48:51]
buffer_store_dwordx4 v[160:163], v22, s[32:35], s54 offen offset:2048 sc0 sc1
v_mfma_f32_16x16x32_bf16 v[52:55], v[148:151], a[20:23], v[52:55]
v_mfma_f32_16x16x32_bf16 v[56:59], v[148:151], a[24:27], v[56:59]
v_mfma_f32_16x16x32_bf16 v[60:63], v[148:151], a[28:31], v[60:63]
s_waitcnt lgkmcnt(2)
v_mfma_f32_16x16x32_bf16 v[32:35], v[128:131], a[32:35], v[32:35]
ds_read_b128 v[144:147], v14 offset:40960
ds_read_b128 v[148:151], v14 offset:45056
v_mfma_f32_16x16x32_bf16 v[36:39], v[128:131], a[36:39], v[36:39]
v_mfma_f32_16x16x32_bf16 v[40:43], v[128:131], a[40:43], v[40:43]
v_mfma_f32_16x16x32_bf16 v[44:47], v[128:131], a[44:47], v[44:47]
v_mfma_f32_16x16x32_bf16 v[48:51], v[132:135], a[32:35], v[48:51]
v_mfma_f32_16x16x32_bf16 v[52:55], v[132:135], a[36:39], v[52:55]
v_mfma_f32_16x16x32_bf16 v[56:59], v[132:135], a[40:43], v[56:59]
v_mfma_f32_16x16x32_bf16 v[60:63], v[132:135], a[44:47], v[60:63]
s_waitcnt lgkmcnt(2)
v_mfma_f32_16x16x32_bf16 v[32:35], v[136:139], a[48:51], v[32:35]
ds_read_b128 v[128:131], v15 offset:40960
ds_read_b128 v[132:135], v15 offset:45056
v_mfma_f32_16x16x32_bf16 v[36:39], v[136:139], a[52:55], v[36:39]
v_mfma_f32_16x16x32_bf16 v[40:43], v[136:139], a[56:59], v[40:43]
v_mfma_f32_16x16x32_bf16 v[44:47], v[136:139], a[60:63], v[44:47]
v_mfma_f32_16x16x32_bf16 v[48:51], v[140:143], a[48:51], v[48:51]
v_mfma_f32_16x16x32_bf16 v[52:55], v[140:143], a[52:55], v[52:55]
v_mfma_f32_16x16x32_bf16 v[56:59], v[140:143], a[56:59], v[56:59]
v_mfma_f32_16x16x32_bf16 v[60:63], v[140:143], a[60:63], v[60:63]
s_waitcnt lgkmcnt(2)
v_mfma_f32_16x16x32_bf16 v[32:35], v[144:147], a[64:67], v[32:35]
ds_read_b128 v[136:139], v16 offset:40960
ds_read_b128 v[140:143], v16 offset:45056
v_mfma_f32_16x16x32_bf16 v[36:39], v[144:147], a[68:71], v[36:39]
v_cvt_pk_bf16_f32 v164, v100, v101
v_cvt_pk_bf16_f32 v165, v102, v103
v_mfma_f32_16x16x32_bf16 v[40:43], v[144:147], a[72:75], v[40:43]
v_cvt_pk_bf16_f32 v166, v116, v117
v_cvt_pk_bf16_f32 v167, v118, v119
v_mfma_f32_16x16x32_bf16 v[44:47], v[144:147], a[76:79], v[44:47]
buffer_store_dwordx4 v[164:167], v22, s[32:35], s54 offen offset:3072 sc0 sc1
v_mfma_f32_16x16x32_bf16 v[48:51], v[148:151], a[64:67], v[48:51]
v_mfma_f32_16x16x32_bf16 v[52:55], v[148:151], a[68:71], v[52:55]
v_mfma_f32_16x16x32_bf16 v[56:59], v[148:151], a[72:75], v[56:59]
v_mfma_f32_16x16x32_bf16 v[60:63], v[148:151], a[76:79], v[60:63]
s_waitcnt lgkmcnt(2)
v_mfma_f32_16x16x32_bf16 v[32:35], v[128:131], a[80:83], v[32:35]
ds_read_b128 v[144:147], v17 offset:40960
ds_read_b128 v[148:151], v17 offset:45056
v_mfma_f32_16x16x32_bf16 v[36:39], v[128:131], a[84:87], v[36:39]
v_mfma_f32_16x16x32_bf16 v[40:43], v[128:131], a[88:91], v[40:43]
v_mfma_f32_16x16x32_bf16 v[44:47], v[128:131], a[92:95], v[44:47]
v_mfma_f32_16x16x32_bf16 v[48:51], v[132:135], a[80:83], v[48:51]
v_mfma_f32_16x16x32_bf16 v[52:55], v[132:135], a[84:87], v[52:55]
v_mfma_f32_16x16x32_bf16 v[56:59], v[132:135], a[88:91], v[56:59]
v_mfma_f32_16x16x32_bf16 v[60:63], v[132:135], a[92:95], v[60:63]
s_waitcnt lgkmcnt(2)
v_mfma_f32_16x16x32_bf16 v[32:35], v[136:139], a[96:99], v[32:35]
ds_read_b128 v[128:131], v14 offset:49152
ds_read_b128 v[132:135], v14 offset:53248
v_mfma_f32_16x16x32_bf16 v[36:39], v[136:139], a[100:103], v[36:39]
v_mfma_f32_16x16x32_bf16 v[40:43], v[136:139], a[104:107], v[40:43]
v_mfma_f32_16x16x32_bf16 v[44:47], v[136:139], a[108:111], v[44:47]
v_mfma_f32_16x16x32_bf16 v[48:51], v[140:143], a[96:99], v[48:51]
v_mfma_f32_16x16x32_bf16 v[52:55], v[140:143], a[100:103], v[52:55]
v_mfma_f32_16x16x32_bf16 v[56:59], v[140:143], a[104:107], v[56:59]
v_cvt_pk_bf16_f32 v168, v104, v105
v_cvt_pk_bf16_f32 v169, v106, v107
v_mfma_f32_16x16x32_bf16 v[60:63], v[140:143], a[108:111], v[60:63]
s_waitcnt lgkmcnt(2)
v_cvt_pk_bf16_f32 v170, v120, v121
v_mfma_f32_16x16x32_bf16 v[32:35], v[144:147], a[112:115], v[32:35]
ds_read_b128 v[136:139], v15 offset:49152
ds_read_b128 v[140:143], v15 offset:53248
v_mfma_f32_16x16x32_bf16 v[36:39], v[144:147], a[116:119], v[36:39]
v_cvt_pk_bf16_f32 v171, v122, v123
v_mfma_f32_16x16x32_bf16 v[40:43], v[144:147], a[120:123], v[40:43]
buffer_store_dwordx4 v[168:171], v23, s[32:35], s54 offen offset:2048 sc0 sc1
v_mfma_f32_16x16x32_bf16 v[44:47], v[144:147], a[124:127], v[44:47]
v_mfma_f32_16x16x32_bf16 v[48:51], v[148:151], a[112:115], v[48:51]
buffer_load_dwordx4 v[224:227], v22, s[56:59], s55 offen offset:0
v_mfma_f32_16x16x32_bf16 v[52:55], v[148:151], a[116:119], v[52:55]
v_mfma_f32_16x16x32_bf16 v[56:59], v[148:151], a[120:123], v[56:59]
v_mfma_f32_16x16x32_bf16 v[60:63], v[148:151], a[124:127], v[60:63]
s_waitcnt lgkmcnt(2)
v_mfma_f32_16x16x32_bf16 v[32:35], v[128:131], a[128:131], v[32:35]
ds_read_b128 v[144:147], v16 offset:49152
ds_read_b128 v[148:151], v16 offset:53248
v_mfma_f32_16x16x32_bf16 v[36:39], v[128:131], a[132:135], v[36:39]
v_mfma_f32_16x16x32_bf16 v[40:43], v[128:131], a[136:139], v[40:43]
v_mfma_f32_16x16x32_bf16 v[44:47], v[128:131], a[140:143], v[44:47]
v_mfma_f32_16x16x32_bf16 v[48:51], v[132:135], a[128:131], v[48:51]
v_mfma_f32_16x16x32_bf16 v[52:55], v[132:135], a[132:135], v[52:55]
buffer_load_dwordx4 v[224:227], v22, s[56:59], s55 offen offset:1024
v_mfma_f32_16x16x32_bf16 v[56:59], v[132:135], a[136:139], v[56:59]
v_mfma_f32_16x16x32_bf16 v[60:63], v[132:135], a[140:143], v[60:63]
s_waitcnt lgkmcnt(2)
v_mfma_f32_16x16x32_bf16 v[32:35], v[136:139], a[144:147], v[32:35]
ds_read_b128 v[128:131], v17 offset:49152
ds_read_b128 v[132:135], v17 offset:53248
v_mfma_f32_16x16x32_bf16 v[36:39], v[136:139], a[148:151], v[36:39]
v_mfma_f32_16x16x32_bf16 v[40:43], v[136:139], a[152:155], v[40:43]
v_mfma_f32_16x16x32_bf16 v[44:47], v[136:139], a[156:159], v[44:47]
v_mfma_f32_16x16x32_bf16 v[48:51], v[140:143], a[144:147], v[48:51]
v_cvt_pk_bf16_f32 v172, v108, v109
v_cvt_pk_bf16_f32 v173, v110, v111
v_mfma_f32_16x16x32_bf16 v[52:55], v[140:143], a[148:151], v[52:55]
v_cvt_pk_bf16_f32 v174, v124, v125
v_cvt_pk_bf16_f32 v175, v126, v127
v_mfma_f32_16x16x32_bf16 v[56:59], v[140:143], a[152:155], v[56:59]
buffer_store_dwordx4 v[172:175], v23, s[32:35], s54 offen offset:3072 sc0 sc1
v_mfma_f32_16x16x32_bf16 v[60:63], v[140:143], a[156:159], v[60:63]
s_waitcnt lgkmcnt(2)
v_mfma_f32_16x16x32_bf16 v[32:35], v[144:147], a[160:163], v[32:35]
ds_read_b128 v[136:139], v14 offset:57344
ds_read_b128 v[140:143], v14 offset:61440
v_mfma_f32_16x16x32_bf16 v[36:39], v[144:147], a[164:167], v[36:39]
buffer_load_dwordx4 v[224:227], v22, s[56:59], s55 offen offset:2048
v_mfma_f32_16x16x32_bf16 v[40:43], v[144:147], a[168:171], v[40:43]
v_mfma_f32_16x16x32_bf16 v[44:47], v[144:147], a[172:175], v[44:47]
v_mfma_f32_16x16x32_bf16 v[48:51], v[148:151], a[160:163], v[48:51]
v_mfma_f32_16x16x32_bf16 v[52:55], v[148:151], a[164:167], v[52:55]
v_mfma_f32_16x16x32_bf16 v[56:59], v[148:151], a[168:171], v[56:59]
v_mfma_f32_16x16x32_bf16 v[60:63], v[148:151], a[172:175], v[60:63]
s_waitcnt lgkmcnt(2)
v_mfma_f32_16x16x32_bf16 v[32:35], v[128:131], a[176:179], v[32:35]
ds_read_b128 v[144:147], v15 offset:57344
ds_read_b128 v[148:151], v15 offset:61440
v_mfma_f32_16x16x32_bf16 v[36:39], v[128:131], a[180:183], v[36:39]
buffer_load_dwordx4 v[224:227], v22, s[56:59], s55 offen offset:3072
v_mfma_f32_16x16x32_bf16 v[40:43], v[128:131], a[184:187], v[40:43]
v_mfma_f32_16x16x32_bf16 v[44:47], v[128:131], a[188:191], v[44:47]
v_mfma_f32_16x16x32_bf16 v[48:51], v[132:135], a[176:179], v[48:51]
v_mfma_f32_16x16x32_bf16 v[52:55], v[132:135], a[180:183], v[52:55]
v_mfma_f32_16x16x32_bf16 v[56:59], v[132:135], a[184:187], v[56:59]
v_mfma_f32_16x16x32_bf16 v[60:63], v[132:135], a[188:191], v[60:63]
s_waitcnt lgkmcnt(2)
v_mfma_f32_16x16x32_bf16 v[32:35], v[136:139], a[192:195], v[32:35]
ds_read_b128 v[128:131], v16 offset:57344
ds_read_b128 v[132:135], v16 offset:61440
v_mfma_f32_16x16x32_bf16 v[36:39], v[136:139], a[196:199], v[36:39]
v_mfma_f32_16x16x32_bf16 v[40:43], v[136:139], a[200:203], v[40:43]
v_mfma_f32_16x16x32_bf16 v[44:47], v[136:139], a[204:207], v[44:47]
v_mfma_f32_16x16x32_bf16 v[48:51], v[140:143], a[192:195], v[48:51]
v_mfma_f32_16x16x32_bf16 v[52:55], v[140:143], a[196:199], v[52:55]
v_mfma_f32_16x16x32_bf16 v[56:59], v[140:143], a[200:203], v[56:59]
v_mfma_f32_16x16x32_bf16 v[60:63], v[140:143], a[204:207], v[60:63]
s_waitcnt lgkmcnt(2)
v_mfma_f32_16x16x32_bf16 v[32:35], v[144:147], a[208:211], v[32:35]
ds_read_b128 v[136:139], v17 offset:57344
ds_read_b128 v[140:143], v17 offset:61440
v_mfma_f32_16x16x32_bf16 v[36:39], v[144:147], a[212:215], v[36:39]
v_mfma_f32_16x16x32_bf16 v[40:43], v[144:147], a[216:219], v[40:43]
v_mfma_f32_16x16x32_bf16 v[44:47], v[144:147], a[220:223], v[44:47]
s_waitcnt vmcnt(12)
v_mfma_f32_16x16x32_bf16 v[48:51], v[148:151], a[208:211], v[48:51]
s_barrier
v_mfma_f32_16x16x32_bf16 v[52:55], v[148:151], a[212:215], v[52:55]
v_mfma_f32_16x16x32_bf16 v[56:59], v[148:151], a[216:219], v[56:59]
v_mfma_f32_16x16x32_bf16 v[60:63], v[148:151], a[220:223], v[60:63]
s_waitcnt lgkmcnt(2)
v_mfma_f32_16x16x32_bf16 v[32:35], v[128:131], a[224:227], v[32:35]
ds_read_b128 v[144:147], v18 offset:0
ds_read_b128 v[148:151], v18 offset:4096
v_mfma_f32_16x16x32_bf16 v[36:39], v[128:131], a[228:231], v[36:39]
v_mfma_f32_16x16x32_bf16 v[40:43], v[128:131], a[232:235], v[40:43]
v_mfma_f32_16x16x32_bf16 v[44:47], v[128:131], a[236:239], v[44:47]
v_mfma_f32_16x16x32_bf16 v[48:51], v[132:135], a[224:227], v[48:51]
v_mfma_f32_16x16x32_bf16 v[52:55], v[132:135], a[228:231], v[52:55]
v_mfma_f32_16x16x32_bf16 v[56:59], v[132:135], a[232:235], v[56:59]
v_mfma_f32_16x16x32_bf16 v[60:63], v[132:135], a[236:239], v[60:63]
s_waitcnt lgkmcnt(2)
v_mfma_f32_16x16x32_bf16 v[32:35], v[136:139], a[240:243], v[32:35]
ds_read_b128 v[128:131], v19 offset:0
ds_read_b128 v[132:135], v19 offset:4096
v_mfma_f32_16x16x32_bf16 v[36:39], v[136:139], a[244:247], v[36:39]
v_mfma_f32_16x16x32_bf16 v[40:43], v[136:139], a[248:251], v[40:43]
v_mfma_f32_16x16x32_bf16 v[44:47], v[136:139], a[252:255], v[44:47]
v_mfma_f32_16x16x32_bf16 v[48:51], v[140:143], a[240:243], v[48:51]
v_mfma_f32_16x16x32_bf16 v[52:55], v[140:143], a[244:247], v[52:55]
v_mfma_f32_16x16x32_bf16 v[56:59], v[140:143], a[248:251], v[56:59]
v_mfma_f32_16x16x32_bf16 v[60:63], v[140:143], a[252:255], v[60:63]
s_waitcnt lgkmcnt(2)
v_mfma_f32_16x16x32_bf16 v[64:67], v[144:147], a[0:3], 0
ds_read_b128 v[136:139], v20 offset:0
ds_read_b128 v[140:143], v20 offset:4096
v_mfma_f32_16x16x32_bf16 v[68:71], v[144:147], a[4:7], 0
v_mfma_f32_16x16x32_bf16 v[72:75], v[144:147], a[8:11], 0
v_mfma_f32_16x16x32_bf16 v[76:79], v[144:147], a[12:15], 0
v_mfma_f32_16x16x32_bf16 v[80:83], v[148:151], a[0:3], 0
v_mfma_f32_16x16x32_bf16 v[84:87], v[148:151], a[4:7], 0
v_mfma_f32_16x16x32_bf16 v[88:91], v[148:151], a[8:11], 0
v_mfma_f32_16x16x32_bf16 v[92:95], v[148:151], a[12:15], 0
s_waitcnt lgkmcnt(2)
v_mfma_f32_16x16x32_bf16 v[64:67], v[128:131], a[16:19], v[64:67]
ds_read_b128 v[144:147], v21 offset:0
ds_read_b128 v[148:151], v21 offset:4096
v_mfma_f32_16x16x32_bf16 v[68:71], v[128:131], a[20:23], v[68:71]
s_add_u32 s53, s44, 98304
v_mfma_f32_16x16x32_bf16 v[72:75], v[128:131], a[24:27], v[72:75]
v_cvt_pk_bf16_f32 v176, v32, v33
v_cvt_pk_bf16_f32 v177, v34, v35
v_mfma_f32_16x16x32_bf16 v[76:79], v[128:131], a[28:31], v[76:79]
v_cvt_pk_bf16_f32 v178, v48, v49
v_cvt_pk_bf16_f32 v179, v50, v51
v_mfma_f32_16x16x32_bf16 v[80:83], v[132:135], a[16:19], v[80:83]
buffer_store_dwordx4 v[176:179], v22, s[32:35], s53 offen offset:2048 sc0 sc1
v_mfma_f32_16x16x32_bf16 v[84:87], v[132:135], a[20:23], v[84:87]
v_mfma_f32_16x16x32_bf16 v[88:91], v[132:135], a[24:27], v[88:91]
v_mfma_f32_16x16x32_bf16 v[92:95], v[132:135], a[28:31], v[92:95]
s_waitcnt lgkmcnt(2)
v_mfma_f32_16x16x32_bf16 v[64:67], v[136:139], a[32:35], v[64:67]
ds_read_b128 v[128:131], v18 offset:8192
ds_read_b128 v[132:135], v18 offset:12288
v_mfma_f32_16x16x32_bf16 v[68:71], v[136:139], a[36:39], v[68:71]
v_mfma_f32_16x16x32_bf16 v[72:75], v[136:139], a[40:43], v[72:75]
v_mfma_f32_16x16x32_bf16 v[76:79], v[136:139], a[44:47], v[76:79]
v_mfma_f32_16x16x32_bf16 v[80:83], v[140:143], a[32:35], v[80:83]
v_mfma_f32_16x16x32_bf16 v[84:87], v[140:143], a[36:39], v[84:87]
v_mfma_f32_16x16x32_bf16 v[88:91], v[140:143], a[40:43], v[88:91]
v_mfma_f32_16x16x32_bf16 v[92:95], v[140:143], a[44:47], v[92:95]
s_waitcnt lgkmcnt(2)
v_mfma_f32_16x16x32_bf16 v[64:67], v[144:147], a[48:51], v[64:67]
ds_read_b128 v[136:139], v19 offset:8192
ds_read_b128 v[140:143], v19 offset:12288
v_mfma_f32_16x16x32_bf16 v[68:71], v[144:147], a[52:55], v[68:71]
v_mfma_f32_16x16x32_bf16 v[72:75], v[144:147], a[56:59], v[72:75]
v_mfma_f32_16x16x32_bf16 v[76:79], v[144:147], a[60:63], v[76:79]
v_mfma_f32_16x16x32_bf16 v[80:83], v[148:151], a[48:51], v[80:83]
v_mfma_f32_16x16x32_bf16 v[84:87], v[148:151], a[52:55], v[84:87]
v_mfma_f32_16x16x32_bf16 v[88:91], v[148:151], a[56:59], v[88:91]
v_mfma_f32_16x16x32_bf16 v[92:95], v[148:151], a[60:63], v[92:95]
s_waitcnt lgkmcnt(2)
v_mfma_f32_16x16x32_bf16 v[64:67], v[128:131], a[64:67], v[64:67]
ds_read_b128 v[144:147], v20 offset:8192
ds_read_b128 v[148:151], v20 offset:12288
v_mfma_f32_16x16x32_bf16 v[68:71], v[128:131], a[68:71], v[68:71]
v_cvt_pk_bf16_f32 v180, v36, v37
v_cvt_pk_bf16_f32 v181, v38, v39
v_mfma_f32_16x16x32_bf16 v[72:75], v[128:131], a[72:75], v[72:75]
v_cvt_pk_bf16_f32 v182, v52, v53
v_cvt_pk_bf16_f32 v183, v54, v55
v_mfma_f32_16x16x32_bf16 v[76:79], v[128:131], a[76:79], v[76:79]
buffer_store_dwordx4 v[180:183], v22, s[32:35], s53 offen offset:3072 sc0 sc1
v_mfma_f32_16x16x32_bf16 v[80:83], v[132:135], a[64:67], v[80:83]
v_mfma_f32_16x16x32_bf16 v[84:87], v[132:135], a[68:71], v[84:87]
v_mfma_f32_16x16x32_bf16 v[88:91], v[132:135], a[72:75], v[88:91]
v_mfma_f32_16x16x32_bf16 v[92:95], v[132:135], a[76:79], v[92:95]
s_waitcnt lgkmcnt(2)
v_mfma_f32_16x16x32_bf16 v[64:67], v[136:139], a[80:83], v[64:67]
ds_read_b128 v[128:131], v21 offset:8192
ds_read_b128 v[132:135], v21 offset:12288
v_mfma_f32_16x16x32_bf16 v[68:71], v[136:139], a[84:87], v[68:71]
v_mfma_f32_16x16x32_bf16 v[72:75], v[136:139], a[88:91], v[72:75]
v_mfma_f32_16x16x32_bf16 v[76:79], v[136:139], a[92:95], v[76:79]
v_mfma_f32_16x16x32_bf16 v[80:83], v[140:143], a[80:83], v[80:83]
v_mfma_f32_16x16x32_bf16 v[84:87], v[140:143], a[84:87], v[84:87]
v_mfma_f32_16x16x32_bf16 v[88:91], v[140:143], a[88:91], v[88:91]
v_mfma_f32_16x16x32_bf16 v[92:95], v[140:143], a[92:95], v[92:95]
s_waitcnt lgkmcnt(2)
v_mfma_f32_16x16x32_bf16 v[64:67], v[144:147], a[96:99], v[64:67]
ds_read_b128 v[136:139], v18 offset:16384
ds_read_b128 v[140:143], v18 offset:20480
v_mfma_f32_16x16x32_bf16 v[68:71], v[144:147], a[100:103], v[68:71]
v_mfma_f32_16x16x32_bf16 v[72:75], v[144:147], a[104:107], v[72:75]
v_mfma_f32_16x16x32_bf16 v[76:79], v[144:147], a[108:111], v[76:79]
v_mfma_f32_16x16x32_bf16 v[80:83], v[148:151], a[96:99], v[80:83]
v_mfma_f32_16x16x32_bf16 v[84:87], v[148:151], a[100:103], v[84:87]
v_mfma_f32_16x16x32_bf16 v[88:91], v[148:151], a[104:107], v[88:91]
v_cvt_pk_bf16_f32 v184, v40, v41
v_cvt_pk_bf16_f32 v185, v42, v43
v_mfma_f32_16x16x32_bf16 v[92:95], v[148:151], a[108:111], v[92:95]
s_waitcnt lgkmcnt(2)
v_cvt_pk_bf16_f32 v186, v56, v57
v_mfma_f32_16x16x32_bf16 v[64:67], v[128:131], a[112:115], v[64:67]
ds_read_b128 v[144:147], v19 offset:16384
ds_read_b128 v[148:151], v19 offset:20480
v_mfma_f32_16x16x32_bf16 v[68:71], v[128:131], a[116:119], v[68:71]
v_cvt_pk_bf16_f32 v187, v58, v59
v_mfma_f32_16x16x32_bf16 v[72:75], v[128:131], a[120:123], v[72:75]
buffer_store_dwordx4 v[184:187], v23, s[32:35], s53 offen offset:2048 sc0 sc1
v_mfma_f32_16x16x32_bf16 v[76:79], v[128:131], a[124:127], v[76:79]
v_mfma_f32_16x16x32_bf16 v[80:83], v[132:135], a[112:115], v[80:83]
v_mfma_f32_16x16x32_bf16 v[84:87], v[132:135], a[116:119], v[84:87]
v_mfma_f32_16x16x32_bf16 v[88:91], v[132:135], a[120:123], v[88:91]
v_mfma_f32_16x16x32_bf16 v[92:95], v[132:135], a[124:127], v[92:95]
s_waitcnt lgkmcnt(2)
v_mfma_f32_16x16x32_bf16 v[64:67], v[136:139], a[128:131], v[64:67]
ds_read_b128 v[128:131], v20 offset:16384
ds_read_b128 v[132:135], v20 offset:20480
v_mfma_f32_16x16x32_bf16 v[68:71], v[136:139], a[132:135], v[68:71]
v_mfma_f32_16x16x32_bf16 v[72:75], v[136:139], a[136:139], v[72:75]
v_mfma_f32_16x16x32_bf16 v[76:79], v[136:139], a[140:143], v[76:79]
v_mfma_f32_16x16x32_bf16 v[80:83], v[140:143], a[128:131], v[80:83]
v_mfma_f32_16x16x32_bf16 v[84:87], v[140:143], a[132:135], v[84:87]
v_mfma_f32_16x16x32_bf16 v[88:91], v[140:143], a[136:139], v[88:91]
v_mfma_f32_16x16x32_bf16 v[92:95], v[140:143], a[140:143], v[92:95]
s_waitcnt lgkmcnt(2)
v_mfma_f32_16x16x32_bf16 v[64:67], v[144:147], a[144:147], v[64:67]
ds_read_b128 v[136:139], v21 offset:16384
ds_read_b128 v[140:143], v21 offset:20480
v_mfma_f32_16x16x32_bf16 v[68:71], v[144:147], a[148:151], v[68:71]
v_mfma_f32_16x16x32_bf16 v[72:75], v[144:147], a[152:155], v[72:75]
v_mfma_f32_16x16x32_bf16 v[76:79], v[144:147], a[156:159], v[76:79]
v_mfma_f32_16x16x32_bf16 v[80:83], v[148:151], a[144:147], v[80:83]
v_cvt_pk_bf16_f32 v188, v44, v45
v_cvt_pk_bf16_f32 v189, v46, v47
v_mfma_f32_16x16x32_bf16 v[84:87], v[148:151], a[148:151], v[84:87]
v_cvt_pk_bf16_f32 v190, v60, v61
v_cvt_pk_bf16_f32 v191, v62, v63
v_mfma_f32_16x16x32_bf16 v[88:91], v[148:151], a[152:155], v[88:91]
buffer_store_dwordx4 v[188:191], v23, s[32:35], s53 offen offset:3072 sc0 sc1
v_mfma_f32_16x16x32_bf16 v[92:95], v[148:151], a[156:159], v[92:95]
s_waitcnt lgkmcnt(2)
v_mfma_f32_16x16x32_bf16 v[64:67], v[128:131], a[160:163], v[64:67]
ds_read_b128 v[144:147], v18 offset:24576
ds_read_b128 v[148:151], v18 offset:28672
v_mfma_f32_16x16x32_bf16 v[68:71], v[128:131], a[164:167], v[68:71]
v_mfma_f32_16x16x32_bf16 v[72:75], v[128:131], a[168:171], v[72:75]
v_mfma_f32_16x16x32_bf16 v[76:79], v[128:131], a[172:175], v[76:79]
v_mfma_f32_16x16x32_bf16 v[80:83], v[132:135], a[160:163], v[80:83]
v_mfma_f32_16x16x32_bf16 v[84:87], v[132:135], a[164:167], v[84:87]
v_mfma_f32_16x16x32_bf16 v[88:91], v[132:135], a[168:171], v[88:91]
v_mfma_f32_16x16x32_bf16 v[92:95], v[132:135], a[172:175], v[92:95]
s_waitcnt lgkmcnt(2)
v_mfma_f32_16x16x32_bf16 v[64:67], v[136:139], a[176:179], v[64:67]
ds_read_b128 v[128:131], v19 offset:24576
ds_read_b128 v[132:135], v19 offset:28672
v_mfma_f32_16x16x32_bf16 v[68:71], v[136:139], a[180:183], v[68:71]
v_mfma_f32_16x16x32_bf16 v[72:75], v[136:139], a[184:187], v[72:75]
v_mfma_f32_16x16x32_bf16 v[76:79], v[136:139], a[188:191], v[76:79]
v_mfma_f32_16x16x32_bf16 v[80:83], v[140:143], a[176:179], v[80:83]
v_mfma_f32_16x16x32_bf16 v[84:87], v[140:143], a[180:183], v[84:87]
v_mfma_f32_16x16x32_bf16 v[88:91], v[140:143], a[184:187], v[88:91]
v_mfma_f32_16x16x32_bf16 v[92:95], v[140:143], a[188:191], v[92:95]
s_waitcnt lgkmcnt(2)
v_mfma_f32_16x16x32_bf16 v[64:67], v[144:147], a[192:195], v[64:67]
ds_read_b128 v[136:139], v20 offset:24576
ds_read_b128 v[140:143], v20 offset:28672
v_mfma_f32_16x16x32_bf16 v[68:71], v[144:147], a[196:199], v[68:71]
v_mfma_f32_16x16x32_bf16 v[72:75], v[144:147], a[200:203], v[72:75]
v_mfma_f32_16x16x32_bf16 v[76:79], v[144:147], a[204:207], v[76:79]
v_mfma_f32_16x16x32_bf16 v[80:83], v[148:151], a[192:195], v[80:83]
v_mfma_f32_16x16x32_bf16 v[84:87], v[148:151], a[196:199], v[84:87]
v_mfma_f32_16x16x32_bf16 v[88:91], v[148:151], a[200:203], v[88:91]
v_mfma_f32_16x16x32_bf16 v[92:95], v[148:151], a[204:207], v[92:95]
s_waitcnt lgkmcnt(2)
v_mfma_f32_16x16x32_bf16 v[64:67], v[128:131], a[208:211], v[64:67]
ds_read_b128 v[144:147], v21 offset:24576
ds_read_b128 v[148:151], v21 offset:28672
v_mfma_f32_16x16x32_bf16 v[68:71], v[128:131], a[212:215], v[68:71]
v_mfma_f32_16x16x32_bf16 v[72:75], v[128:131], a[216:219], v[72:75]
v_mfma_f32_16x16x32_bf16 v[76:79], v[128:131], a[220:223], v[76:79]
v_mfma_f32_16x16x32_bf16 v[80:83], v[132:135], a[208:211], v[80:83]
v_mfma_f32_16x16x32_bf16 v[84:87], v[132:135], a[212:215], v[84:87]
v_mfma_f32_16x16x32_bf16 v[88:91], v[132:135], a[216:219], v[88:91]
v_mfma_f32_16x16x32_bf16 v[92:95], v[132:135], a[220:223], v[92:95]
s_waitcnt lgkmcnt(2)
v_mfma_f32_16x16x32_bf16 v[64:67], v[136:139], a[224:227], v[64:67]
v_mfma_f32_16x16x32_bf16 v[68:71], v[136:139], a[228:231], v[68:71]
v_mfma_f32_16x16x32_bf16 v[72:75], v[136:139], a[232:235], v[72:75]
v_mfma_f32_16x16x32_bf16 v[76:79], v[136:139], a[236:239], v[76:79]
v_mfma_f32_16x16x32_bf16 v[80:83], v[140:143], a[224:227], v[80:83]
v_mfma_f32_16x16x32_bf16 v[84:87], v[140:143], a[228:231], v[84:87]
v_mfma_f32_16x16x32_bf16 v[88:91], v[140:143], a[232:235], v[88:91]
v_mfma_f32_16x16x32_bf16 v[92:95], v[140:143], a[236:239], v[92:95]
s_waitcnt lgkmcnt(0)
v_mfma_f32_16x16x32_bf16 v[64:67], v[144:147], a[240:243], v[64:67]
v_mfma_f32_16x16x32_bf16 v[68:71], v[144:147], a[244:247], v[68:71]
v_mfma_f32_16x16x32_bf16 v[72:75], v[144:147], a[248:251], v[72:75]
v_mfma_f32_16x16x32_bf16 v[76:79], v[144:147], a[252:255], v[76:79]
v_mfma_f32_16x16x32_bf16 v[80:83], v[148:151], a[240:243], v[80:83]
v_mfma_f32_16x16x32_bf16 v[84:87], v[148:151], a[244:247], v[84:87]
v_mfma_f32_16x16x32_bf16 v[88:91], v[148:151], a[248:251], v[88:91]
v_mfma_f32_16x16x32_bf16 v[92:95], v[148:151], a[252:255], v[92:95]
s_nop 7
s_nop 1
s_add_u32 s53, s44, 114688
v_cvt_pk_bf16_f32 v176, v64, v65
v_cvt_pk_bf16_f32 v177, v66, v67
v_cvt_pk_bf16_f32 v178, v80, v81
v_cvt_pk_bf16_f32 v179, v82, v83
buffer_store_dwordx4 v[176:179], v22, s[32:35], s53 offen offset:2048 sc0 sc1
v_cvt_pk_bf16_f32 v180, v68, v69
v_cvt_pk_bf16_f32 v181, v70, v71
v_cvt_pk_bf16_f32 v182, v84, v85
v_cvt_pk_bf16_f32 v183, v86, v87
buffer_store_dwordx4 v[180:183], v22, s[32:35], s53 offen offset:3072 sc0 sc1
v_cvt_pk_bf16_f32 v184, v72, v73
v_cvt_pk_bf16_f32 v185, v74, v75
v_cvt_pk_bf16_f32 v186, v88, v89
v_cvt_pk_bf16_f32 v187, v90, v91
buffer_store_dwordx4 v[184:187], v23, s[32:35], s53 offen offset:2048 sc0 sc1
v_cvt_pk_bf16_f32 v188, v76, v77
v_cvt_pk_bf16_f32 v189, v78, v79
v_cvt_pk_bf16_f32 v190, v92, v93
v_cvt_pk_bf16_f32 v191, v94, v95
buffer_store_dwordx4 v[188:191], v23, s[32:35], s53 offen offset:3072 sc0 sc1
s_endpgm
K1_END:
s_endpgm
.text
.globl k2_kernel
.p2align 8
.type k2_kernel,@function
k2_kernel:
s_cmp_ge_u32 s2, 256
s_cbranch_scc1 K2_END
s_load_dwordx2 s[4:5], s[0:1], 16
s_load_dwordx2 s[12:13], s[0:1], 96
s_load_dwordx2 s[6:7], s[0:1], 40
s_load_dwordx4 s[8:11], s[0:1], 56
s_load_dwordx2 s[14:15], s[0:1], 72
v_and_b32 v5, 63, v0
v_lshlrev_b32 v1, 4, v5
v_lshrrev_b32 v6, 6, v0
s_nop 0
v_readfirstlane_b32 s36, v6
s_lshr_b32 s37, s2, 5
s_and_b32 s43, s2, 7
s_lshl_b32 s43, s43, 2
s_lshr_b32 s44, s2, 3
s_and_b32 s44, s44, 3
s_add_u32 s38, s43, s44
s_lshl_b32 s43, s37, 3
s_add_u32 s45, s43, s36
s_add_u32 s47, s43, 7
s_sub_u32 s47, s47, s36
s_sub_u32 s43, 15, s37
s_lshl_b32 s43, s43, 3
s_add_u32 s46, s43, s36
s_add_u32 s79, s43, 7
s_sub_u32 s79, s79, s36
s_waitcnt lgkmcnt(0)
s_cmp_lt_u32 s2, 8
s_cbranch_scc0 CPF4_X
s_cmp_eq_u32 s36, 3
s_cbranch_scc0 CPF4_X
s_getpc_b64 s[68:69]
CPF4_P:
s_add_u32 s68, s68, k2_kernel-CPF4_P
s_addc_u32 s69, s69, ((k2_kernel-CPF4_P)>>32)&0xffffffff
s_mov_b32 s70, K2_END-k2_kernel
s_mov_b32 s71, 0x00020000
v_lshlrev_b32 v228, 7, v5
s_mov_b32 s72, 0
CPF4_L:
buffer_load_dword v229, v228, s[68:71], s72 offen
s_add_u32 s72, s72, 8192
s_cmp_lt_u32 s72, s70
s_cbranch_scc1 CPF4_L
CPF4_X:
s_mov_b32 s24, s4
s_mov_b32 s25, s5
s_mov_b32 s26, 4194304
s_mov_b32 s27, 0x00020000
s_add_u32 s20, s12, 0
s_addc_u32 s21, s13, 0
s_mov_b32 s22, 2097152
s_mov_b32 s23, 0x00020000
s_add_u32 s16, s12, 2097152
s_addc_u32 s17, s13, 0
s_mov_b32 s18, 33554432
s_mov_b32 s19, 0x00020000
s_add_u32 s28, s12, 35651584
s_addc_u32 s29, s13, 0
s_mov_b32 s30, 16777216
s_mov_b32 s31, 0x00020000
v_lshrrev_b32 v6, 4, v5
v_and_b32 v7, 15, v5
v_lshrrev_b32 v216, 1, v7
v_and_b32 v217, 1, v7
v_lshlrev_b32 v217, 4, v217
s_lshl_b32 s43, s38, 8
s_lshl_b32 s44, s36, 18
s_add_u32 s43, s43, s44
v_add_u32 v217, s43, v217
v_lshl_add_u32 v217, v6, 13, v217
v_or_b32 v218, 0, v6
v_xor_b32 v218, v218, v216
v_lshl_add_u32 v8, v218, 5, v217
v_or_b32 v218, 0, v6
v_xor_b32 v218, v218, v216
v_lshl_add_u32 v9, v218, 5, v217
v_add_u32 v9, 31744, v9
v_or_b32 v218, 4, v6
v_xor_b32 v218, v218, v216
v_lshl_add_u32 v10, v218, 5, v217
v_add_u32 v10, 63488, v10
v_or_b32 v218, 4, v6
v_xor_b32 v218, v218, v216
v_lshl_add_u32 v11, v218, 5, v217
v_add_u32 v11, 95232, v11
s_lshl_b32 s50, s36, 13
s_and_b32 s43, s36, 1
s_lshl_b32 s43, s43, 2
v_or_b32 v218, s43, v6
v_lshrrev_b32 v216, 1, v7
v_xor_b32 v218, v218, v216
v_and_b32 v217, 1, v7
v_lshlrev_b32 v217, 4, v217
v_lshl_add_u32 v218, v218, 5, v217
s_lshl_b32 s43, s38, 8
s_lshl_b32 s44, s36, 16
s_add_u32 s43, s43, s44
v_add_u32 v218, s43, v218
v_lshl_add_u32 v224, v6, 13, v218
v_add_u32 v225, 31744, v224
s_lshl_b32 s53, s36, 11
s_lshl_b32 s68, s45, 14
s_lshl_b32 s69, s47, 14
s_lshl_b32 s70, s46, 14
s_lshl_b32 s71, s79, 14
s_add_u32 m0, s53, 0
s_mov_b32 s51, 0
buffer_load_dwordx4 v224, s[24:27], s51 offen lds
buffer_load_dwordx4 v225, s[24:27], s51 offen offset:1024 lds
buffer_load_dwordx4 a[0:3], v1, s[20:23], s68 offen offset:0
buffer_load_dwordx4 a[16:19], v1, s[20:23], s69 offen offset:0
buffer_load_dwordx4 a[32:35], v1, s[20:23], s70 offen offset:0
buffer_load_dwordx4 a[48:51], v1, s[20:23], s71 offen offset:0
s_add_u32 m0, s53, 8192
s_mov_b32 s51, 262144
buffer_load_dwordx4 v224, s[24:27], s51 offen lds
buffer_load_dwordx4 v225, s[24:27], s51 offen offset:1024 lds
buffer_load_dwordx4 a[4:7], v1, s[20:23], s68 offen offset:1024
buffer_load_dwordx4 a[20:23], v1, s[20:23], s69 offen offset:1024
buffer_load_dwordx4 a[36:39], v1, s[20:23], s70 offen offset:1024
buffer_load_dwordx4 a[52:55], v1, s[20:23], s71 offen offset:1024
s_add_u32 m0, s53, 16384
s_mov_b32 s51, 524288
buffer_load_dwordx4 v224, s[24:27], s51 offen lds
buffer_load_dwordx4 v225, s[24:27], s51 offen offset:1024 lds
buffer_load_dwordx4 a[8:11], v1, s[20:23], s68 offen offset:2048
buffer_load_dwordx4 a[24:27], v1, s[20:23], s69 offen offset:2048
buffer_load_dwordx4 a[40:43], v1, s[20:23], s70 offen offset:2048
buffer_load_dwordx4 a[56:59], v1, s[20:23], s71 offen offset:2048
s_add_u32 m0, s53, 24576
s_mov_b32 s51, 786432
buffer_load_dwordx4 v224, s[24:27], s51 offen lds
buffer_load_dwordx4 v225, s[24:27], s51 offen offset:1024 lds
buffer_load_dwordx4 a[12:15], v1, s[20:23], s68 offen offset:3072
buffer_load_dwordx4 a[28:31], v1, s[20:23], s69 offen offset:3072
buffer_load_dwordx4 a[44:47], v1, s[20:23], s70 offen offset:3072
buffer_load_dwordx4 a[60:63], v1, s[20:23], s71 offen offset:3072
s_lshl_b32 s54, s2, 2
s_add_u32 s54, s54, s36
s_lshl_b32 s55, s36, 13
s_add_u32 s55, s55, 131072
v_lshrrev_b32 v216, 3, v5
v_and_b32 v217, 7, v5
v_lshlrev_b32 v217, 4, v217
v_lshl_add_u32 v12, v216, 10, v217
s_mov_b32 s43, 2752
v_mul_lo_u32 v216, v216, s43
v_add_u32 v13, v216, v217
v_lshrrev_b32 v216, 2, v7
v_and_b32 v217, 3, v7
v_lshlrev_b32 v217, 3, v217
v_lshl_add_u32 v218, v6, 2, v216
v_lshl_add_u32 v14, v218, 7, v217
v_add_u32 v14, s55, v14
v_lshl_add_u32 v218, v6, 3, v216
v_lshl_add_u32 v15, v218, 7, v217
v_add_u32 v15, s55, v15
s_add_u32 m0, s50, 32768
s_mov_b32 s51, 1048576
buffer_load_dwordx4 v8, s[24:27], s51 offen offset:0 lds
buffer_load_dwordx4 v9, s[24:27], s51 offen offset:1024 lds
buffer_load_dwordx4 v10, s[24:27], s51 offen offset:2048 lds
buffer_load_dwordx4 v11, s[24:27], s51 offen offset:3072 lds
s_add_u32 m0, s50, 36864
s_mov_b32 s51, 1179648
buffer_load_dwordx4 v8, s[24:27], s51 offen offset:0 lds
buffer_load_dwordx4 v9, s[24:27], s51 offen offset:1024 lds
buffer_load_dwordx4 v10, s[24:27], s51 offen offset:2048 lds
buffer_load_dwordx4 v11, s[24:27], s51 offen offset:3072 lds
s_lshl_b32 s52, s45, 14
s_add_u32 s52, s52, 4096
buffer_load_dwordx4 a[64:67], v1, s[20:23], s52 offen offset:0
buffer_load_dwordx4 a[68:71], v1, s[20:23], s52 offen offset:1024
buffer_load_dwordx4 a[72:75], v1, s[20:23], s52 offen offset:2048
buffer_load_dwordx4 a[76:79], v1, s[20:23], s52 offen offset:3072
s_lshl_b32 s52, s47, 14
s_add_u32 s52, s52, 4096
buffer_load_dwordx4 a[80:83], v1, s[20:23], s52 offen offset:0
buffer_load_dwordx4 a[84:87], v1, s[20:23], s52 offen offset:1024
buffer_load_dwordx4 a[88:91], v1, s[20:23], s52 offen offset:2048
buffer_load_dwordx4 a[92:95], v1, s[20:23], s52 offen offset:3072
s_lshl_b32 s52, s46, 14
s_add_u32 s52, s52, 4096
buffer_load_dwordx4 a[96:99], v1, s[20:23], s52 offen offset:0
buffer_load_dwordx4 a[100:103], v1, s[20:23], s52 offen offset:1024
buffer_load_dwordx4 a[104:107], v1, s[20:23], s52 offen offset:2048
buffer_load_dwordx4 a[108:111], v1, s[20:23], s52 offen offset:3072
s_lshl_b32 s52, s79, 14
s_add_u32 s52, s52, 4096
buffer_load_dwordx4 a[112:115], v1, s[20:23], s52 offen offset:0
buffer_load_dwordx4 a[116:119], v1, s[20:23], s52 offen offset:1024
buffer_load_dwordx4 a[120:123], v1, s[20:23], s52 offen offset:2048
buffer_load_dwordx4 a[124:127], v1, s[20:23], s52 offen offset:3072
v_lshrrev_b32 v216, 2, v7
v_and_b32 v217, 1, v6
v_lshl_or_b32 v217, v217, 2, v216
v_lshl_add_u32 v218, v6, 3, v216
v_lshlrev_b32 v218, 8, v218
v_and_b32 v219, 3, v7
v_lshl_add_u32 v218, v219, 3, v218
v_xor_b32 v219, 0, v217
v_lshl_add_u32 v224, v219, 5, v218
v_xor_b32 v219, 1, v217
v_lshl_add_u32 v225, v219, 5, v218
v_xor_b32 v219, 2, v217
v_lshl_add_u32 v226, v219, 5, v218
v_xor_b32 v219, 3, v217
v_lshl_add_u32 v227, v219, 5, v218
v_xor_b32 v219, 4, v217
v_lshl_add_u32 v228, v219, 5, v218
v_xor_b32 v219, 5, v217
v_lshl_add_u32 v229, v219, 5, v218
v_xor_b32 v219, 6, v217
v_lshl_add_u32 v230, v219, 5, v218
v_xor_b32 v219, 7, v217
v_lshl_add_u32 v231, v219, 5, v218
s_lshl_b32 s43, s36, 12
v_add_u32 v4, s43, v1
s_mov_b32 s39, s43
s_add_u32 s40, s43, 0x10000
v_mov_b32 v2, v1
v_add_u32 v3, 0x10000, v1
s_lshl_b32 s41, s38, 20
s_mov_b64 s[48:49], 0
s_waitcnt vmcnt(42)
s_barrier
ds_read_b64_tr_b16 a[192:193], v224 offset:0
ds_read_b64_tr_b16 a[194:195], v224 offset:1024
ds_read_b64_tr_b16 a[196:197], v225 offset:0
ds_read_b64_tr_b16 a[198:199], v225 offset:1024
ds_read_b64_tr_b16 a[200:201], v226 offset:0
ds_read_b64_tr_b16 a[202:203], v226 offset:1024
ds_read_b64_tr_b16 a[204:205], v227 offset:0
ds_read_b64_tr_b16 a[206:207], v227 offset:1024
ds_read_b64_tr_b16 a[208:209], v228 offset:0
ds_read_b64_tr_b16 a[210:211], v228 offset:1024
ds_read_b64_tr_b16 a[212:213], v229 offset:0
ds_read_b64_tr_b16 a[214:215], v229 offset:1024
ds_read_b64_tr_b16 a[216:217], v230 offset:0
ds_read_b64_tr_b16 a[218:219], v230 offset:1024
ds_read_b64_tr_b16 a[220:221], v231 offset:0
ds_read_b64_tr_b16 a[222:223], v231 offset:1024
s_waitcnt lgkmcnt(0)
v_mfma_f32_16x16x32_bf16 v[16:19], a[192:195], a[0:3], 0
s_waitcnt vmcnt(36)
v_mfma_f32_16x16x32_bf16 v[20:23], a[192:195], a[16:19], 0
s_barrier
v_mfma_f32_16x16x32_bf16 v[24:27], a[192:195], a[32:35], 0
ds_read_b64_tr_b16 a[224:225], v224 offset:8192
ds_read_b64_tr_b16 a[226:227], v224 offset:9216
v_mfma_f32_16x16x32_bf16 v[28:31], a[192:195], a[48:51], 0
ds_read_b64_tr_b16 a[228:229], v225 offset:8192
ds_read_b64_tr_b16 a[230:231], v225 offset:9216
v_mfma_f32_16x16x32_bf16 v[32:35], a[196:199], a[0:3], 0
ds_read_b64_tr_b16 a[232:233], v226 offset:8192
ds_read_b64_tr_b16 a[234:235], v226 offset:9216
v_mfma_f32_16x16x32_bf16 v[36:39], a[196:199], a[16:19], 0
ds_read_b64_tr_b16 a[236:237], v227 offset:8192
ds_read_b64_tr_b16 a[238:239], v227 offset:9216
v_mfma_f32_16x16x32_bf16 v[40:43], a[196:199], a[32:35], 0
ds_read_b64_tr_b16 a[240:241], v228 offset:8192
ds_read_b64_tr_b16 a[242:243], v228 offset:9216
v_mfma_f32_16x16x32_bf16 v[44:47], a[196:199], a[48:51], 0
ds_read_b64_tr_b16 a[244:245], v229 offset:8192
ds_read_b64_tr_b16 a[246:247], v229 offset:9216
v_mfma_f32_16x16x32_bf16 v[48:51], a[200:203], a[0:3], 0
ds_read_b64_tr_b16 a[248:249], v230 offset:8192
ds_read_b64_tr_b16 a[250:251], v230 offset:9216
v_mfma_f32_16x16x32_bf16 v[52:55], a[200:203], a[16:19], 0
ds_read_b64_tr_b16 a[252:253], v231 offset:8192
ds_read_b64_tr_b16 a[254:255], v231 offset:9216
v_mfma_f32_16x16x32_bf16 v[56:59], a[200:203], a[32:35], 0
s_add_u32 m0, s50, 65536
s_mov_b32 s51, 2097152
v_mfma_f32_16x16x32_bf16 v[60:63], a[200:203], a[48:51], 0
buffer_load_dwordx4 v8, s[24:27], s51 offen offset:0 lds
v_mfma_f32_16x16x32_bf16 v[64:67], a[204:207], a[0:3], 0
v_mfma_f32_16x16x32_bf16 v[68:71], a[204:207], a[16:19], 0
buffer_load_dwordx4 v9, s[24:27], s51 offen offset:1024 lds
v_mfma_f32_16x16x32_bf16 v[72:75], a[204:207], a[32:35], 0
v_mfma_f32_16x16x32_bf16 v[76:79], a[204:207], a[48:51], 0
buffer_load_dwordx4 v10, s[24:27], s51 offen offset:2048 lds
v_mfma_f32_16x16x32_bf16 v[80:83], a[208:211], a[0:3], 0
v_mfma_f32_16x16x32_bf16 v[84:87], a[208:211], a[16:19], 0
buffer_load_dwordx4 v11, s[24:27], s51 offen offset:3072 lds
v_mfma_f32_16x16x32_bf16 v[88:91], a[208:211], a[32:35], 0
s_add_u32 m0, s50, 69632
s_mov_b32 s51, 2228224
v_mfma_f32_16x16x32_bf16 v[92:95], a[208:211], a[48:51], 0
buffer_load_dwordx4 v8, s[24:27], s51 offen offset:0 lds
v_mfma_f32_16x16x32_bf16 v[96:99], a[212:215], a[0:3], 0
v_mfma_f32_16x16x32_bf16 v[100:103], a[212:215], a[16:19], 0
buffer_load_dwordx4 v9, s[24:27], s51 offen offset:1024 lds
v_mfma_f32_16x16x32_bf16 v[104:107], a[212:215], a[32:35], 0
v_mfma_f32_16x16x32_bf16 v[108:111], a[212:215], a[48:51], 0
buffer_load_dwordx4 v10, s[24:27], s51 offen offset:2048 lds
v_mfma_f32_16x16x32_bf16 v[112:115], a[216:219], a[0:3], 0
v_mfma_f32_16x16x32_bf16 v[116:119], a[216:219], a[16:19], 0
buffer_load_dwordx4 v11, s[24:27], s51 offen offset:3072 lds
v_mfma_f32_16x16x32_bf16 v[120:123], a[216:219], a[32:35], 0
v_mfma_f32_16x16x32_bf16 v[124:127], a[216:219], a[48:51], 0
v_mfma_f32_16x16x32_bf16 v[128:131], a[220:223], a[0:3], 0
v_mfma_f32_16x16x32_bf16 v[132:135], a[220:223], a[16:19], 0
v_mfma_f32_16x16x32_bf16 v[136:139], a[220:223], a[32:35], 0
v_mfma_f32_16x16x32_bf16 v[140:143], a[220:223], a[48:51], 0
s_waitcnt lgkmcnt(0)
v_mfma_f32_16x16x32_bf16 v[16:19], a[224:227], a[4:7], v[16:19]
s_waitcnt vmcnt(38)
v_mfma_f32_16x16x32_bf16 v[20:23], a[224:227], a[20:23], v[20:23]
s_barrier
v_mfma_f32_16x16x32_bf16 v[24:27], a[224:227], a[36:39], v[24:27]
ds_read_b64_tr_b16 a[192:193], v224 offset:16384
ds_read_b64_tr_b16 a[194:195], v224 offset:17408
v_mfma_f32_16x16x32_bf16 v[28:31], a[224:227], a[52:55], v[28:31]
ds_read_b64_tr_b16 a[196:197], v225 offset:16384
ds_read_b64_tr_b16 a[198:199], v225 offset:17408
v_mfma_f32_16x16x32_bf16 v[32:35], a[228:231], a[4:7], v[32:35]
ds_read_b64_tr_b16 a[200:201], v226 offset:16384
ds_read_b64_tr_b16 a[202:203], v226 offset:17408
v_mfma_f32_16x16x32_bf16 v[36:39], a[228:231], a[20:23], v[36:39]
ds_read_b64_tr_b16 a[204:205], v227 offset:16384
ds_read_b64_tr_b16 a[206:207], v227 offset:17408
v_mfma_f32_16x16x32_bf16 v[40:43], a[228:231], a[36:39], v[40:43]
ds_read_b64_tr_b16 a[208:209], v228 offset:16384
ds_read_b64_tr_b16 a[210:211], v228 offset:17408
v_mfma_f32_16x16x32_bf16 v[44:47], a[228:231], a[52:55], v[44:47]
ds_read_b64_tr_b16 a[212:213], v229 offset:16384
ds_read_b64_tr_b16 a[214:215], v229 offset:17408
v_mfma_f32_16x16x32_bf16 v[48:51], a[232:235], a[4:7], v[48:51]
ds_read_b64_tr_b16 a[216:217], v230 offset:16384
ds_read_b64_tr_b16 a[218:219], v230 offset:17408
v_mfma_f32_16x16x32_bf16 v[52:55], a[232:235], a[20:23], v[52:55]
ds_read_b64_tr_b16 a[220:221], v231 offset:16384
ds_read_b64_tr_b16 a[222:223], v231 offset:17408
v_mfma_f32_16x16x32_bf16 v[56:59], a[232:235], a[36:39], v[56:59]
s_lshl_b32 s52, s45, 14
s_add_u32 s52, s52, 8192
v_mfma_f32_16x16x32_bf16 v[60:63], a[232:235], a[52:55], v[60:63]
buffer_load_dwordx4 a[128:131], v1, s[20:23], s52 offen offset:0
v_mfma_f32_16x16x32_bf16 v[64:67], a[236:239], a[4:7], v[64:67]
v_mfma_f32_16x16x32_bf16 v[68:71], a[236:239], a[20:23], v[68:71]
buffer_load_dwordx4 a[132:135], v1, s[20:23], s52 offen offset:1024
v_mfma_f32_16x16x32_bf16 v[72:75], a[236:239], a[36:39], v[72:75]
v_mfma_f32_16x16x32_bf16 v[76:79], a[236:239], a[52:55], v[76:79]
buffer_load_dwordx4 a[136:139], v1, s[20:23], s52 offen offset:2048
v_mfma_f32_16x16x32_bf16 v[80:83], a[240:243], a[4:7], v[80:83]
v_mfma_f32_16x16x32_bf16 v[84:87], a[240:243], a[20:23], v[84:87]
buffer_load_dwordx4 a[140:143], v1, s[20:23], s52 offen offset:3072
v_mfma_f32_16x16x32_bf16 v[88:91], a[240:243], a[36:39], v[88:91]
s_lshl_b32 s52, s47, 14
s_add_u32 s52, s52, 8192
v_mfma_f32_16x16x32_bf16 v[92:95], a[240:243], a[52:55], v[92:95]
buffer_load_dwordx4 a[144:147], v1, s[20:23], s52 offen offset:0
v_mfma_f32_16x16x32_bf16 v[96:99], a[244:247], a[4:7], v[96:99]
v_mfma_f32_16x16x32_bf16 v[100:103], a[244:247], a[20:23], v[100:103]
buffer_load_dwordx4 a[148:151], v1, s[20:23], s52 offen offset:1024
v_mfma_f32_16x16x32_bf16 v[104:107], a[244:247], a[36:39], v[104:107]
v_mfma_f32_16x16x32_bf16 v[108:111], a[244:247], a[52:55], v[108:111]
buffer_load_dwordx4 a[152:155], v1, s[20:23], s52 offen offset:2048
v_mfma_f32_16x16x32_bf16 v[112:115], a[248:251], a[4:7], v[112:115]
v_mfma_f32_16x16x32_bf16 v[116:119], a[248:251], a[20:23], v[116:119]
buffer_load_dwordx4 a[156:159], v1, s[20:23], s52 offen offset:3072
v_mfma_f32_16x16x32_bf16 v[120:123], a[248:251], a[36:39], v[120:123]
v_mfma_f32_16x16x32_bf16 v[124:127], a[248:251], a[52:55], v[124:127]
v_mfma_f32_16x16x32_bf16 v[128:131], a[252:255], a[4:7], v[128:131]
v_mfma_f32_16x16x32_bf16 v[132:135], a[252:255], a[20:23], v[132:135]
v_mfma_f32_16x16x32_bf16 v[136:139], a[252:255], a[36:39], v[136:139]
v_mfma_f32_16x16x32_bf16 v[140:143], a[252:255], a[52:55], v[140:143]
s_waitcnt lgkmcnt(0)
v_mfma_f32_16x16x32_bf16 v[16:19], a[192:195], a[8:11], v[16:19]
s_waitcnt vmcnt(40)
v_mfma_f32_16x16x32_bf16 v[20:23], a[192:195], a[24:27], v[20:23]
s_barrier
v_mfma_f32_16x16x32_bf16 v[24:27], a[192:195], a[40:43], v[24:27]
ds_read_b64_tr_b16 a[224:225], v224 offset:24576
ds_read_b64_tr_b16 a[226:227], v224 offset:25600
v_mfma_f32_16x16x32_bf16 v[28:31], a[192:195], a[56:59], v[28:31]
ds_read_b64_tr_b16 a[228:229], v225 offset:24576
ds_read_b64_tr_b16 a[230:231], v225 offset:25600
v_mfma_f32_16x16x32_bf16 v[32:35], a[196:199], a[8:11], v[32:35]
ds_read_b64_tr_b16 a[232:233], v226 offset:24576
ds_read_b64_tr_b16 a[234:235], v226 offset:25600
v_mfma_f32_16x16x32_bf16 v[36:39], a[196:199], a[24:27], v[36:39]
ds_read_b64_tr_b16 a[236:237], v227 offset:24576
ds_read_b64_tr_b16 a[238:239], v227 offset:25600
v_mfma_f32_16x16x32_bf16 v[40:43], a[196:199], a[40:43], v[40:43]
ds_read_b64_tr_b16 a[240:241], v228 offset:24576
ds_read_b64_tr_b16 a[242:243], v228 offset:25600
v_mfma_f32_16x16x32_bf16 v[44:47], a[196:199], a[56:59], v[44:47]
ds_read_b64_tr_b16 a[244:245], v229 offset:24576
ds_read_b64_tr_b16 a[246:247], v229 offset:25600
v_mfma_f32_16x16x32_bf16 v[48:51], a[200:203], a[8:11], v[48:51]
ds_read_b64_tr_b16 a[248:249], v230 offset:24576
ds_read_b64_tr_b16 a[250:251], v230 offset:25600
v_mfma_f32_16x16x32_bf16 v[52:55], a[200:203], a[24:27], v[52:55]
ds_read_b64_tr_b16 a[252:253], v231 offset:24576
ds_read_b64_tr_b16 a[254:255], v231 offset:25600
v_mfma_f32_16x16x32_bf16 v[56:59], a[200:203], a[40:43], v[56:59]
s_lshl_b32 s52, s46, 14
s_add_u32 s52, s52, 8192
v_mfma_f32_16x16x32_bf16 v[60:63], a[200:203], a[56:59], v[60:63]
buffer_load_dwordx4 a[160:163], v1, s[20:23], s52 offen offset:0
v_mfma_f32_16x16x32_bf16 v[64:67], a[204:207], a[8:11], v[64:67]
v_mfma_f32_16x16x32_bf16 v[68:71], a[204:207], a[24:27], v[68:71]
buffer_load_dwordx4 a[164:167], v1, s[20:23], s52 offen offset:1024
v_mfma_f32_16x16x32_bf16 v[72:75], a[204:207], a[40:43], v[72:75]
v_mfma_f32_16x16x32_bf16 v[76:79], a[204:207], a[56:59], v[76:79]
buffer_load_dwordx4 a[168:171], v1, s[20:23], s52 offen offset:2048
v_mfma_f32_16x16x32_bf16 v[80:83], a[208:211], a[8:11], v[80:83]
v_mfma_f32_16x16x32_bf16 v[84:87], a[208:211], a[24:27], v[84:87]
buffer_load_dwordx4 a[172:175], v1, s[20:23], s52 offen offset:3072
v_mfma_f32_16x16x32_bf16 v[88:91], a[208:211], a[40:43], v[88:91]
s_lshl_b32 s52, s79, 14
s_add_u32 s52, s52, 8192
v_mfma_f32_16x16x32_bf16 v[92:95], a[208:211], a[56:59], v[92:95]
buffer_load_dwordx4 a[176:179], v1, s[20:23], s52 offen offset:0
v_mfma_f32_16x16x32_bf16 v[96:99], a[212:215], a[8:11], v[96:99]
v_mfma_f32_16x16x32_bf16 v[100:103], a[212:215], a[24:27], v[100:103]
buffer_load_dwordx4 a[180:183], v1, s[20:23], s52 offen offset:1024
v_mfma_f32_16x16x32_bf16 v[104:107], a[212:215], a[40:43], v[104:107]
v_mfma_f32_16x16x32_bf16 v[108:111], a[212:215], a[56:59], v[108:111]
buffer_load_dwordx4 a[184:187], v1, s[20:23], s52 offen offset:2048
v_mfma_f32_16x16x32_bf16 v[112:115], a[216:219], a[8:11], v[112:115]
v_mfma_f32_16x16x32_bf16 v[116:119], a[216:219], a[24:27], v[116:119]
buffer_load_dwordx4 a[188:191], v1, s[20:23], s52 offen offset:3072
v_mfma_f32_16x16x32_bf16 v[120:123], a[216:219], a[40:43], v[120:123]
v_mfma_f32_16x16x32_bf16 v[124:127], a[216:219], a[56:59], v[124:127]
v_mfma_f32_16x16x32_bf16 v[128:131], a[220:223], a[8:11], v[128:131]
v_mfma_f32_16x16x32_bf16 v[132:135], a[220:223], a[24:27], v[132:135]
v_mfma_f32_16x16x32_bf16 v[136:139], a[220:223], a[40:43], v[136:139]
v_mfma_f32_16x16x32_bf16 v[140:143], a[220:223], a[56:59], v[140:143]
s_waitcnt lgkmcnt(0)
s_waitcnt vmcnt(24)
s_barrier
v_mfma_f32_16x16x32_bf16 v[16:19], a[224:227], a[12:15], v[16:19]
ds_read_b64_tr_b16 a[192:193], v224 offset:32768
ds_read_b64_tr_b16 a[194:195], v224 offset:33792
v_mfma_f32_16x16x32_bf16 v[20:23], a[224:227], a[28:31], v[20:23]
ds_read_b64_tr_b16 a[196:197], v225 offset:32768
ds_read_b64_tr_b16 a[198:199], v225 offset:33792
v_mfma_f32_16x16x32_bf16 v[24:27], a[224:227], a[44:47], v[24:27]
ds_read_b64_tr_b16 a[200:201], v226 offset:32768
ds_read_b64_tr_b16 a[202:203], v226 offset:33792
v_mfma_f32_16x16x32_bf16 v[28:31], a[224:227], a[60:63], v[28:31]
ds_read_b64_tr_b16 a[204:205], v227 offset:32768
ds_read_b64_tr_b16 a[206:207], v227 offset:33792
v_mfma_f32_16x16x32_bf16 v[32:35], a[228:231], a[12:15], v[32:35]
ds_read_b64_tr_b16 a[208:209], v228 offset:32768
ds_read_b64_tr_b16 a[210:211], v228 offset:33792
v_mfma_f32_16x16x32_bf16 v[36:39], a[228:231], a[28:31], v[36:39]
ds_read_b64_tr_b16 a[212:213], v229 offset:32768
ds_read_b64_tr_b16 a[214:215], v229 offset:33792
v_mfma_f32_16x16x32_bf16 v[40:43], a[228:231], a[44:47], v[40:43]
ds_read_b64_tr_b16 a[216:217], v230 offset:32768
ds_read_b64_tr_b16 a[218:219], v230 offset:33792
v_mfma_f32_16x16x32_bf16 v[44:47], a[228:231], a[60:63], v[44:47]
ds_read_b64_tr_b16 a[220:221], v231 offset:32768
ds_read_b64_tr_b16 a[222:223], v231 offset:33792
v_mfma_f32_16x16x32_bf16 v[48:51], a[232:235], a[12:15], v[48:51]
v_mfma_f32_16x16x32_bf16 v[52:55], a[232:235], a[28:31], v[52:55]
v_mfma_f32_16x16x32_bf16 v[56:59], a[232:235], a[44:47], v[56:59]
v_mfma_f32_16x16x32_bf16 v[60:63], a[232:235], a[60:63], v[60:63]
v_mfma_f32_16x16x32_bf16 v[64:67], a[236:239], a[12:15], v[64:67]
v_mfma_f32_16x16x32_bf16 v[68:71], a[236:239], a[28:31], v[68:71]
v_mfma_f32_16x16x32_bf16 v[72:75], a[236:239], a[44:47], v[72:75]
v_mfma_f32_16x16x32_bf16 v[76:79], a[236:239], a[60:63], v[76:79]
v_mfma_f32_16x16x32_bf16 v[80:83], a[240:243], a[12:15], v[80:83]
v_mfma_f32_16x16x32_bf16 v[84:87], a[240:243], a[28:31], v[84:87]
v_mfma_f32_16x16x32_bf16 v[88:91], a[240:243], a[44:47], v[88:91]
v_mfma_f32_16x16x32_bf16 v[92:95], a[240:243], a[60:63], v[92:95]
v_mfma_f32_16x16x32_bf16 v[96:99], a[244:247], a[12:15], v[96:99]
v_mfma_f32_16x16x32_bf16 v[100:103], a[244:247], a[28:31], v[100:103]
v_mfma_f32_16x16x32_bf16 v[104:107], a[244:247], a[44:47], v[104:107]
v_mfma_f32_16x16x32_bf16 v[108:111], a[244:247], a[60:63], v[108:111]
v_mfma_f32_16x16x32_bf16 v[112:115], a[248:251], a[12:15], v[112:115]
v_mfma_f32_16x16x32_bf16 v[116:119], a[248:251], a[28:31], v[116:119]
v_mfma_f32_16x16x32_bf16 v[120:123], a[248:251], a[44:47], v[120:123]
v_mfma_f32_16x16x32_bf16 v[124:127], a[248:251], a[60:63], v[124:127]
v_mfma_f32_16x16x32_bf16 v[128:131], a[252:255], a[12:15], v[128:131]
v_mfma_f32_16x16x32_bf16 v[132:135], a[252:255], a[28:31], v[132:135]
v_mfma_f32_16x16x32_bf16 v[136:139], a[252:255], a[44:47], v[136:139]
v_mfma_f32_16x16x32_bf16 v[140:143], a[252:255], a[60:63], v[140:143]
s_waitcnt lgkmcnt(0)
v_mfma_f32_16x16x32_bf16 v[16:19], a[192:195], a[64:67], v[16:19]
ds_read_b64_tr_b16 a[224:225], v224 offset:40960
ds_read_b64_tr_b16 a[226:227], v224 offset:41984
v_mfma_f32_16x16x32_bf16 v[20:23], a[192:195], a[80:83], v[20:23]
ds_read_b64_tr_b16 a[228:229], v225 offset:40960
ds_read_b64_tr_b16 a[230:231], v225 offset:41984
v_mfma_f32_16x16x32_bf16 v[24:27], a[192:195], a[96:99], v[24:27]
ds_read_b64_tr_b16 a[232:233], v226 offset:40960
ds_read_b64_tr_b16 a[234:235], v226 offset:41984
v_mfma_f32_16x16x32_bf16 v[28:31], a[192:195], a[112:115], v[28:31]
ds_read_b64_tr_b16 a[236:237], v227 offset:40960
ds_read_b64_tr_b16 a[238:239], v227 offset:41984
v_mfma_f32_16x16x32_bf16 v[32:35], a[196:199], a[64:67], v[32:35]
ds_read_b64_tr_b16 a[240:241], v228 offset:40960
ds_read_b64_tr_b16 a[242:243], v228 offset:41984
v_mfma_f32_16x16x32_bf16 v[36:39], a[196:199], a[80:83], v[36:39]
ds_read_b64_tr_b16 a[244:245], v229 offset:40960
ds_read_b64_tr_b16 a[246:247], v229 offset:41984
v_mfma_f32_16x16x32_bf16 v[40:43], a[196:199], a[96:99], v[40:43]
ds_read_b64_tr_b16 a[248:249], v230 offset:40960
ds_read_b64_tr_b16 a[250:251], v230 offset:41984
v_mfma_f32_16x16x32_bf16 v[44:47], a[196:199], a[112:115], v[44:47]
ds_read_b64_tr_b16 a[252:253], v231 offset:40960
ds_read_b64_tr_b16 a[254:255], v231 offset:41984
v_mfma_f32_16x16x32_bf16 v[48:51], a[200:203], a[64:67], v[48:51]
s_add_u32 m0, s50, 98304
s_mov_b32 s51, 3145728
v_mfma_f32_16x16x32_bf16 v[52:55], a[200:203], a[80:83], v[52:55]
buffer_load_dwordx4 v8, s[24:27], s51 offen offset:0 lds
v_mfma_f32_16x16x32_bf16 v[56:59], a[200:203], a[96:99], v[56:59]
v_mfma_f32_16x16x32_bf16 v[60:63], a[200:203], a[112:115], v[60:63]
buffer_load_dwordx4 v9, s[24:27], s51 offen offset:1024 lds
v_mfma_f32_16x16x32_bf16 v[64:67], a[204:207], a[64:67], v[64:67]
v_mfma_f32_16x16x32_bf16 v[68:71], a[204:207], a[80:83], v[68:71]
buffer_load_dwordx4 v10, s[24:27], s51 offen offset:2048 lds
v_mfma_f32_16x16x32_bf16 v[72:75], a[204:207], a[96:99], v[72:75]
v_mfma_f32_16x16x32_bf16 v[76:79], a[204:207], a[112:115], v[76:79]
buffer_load_dwordx4 v11, s[24:27], s51 offen offset:3072 lds
v_mfma_f32_16x16x32_bf16 v[80:83], a[208:211], a[64:67], v[80:83]
s_add_u32 m0, s50, 102400
s_mov_b32 s51, 3276800
v_mfma_f32_16x16x32_bf16 v[84:87], a[208:211], a[80:83], v[84:87]
buffer_load_dwordx4 v8, s[24:27], s51 offen offset:0 lds
v_mfma_f32_16x16x32_bf16 v[88:91], a[208:211], a[96:99], v[88:91]
v_mfma_f32_16x16x32_bf16 v[92:95], a[208:211], a[112:115], v[92:95]
buffer_load_dwordx4 v9, s[24:27], s51 offen offset:1024 lds
v_mfma_f32_16x16x32_bf16 v[96:99], a[212:215], a[64:67], v[96:99]
v_mfma_f32_16x16x32_bf16 v[100:103], a[212:215], a[80:83], v[100:103]
buffer_load_dwordx4 v10, s[24:27], s51 offen offset:2048 lds
v_mfma_f32_16x16x32_bf16 v[104:107], a[212:215], a[96:99], v[104:107]
v_mfma_f32_16x16x32_bf16 v[108:111], a[212:215], a[112:115], v[108:111]
buffer_load_dwordx4 v11, s[24:27], s51 offen offset:3072 lds
v_mfma_f32_16x16x32_bf16 v[112:115], a[216:219], a[64:67], v[112:115]
v_mfma_f32_16x16x32_bf16 v[116:119], a[216:219], a[80:83], v[116:119]
v_mfma_f32_16x16x32_bf16 v[120:123], a[216:219], a[96:99], v[120:123]
v_mfma_f32_16x16x32_bf16 v[124:127], a[216:219], a[112:115], v[124:127]
v_mfma_f32_16x16x32_bf16 v[128:131], a[220:223], a[64:67], v[128:131]
v_mfma_f32_16x16x32_bf16 v[132:135], a[220:223], a[80:83], v[132:135]
v_mfma_f32_16x16x32_bf16 v[136:139], a[220:223], a[96:99], v[136:139]
v_mfma_f32_16x16x32_bf16 v[140:143], a[220:223], a[112:115], v[140:143]
s_waitcnt lgkmcnt(0)
v_mfma_f32_16x16x32_bf16 v[16:19], a[224:227], a[68:71], v[16:19]
ds_read_b64_tr_b16 a[192:193], v224 offset:49152
ds_read_b64_tr_b16 a[194:195], v224 offset:50176
v_mfma_f32_16x16x32_bf16 v[20:23], a[224:227], a[84:87], v[20:23]
ds_read_b64_tr_b16 a[196:197], v225 offset:49152
ds_read_b64_tr_b16 a[198:199], v225 offset:50176
v_mfma_f32_16x16x32_bf16 v[24:27], a[224:227], a[100:103], v[24:27]
ds_read_b64_tr_b16 a[200:201], v226 offset:49152
ds_read_b64_tr_b16 a[202:203], v226 offset:50176
v_mfma_f32_16x16x32_bf16 v[28:31], a[224:227], a[116:119], v[28:31]
ds_read_b64_tr_b16 a[204:205], v227 offset:49152
ds_read_b64_tr_b16 a[206:207], v227 offset:50176
v_mfma_f32_16x16x32_bf16 v[32:35], a[228:231], a[68:71], v[32:35]
ds_read_b64_tr_b16 a[208:209], v228 offset:49152
ds_read_b64_tr_b16 a[210:211], v228 offset:50176
v_mfma_f32_16x16x32_bf16 v[36:39], a[228:231], a[84:87], v[36:39]
ds_read_b64_tr_b16 a[212:213], v229 offset:49152
ds_read_b64_tr_b16 a[214:215], v229 offset:50176
v_mfma_f32_16x16x32_bf16 v[40:43], a[228:231], a[100:103], v[40:43]
ds_read_b64_tr_b16 a[216:217], v230 offset:49152
ds_read_b64_tr_b16 a[218:219], v230 offset:50176
v_mfma_f32_16x16x32_bf16 v[44:47], a[228:231], a[116:119], v[44:47]
ds_read_b64_tr_b16 a[220:221], v231 offset:49152
ds_read_b64_tr_b16 a[222:223], v231 offset:50176
v_mfma_f32_16x16x32_bf16 v[48:51], a[232:235], a[68:71], v[48:51]
s_lshl_b32 s52, s45, 14
s_add_u32 s52, s52, 12288
v_mfma_f32_16x16x32_bf16 v[52:55], a[232:235], a[84:87], v[52:55]
buffer_load_dwordx4 a[0:3], v1, s[20:23], s52 offen offset:0
v_mfma_f32_16x16x32_bf16 v[56:59], a[232:235], a[100:103], v[56:59]
v_mfma_f32_16x16x32_bf16 v[60:63], a[232:235], a[116:119], v[60:63]
buffer_load_dwordx4 a[4:7], v1, s[20:23], s52 offen offset:1024
v_mfma_f32_16x16x32_bf16 v[64:67], a[236:239], a[68:71], v[64:67]
v_mfma_f32_16x16x32_bf16 v[68:71], a[236:239], a[84:87], v[68:71]
buffer_load_dwordx4 a[8:11], v1, s[20:23], s52 offen offset:2048
v_mfma_f32_16x16x32_bf16 v[72:75], a[236:239], a[100:103], v[72:75]
v_mfma_f32_16x16x32_bf16 v[76:79], a[236:239], a[116:119], v[76:79]
buffer_load_dwordx4 a[12:15], v1, s[20:23], s52 offen offset:3072
v_mfma_f32_16x16x32_bf16 v[80:83], a[240:243], a[68:71], v[80:83]
s_lshl_b32 s52, s47, 14
s_add_u32 s52, s52, 12288
v_mfma_f32_16x16x32_bf16 v[84:87], a[240:243], a[84:87], v[84:87]
buffer_load_dwordx4 a[16:19], v1, s[20:23], s52 offen offset:0
v_mfma_f32_16x16x32_bf16 v[88:91], a[240:243], a[100:103], v[88:91]
v_mfma_f32_16x16x32_bf16 v[92:95], a[240:243], a[116:119], v[92:95]
buffer_load_dwordx4 a[20:23], v1, s[20:23], s52 offen offset:1024
v_mfma_f32_16x16x32_bf16 v[96:99], a[244:247], a[68:71], v[96:99]
v_mfma_f32_16x16x32_bf16 v[100:103], a[244:247], a[84:87], v[100:103]
buffer_load_dwordx4 a[24:27], v1, s[20:23], s52 offen offset:2048
v_mfma_f32_16x16x32_bf16 v[104:107], a[244:247], a[100:103], v[104:107]
v_mfma_f32_16x16x32_bf16 v[108:111], a[244:247], a[116:119], v[108:111]
buffer_load_dwordx4 a[28:31], v1, s[20:23], s52 offen offset:3072
v_mfma_f32_16x16x32_bf16 v[112:115], a[248:251], a[68:71], v[112:115]
v_mfma_f32_16x16x32_bf16 v[116:119], a[248:251], a[84:87], v[116:119]
v_mfma_f32_16x16x32_bf16 v[120:123], a[248:251], a[100:103], v[120:123]
v_mfma_f32_16x16x32_bf16 v[124:127], a[248:251], a[116:119], v[124:127]
v_mfma_f32_16x16x32_bf16 v[128:131], a[252:255], a[68:71], v[128:131]
v_mfma_f32_16x16x32_bf16 v[132:135], a[252:255], a[84:87], v[132:135]
v_mfma_f32_16x16x32_bf16 v[136:139], a[252:255], a[100:103], v[136:139]
v_mfma_f32_16x16x32_bf16 v[140:143], a[252:255], a[116:119], v[140:143]
s_waitcnt lgkmcnt(0)
v_mfma_f32_16x16x32_bf16 v[16:19], a[192:195], a[72:75], v[16:19]
ds_read_b64_tr_b16 a[224:225], v224 offset:57344
ds_read_b64_tr_b16 a[226:227], v224 offset:58368
v_mfma_f32_16x16x32_bf16 v[20:23], a[192:195], a[88:91], v[20:23]
ds_read_b64_tr_b16 a[228:229], v225 offset:57344
ds_read_b64_tr_b16 a[230:231], v225 offset:58368
v_mfma_f32_16x16x32_bf16 v[24:27], a[192:195], a[104:107], v[24:27]
ds_read_b64_tr_b16 a[232:233], v226 offset:57344
ds_read_b64_tr_b16 a[234:235], v226 offset:58368
v_mfma_f32_16x16x32_bf16 v[28:31], a[192:195], a[120:123], v[28:31]
ds_read_b64_tr_b16 a[236:237], v227 offset:57344
ds_read_b64_tr_b16 a[238:239], v227 offset:58368
v_mfma_f32_16x16x32_bf16 v[32:35], a[196:199], a[72:75], v[32:35]
ds_read_b64_tr_b16 a[240:241], v228 offset:57344
ds_read_b64_tr_b16 a[242:243], v228 offset:58368
v_mfma_f32_16x16x32_bf16 v[36:39], a[196:199], a[88:91], v[36:39]
ds_read_b64_tr_b16 a[244:245], v229 offset:57344
ds_read_b64_tr_b16 a[246:247], v229 offset:58368
v_mfma_f32_16x16x32_bf16 v[40:43], a[196:199], a[104:107], v[40:43]
ds_read_b64_tr_b16 a[248:249], v230 offset:57344
ds_read_b64_tr_b16 a[250:251], v230 offset:58368
v_mfma_f32_16x16x32_bf16 v[44:47], a[196:199], a[120:123], v[44:47]
ds_read_b64_tr_b16 a[252:253], v231 offset:57344
ds_read_b64_tr_b16 a[254:255], v231 offset:58368
v_mfma_f32_16x16x32_bf16 v[48:51], a[200:203], a[72:75], v[48:51]
s_lshl_b32 s52, s46, 14
s_add_u32 s52, s52, 12288
v_mfma_f32_16x16x32_bf16 v[52:55], a[200:203], a[88:91], v[52:55]
buffer_load_dwordx4 a[32:35], v1, s[20:23], s52 offen offset:0
v_mfma_f32_16x16x32_bf16 v[56:59], a[200:203], a[104:107], v[56:59]
v_mfma_f32_16x16x32_bf16 v[60:63], a[200:203], a[120:123], v[60:63]
buffer_load_dwordx4 a[36:39], v1, s[20:23], s52 offen offset:1024
v_mfma_f32_16x16x32_bf16 v[64:67], a[204:207], a[72:75], v[64:67]
v_mfma_f32_16x16x32_bf16 v[68:71], a[204:207], a[88:91], v[68:71]
buffer_load_dwordx4 a[40:43], v1, s[20:23], s52 offen offset:2048
v_mfma_f32_16x16x32_bf16 v[72:75], a[204:207], a[104:107], v[72:75]
v_mfma_f32_16x16x32_bf16 v[76:79], a[204:207], a[120:123], v[76:79]
buffer_load_dwordx4 a[44:47], v1, s[20:23], s52 offen offset:3072
v_mfma_f32_16x16x32_bf16 v[80:83], a[208:211], a[72:75], v[80:83]
s_lshl_b32 s52, s79, 14
s_add_u32 s52, s52, 12288
v_mfma_f32_16x16x32_bf16 v[84:87], a[208:211], a[88:91], v[84:87]
buffer_load_dwordx4 a[48:51], v1, s[20:23], s52 offen offset:0
v_mfma_f32_16x16x32_bf16 v[88:91], a[208:211], a[104:107], v[88:91]
v_mfma_f32_16x16x32_bf16 v[92:95], a[208:211], a[120:123], v[92:95]
buffer_load_dwordx4 a[52:55], v1, s[20:23], s52 offen offset:1024
v_mfma_f32_16x16x32_bf16 v[96:99], a[212:215], a[72:75], v[96:99]
v_mfma_f32_16x16x32_bf16 v[100:103], a[212:215], a[88:91], v[100:103]
buffer_load_dwordx4 a[56:59], v1, s[20:23], s52 offen offset:2048
v_mfma_f32_16x16x32_bf16 v[104:107], a[212:215], a[104:107], v[104:107]
v_mfma_f32_16x16x32_bf16 v[108:111], a[212:215], a[120:123], v[108:111]
buffer_load_dwordx4 a[60:63], v1, s[20:23], s52 offen offset:3072
v_mfma_f32_16x16x32_bf16 v[112:115], a[216:219], a[72:75], v[112:115]
v_mfma_f32_16x16x32_bf16 v[116:119], a[216:219], a[88:91], v[116:119]
v_mfma_f32_16x16x32_bf16 v[120:123], a[216:219], a[104:107], v[120:123]
v_mfma_f32_16x16x32_bf16 v[124:127], a[216:219], a[120:123], v[124:127]
v_mfma_f32_16x16x32_bf16 v[128:131], a[220:223], a[72:75], v[128:131]
v_mfma_f32_16x16x32_bf16 v[132:135], a[220:223], a[88:91], v[132:135]
v_mfma_f32_16x16x32_bf16 v[136:139], a[220:223], a[104:107], v[136:139]
v_mfma_f32_16x16x32_bf16 v[140:143], a[220:223], a[120:123], v[140:143]
s_waitcnt lgkmcnt(0)
s_waitcnt vmcnt(24)
s_barrier
v_mfma_f32_16x16x32_bf16 v[16:19], a[224:227], a[76:79], v[16:19]
v_add_u32 v224, 0x10000, v224
v_add_u32 v225, 0x10000, v225
v_mfma_f32_16x16x32_bf16 v[20:23], a[224:227], a[92:95], v[20:23]
v_add_u32 v226, 0x10000, v226
v_add_u32 v227, 0x10000, v227
v_mfma_f32_16x16x32_bf16 v[24:27], a[224:227], a[108:111], v[24:27]
v_add_u32 v228, 0x10000, v228
v_add_u32 v229, 0x10000, v229
v_mfma_f32_16x16x32_bf16 v[28:31], a[224:227], a[124:127], v[28:31]
v_add_u32 v230, 0x10000, v230
v_add_u32 v231, 0x10000, v231
v_mfma_f32_16x16x32_bf16 v[32:35], a[228:231], a[76:79], v[32:35]
ds_read_b64_tr_b16 a[192:193], v224 offset:0
ds_read_b64_tr_b16 a[194:195], v224 offset:1024
v_mfma_f32_16x16x32_bf16 v[36:39], a[228:231], a[92:95], v[36:39]
ds_read_b64_tr_b16 a[196:197], v225 offset:0
ds_read_b64_tr_b16 a[198:199], v225 offset:1024
v_mfma_f32_16x16x32_bf16 v[40:43], a[228:231], a[108:111], v[40:43]
ds_read_b64_tr_b16 a[200:201], v226 offset:0
ds_read_b64_tr_b16 a[202:203], v226 offset:1024
v_mfma_f32_16x16x32_bf16 v[44:47], a[228:231], a[124:127], v[44:47]
ds_read_b64_tr_b16 a[204:205], v227 offset:0
ds_read_b64_tr_b16 a[206:207], v227 offset:1024
v_mfma_f32_16x16x32_bf16 v[48:51], a[232:235], a[76:79], v[48:51]
ds_read_b64_tr_b16 a[208:209], v228 offset:0
ds_read_b64_tr_b16 a[210:211], v228 offset:1024
v_mfma_f32_16x16x32_bf16 v[52:55], a[232:235], a[92:95], v[52:55]
ds_read_b64_tr_b16 a[212:213], v229 offset:0
ds_read_b64_tr_b16 a[214:215], v229 offset:1024
v_mfma_f32_16x16x32_bf16 v[56:59], a[232:235], a[108:111], v[56:59]
ds_read_b64_tr_b16 a[216:217], v230 offset:0
ds_read_b64_tr_b16 a[218:219], v230 offset:1024
v_mfma_f32_16x16x32_bf16 v[60:63], a[232:235], a[124:127], v[60:63]
ds_read_b64_tr_b16 a[220:221], v231 offset:0
ds_read_b64_tr_b16 a[222:223], v231 offset:1024
v_mfma_f32_16x16x32_bf16 v[64:67], a[236:239], a[76:79], v[64:67]
s_add_u32 m0, s39, 0
s_add_u32 s53, s41, 0
v_mfma_f32_16x16x32_bf16 v[68:71], a[236:239], a[92:95], v[68:71]
buffer_load_dwordx4 v4, s[16:19], s53 offen offset:0 lds
v_mfma_f32_16x16x32_bf16 v[72:75], a[236:239], a[108:111], v[72:75]
v_mfma_f32_16x16x32_bf16 v[76:79], a[236:239], a[124:127], v[76:79]
buffer_load_dwordx4 v4, s[16:19], s53 offen offset:1024 lds
v_mfma_f32_16x16x32_bf16 v[80:83], a[240:243], a[76:79], v[80:83]
v_mfma_f32_16x16x32_bf16 v[84:87], a[240:243], a[92:95], v[84:87]
buffer_load_dwordx4 v4, s[16:19], s53 offen offset:2048 lds
v_mfma_f32_16x16x32_bf16 v[88:91], a[240:243], a[108:111], v[88:91]
v_mfma_f32_16x16x32_bf16 v[92:95], a[240:243], a[124:127], v[92:95]
buffer_load_dwordx4 v4, s[16:19], s53 offen offset:3072 lds
v_mfma_f32_16x16x32_bf16 v[96:99], a[244:247], a[76:79], v[96:99]
v_mfma_f32_16x16x32_bf16 v[100:103], a[244:247], a[92:95], v[100:103]
v_mfma_f32_16x16x32_bf16 v[104:107], a[244:247], a[108:111], v[104:107]
v_mfma_f32_16x16x32_bf16 v[108:111], a[244:247], a[124:127], v[108:111]
v_mfma_f32_16x16x32_bf16 v[112:115], a[248:251], a[76:79], v[112:115]
v_mfma_f32_16x16x32_bf16 v[116:119], a[248:251], a[92:95], v[116:119]
v_mfma_f32_16x16x32_bf16 v[120:123], a[248:251], a[108:111], v[120:123]
v_mfma_f32_16x16x32_bf16 v[124:127], a[248:251], a[124:127], v[124:127]
v_mfma_f32_16x16x32_bf16 v[128:131], a[252:255], a[76:79], v[128:131]
v_mfma_f32_16x16x32_bf16 v[132:135], a[252:255], a[92:95], v[132:135]
v_mfma_f32_16x16x32_bf16 v[136:139], a[252:255], a[108:111], v[136:139]
v_mfma_f32_16x16x32_bf16 v[140:143], a[252:255], a[124:127], v[140:143]
s_waitcnt lgkmcnt(0)
v_mfma_f32_16x16x32_bf16 v[16:19], a[192:195], a[128:131], v[16:19]
ds_read_b64_tr_b16 a[224:225], v224 offset:8192
ds_read_b64_tr_b16 a[226:227], v224 offset:9216
v_mfma_f32_16x16x32_bf16 v[20:23], a[192:195], a[144:147], v[20:23]
ds_read_b64_tr_b16 a[228:229], v225 offset:8192
ds_read_b64_tr_b16 a[230:231], v225 offset:9216
v_mfma_f32_16x16x32_bf16 v[24:27], a[192:195], a[160:163], v[24:27]
ds_read_b64_tr_b16 a[232:233], v226 offset:8192
ds_read_b64_tr_b16 a[234:235], v226 offset:9216
v_mfma_f32_16x16x32_bf16 v[28:31], a[192:195], a[176:179], v[28:31]
ds_read_b64_tr_b16 a[236:237], v227 offset:8192
ds_read_b64_tr_b16 a[238:239], v227 offset:9216
v_mfma_f32_16x16x32_bf16 v[32:35], a[196:199], a[128:131], v[32:35]
ds_read_b64_tr_b16 a[240:241], v228 offset:8192
ds_read_b64_tr_b16 a[242:243], v228 offset:9216
v_mfma_f32_16x16x32_bf16 v[36:39], a[196:199], a[144:147], v[36:39]
ds_read_b64_tr_b16 a[244:245], v229 offset:8192
ds_read_b64_tr_b16 a[246:247], v229 offset:9216
v_mfma_f32_16x16x32_bf16 v[40:43], a[196:199], a[160:163], v[40:43]
ds_read_b64_tr_b16 a[248:249], v230 offset:8192
ds_read_b64_tr_b16 a[250:251], v230 offset:9216
v_mfma_f32_16x16x32_bf16 v[44:47], a[196:199], a[176:179], v[44:47]
ds_read_b64_tr_b16 a[252:253], v231 offset:8192
ds_read_b64_tr_b16 a[254:255], v231 offset:9216
v_mfma_f32_16x16x32_bf16 v[48:51], a[200:203], a[128:131], v[48:51]
v_mfma_f32_16x16x32_bf16 v[52:55], a[200:203], a[144:147], v[52:55]
v_mfma_f32_16x16x32_bf16 v[56:59], a[200:203], a[160:163], v[56:59]
v_mfma_f32_16x16x32_bf16 v[60:63], a[200:203], a[176:179], v[60:63]
v_mfma_f32_16x16x32_bf16 v[64:67], a[204:207], a[128:131], v[64:67]
v_mfma_f32_16x16x32_bf16 v[68:71], a[204:207], a[144:147], v[68:71]
v_mfma_f32_16x16x32_bf16 v[72:75], a[204:207], a[160:163], v[72:75]
v_mfma_f32_16x16x32_bf16 v[76:79], a[204:207], a[176:179], v[76:79]
v_mfma_f32_16x16x32_bf16 v[80:83], a[208:211], a[128:131], v[80:83]
v_mfma_f32_16x16x32_bf16 v[84:87], a[208:211], a[144:147], v[84:87]
v_mfma_f32_16x16x32_bf16 v[88:91], a[208:211], a[160:163], v[88:91]
v_mfma_f32_16x16x32_bf16 v[92:95], a[208:211], a[176:179], v[92:95]
v_mfma_f32_16x16x32_bf16 v[96:99], a[212:215], a[128:131], v[96:99]
v_mfma_f32_16x16x32_bf16 v[100:103], a[212:215], a[144:147], v[100:103]
v_mfma_f32_16x16x32_bf16 v[104:107], a[212:215], a[160:163], v[104:107]
v_mfma_f32_16x16x32_bf16 v[108:111], a[212:215], a[176:179], v[108:111]
v_mfma_f32_16x16x32_bf16 v[112:115], a[216:219], a[128:131], v[112:115]
v_mfma_f32_16x16x32_bf16 v[116:119], a[216:219], a[144:147], v[116:119]
v_mfma_f32_16x16x32_bf16 v[120:123], a[216:219], a[160:163], v[120:123]
v_mfma_f32_16x16x32_bf16 v[124:127], a[216:219], a[176:179], v[124:127]
v_mfma_f32_16x16x32_bf16 v[128:131], a[220:223], a[128:131], v[128:131]
v_mfma_f32_16x16x32_bf16 v[132:135], a[220:223], a[144:147], v[132:135]
v_mfma_f32_16x16x32_bf16 v[136:139], a[220:223], a[160:163], v[136:139]
v_mfma_f32_16x16x32_bf16 v[140:143], a[220:223], a[176:179], v[140:143]
s_waitcnt lgkmcnt(0)
v_mfma_f32_16x16x32_bf16 v[16:19], a[224:227], a[132:135], v[16:19]
ds_read_b64_tr_b16 a[192:193], v224 offset:16384
ds_read_b64_tr_b16 a[194:195], v224 offset:17408
v_mfma_f32_16x16x32_bf16 v[20:23], a[224:227], a[148:151], v[20:23]
ds_read_b64_tr_b16 a[196:197], v225 offset:16384
ds_read_b64_tr_b16 a[198:199], v225 offset:17408
v_mfma_f32_16x16x32_bf16 v[24:27], a[224:227], a[164:167], v[24:27]
ds_read_b64_tr_b16 a[200:201], v226 offset:16384
ds_read_b64_tr_b16 a[202:203], v226 offset:17408
v_mfma_f32_16x16x32_bf16 v[28:31], a[224:227], a[180:183], v[28:31]
ds_read_b64_tr_b16 a[204:205], v227 offset:16384
ds_read_b64_tr_b16 a[206:207], v227 offset:17408
v_mfma_f32_16x16x32_bf16 v[32:35], a[228:231], a[132:135], v[32:35]
ds_read_b64_tr_b16 a[208:209], v228 offset:16384
ds_read_b64_tr_b16 a[210:211], v228 offset:17408
v_mfma_f32_16x16x32_bf16 v[36:39], a[228:231], a[148:151], v[36:39]
ds_read_b64_tr_b16 a[212:213], v229 offset:16384
ds_read_b64_tr_b16 a[214:215], v229 offset:17408
v_mfma_f32_16x16x32_bf16 v[40:43], a[228:231], a[164:167], v[40:43]
ds_read_b64_tr_b16 a[216:217], v230 offset:16384
ds_read_b64_tr_b16 a[218:219], v230 offset:17408
v_mfma_f32_16x16x32_bf16 v[44:47], a[228:231], a[180:183], v[44:47]
ds_read_b64_tr_b16 a[220:221], v231 offset:16384
ds_read_b64_tr_b16 a[222:223], v231 offset:17408
v_mfma_f32_16x16x32_bf16 v[48:51], a[232:235], a[132:135], v[48:51]
v_mfma_f32_16x16x32_bf16 v[52:55], a[232:235], a[148:151], v[52:55]
v_mfma_f32_16x16x32_bf16 v[56:59], a[232:235], a[164:167], v[56:59]
v_mfma_f32_16x16x32_bf16 v[60:63], a[232:235], a[180:183], v[60:63]
v_mfma_f32_16x16x32_bf16 v[64:67], a[236:239], a[132:135], v[64:67]
v_mfma_f32_16x16x32_bf16 v[68:71], a[236:239], a[148:151], v[68:71]
v_mfma_f32_16x16x32_bf16 v[72:75], a[236:239], a[164:167], v[72:75]
v_mfma_f32_16x16x32_bf16 v[76:79], a[236:239], a[180:183], v[76:79]
v_mfma_f32_16x16x32_bf16 v[80:83], a[240:243], a[132:135], v[80:83]
v_mfma_f32_16x16x32_bf16 v[84:87], a[240:243], a[148:151], v[84:87]
v_mfma_f32_16x16x32_bf16 v[88:91], a[240:243], a[164:167], v[88:91]
v_mfma_f32_16x16x32_bf16 v[92:95], a[240:243], a[180:183], v[92:95]
v_mfma_f32_16x16x32_bf16 v[96:99], a[244:247], a[132:135], v[96:99]
v_mfma_f32_16x16x32_bf16 v[100:103], a[244:247], a[148:151], v[100:103]
v_mfma_f32_16x16x32_bf16 v[104:107], a[244:247], a[164:167], v[104:107]
v_mfma_f32_16x16x32_bf16 v[108:111], a[244:247], a[180:183], v[108:111]
v_mfma_f32_16x16x32_bf16 v[112:115], a[248:251], a[132:135], v[112:115]
v_mfma_f32_16x16x32_bf16 v[116:119], a[248:251], a[148:151], v[116:119]
v_mfma_f32_16x16x32_bf16 v[120:123], a[248:251], a[164:167], v[120:123]
v_mfma_f32_16x16x32_bf16 v[124:127], a[248:251], a[180:183], v[124:127]
v_mfma_f32_16x16x32_bf16 v[128:131], a[252:255], a[132:135], v[128:131]
v_mfma_f32_16x16x32_bf16 v[132:135], a[252:255], a[148:151], v[132:135]
v_mfma_f32_16x16x32_bf16 v[136:139], a[252:255], a[164:167], v[136:139]
v_mfma_f32_16x16x32_bf16 v[140:143], a[252:255], a[180:183], v[140:143]
s_waitcnt lgkmcnt(0)
v_mfma_f32_16x16x32_bf16 v[16:19], a[192:195], a[136:139], v[16:19]
ds_read_b64_tr_b16 a[224:225], v224 offset:24576
ds_read_b64_tr_b16 a[226:227], v224 offset:25600
v_mfma_f32_16x16x32_bf16 v[20:23], a[192:195], a[152:155], v[20:23]
ds_read_b64_tr_b16 a[228:229], v225 offset:24576
ds_read_b64_tr_b16 a[230:231], v225 offset:25600
v_mfma_f32_16x16x32_bf16 v[24:27], a[192:195], a[168:171], v[24:27]
ds_read_b64_tr_b16 a[232:233], v226 offset:24576
ds_read_b64_tr_b16 a[234:235], v226 offset:25600
v_mfma_f32_16x16x32_bf16 v[28:31], a[192:195], a[184:187], v[28:31]
ds_read_b64_tr_b16 a[236:237], v227 offset:24576
ds_read_b64_tr_b16 a[238:239], v227 offset:25600
v_mfma_f32_16x16x32_bf16 v[32:35], a[196:199], a[136:139], v[32:35]
ds_read_b64_tr_b16 a[240:241], v228 offset:24576
ds_read_b64_tr_b16 a[242:243], v228 offset:25600
v_mfma_f32_16x16x32_bf16 v[36:39], a[196:199], a[152:155], v[36:39]
ds_read_b64_tr_b16 a[244:245], v229 offset:24576
ds_read_b64_tr_b16 a[246:247], v229 offset:25600
v_mfma_f32_16x16x32_bf16 v[40:43], a[196:199], a[168:171], v[40:43]
ds_read_b64_tr_b16 a[248:249], v230 offset:24576
ds_read_b64_tr_b16 a[250:251], v230 offset:25600
v_mfma_f32_16x16x32_bf16 v[44:47], a[196:199], a[184:187], v[44:47]
ds_read_b64_tr_b16 a[252:253], v231 offset:24576
ds_read_b64_tr_b16 a[254:255], v231 offset:25600
v_mfma_f32_16x16x32_bf16 v[48:51], a[200:203], a[136:139], v[48:51]
v_mfma_f32_16x16x32_bf16 v[52:55], a[200:203], a[152:155], v[52:55]
v_mfma_f32_16x16x32_bf16 v[56:59], a[200:203], a[168:171], v[56:59]
v_mfma_f32_16x16x32_bf16 v[60:63], a[200:203], a[184:187], v[60:63]
v_mfma_f32_16x16x32_bf16 v[64:67], a[204:207], a[136:139], v[64:67]
v_mfma_f32_16x16x32_bf16 v[68:71], a[204:207], a[152:155], v[68:71]
v_mfma_f32_16x16x32_bf16 v[72:75], a[204:207], a[168:171], v[72:75]
v_mfma_f32_16x16x32_bf16 v[76:79], a[204:207], a[184:187], v[76:79]
v_mfma_f32_16x16x32_bf16 v[80:83], a[208:211], a[136:139], v[80:83]
v_mfma_f32_16x16x32_bf16 v[84:87], a[208:211], a[152:155], v[84:87]
v_mfma_f32_16x16x32_bf16 v[88:91], a[208:211], a[168:171], v[88:91]
v_mfma_f32_16x16x32_bf16 v[92:95], a[208:211], a[184:187], v[92:95]
v_mfma_f32_16x16x32_bf16 v[96:99], a[212:215], a[136:139], v[96:99]
v_mfma_f32_16x16x32_bf16 v[100:103], a[212:215], a[152:155], v[100:103]
v_mfma_f32_16x16x32_bf16 v[104:107], a[212:215], a[168:171], v[104:107]
v_mfma_f32_16x16x32_bf16 v[108:111], a[212:215], a[184:187], v[108:111]
v_mfma_f32_16x16x32_bf16 v[112:115], a[216:219], a[136:139], v[112:115]
v_mfma_f32_16x16x32_bf16 v[116:119], a[216:219], a[152:155], v[116:119]
v_mfma_f32_16x16x32_bf16 v[120:123], a[216:219], a[168:171], v[120:123]
v_mfma_f32_16x16x32_bf16 v[124:127], a[216:219], a[184:187], v[124:127]
v_mfma_f32_16x16x32_bf16 v[128:131], a[220:223], a[136:139], v[128:131]
v_mfma_f32_16x16x32_bf16 v[132:135], a[220:223], a[152:155], v[132:135]
v_mfma_f32_16x16x32_bf16 v[136:139], a[220:223], a[168:171], v[136:139]
v_mfma_f32_16x16x32_bf16 v[140:143], a[220:223], a[184:187], v[140:143]
s_waitcnt lgkmcnt(0)
s_waitcnt vmcnt(4)
s_barrier
v_mfma_f32_16x16x32_bf16 v[16:19], a[224:227], a[140:143], v[16:19]
ds_read_b64_tr_b16 a[192:193], v224 offset:32768
ds_read_b64_tr_b16 a[194:195], v224 offset:33792
v_mfma_f32_16x16x32_bf16 v[20:23], a[224:227], a[156:159], v[20:23]
ds_read_b64_tr_b16 a[196:197], v225 offset:32768
ds_read_b64_tr_b16 a[198:199], v225 offset:33792
v_mfma_f32_16x16x32_bf16 v[24:27], a[224:227], a[172:175], v[24:27]
ds_read_b64_tr_b16 a[200:201], v226 offset:32768
ds_read_b64_tr_b16 a[202:203], v226 offset:33792
v_mfma_f32_16x16x32_bf16 v[28:31], a[224:227], a[188:191], v[28:31]
ds_read_b64_tr_b16 a[204:205], v227 offset:32768
ds_read_b64_tr_b16 a[206:207], v227 offset:33792
v_mfma_f32_16x16x32_bf16 v[32:35], a[228:231], a[140:143], v[32:35]
ds_read_b64_tr_b16 a[208:209], v228 offset:32768
ds_read_b64_tr_b16 a[210:211], v228 offset:33792
v_mfma_f32_16x16x32_bf16 v[36:39], a[228:231], a[156:159], v[36:39]
ds_read_b64_tr_b16 a[212:213], v229 offset:32768
ds_read_b64_tr_b16 a[214:215], v229 offset:33792
v_mfma_f32_16x16x32_bf16 v[40:43], a[228:231], a[172:175], v[40:43]
ds_read_b64_tr_b16 a[216:217], v230 offset:32768
ds_read_b64_tr_b16 a[218:219], v230 offset:33792
v_mfma_f32_16x16x32_bf16 v[44:47], a[228:231], a[188:191], v[44:47]
ds_read_b64_tr_b16 a[220:221], v231 offset:32768
ds_read_b64_tr_b16 a[222:223], v231 offset:33792
v_mfma_f32_16x16x32_bf16 v[48:51], a[232:235], a[140:143], v[48:51]
s_add_u32 m0, s39, 16384
s_add_u32 s53, s41, 16384
v_mfma_f32_16x16x32_bf16 v[52:55], a[232:235], a[156:159], v[52:55]
buffer_load_dwordx4 v4, s[16:19], s53 offen offset:0 lds
v_mfma_f32_16x16x32_bf16 v[56:59], a[232:235], a[172:175], v[56:59]
v_mfma_f32_16x16x32_bf16 v[60:63], a[232:235], a[188:191], v[60:63]
buffer_load_dwordx4 v4, s[16:19], s53 offen offset:1024 lds
v_mfma_f32_16x16x32_bf16 v[64:67], a[236:239], a[140:143], v[64:67]
v_mfma_f32_16x16x32_bf16 v[68:71], a[236:239], a[156:159], v[68:71]
buffer_load_dwordx4 v4, s[16:19], s53 offen offset:2048 lds
v_mfma_f32_16x16x32_bf16 v[72:75], a[236:239], a[172:175], v[72:75]
v_mfma_f32_16x16x32_bf16 v[76:79], a[236:239], a[188:191], v[76:79]
buffer_load_dwordx4 v4, s[16:19], s53 offen offset:3072 lds
v_mfma_f32_16x16x32_bf16 v[80:83], a[240:243], a[140:143], v[80:83]
s_add_u32 m0, s39, 32768
s_add_u32 s53, s41, 32768
v_mfma_f32_16x16x32_bf16 v[84:87], a[240:243], a[156:159], v[84:87]
buffer_load_dwordx4 v4, s[16:19], s53 offen offset:0 lds
v_mfma_f32_16x16x32_bf16 v[88:91], a[240:243], a[172:175], v[88:91]
v_mfma_f32_16x16x32_bf16 v[92:95], a[240:243], a[188:191], v[92:95]
buffer_load_dwordx4 v4, s[16:19], s53 offen offset:1024 lds
v_mfma_f32_16x16x32_bf16 v[96:99], a[244:247], a[140:143], v[96:99]
v_mfma_f32_16x16x32_bf16 v[100:103], a[244:247], a[156:159], v[100:103]
buffer_load_dwordx4 v4, s[16:19], s53 offen offset:2048 lds
v_mfma_f32_16x16x32_bf16 v[104:107], a[244:247], a[172:175], v[104:107]
v_mfma_f32_16x16x32_bf16 v[108:111], a[244:247], a[188:191], v[108:111]
buffer_load_dwordx4 v4, s[16:19], s53 offen offset:3072 lds
v_mfma_f32_16x16x32_bf16 v[112:115], a[248:251], a[140:143], v[112:115]
v_mfma_f32_16x16x32_bf16 v[116:119], a[248:251], a[156:159], v[116:119]
v_mfma_f32_16x16x32_bf16 v[120:123], a[248:251], a[172:175], v[120:123]
v_mfma_f32_16x16x32_bf16 v[124:127], a[248:251], a[188:191], v[124:127]
v_mfma_f32_16x16x32_bf16 v[128:131], a[252:255], a[140:143], v[128:131]
v_mfma_f32_16x16x32_bf16 v[132:135], a[252:255], a[156:159], v[132:135]
v_mfma_f32_16x16x32_bf16 v[136:139], a[252:255], a[172:175], v[136:139]
v_mfma_f32_16x16x32_bf16 v[140:143], a[252:255], a[188:191], v[140:143]
s_waitcnt lgkmcnt(0)
v_mfma_f32_16x16x32_bf16 v[16:19], a[192:195], a[0:3], v[16:19]
ds_read_b64_tr_b16 a[224:225], v224 offset:40960
ds_read_b64_tr_b16 a[226:227], v224 offset:41984
v_mfma_f32_16x16x32_bf16 v[20:23], a[192:195], a[16:19], v[20:23]
ds_read_b64_tr_b16 a[228:229], v225 offset:40960
ds_read_b64_tr_b16 a[230:231], v225 offset:41984
v_mfma_f32_16x16x32_bf16 v[24:27], a[192:195], a[32:35], v[24:27]
ds_read_b64_tr_b16 a[232:233], v226 offset:40960
ds_read_b64_tr_b16 a[234:235], v226 offset:41984
v_mfma_f32_16x16x32_bf16 v[28:31], a[192:195], a[48:51], v[28:31]
ds_read_b64_tr_b16 a[236:237], v227 offset:40960
ds_read_b64_tr_b16 a[238:239], v227 offset:41984
v_mfma_f32_16x16x32_bf16 v[32:35], a[196:199], a[0:3], v[32:35]
ds_read_b64_tr_b16 a[240:241], v228 offset:40960
ds_read_b64_tr_b16 a[242:243], v228 offset:41984
v_mfma_f32_16x16x32_bf16 v[36:39], a[196:199], a[16:19], v[36:39]
ds_read_b64_tr_b16 a[244:245], v229 offset:40960
ds_read_b64_tr_b16 a[246:247], v229 offset:41984
v_mfma_f32_16x16x32_bf16 v[40:43], a[196:199], a[32:35], v[40:43]
ds_read_b64_tr_b16 a[248:249], v230 offset:40960
ds_read_b64_tr_b16 a[250:251], v230 offset:41984
v_mfma_f32_16x16x32_bf16 v[44:47], a[196:199], a[48:51], v[44:47]
ds_read_b64_tr_b16 a[252:253], v231 offset:40960
ds_read_b64_tr_b16 a[254:255], v231 offset:41984
v_mfma_f32_16x16x32_bf16 v[48:51], a[200:203], a[0:3], v[48:51]
v_mfma_f32_16x16x32_bf16 v[52:55], a[200:203], a[16:19], v[52:55]
v_mfma_f32_16x16x32_bf16 v[56:59], a[200:203], a[32:35], v[56:59]
v_mfma_f32_16x16x32_bf16 v[60:63], a[200:203], a[48:51], v[60:63]
v_mfma_f32_16x16x32_bf16 v[64:67], a[204:207], a[0:3], v[64:67]
v_mfma_f32_16x16x32_bf16 v[68:71], a[204:207], a[16:19], v[68:71]
v_mfma_f32_16x16x32_bf16 v[72:75], a[204:207], a[32:35], v[72:75]
v_mfma_f32_16x16x32_bf16 v[76:79], a[204:207], a[48:51], v[76:79]
v_mfma_f32_16x16x32_bf16 v[80:83], a[208:211], a[0:3], v[80:83]
v_mfma_f32_16x16x32_bf16 v[84:87], a[208:211], a[16:19], v[84:87]
v_mfma_f32_16x16x32_bf16 v[88:91], a[208:211], a[32:35], v[88:91]
v_mfma_f32_16x16x32_bf16 v[92:95], a[208:211], a[48:51], v[92:95]
v_mfma_f32_16x16x32_bf16 v[96:99], a[212:215], a[0:3], v[96:99]
v_mfma_f32_16x16x32_bf16 v[100:103], a[212:215], a[16:19], v[100:103]
v_mfma_f32_16x16x32_bf16 v[104:107], a[212:215], a[32:35], v[104:107]
v_mfma_f32_16x16x32_bf16 v[108:111], a[212:215], a[48:51], v[108:111]
v_mfma_f32_16x16x32_bf16 v[112:115], a[216:219], a[0:3], v[112:115]
v_mfma_f32_16x16x32_bf16 v[116:119], a[216:219], a[16:19], v[116:119]
v_mfma_f32_16x16x32_bf16 v[120:123], a[216:219], a[32:35], v[120:123]
v_mfma_f32_16x16x32_bf16 v[124:127], a[216:219], a[48:51], v[124:127]
v_mfma_f32_16x16x32_bf16 v[128:131], a[220:223], a[0:3], v[128:131]
v_mfma_f32_16x16x32_bf16 v[132:135], a[220:223], a[16:19], v[132:135]
v_mfma_f32_16x16x32_bf16 v[136:139], a[220:223], a[32:35], v[136:139]
v_mfma_f32_16x16x32_bf16 v[140:143], a[220:223], a[48:51], v[140:143]
s_waitcnt lgkmcnt(0)
v_mfma_f32_16x16x32_bf16 v[16:19], a[224:227], a[4:7], v[16:19]
ds_read_b64_tr_b16 a[192:193], v224 offset:49152
ds_read_b64_tr_b16 a[194:195], v224 offset:50176
v_mfma_f32_16x16x32_bf16 v[20:23], a[224:227], a[20:23], v[20:23]
ds_read_b64_tr_b16 a[196:197], v225 offset:49152
ds_read_b64_tr_b16 a[198:199], v225 offset:50176
v_mfma_f32_16x16x32_bf16 v[24:27], a[224:227], a[36:39], v[24:27]
ds_read_b64_tr_b16 a[200:201], v226 offset:49152
ds_read_b64_tr_b16 a[202:203], v226 offset:50176
v_mfma_f32_16x16x32_bf16 v[28:31], a[224:227], a[52:55], v[28:31]
ds_read_b64_tr_b16 a[204:205], v227 offset:49152
ds_read_b64_tr_b16 a[206:207], v227 offset:50176
v_mfma_f32_16x16x32_bf16 v[32:35], a[228:231], a[4:7], v[32:35]
ds_read_b64_tr_b16 a[208:209], v228 offset:49152
ds_read_b64_tr_b16 a[210:211], v228 offset:50176
v_mfma_f32_16x16x32_bf16 v[36:39], a[228:231], a[20:23], v[36:39]
ds_read_b64_tr_b16 a[212:213], v229 offset:49152
ds_read_b64_tr_b16 a[214:215], v229 offset:50176
v_mfma_f32_16x16x32_bf16 v[40:43], a[228:231], a[36:39], v[40:43]
ds_read_b64_tr_b16 a[216:217], v230 offset:49152
ds_read_b64_tr_b16 a[218:219], v230 offset:50176
v_mfma_f32_16x16x32_bf16 v[44:47], a[228:231], a[52:55], v[44:47]
ds_read_b64_tr_b16 a[220:221], v231 offset:49152
ds_read_b64_tr_b16 a[222:223], v231 offset:50176
v_mfma_f32_16x16x32_bf16 v[48:51], a[232:235], a[4:7], v[48:51]
v_mfma_f32_16x16x32_bf16 v[52:55], a[232:235], a[20:23], v[52:55]
v_mfma_f32_16x16x32_bf16 v[56:59], a[232:235], a[36:39], v[56:59]
v_mfma_f32_16x16x32_bf16 v[60:63], a[232:235], a[52:55], v[60:63]
v_mfma_f32_16x16x32_bf16 v[64:67], a[236:239], a[4:7], v[64:67]
v_mfma_f32_16x16x32_bf16 v[68:71], a[236:239], a[20:23], v[68:71]
v_mfma_f32_16x16x32_bf16 v[72:75], a[236:239], a[36:39], v[72:75]
v_mfma_f32_16x16x32_bf16 v[76:79], a[236:239], a[52:55], v[76:79]
v_mfma_f32_16x16x32_bf16 v[80:83], a[240:243], a[4:7], v[80:83]
v_mfma_f32_16x16x32_bf16 v[84:87], a[240:243], a[20:23], v[84:87]
v_mfma_f32_16x16x32_bf16 v[88:91], a[240:243], a[36:39], v[88:91]
v_mfma_f32_16x16x32_bf16 v[92:95], a[240:243], a[52:55], v[92:95]
v_mfma_f32_16x16x32_bf16 v[96:99], a[244:247], a[4:7], v[96:99]
v_mfma_f32_16x16x32_bf16 v[100:103], a[244:247], a[20:23], v[100:103]
v_mfma_f32_16x16x32_bf16 v[104:107], a[244:247], a[36:39], v[104:107]
v_mfma_f32_16x16x32_bf16 v[108:111], a[244:247], a[52:55], v[108:111]
v_mfma_f32_16x16x32_bf16 v[112:115], a[248:251], a[4:7], v[112:115]
v_mfma_f32_16x16x32_bf16 v[116:119], a[248:251], a[20:23], v[116:119]
v_mfma_f32_16x16x32_bf16 v[120:123], a[248:251], a[36:39], v[120:123]
v_mfma_f32_16x16x32_bf16 v[124:127], a[248:251], a[52:55], v[124:127]
v_mfma_f32_16x16x32_bf16 v[128:131], a[252:255], a[4:7], v[128:131]
v_mfma_f32_16x16x32_bf16 v[132:135], a[252:255], a[20:23], v[132:135]
v_mfma_f32_16x16x32_bf16 v[136:139], a[252:255], a[36:39], v[136:139]
v_mfma_f32_16x16x32_bf16 v[140:143], a[252:255], a[52:55], v[140:143]
s_waitcnt lgkmcnt(0)
v_mfma_f32_16x16x32_bf16 v[16:19], a[192:195], a[8:11], v[16:19]
ds_read_b64_tr_b16 a[224:225], v224 offset:57344
ds_read_b64_tr_b16 a[226:227], v224 offset:58368
v_mfma_f32_16x16x32_bf16 v[20:23], a[192:195], a[24:27], v[20:23]
ds_read_b64_tr_b16 a[228:229], v225 offset:57344
ds_read_b64_tr_b16 a[230:231], v225 offset:58368
v_mfma_f32_16x16x32_bf16 v[24:27], a[192:195], a[40:43], v[24:27]
ds_read_b64_tr_b16 a[232:233], v226 offset:57344
ds_read_b64_tr_b16 a[234:235], v226 offset:58368
v_mfma_f32_16x16x32_bf16 v[28:31], a[192:195], a[56:59], v[28:31]
ds_read_b64_tr_b16 a[236:237], v227 offset:57344
ds_read_b64_tr_b16 a[238:239], v227 offset:58368
v_mfma_f32_16x16x32_bf16 v[32:35], a[196:199], a[8:11], v[32:35]
ds_read_b64_tr_b16 a[240:241], v228 offset:57344
ds_read_b64_tr_b16 a[242:243], v228 offset:58368
v_mfma_f32_16x16x32_bf16 v[36:39], a[196:199], a[24:27], v[36:39]
ds_read_b64_tr_b16 a[244:245], v229 offset:57344
ds_read_b64_tr_b16 a[246:247], v229 offset:58368
v_mfma_f32_16x16x32_bf16 v[40:43], a[196:199], a[40:43], v[40:43]
ds_read_b64_tr_b16 a[248:249], v230 offset:57344
ds_read_b64_tr_b16 a[250:251], v230 offset:58368
v_mfma_f32_16x16x32_bf16 v[44:47], a[196:199], a[56:59], v[44:47]
ds_read_b64_tr_b16 a[252:253], v231 offset:57344
ds_read_b64_tr_b16 a[254:255], v231 offset:58368
v_mfma_f32_16x16x32_bf16 v[48:51], a[200:203], a[8:11], v[48:51]
v_mfma_f32_16x16x32_bf16 v[52:55], a[200:203], a[24:27], v[52:55]
v_mfma_f32_16x16x32_bf16 v[56:59], a[200:203], a[40:43], v[56:59]
v_mfma_f32_16x16x32_bf16 v[60:63], a[200:203], a[56:59], v[60:63]
v_mfma_f32_16x16x32_bf16 v[64:67], a[204:207], a[8:11], v[64:67]
v_mfma_f32_16x16x32_bf16 v[68:71], a[204:207], a[24:27], v[68:71]
v_mfma_f32_16x16x32_bf16 v[72:75], a[204:207], a[40:43], v[72:75]
v_mfma_f32_16x16x32_bf16 v[76:79], a[204:207], a[56:59], v[76:79]
v_mfma_f32_16x16x32_bf16 v[80:83], a[208:211], a[8:11], v[80:83]
v_mfma_f32_16x16x32_bf16 v[84:87], a[208:211], a[24:27], v[84:87]
v_mfma_f32_16x16x32_bf16 v[88:91], a[208:211], a[40:43], v[88:91]
v_mfma_f32_16x16x32_bf16 v[92:95], a[208:211], a[56:59], v[92:95]
v_mfma_f32_16x16x32_bf16 v[96:99], a[212:215], a[8:11], v[96:99]
v_mfma_f32_16x16x32_bf16 v[100:103], a[212:215], a[24:27], v[100:103]
v_mfma_f32_16x16x32_bf16 v[104:107], a[212:215], a[40:43], v[104:107]
v_mfma_f32_16x16x32_bf16 v[108:111], a[212:215], a[56:59], v[108:111]
v_mfma_f32_16x16x32_bf16 v[112:115], a[216:219], a[8:11], v[112:115]
v_mfma_f32_16x16x32_bf16 v[116:119], a[216:219], a[24:27], v[116:119]
v_mfma_f32_16x16x32_bf16 v[120:123], a[216:219], a[40:43], v[120:123]
v_mfma_f32_16x16x32_bf16 v[124:127], a[216:219], a[56:59], v[124:127]
v_mfma_f32_16x16x32_bf16 v[128:131], a[220:223], a[8:11], v[128:131]
v_mfma_f32_16x16x32_bf16 v[132:135], a[220:223], a[24:27], v[132:135]
v_mfma_f32_16x16x32_bf16 v[136:139], a[220:223], a[40:43], v[136:139]
v_mfma_f32_16x16x32_bf16 v[140:143], a[220:223], a[56:59], v[140:143]
s_waitcnt lgkmcnt(0)
s_barrier
v_mfma_f32_16x16x32_bf16 v[16:19], a[224:227], a[12:15], v[16:19]
v_mfma_f32_16x16x32_bf16 v[20:23], a[224:227], a[28:31], v[20:23]
s_add_u32 m0, s39, 49152
s_add_u32 s53, s41, 49152
v_mfma_f32_16x16x32_bf16 v[24:27], a[224:227], a[44:47], v[24:27]
buffer_load_dwordx4 v4, s[16:19], s53 offen offset:0 lds
v_mfma_f32_16x16x32_bf16 v[28:31], a[224:227], a[60:63], v[28:31]
v_mfma_f32_16x16x32_bf16 v[32:35], a[228:231], a[12:15], v[32:35]
buffer_load_dwordx4 v4, s[16:19], s53 offen offset:1024 lds
v_mfma_f32_16x16x32_bf16 v[36:39], a[228:231], a[28:31], v[36:39]
v_mfma_f32_16x16x32_bf16 v[40:43], a[228:231], a[44:47], v[40:43]
buffer_load_dwordx4 v4, s[16:19], s53 offen offset:2048 lds
v_mfma_f32_16x16x32_bf16 v[44:47], a[228:231], a[60:63], v[44:47]
v_mfma_f32_16x16x32_bf16 v[48:51], a[232:235], a[12:15], v[48:51]
buffer_load_dwordx4 v4, s[16:19], s53 offen offset:3072 lds
v_mfma_f32_16x16x32_bf16 v[52:55], a[232:235], a[28:31], v[52:55]
v_mfma_f32_16x16x32_bf16 v[56:59], a[232:235], a[44:47], v[56:59]
v_mfma_f32_16x16x32_bf16 v[60:63], a[232:235], a[60:63], v[60:63]
v_mfma_f32_16x16x32_bf16 v[64:67], a[236:239], a[12:15], v[64:67]
v_mfma_f32_16x16x32_bf16 v[68:71], a[236:239], a[28:31], v[68:71]
v_cvt_pk_bf16_f32 v144, v16, v17
v_cvt_pk_bf16_f32 v145, v18, v19
v_mfma_f32_16x16x32_bf16 v[72:75], a[236:239], a[44:47], v[72:75]
v_cvt_pk_bf16_f32 v146, v32, v33
v_cvt_pk_bf16_f32 v147, v34, v35
v_mfma_f32_16x16x32_bf16 v[76:79], a[236:239], a[60:63], v[76:79]
v_cvt_pk_bf16_f32 v160, v20, v21
v_cvt_pk_bf16_f32 v161, v22, v23
v_mfma_f32_16x16x32_bf16 v[80:83], a[240:243], a[12:15], v[80:83]
v_cvt_pk_bf16_f32 v162, v36, v37
v_cvt_pk_bf16_f32 v163, v38, v39
v_mfma_f32_16x16x32_bf16 v[84:87], a[240:243], a[28:31], v[84:87]
v_cvt_pk_bf16_f32 v176, v24, v25
v_cvt_pk_bf16_f32 v177, v26, v27
v_mfma_f32_16x16x32_bf16 v[88:91], a[240:243], a[44:47], v[88:91]
v_cvt_pk_bf16_f32 v178, v40, v41
v_cvt_pk_bf16_f32 v179, v42, v43
v_mfma_f32_16x16x32_bf16 v[92:95], a[240:243], a[60:63], v[92:95]
v_cvt_pk_bf16_f32 v192, v28, v29
v_cvt_pk_bf16_f32 v193, v30, v31
v_mfma_f32_16x16x32_bf16 v[96:99], a[244:247], a[12:15], v[96:99]
v_cvt_pk_bf16_f32 v194, v44, v45
v_cvt_pk_bf16_f32 v195, v46, v47
v_mfma_f32_16x16x32_bf16 v[100:103], a[244:247], a[28:31], v[100:103]
v_cvt_pk_bf16_f32 v148, v48, v49
v_cvt_pk_bf16_f32 v149, v50, v51
v_mfma_f32_16x16x32_bf16 v[104:107], a[244:247], a[44:47], v[104:107]
v_cvt_pk_bf16_f32 v150, v64, v65
v_cvt_pk_bf16_f32 v151, v66, v67
v_mfma_f32_16x16x32_bf16 v[108:111], a[244:247], a[60:63], v[108:111]
v_cvt_pk_bf16_f32 v164, v52, v53
v_cvt_pk_bf16_f32 v165, v54, v55
v_mfma_f32_16x16x32_bf16 v[112:115], a[248:251], a[12:15], v[112:115]
v_cvt_pk_bf16_f32 v166, v68, v69
v_cvt_pk_bf16_f32 v167, v70, v71
v_mfma_f32_16x16x32_bf16 v[116:119], a[248:251], a[28:31], v[116:119]
v_cvt_pk_bf16_f32 v180, v56, v57
v_cvt_pk_bf16_f32 v181, v58, v59
v_mfma_f32_16x16x32_bf16 v[120:123], a[248:251], a[44:47], v[120:123]
v_cvt_pk_bf16_f32 v182, v72, v73
v_cvt_pk_bf16_f32 v183, v74, v75
v_mfma_f32_16x16x32_bf16 v[124:127], a[248:251], a[60:63], v[124:127]
v_cvt_pk_bf16_f32 v196, v60, v61
v_cvt_pk_bf16_f32 v197, v62, v63
v_mfma_f32_16x16x32_bf16 v[128:131], a[252:255], a[12:15], v[128:131]
v_cvt_pk_bf16_f32 v198, v76, v77
v_cvt_pk_bf16_f32 v199, v78, v79
v_mfma_f32_16x16x32_bf16 v[132:135], a[252:255], a[28:31], v[132:135]
v_cvt_pk_bf16_f32 v152, v80, v81
v_cvt_pk_bf16_f32 v153, v82, v83
v_mfma_f32_16x16x32_bf16 v[136:139], a[252:255], a[44:47], v[136:139]
v_cvt_pk_bf16_f32 v154, v96, v97
v_cvt_pk_bf16_f32 v155, v98, v99
v_cvt_pk_bf16_f32 v170, v100, v101
v_mfma_f32_16x16x32_bf16 v[140:143], a[252:255], a[60:63], v[140:143]
v_cvt_pk_bf16_f32 v168, v84, v85
v_cvt_pk_bf16_f32 v169, v86, v87
s_mov_b32 s56, s6
s_mov_b32 s57, s7
s_mov_b32 s58, 4194304
s_mov_b32 s59, 0x00020000
s_and_b32 s43, s54, 127
s_lshl_b32 s43, s43, 15
s_lshr_b32 s44, s54, 7
s_lshl_b32 s44, s44, 7
s_add_u32 s68, s43, s44
s_add_u32 m0, s55, 0
s_add_u32 s67, s68, 0
buffer_load_dwordx4 v12, s[56:59], s67 offen lds
s_add_u32 m0, s55, 1024
s_add_u32 s67, s68, 8192
buffer_load_dwordx4 v12, s[56:59], s67 offen lds
s_add_u32 m0, s55, 2048
s_add_u32 s67, s68, 16384
buffer_load_dwordx4 v12, s[56:59], s67 offen lds
s_add_u32 m0, s55, 3072
s_add_u32 s67, s68, 24576
buffer_load_dwordx4 v12, s[56:59], s67 offen lds
s_lshl_b32 s76, s54, 12
s_add_u32 s76, s76, 0
s_cmp_lt_u32 s54, 704
s_cbranch_scc0 K2_RP_WD
s_and_b32 s43, s54, 1
s_cmp_eq_u32 s43, 0
s_cselect_b32 s60, s8, s10
s_cselect_b32 s61, s9, s11
s_mov_b32 s62, 1409024
s_mov_b32 s63, 0x00020000
s_lshr_b32 s43, s54, 1
s_and_b32 s43, s43, 15
s_mul_i32 s43, s43, 88064
s_lshr_b32 s44, s54, 5
s_lshl_b32 s44, s44, 7
s_add_u32 s68, s43, s44
s_add_u32 m0, s55, 4096
s_add_u32 s67, s68, 0
buffer_load_dwordx4 v13, s[60:63], s67 offen lds
s_add_u32 m0, s55, 5120
s_add_u32 s67, s68, 22016
buffer_load_dwordx4 v13, s[60:63], s67 offen lds
s_add_u32 m0, s55, 6144
s_add_u32 s67, s68, 44032
buffer_load_dwordx4 v13, s[60:63], s67 offen lds
s_add_u32 m0, s55, 7168
s_add_u32 s67, s68, 66048
buffer_load_dwordx4 v13, s[60:63], s67 offen lds
s_lshl_b32 s77, s54, 12
s_add_u32 s77, s77, 6291456
s_mov_b32 s78, 0
s_branch K2_RP_J
K2_RP_WD:
s_mov_b32 s60, s14
s_mov_b32 s61, s15
s_mov_b32 s62, 1409024
s_mov_b32 s63, 0x00020000
s_sub_u32 s70, s54, 704
s_mul_hi_u32 s43, s70, 99882961
s_mul_i32 s44, s43, 43
s_sub_u32 s44, s70, s44
s_lshl_b32 s68, s44, 15
s_lshl_b32 s69, s43, 7
s_add_u32 s68, s68, s69
s_mul_i32 s77, s43, 44
s_add_u32 s77, s77, s44
s_lshl_b32 s77, s77, 12
s_add_u32 s77, s77, 4194304
s_add_u32 m0, s55, 4096
s_add_u32 s67, s68, 0
buffer_load_dwordx4 v12, s[60:63], s67 offen lds
s_add_u32 m0, s55, 5120
s_add_u32 s67, s68, 8192
buffer_load_dwordx4 v12, s[60:63], s67 offen lds
s_add_u32 m0, s55, 6144
s_add_u32 s67, s68, 16384
buffer_load_dwordx4 v12, s[60:63], s67 offen lds
s_add_u32 m0, s55, 7168
s_add_u32 s67, s68, 24576
buffer_load_dwordx4 v12, s[60:63], s67 offen lds
s_mov_b32 s78, 1
K2_RP_J:
s_add_u32 s56, s12, 67108864
s_addc_u32 s57, s13, 0
s_mov_b32 s58, 9175040
s_mov_b32 s59, 0x00020000
s_nop 7
v_cvt_pk_bf16_f32 v156, v112, v113
v_cvt_pk_bf16_f32 v157, v114, v115
v_cvt_pk_bf16_f32 v158, v128, v129
v_cvt_pk_bf16_f32 v159, v130, v131
v_cvt_pk_bf16_f32 v171, v102, v103
v_cvt_pk_bf16_f32 v172, v116, v117
v_cvt_pk_bf16_f32 v173, v118, v119
v_cvt_pk_bf16_f32 v174, v132, v133
v_cvt_pk_bf16_f32 v175, v134, v135
v_cvt_pk_bf16_f32 v184, v88, v89
v_cvt_pk_bf16_f32 v185, v90, v91
v_cvt_pk_bf16_f32 v186, v104, v105
v_cvt_pk_bf16_f32 v187, v106, v107
v_cvt_pk_bf16_f32 v188, v120, v121
v_cvt_pk_bf16_f32 v189, v122, v123
v_cvt_pk_bf16_f32 v190, v136, v137
v_cvt_pk_bf16_f32 v191, v138, v139
v_cvt_pk_bf16_f32 v200, v92, v93
v_cvt_pk_bf16_f32 v201, v94, v95
v_cvt_pk_bf16_f32 v202, v108, v109
v_cvt_pk_bf16_f32 v203, v110, v111
v_cvt_pk_bf16_f32 v204, v124, v125
v_cvt_pk_bf16_f32 v205, v126, v127
v_cvt_pk_bf16_f32 v206, v140, v141
v_cvt_pk_bf16_f32 v207, v142, v143
v_mov_b32 v216, 0xf149f2ca
v_mov_b32 v220, 0x4f800000
v_mov_b32 v217, 0x3f803f80
v_accvgpr_write_b32 a208, v217
v_accvgpr_write_b32 a209, v217
v_accvgpr_write_b32 a210, v217
v_accvgpr_write_b32 a211, v217
v_lshlrev_b32 v218, 2, v6
v_sub_u32 v218, v7, v218
v_cmp_le_i32 s[60:61], 0, v218
v_cmp_le_i32 s[62:63], 1, v218
v_cmp_le_i32 s[64:65], 2, v218
v_cmp_le_i32 s[66:67], 3, v218
v_mov_b32 v208, 0
v_mov_b32 v112, 0
v_mov_b32 v113, 0
v_mov_b32 v114, 0
v_mov_b32 v115, 0
v_mov_b32 v128, 0
v_mov_b32 v129, 0
v_mov_b32 v130, 0
v_mov_b32 v131, 0
v_mov_b32 v209, 0
v_mov_b32 v116, 0
v_mov_b32 v117, 0
v_mov_b32 v118, 0
v_mov_b32 v119, 0
v_mov_b32 v132, 0
v_mov_b32 v133, 0
v_mov_b32 v134, 0
v_mov_b32 v135, 0
v_mov_b32 v210, 0
v_mov_b32 v120, 0
v_mov_b32 v121, 0
v_mov_b32 v122, 0
v_mov_b32 v123, 0
v_mov_b32 v136, 0
v_mov_b32 v137, 0
v_mov_b32 v138, 0
v_mov_b32 v139, 0
v_mov_b32 v211, 0
v_mov_b32 v124, 0
v_mov_b32 v125, 0
v_mov_b32 v126, 0
v_mov_b32 v127, 0
v_mov_b32 v140, 0
v_mov_b32 v141, 0
v_mov_b32 v142, 0
v_mov_b32 v143, 0
s_mov_b32 s71, 0
K2_U0:
s_waitcnt vmcnt(16)
s_barrier
ds_read_b128 a[144:147], v2 offset:0
ds_read_b128 a[148:151], v2 offset:1024
ds_read_b128 a[152:155], v2 offset:4096
ds_read_b128 a[156:159], v2 offset:5120
ds_read_b128 a[160:163], v2 offset:8192
ds_read_b128 a[164:167], v2 offset:9216
ds_read_b128 a[168:171], v2 offset:12288
ds_read_b128 a[172:175], v2 offset:13312
s_cmp_eq_u32 s37, 0
s_cbranch_scc0 K2_NM0
s_cmp_eq_u32 s36, 0
s_cbranch_scc0 K2_MK1
v_cndmask_b32 v112, v216, v208, s[60:61]
v_cndmask_b32 v113, v216, v208, s[62:63]
v_cndmask_b32 v114, v216, v208, s[64:65]
v_cndmask_b32 v115, v216, v208, s[66:67]
K2_MK1:
s_cmp_eq_u32 s36, 1
s_cbranch_scc0 K2_MK2
v_cndmask_b32 v128, v216, v208, s[60:61]
v_cndmask_b32 v129, v216, v208, s[62:63]
v_cndmask_b32 v130, v216, v208, s[64:65]
v_cndmask_b32 v131, v216, v208, s[66:67]
K2_MK2:
s_cmp_lt_u32 s36, 1
s_cbranch_scc0 K2_ML2
v_mov_b32 v128, v216
v_mov_b32 v129, v216
v_mov_b32 v130, v216
v_mov_b32 v131, v216
K2_ML2:
K2_NM0:
s_waitcnt lgkmcnt(0)
v_mfma_f32_16x16x32_bf16 v[16:19], a[144:147], v[144:147], v[112:115]
v_mfma_f32_16x16x32_bf16 v[20:23], a[144:147], v[160:163], v[116:119]
v_mfma_f32_16x16x32_bf16 v[24:27], a[144:147], v[176:179], v[120:123]
v_mfma_f32_16x16x32_bf16 v[28:31], a[144:147], v[192:195], v[124:127]
v_mfma_f32_16x16x32_bf16 v[16:19], a[148:151], v[148:151], v[16:19]
v_mfma_f32_16x16x32_bf16 v[20:23], a[148:151], v[164:167], v[20:23]
v_mfma_f32_16x16x32_bf16 v[24:27], a[148:151], v[180:183], v[24:27]
v_mfma_f32_16x16x32_bf16 v[28:31], a[148:151], v[196:199], v[28:31]
v_mfma_f32_16x16x32_bf16 v[16:19], a[152:155], v[152:155], v[16:19]
v_mfma_f32_16x16x32_bf16 v[20:23], a[152:155], v[168:171], v[20:23]
v_mfma_f32_16x16x32_bf16 v[24:27], a[152:155], v[184:187], v[24:27]
v_mfma_f32_16x16x32_bf16 v[28:31], a[152:155], v[200:203], v[28:31]
v_mfma_f32_16x16x32_bf16 v[16:19], a[156:159], v[156:159], v[16:19]
v_mfma_f32_16x16x32_bf16 v[20:23], a[156:159], v[172:175], v[20:23]
v_mfma_f32_16x16x32_bf16 v[24:27], a[156:159], v[188:191], v[24:27]
v_mfma_f32_16x16x32_bf16 v[28:31], a[156:159], v[204:207], v[28:31]
v_mfma_f32_16x16x32_bf16 v[32:35], a[160:163], v[144:147], v[128:131]
v_mfma_f32_16x16x32_bf16 v[36:39], a[160:163], v[160:163], v[132:135]
v_mfma_f32_16x16x32_bf16 v[40:43], a[160:163], v[176:179], v[136:139]
v_mfma_f32_16x16x32_bf16 v[44:47], a[160:163], v[192:195], v[140:143]
v_mfma_f32_16x16x32_bf16 v[32:35], a[164:167], v[148:151], v[32:35]
v_mfma_f32_16x16x32_bf16 v[36:39], a[164:167], v[164:167], v[36:39]
v_mfma_f32_16x16x32_bf16 v[40:43], a[164:167], v[180:183], v[40:43]
v_mfma_f32_16x16x32_bf16 v[44:47], a[164:167], v[196:199], v[44:47]
v_mfma_f32_16x16x32_bf16 v[32:35], a[168:171], v[152:155], v[32:35]
v_mfma_f32_16x16x32_bf16 v[36:39], a[168:171], v[168:171], v[36:39]
v_mfma_f32_16x16x32_bf16 v[40:43], a[168:171], v[184:187], v[40:43]
v_mfma_f32_16x16x32_bf16 v[44:47], a[168:171], v[200:203], v[44:47]
v_mfma_f32_16x16x32_bf16 v[32:35], a[172:175], v[156:159], v[32:35]
v_mfma_f32_16x16x32_bf16 v[36:39], a[172:175], v[172:175], v[36:39]
v_mfma_f32_16x16x32_bf16 v[40:43], a[172:175], v[188:191], v[40:43]
v_mfma_f32_16x16x32_bf16 v[44:47], a[172:175], v[204:207], v[44:47]
ds_read_b128 a[144:147], v2 offset:16384
ds_read_b128 a[148:151], v2 offset:17408
ds_read_b128 a[152:155], v2 offset:20480
ds_read_b128 a[156:159], v2 offset:21504
ds_read_b128 a[160:163], v2 offset:24576
ds_read_b128 a[164:167], v2 offset:25600
ds_read_b128 a[168:171], v2 offset:28672
ds_read_b128 a[172:175], v2 offset:29696
s_cmp_eq_u32 s71, 1
s_cbranch_scc1 K2_NM0b
s_nop 7
v_max3_f32 v208, v16, v17, v18
v_max3_f32 v208, v208, v19, v32
v_max3_f32 v208, v208, v33, v34
v_max_f32 v208, v208, v35
v_max3_f32 v209, v20, v21, v22
v_max3_f32 v209, v209, v23, v36
v_max3_f32 v209, v209, v37, v38
v_max_f32 v209, v209, v39
v_max3_f32 v210, v24, v25, v26
v_max3_f32 v210, v210, v27, v40
v_max3_f32 v210, v210, v41, v42
v_max_f32 v210, v210, v43
v_max3_f32 v211, v28, v29, v30
v_max3_f32 v211, v211, v31, v44
v_max3_f32 v211, v211, v45, v46
v_max_f32 v211, v211, v47
v_mov_b32 v224, v208
v_mov_b32 v225, v209
v_mov_b32 v226, v210
v_mov_b32 v227, v211
s_nop 1
v_permlane16_swap_b32 v208, v224
v_permlane16_swap_b32 v209, v225
v_permlane16_swap_b32 v210, v226
v_permlane16_swap_b32 v211, v227
s_nop 1
v_max_f32 v208, v208, v224
v_max_f32 v209, v209, v225
v_max_f32 v210, v210, v226
v_max_f32 v211, v211, v227
v_mov_b32 v224, v208
v_mov_b32 v225, v209
v_mov_b32 v226, v210
v_mov_b32 v227, v211
s_nop 1
v_permlane32_swap_b32 v208, v224
v_permlane32_swap_b32 v209, v225
v_permlane32_swap_b32 v210, v226
v_permlane32_swap_b32 v211, v227
s_nop 1
v_max_f32 v208, v208, v224
v_max_f32 v209, v209, v225
v_max_f32 v210, v210, v226
v_max_f32 v211, v211, v227
v_sub_f32 v208, 0, v208
v_sub_f32 v209, 0, v209
v_sub_f32 v210, 0, v210
v_sub_f32 v211, 0, v211
v_add_f32 v16, v16, v208
v_mov_b32 v112, v208
v_add_f32 v17, v17, v208
v_mov_b32 v113, v208
v_add_f32 v18, v18, v208
v_mov_b32 v114, v208
v_add_f32 v19, v19, v208
v_mov_b32 v115, v208
v_add_f32 v32, v32, v208
v_mov_b32 v128, v208
v_add_f32 v33, v33, v208
v_mov_b32 v129, v208
v_add_f32 v34, v34, v208
v_mov_b32 v130, v208
v_add_f32 v35, v35, v208
v_mov_b32 v131, v208
v_add_f32 v20, v20, v209
v_mov_b32 v116, v209
v_add_f32 v21, v21, v209
v_mov_b32 v117, v209
v_add_f32 v22, v22, v209
v_mov_b32 v118, v209
v_add_f32 v23, v23, v209
v_mov_b32 v119, v209
v_add_f32 v36, v36, v209
v_mov_b32 v132, v209
v_add_f32 v37, v37, v209
v_mov_b32 v133, v209
v_add_f32 v38, v38, v209
v_mov_b32 v134, v209
v_add_f32 v39, v39, v209
v_mov_b32 v135, v209
v_add_f32 v24, v24, v210
v_mov_b32 v120, v210
v_add_f32 v25, v25, v210
v_mov_b32 v121, v210
v_add_f32 v26, v26, v210
v_mov_b32 v122, v210
v_add_f32 v27, v27, v210
v_mov_b32 v123, v210
v_add_f32 v40, v40, v210
v_mov_b32 v136, v210
v_add_f32 v41, v41, v210
v_mov_b32 v137, v210
v_add_f32 v42, v42, v210
v_mov_b32 v138, v210
v_add_f32 v43, v43, v210
v_mov_b32 v139, v210
v_add_f32 v28, v28, v211
v_mov_b32 v124, v211
v_add_f32 v29, v29, v211
v_mov_b32 v125, v211
v_add_f32 v30, v30, v211
v_mov_b32 v126, v211
v_add_f32 v31, v31, v211
v_mov_b32 v127, v211
v_add_f32 v44, v44, v211
v_mov_b32 v140, v211
v_add_f32 v45, v45, v211
v_mov_b32 v141, v211
v_add_f32 v46, v46, v211
v_mov_b32 v142, v211
v_add_f32 v47, v47, v211
v_mov_b32 v143, v211
s_cmp_eq_u32 s37, 0
s_cbranch_scc0 K2_NM0b
s_cmp_eq_u32 s36, 0
s_cbranch_scc0 K2_MK3
v_cndmask_b32 v112, v216, v208, s[60:61]
v_cndmask_b32 v113, v216, v208, s[62:63]
v_cndmask_b32 v114, v216, v208, s[64:65]
v_cndmask_b32 v115, v216, v208, s[66:67]
K2_MK3:
s_cmp_eq_u32 s36, 1
s_cbranch_scc0 K2_MK4
v_cndmask_b32 v128, v216, v208, s[60:61]
v_cndmask_b32 v129, v216, v208, s[62:63]
v_cndmask_b32 v130, v216, v208, s[64:65]
v_cndmask_b32 v131, v216, v208, s[66:67]
K2_MK4:
s_cmp_lt_u32 s36, 1
s_cbranch_scc0 K2_ML4
v_mov_b32 v128, v216
v_mov_b32 v129, v216
v_mov_b32 v130, v216
v_mov_b32 v131, v216
K2_ML4:
K2_NM0b:
s_waitcnt lgkmcnt(0)
s_add_u32 s41, s41, 65536
v_add_u32 v248, 16384, v4
v_add_u32 v249, 32768, v4
v_add_u32 v250, 49152, v4
v_add_u32 v251, 65536, v4
s_cmp_eq_u32 s37, 0
s_cbranch_scc0 first_NM1_0
s_cmp_eq_u32 s36, 2
s_cbranch_scc0 K2_MK5
v_cndmask_b32 v112, v216, v208, s[60:61]
v_cndmask_b32 v113, v216, v208, s[62:63]
v_cndmask_b32 v114, v216, v208, s[64:65]
v_cndmask_b32 v115, v216, v208, s[66:67]
K2_MK5:
s_cmp_lt_u32 s36, 2
s_cbranch_scc0 K2_ML5
v_mov_b32 v112, v216
v_mov_b32 v113, v216
v_mov_b32 v114, v216
v_mov_b32 v115, v216
K2_ML5:
s_cmp_eq_u32 s36, 3
s_cbranch_scc0 K2_MK6
v_cndmask_b32 v128, v216, v208, s[60:61]
v_cndmask_b32 v129, v216, v208, s[62:63]
v_cndmask_b32 v130, v216, v208, s[64:65]
v_cndmask_b32 v131, v216, v208, s[66:67]
K2_MK6:
s_cmp_lt_u32 s36, 3
s_cbranch_scc0 K2_ML6
v_mov_b32 v128, v216
v_mov_b32 v129, v216
v_mov_b32 v130, v216
v_mov_b32 v131, v216
K2_ML6:
first_NM1_0:
s_nop 1
v_mfma_f32_16x16x32_bf16 v[48:51], a[144:147], v[144:147], v[112:115]
v_exp_f32 v16, v16
v_mfma_f32_16x16x32_bf16 v[52:55], a[144:147], v[160:163], v[116:119]
v_exp_f32 v17, v17
v_mfma_f32_16x16x32_bf16 v[56:59], a[144:147], v[176:179], v[120:123]
v_exp_f32 v18, v18
v_cvt_pk_bf16_f32 v80, v16, v17
v_mfma_f32_16x16x32_bf16 v[60:63], a[144:147], v[192:195], v[124:127]
v_exp_f32 v19, v19
v_mfma_f32_16x16x32_bf16 v[48:51], a[148:151], v[148:151], v[48:51]
v_exp_f32 v32, v32
v_cvt_pk_bf16_f32 v81, v18, v19
v_mfma_f32_16x16x32_bf16 v[52:55], a[148:151], v[164:167], v[52:55]
v_exp_f32 v33, v33
v_mfma_f32_16x16x32_bf16 v[56:59], a[148:151], v[180:183], v[56:59]
v_exp_f32 v34, v34
v_cvt_pk_bf16_f32 v82, v32, v33
v_mfma_f32_16x16x32_bf16 v[60:63], a[148:151], v[196:199], v[60:63]
v_exp_f32 v35, v35
v_mfma_f32_16x16x32_bf16 v[48:51], a[152:155], v[152:155], v[48:51]
v_exp_f32 v20, v20
v_cvt_pk_bf16_f32 v83, v34, v35
v_mfma_f32_16x16x32_bf16 v[52:55], a[152:155], v[168:171], v[52:55]
v_exp_f32 v21, v21
s_waitcnt vmcnt(12)
v_mfma_f32_16x16x32_bf16 v[56:59], a[152:155], v[184:187], v[56:59]
v_exp_f32 v22, v22
v_cvt_pk_bf16_f32 v84, v20, v21
v_mfma_f32_16x16x32_bf16 v[60:63], a[152:155], v[200:203], v[60:63]
v_exp_f32 v23, v23
s_barrier
v_mfma_f32_16x16x32_bf16 v[48:51], a[156:159], v[156:159], v[48:51]
ds_read_b128 a[144:147], v2 offset:32768
v_exp_f32 v36, v36
v_cvt_pk_bf16_f32 v85, v22, v23
v_mfma_f32_16x16x32_bf16 v[52:55], a[156:159], v[172:175], v[52:55]
v_exp_f32 v37, v37
s_add_u32 m0, s40, 0
ds_read_b128 a[148:151], v2 offset:33792
v_mfma_f32_16x16x32_bf16 v[56:59], a[156:159], v[188:191], v[56:59]
ds_read_b128 a[152:155], v2 offset:36864
v_exp_f32 v38, v38
v_cvt_pk_bf16_f32 v86, v36, v37
v_mfma_f32_16x16x32_bf16 v[60:63], a[156:159], v[204:207], v[60:63]
buffer_load_dwordx4 v4, s[16:19], s41 offen offset:0 lds
v_exp_f32 v39, v39
v_mfma_f32_16x16x32_bf16 v[64:67], a[160:163], v[144:147], v[128:131]
ds_read_b128 a[156:159], v2 offset:37888
v_exp_f32 v24, v24
v_cvt_pk_bf16_f32 v87, v38, v39
v_mfma_f32_16x16x32_bf16 v[68:71], a[160:163], v[160:163], v[132:135]
buffer_load_dwordx4 v4, s[16:19], s41 offen offset:1024 lds
v_exp_f32 v25, v25
v_mfma_f32_16x16x32_bf16 v[72:75], a[160:163], v[176:179], v[136:139]
v_exp_f32 v26, v26
v_cvt_pk_bf16_f32 v88, v24, v25
v_mfma_f32_16x16x32_bf16 v[76:79], a[160:163], v[192:195], v[140:143]
buffer_load_dwordx4 v4, s[16:19], s41 offen offset:2048 lds
v_exp_f32 v27, v27
v_mfma_f32_16x16x32_bf16 v[64:67], a[164:167], v[148:151], v[64:67]
ds_read_b128 a[160:163], v2 offset:40960
v_exp_f32 v40, v40
v_cvt_pk_bf16_f32 v89, v26, v27
v_mfma_f32_16x16x32_bf16 v[68:71], a[164:167], v[164:167], v[68:71]
buffer_load_dwordx4 v4, s[16:19], s41 offen offset:3072 lds
v_exp_f32 v41, v41
v_mfma_f32_16x16x32_bf16 v[72:75], a[164:167], v[180:183], v[72:75]
v_exp_f32 v42, v42
v_cvt_pk_bf16_f32 v90, v40, v41
v_mfma_f32_16x16x32_bf16 v[76:79], a[164:167], v[196:199], v[76:79]
v_exp_f32 v43, v43
s_add_u32 m0, s40, 16384
v_mfma_f32_16x16x32_bf16 v[64:67], a[168:171], v[152:155], v[64:67]
ds_read_b128 a[164:167], v2 offset:41984
v_exp_f32 v28, v28
v_cvt_pk_bf16_f32 v91, v42, v43
v_mfma_f32_16x16x32_bf16 v[68:71], a[168:171], v[168:171], v[68:71]
buffer_load_dwordx4 v248, s[16:19], s41 offen offset:0 lds
v_exp_f32 v29, v29
v_mfma_f32_16x16x32_bf16 v[72:75], a[168:171], v[184:187], v[72:75]
v_exp_f32 v30, v30
v_cvt_pk_bf16_f32 v92, v28, v29
v_mfma_f32_16x16x32_bf16 v[76:79], a[168:171], v[200:203], v[76:79]
buffer_load_dwordx4 v248, s[16:19], s41 offen offset:1024 lds
v_exp_f32 v31, v31
v_mfma_f32_16x16x32_bf16 v[64:67], a[172:175], v[156:159], v[64:67]
v_exp_f32 v44, v44
v_cvt_pk_bf16_f32 v93, v30, v31
v_mfma_f32_16x16x32_bf16 v[68:71], a[172:175], v[172:175], v[68:71]
buffer_load_dwordx4 v248, s[16:19], s41 offen offset:2048 lds
v_exp_f32 v45, v45
v_mfma_f32_16x16x32_bf16 v[72:75], a[172:175], v[188:191], v[72:75]
v_exp_f32 v46, v46
v_cvt_pk_bf16_f32 v94, v44, v45
v_mfma_f32_16x16x32_bf16 v[76:79], a[172:175], v[204:207], v[76:79]
buffer_load_dwordx4 v248, s[16:19], s41 offen offset:3072 lds
v_exp_f32 v47, v47
s_nop 0
v_cvt_pk_bf16_f32 v95, v46, v47
ds_read_b128 a[168:171], v2 offset:45056
ds_read_b128 a[172:175], v2 offset:46080
s_waitcnt lgkmcnt(0)
s_cmp_eq_u32 s37, 0
s_cbranch_scc0 first_NM2_0
s_cmp_eq_u32 s36, 3
s_cbranch_scc0 K2_MK7
v_cndmask_b32 v116, v216, v209, s[60:61]
v_cndmask_b32 v117, v216, v209, s[62:63]
v_cndmask_b32 v118, v216, v209, s[64:65]
v_cndmask_b32 v119, v216, v209, s[66:67]
K2_MK7:
s_cmp_eq_u32 s36, 2
s_cbranch_scc0 K2_MK8
v_cndmask_b32 v132, v216, v209, s[60:61]
v_cndmask_b32 v133, v216, v209, s[62:63]
v_cndmask_b32 v134, v216, v209, s[64:65]
v_cndmask_b32 v135, v216, v209, s[66:67]
K2_MK8:
s_cmp_gt_u32 s36, 2
s_cbranch_scc0 K2_ML8
v_mov_b32 v132, v216
v_mov_b32 v133, v216
v_mov_b32 v134, v216
v_mov_b32 v135, v216
K2_ML8:
first_NM2_0:
s_nop 1
v_mfma_f32_16x16x32_bf16 v[16:19], a[144:147], v[144:147], v[112:115]
v_exp_f32 v48, v48
v_mfma_f32_16x16x32_bf16 v[20:23], a[144:147], v[160:163], v[116:119]
ds_read_b128 a[176:179], v2 offset:2048
ds_read_b128 a[180:183], v2 offset:3072
v_mfma_f32_16x16x32_bf16 v[24:27], a[144:147], v[176:179], v[120:123]
v_exp_f32 v49, v49
v_mfma_f32_16x16x32_bf16 v[28:31], a[144:147], v[192:195], v[124:127]
ds_read_b128 a[184:187], v2 offset:6144
ds_read_b128 a[188:191], v2 offset:7168
v_mfma_f32_16x16x32_bf16 v[16:19], a[148:151], v[148:151], v[16:19]
v_exp_f32 v50, v50
v_mfma_f32_16x16x32_bf16 v[20:23], a[148:151], v[164:167], v[20:23]
ds_read_b128 a[192:195], v2 offset:10240
ds_read_b128 a[196:199], v2 offset:11264
v_mfma_f32_16x16x32_bf16 v[24:27], a[148:151], v[180:183], v[24:27]
v_exp_f32 v51, v51
v_mfma_f32_16x16x32_bf16 v[28:31], a[148:151], v[196:199], v[28:31]
ds_read_b128 a[200:203], v2 offset:14336
ds_read_b128 a[204:207], v2 offset:15360
v_mfma_f32_16x16x32_bf16 v[16:19], a[152:155], v[152:155], v[16:19]
v_exp_f32 v64, v64
v_mfma_f32_16x16x32_bf16 v[20:23], a[152:155], v[168:171], v[20:23]
v_cvt_pk_bf16_f32 v96, v48, v49
v_cvt_pk_bf16_f32 v97, v50, v51
v_mfma_f32_16x16x32_bf16 v[24:27], a[152:155], v[184:187], v[24:27]
v_exp_f32 v65, v65
v_mfma_f32_16x16x32_bf16 v[28:31], a[152:155], v[200:203], v[28:31]
v_cvt_pk_bf16_f32 v98, v64, v65
v_mfma_f32_16x16x32_bf16 v[16:19], a[156:159], v[156:159], v[16:19]
v_exp_f32 v66, v66
v_mfma_f32_16x16x32_bf16 v[20:23], a[156:159], v[172:175], v[20:23]
v_mfma_f32_16x16x32_bf16 v[24:27], a[156:159], v[188:191], v[24:27]
v_exp_f32 v67, v67
v_mfma_f32_16x16x32_bf16 v[28:31], a[156:159], v[204:207], v[28:31]
v_cvt_pk_bf16_f32 v99, v66, v67
v_mfma_f32_16x16x32_bf16 v[32:35], a[160:163], v[144:147], v[128:131]
v_exp_f32 v52, v52
v_mfma_f32_16x16x32_bf16 v[36:39], a[160:163], v[160:163], v[132:135]
s_waitcnt vmcnt(16)
v_mfma_f32_16x16x32_bf16 v[40:43], a[160:163], v[176:179], v[136:139]
v_exp_f32 v53, v53
v_mfma_f32_16x16x32_bf16 v[44:47], a[160:163], v[192:195], v[140:143]
v_cvt_pk_bf16_f32 v100, v52, v53
s_barrier
v_mfma_f32_16x16x32_bf16 v[32:35], a[164:167], v[148:151], v[32:35]
v_exp_f32 v54, v54
v_mfma_f32_16x16x32_bf16 v[36:39], a[164:167], v[164:167], v[36:39]
s_add_u32 m0, s40, 32768
v_mfma_f32_16x16x32_bf16 v[40:43], a[164:167], v[180:183], v[40:43]
v_exp_f32 v55, v55
v_mfma_f32_16x16x32_bf16 v[44:47], a[164:167], v[196:199], v[44:47]
v_cvt_pk_bf16_f32 v101, v54, v55
v_mfma_f32_16x16x32_bf16 v[32:35], a[168:171], v[152:155], v[32:35]
v_exp_f32 v68, v68
v_mfma_f32_16x16x32_bf16 v[36:39], a[168:171], v[168:171], v[36:39]
buffer_load_dwordx4 v249, s[16:19], s41 offen offset:0 lds
v_mfma_f32_16x16x32_bf16 v[40:43], a[168:171], v[184:187], v[40:43]
v_exp_f32 v69, v69
v_mfma_f32_16x16x32_bf16 v[44:47], a[168:171], v[200:203], v[44:47]
v_cvt_pk_bf16_f32 v102, v68, v69
v_mfma_f32_16x16x32_bf16 v[32:35], a[172:175], v[156:159], v[32:35]
v_exp_f32 v70, v70
v_mfma_f32_16x16x32_bf16 v[36:39], a[172:175], v[172:175], v[36:39]
buffer_load_dwordx4 v249, s[16:19], s41 offen offset:1024 lds
v_mfma_f32_16x16x32_bf16 v[40:43], a[172:175], v[188:191], v[40:43]
v_exp_f32 v71, v71
v_mfma_f32_16x16x32_bf16 v[44:47], a[172:175], v[204:207], v[44:47]
v_cvt_pk_bf16_f32 v103, v70, v71
v_mfma_f32_16x16x32_bf16 a[128:131], a[208:211], v[80:83], 0
v_mfma_f32_16x16x32_bf16 a[132:135], a[208:211], v[84:87], 0
v_exp_f32 v56, v56
v_mfma_f32_16x16x32_bf16 a[136:139], a[208:211], v[88:91], 0
buffer_load_dwordx4 v249, s[16:19], s41 offen offset:2048 lds
v_mfma_f32_16x16x32_bf16 a[140:143], a[208:211], v[92:95], 0
v_exp_f32 v57, v57
s_waitcnt lgkmcnt(0)
v_mfma_f32_16x16x32_bf16 a[0:3], a[176:179], v[80:83], 0
ds_read_b128 a[144:147], v2 offset:49152
v_cvt_pk_bf16_f32 v104, v56, v57
v_mfma_f32_16x16x32_bf16 a[32:35], a[176:179], v[84:87], 0
v_exp_f32 v58, v58
v_mfma_f32_16x16x32_bf16 a[64:67], a[176:179], v[88:91], 0
buffer_load_dwordx4 v249, s[16:19], s41 offen offset:3072 lds
v_mfma_f32_16x16x32_bf16 a[96:99], a[176:179], v[92:95], 0
v_exp_f32 v59, v59
v_mfma_f32_16x16x32_bf16 a[4:7], a[180:183], v[80:83], 0
v_cvt_pk_bf16_f32 v105, v58, v59
s_add_u32 m0, s40, 49152
v_mfma_f32_16x16x32_bf16 a[36:39], a[180:183], v[84:87], 0
v_exp_f32 v72, v72
v_mfma_f32_16x16x32_bf16 a[68:71], a[180:183], v[88:91], 0
buffer_load_dwordx4 v250, s[16:19], s41 offen offset:0 lds
v_mfma_f32_16x16x32_bf16 a[100:103], a[180:183], v[92:95], 0
v_exp_f32 v73, v73
v_mfma_f32_16x16x32_bf16 a[8:11], a[184:187], v[80:83], 0
ds_read_b128 a[148:151], v2 offset:50176
v_cvt_pk_bf16_f32 v106, v72, v73
v_mfma_f32_16x16x32_bf16 a[40:43], a[184:187], v[84:87], 0
v_exp_f32 v74, v74
v_mfma_f32_16x16x32_bf16 a[72:75], a[184:187], v[88:91], 0
buffer_load_dwordx4 v250, s[16:19], s41 offen offset:1024 lds
v_mfma_f32_16x16x32_bf16 a[104:107], a[184:187], v[92:95], 0
v_exp_f32 v75, v75
v_mfma_f32_16x16x32_bf16 a[12:15], a[188:191], v[80:83], 0
ds_read_b128 a[152:155], v2 offset:53248
v_cvt_pk_bf16_f32 v107, v74, v75
v_mfma_f32_16x16x32_bf16 a[44:47], a[188:191], v[84:87], 0
v_exp_f32 v60, v60
v_mfma_f32_16x16x32_bf16 a[76:79], a[188:191], v[88:91], 0
buffer_load_dwordx4 v250, s[16:19], s41 offen offset:2048 lds
v_mfma_f32_16x16x32_bf16 a[108:111], a[188:191], v[92:95], 0
v_exp_f32 v61, v61
v_mfma_f32_16x16x32_bf16 a[16:19], a[192:195], v[80:83], 0
ds_read_b128 a[156:159], v2 offset:54272
v_cvt_pk_bf16_f32 v108, v60, v61
v_mfma_f32_16x16x32_bf16 a[48:51], a[192:195], v[84:87], 0
v_exp_f32 v62, v62
v_mfma_f32_16x16x32_bf16 a[80:83], a[192:195], v[88:91], 0
buffer_load_dwordx4 v250, s[16:19], s41 offen offset:3072 lds
v_mfma_f32_16x16x32_bf16 a[112:115], a[192:195], v[92:95], 0
v_exp_f32 v63, v63
v_mfma_f32_16x16x32_bf16 a[20:23], a[196:199], v[80:83], 0
ds_read_b128 a[160:163], v2 offset:57344
v_cvt_pk_bf16_f32 v109, v62, v63
v_mfma_f32_16x16x32_bf16 a[52:55], a[196:199], v[84:87], 0
v_exp_f32 v76, v76
v_mfma_f32_16x16x32_bf16 a[84:87], a[196:199], v[88:91], 0
ds_read_b128 a[164:167], v2 offset:58368
ds_read_b128 a[168:171], v2 offset:61440
v_mfma_f32_16x16x32_bf16 a[116:119], a[196:199], v[92:95], 0
v_exp_f32 v77, v77
v_mfma_f32_16x16x32_bf16 a[24:27], a[200:203], v[80:83], 0
ds_read_b128 a[172:175], v2 offset:62464
v_cvt_pk_bf16_f32 v110, v76, v77
v_mfma_f32_16x16x32_bf16 a[56:59], a[200:203], v[84:87], 0
v_exp_f32 v78, v78
v_mfma_f32_16x16x32_bf16 a[88:91], a[200:203], v[88:91], 0
v_mfma_f32_16x16x32_bf16 a[120:123], a[200:203], v[92:95], 0
v_exp_f32 v79, v79
v_mfma_f32_16x16x32_bf16 a[28:31], a[204:207], v[80:83], 0
v_cvt_pk_bf16_f32 v111, v78, v79
v_mfma_f32_16x16x32_bf16 a[60:63], a[204:207], v[84:87], 0
v_mfma_f32_16x16x32_bf16 a[92:95], a[204:207], v[88:91], 0
v_mfma_f32_16x16x32_bf16 a[124:127], a[204:207], v[92:95], 0
s_waitcnt lgkmcnt(0)
s_cmp_eq_u32 s37, 0
s_cbranch_scc0 first_NM3_0
s_cmp_eq_u32 s36, 1
s_cbranch_scc0 K2_MK9
v_cndmask_b32 v116, v216, v209, s[60:61]
v_cndmask_b32 v117, v216, v209, s[62:63]
v_cndmask_b32 v118, v216, v209, s[64:65]
v_cndmask_b32 v119, v216, v209, s[66:67]
K2_MK9:
s_cmp_gt_u32 s36, 1
s_cbranch_scc0 K2_ML9
v_mov_b32 v116, v216
v_mov_b32 v117, v216
v_mov_b32 v118, v216
v_mov_b32 v119, v216
K2_ML9:
s_cmp_eq_u32 s36, 0
s_cbranch_scc0 K2_MK10
v_cndmask_b32 v132, v216, v209, s[60:61]
v_cndmask_b32 v133, v216, v209, s[62:63]
v_cndmask_b32 v134, v216, v209, s[64:65]
v_cndmask_b32 v135, v216, v209, s[66:67]
K2_MK10:
s_cmp_gt_u32 s36, 0
s_cbranch_scc0 K2_ML10
v_mov_b32 v132, v216
v_mov_b32 v133, v216
v_mov_b32 v134, v216
v_mov_b32 v135, v216
K2_ML10:
first_NM3_0:
s_nop 1
v_mfma_f32_16x16x32_bf16 v[48:51], a[144:147], v[144:147], v[112:115]
v_exp_f32 v16, v16
v_mfma_f32_16x16x32_bf16 v[52:55], a[144:147], v[160:163], v[116:119]
ds_read_b128 a[176:179], v2 offset:18432
ds_read_b128 a[180:183], v2 offset:19456
v_mfma_f32_16x16x32_bf16 v[56:59], a[144:147], v[176:179], v[120:123]
v_exp_f32 v17, v17
v_mfma_f32_16x16x32_bf16 v[60:63], a[144:147], v[192:195], v[124:127]
ds_read_b128 a[184:187], v2 offset:22528
ds_read_b128 a[188:191], v2 offset:23552
v_mfma_f32_16x16x32_bf16 v[48:51], a[148:151], v[148:151], v[48:51]
v_exp_f32 v18, v18
v_mfma_f32_16x16x32_bf16 v[52:55], a[148:151], v[164:167], v[52:55]
ds_read_b128 a[192:195], v2 offset:26624
ds_read_b128 a[196:199], v2 offset:27648
v_mfma_f32_16x16x32_bf16 v[56:59], a[148:151], v[180:183], v[56:59]
v_exp_f32 v19, v19
v_mfma_f32_16x16x32_bf16 v[60:63], a[148:151], v[196:199], v[60:63]
ds_read_b128 a[200:203], v2 offset:30720
ds_read_b128 a[204:207], v2 offset:31744
v_mfma_f32_16x16x32_bf16 v[48:51], a[152:155], v[152:155], v[48:51]
v_exp_f32 v32, v32
v_mfma_f32_16x16x32_bf16 v[52:55], a[152:155], v[168:171], v[52:55]
v_cvt_pk_bf16_f32 v80, v16, v17
v_cvt_pk_bf16_f32 v81, v18, v19
v_mfma_f32_16x16x32_bf16 v[56:59], a[152:155], v[184:187], v[56:59]
v_exp_f32 v33, v33
v_mfma_f32_16x16x32_bf16 v[60:63], a[152:155], v[200:203], v[60:63]
v_cvt_pk_bf16_f32 v82, v32, v33
v_mfma_f32_16x16x32_bf16 v[48:51], a[156:159], v[156:159], v[48:51]
v_exp_f32 v34, v34
v_mfma_f32_16x16x32_bf16 v[52:55], a[156:159], v[172:175], v[52:55]
v_mfma_f32_16x16x32_bf16 v[56:59], a[156:159], v[188:191], v[56:59]
v_exp_f32 v35, v35
v_mfma_f32_16x16x32_bf16 v[60:63], a[156:159], v[204:207], v[60:63]
v_cvt_pk_bf16_f32 v83, v34, v35
v_mfma_f32_16x16x32_bf16 v[64:67], a[160:163], v[144:147], v[128:131]
v_exp_f32 v20, v20
v_mfma_f32_16x16x32_bf16 v[68:71], a[160:163], v[160:163], v[132:135]
s_waitcnt vmcnt(12)
v_mfma_f32_16x16x32_bf16 v[72:75], a[160:163], v[176:179], v[136:139]
v_exp_f32 v21, v21
v_mfma_f32_16x16x32_bf16 v[76:79], a[160:163], v[192:195], v[140:143]
v_cvt_pk_bf16_f32 v84, v20, v21
s_barrier
v_mfma_f32_16x16x32_bf16 v[64:67], a[164:167], v[148:151], v[64:67]
v_exp_f32 v22, v22
v_mfma_f32_16x16x32_bf16 v[68:71], a[164:167], v[164:167], v[68:71]
s_add_u32 m0, s39, 0
v_mfma_f32_16x16x32_bf16 v[72:75], a[164:167], v[180:183], v[72:75]
v_exp_f32 v23, v23
v_mfma_f32_16x16x32_bf16 v[76:79], a[164:167], v[196:199], v[76:79]
v_cvt_pk_bf16_f32 v85, v22, v23
v_mfma_f32_16x16x32_bf16 v[64:67], a[168:171], v[152:155], v[64:67]
v_exp_f32 v36, v36
v_mfma_f32_16x16x32_bf16 v[68:71], a[168:171], v[168:171], v[68:71]
buffer_load_dwordx4 v251, s[16:19], s41 offen offset:0 lds
v_mfma_f32_16x16x32_bf16 v[72:75], a[168:171], v[184:187], v[72:75]
v_exp_f32 v37, v37
v_mfma_f32_16x16x32_bf16 v[76:79], a[168:171], v[200:203], v[76:79]
v_cvt_pk_bf16_f32 v86, v36, v37
v_mfma_f32_16x16x32_bf16 v[64:67], a[172:175], v[156:159], v[64:67]
v_exp_f32 v38, v38
v_mfma_f32_16x16x32_bf16 v[68:71], a[172:175], v[172:175], v[68:71]
v_mfma_f32_16x16x32_bf16 v[72:75], a[172:175], v[188:191], v[72:75]
v_exp_f32 v39, v39
v_mfma_f32_16x16x32_bf16 v[76:79], a[172:175], v[204:207], v[76:79]
v_cvt_pk_bf16_f32 v87, v38, v39
v_mfma_f32_16x16x32_bf16 a[128:131], a[208:211], v[96:99], a[128:131]
v_mfma_f32_16x16x32_bf16 a[132:135], a[208:211], v[100:103], a[132:135]
v_exp_f32 v24, v24
v_mfma_f32_16x16x32_bf16 a[136:139], a[208:211], v[104:107], a[136:139]
buffer_load_dwordx4 v251, s[16:19], s41 offen offset:1024 lds
v_mfma_f32_16x16x32_bf16 a[140:143], a[208:211], v[108:111], a[140:143]
v_exp_f32 v25, v25
s_waitcnt lgkmcnt(0)
v_mfma_f32_16x16x32_bf16 a[0:3], a[176:179], v[96:99], a[0:3]
ds_read_b128 a[144:147], v3 offset:0
v_cvt_pk_bf16_f32 v88, v24, v25
v_mfma_f32_16x16x32_bf16 a[32:35], a[176:179], v[100:103], a[32:35]
v_exp_f32 v26, v26
v_mfma_f32_16x16x32_bf16 a[64:67], a[176:179], v[104:107], a[64:67]
ds_read_b128 a[148:151], v3 offset:1024
ds_read_b128 a[152:155], v3 offset:4096
v_mfma_f32_16x16x32_bf16 a[96:99], a[176:179], v[108:111], a[96:99]
v_exp_f32 v27, v27
v_mfma_f32_16x16x32_bf16 a[4:7], a[180:183], v[96:99], a[4:7]
ds_read_b128 a[156:159], v3 offset:5120
v_cvt_pk_bf16_f32 v89, v26, v27
v_mfma_f32_16x16x32_bf16 a[36:39], a[180:183], v[100:103], a[36:39]
v_exp_f32 v40, v40
v_mfma_f32_16x16x32_bf16 a[68:71], a[180:183], v[104:107], a[68:71]
buffer_load_dwordx4 v251, s[16:19], s41 offen offset:2048 lds
v_mfma_f32_16x16x32_bf16 a[100:103], a[180:183], v[108:111], a[100:103]
v_exp_f32 v41, v41
v_mfma_f32_16x16x32_bf16 a[8:11], a[184:187], v[96:99], a[8:11]
ds_read_b128 a[160:163], v3 offset:8192
v_cvt_pk_bf16_f32 v90, v40, v41
v_mfma_f32_16x16x32_bf16 a[40:43], a[184:187], v[100:103], a[40:43]
v_exp_f32 v42, v42
v_mfma_f32_16x16x32_bf16 a[72:75], a[184:187], v[104:107], a[72:75]
ds_read_b128 a[164:167], v3 offset:9216
ds_read_b128 a[168:171], v3 offset:12288
v_mfma_f32_16x16x32_bf16 a[104:107], a[184:187], v[108:111], a[104:107]
v_exp_f32 v43, v43
v_mfma_f32_16x16x32_bf16 a[12:15], a[188:191], v[96:99], a[12:15]
ds_read_b128 a[172:175], v3 offset:13312
v_cvt_pk_bf16_f32 v91, v42, v43
v_mfma_f32_16x16x32_bf16 a[44:47], a[188:191], v[100:103], a[44:47]
v_exp_f32 v28, v28
v_mfma_f32_16x16x32_bf16 a[76:79], a[188:191], v[104:107], a[76:79]
buffer_load_dwordx4 v251, s[16:19], s41 offen offset:3072 lds
v_mfma_f32_16x16x32_bf16 a[108:111], a[188:191], v[108:111], a[108:111]
v_exp_f32 v29, v29
v_mfma_f32_16x16x32_bf16 a[16:19], a[192:195], v[96:99], a[16:19]
v_cvt_pk_bf16_f32 v92, v28, v29
v_mfma_f32_16x16x32_bf16 a[48:51], a[192:195], v[100:103], a[48:51]
v_exp_f32 v30, v30
v_mfma_f32_16x16x32_bf16 a[80:83], a[192:195], v[104:107], a[80:83]
v_mfma_f32_16x16x32_bf16 a[112:115], a[192:195], v[108:111], a[112:115]
v_exp_f32 v31, v31
v_mfma_f32_16x16x32_bf16 a[20:23], a[196:199], v[96:99], a[20:23]
v_cvt_pk_bf16_f32 v93, v30, v31
v_mfma_f32_16x16x32_bf16 a[52:55], a[196:199], v[100:103], a[52:55]
v_exp_f32 v44, v44
v_mfma_f32_16x16x32_bf16 a[84:87], a[196:199], v[104:107], a[84:87]
v_mfma_f32_16x16x32_bf16 a[116:119], a[196:199], v[108:111], a[116:119]
v_exp_f32 v45, v45
v_mfma_f32_16x16x32_bf16 a[24:27], a[200:203], v[96:99], a[24:27]
v_cvt_pk_bf16_f32 v94, v44, v45
v_mfma_f32_16x16x32_bf16 a[56:59], a[200:203], v[100:103], a[56:59]
v_exp_f32 v46, v46
v_mfma_f32_16x16x32_bf16 a[88:91], a[200:203], v[104:107], a[88:91]
v_mfma_f32_16x16x32_bf16 a[120:123], a[200:203], v[108:111], a[120:123]
v_exp_f32 v47, v47
v_mfma_f32_16x16x32_bf16 a[28:31], a[204:207], v[96:99], a[28:31]
v_cvt_pk_bf16_f32 v95, v46, v47
v_mfma_f32_16x16x32_bf16 a[60:63], a[204:207], v[100:103], a[60:63]
v_xor_b32 v2, 0x10000, v2
v_xor_b32 v3, 0x10000, v3
v_mfma_f32_16x16x32_bf16 a[92:95], a[204:207], v[104:107], a[92:95]
s_xor_b32 s39, s39, 0x10000
s_xor_b32 s40, s40, 0x10000
v_mfma_f32_16x16x32_bf16 a[124:127], a[204:207], v[108:111], a[124:127]
s_waitcnt lgkmcnt(0)
s_add_u32 s41, s41, 65536
s_cmp_lt_u32 s37, 2
s_cbranch_scc1 K2_DUALM
s_sub_u32 s42, s37, 1
s_bitcmp1_b32 s36, 0
s_cbranch_scc1 K2_DUAL_B
.p2align 6
K2_DUAL:
v_mfma_f32_16x16x32_bf16 v[16:19], a[144:147], v[144:147], v[112:115]
v_exp_f32 v48, v48
v_mfma_f32_16x16x32_bf16 v[20:23], a[144:147], v[160:163], v[116:119]
ds_read_b128 a[176:179], v3 offset:34816
ds_read_b128 a[180:183], v3 offset:35840
v_mfma_f32_16x16x32_bf16 v[24:27], a[144:147], v[176:179], v[120:123]
v_exp_f32 v49, v49
v_mfma_f32_16x16x32_bf16 v[28:31], a[144:147], v[192:195], v[124:127]
ds_read_b128 a[184:187], v3 offset:38912
ds_read_b128 a[188:191], v3 offset:39936
v_mfma_f32_16x16x32_bf16 v[16:19], a[148:151], v[148:151], v[16:19]
v_exp_f32 v50, v50
v_mfma_f32_16x16x32_bf16 v[20:23], a[148:151], v[164:167], v[20:23]
ds_read_b128 a[192:195], v3 offset:43008
ds_read_b128 a[196:199], v3 offset:44032
v_mfma_f32_16x16x32_bf16 v[24:27], a[148:151], v[180:183], v[24:27]
v_exp_f32 v51, v51
v_mfma_f32_16x16x32_bf16 v[28:31], a[148:151], v[196:199], v[28:31]
ds_read_b128 a[200:203], v3 offset:47104
ds_read_b128 a[204:207], v3 offset:48128
v_mfma_f32_16x16x32_bf16 v[16:19], a[152:155], v[152:155], v[16:19]
v_exp_f32 v64, v64
v_mfma_f32_16x16x32_bf16 v[20:23], a[152:155], v[168:171], v[20:23]
v_cvt_pk_bf16_f32 v96, v48, v49
v_cvt_pk_bf16_f32 v97, v50, v51
v_mfma_f32_16x16x32_bf16 v[24:27], a[152:155], v[184:187], v[24:27]
v_exp_f32 v65, v65
v_mfma_f32_16x16x32_bf16 v[28:31], a[152:155], v[200:203], v[28:31]
v_cvt_pk_bf16_f32 v98, v64, v65
v_mfma_f32_16x16x32_bf16 v[16:19], a[156:159], v[156:159], v[16:19]
v_exp_f32 v66, v66
v_mfma_f32_16x16x32_bf16 v[20:23], a[156:159], v[172:175], v[20:23]
v_mfma_f32_16x16x32_bf16 v[24:27], a[156:159], v[188:191], v[24:27]
v_exp_f32 v67, v67
v_mfma_f32_16x16x32_bf16 v[28:31], a[156:159], v[204:207], v[28:31]
v_cvt_pk_bf16_f32 v99, v66, v67
v_mfma_f32_16x16x32_bf16 v[32:35], a[160:163], v[144:147], v[128:131]
v_exp_f32 v52, v52
v_mfma_f32_16x16x32_bf16 v[36:39], a[160:163], v[160:163], v[132:135]
s_waitcnt vmcnt(12)
v_mfma_f32_16x16x32_bf16 v[40:43], a[160:163], v[176:179], v[136:139]
v_exp_f32 v53, v53
v_mfma_f32_16x16x32_bf16 v[44:47], a[160:163], v[192:195], v[140:143]
v_cvt_pk_bf16_f32 v100, v52, v53
s_barrier
v_mfma_f32_16x16x32_bf16 v[32:35], a[164:167], v[148:151], v[32:35]
v_exp_f32 v54, v54
v_mfma_f32_16x16x32_bf16 v[36:39], a[164:167], v[164:167], v[36:39]
s_add_u32 m0, s40, 16384
v_mfma_f32_16x16x32_bf16 v[40:43], a[164:167], v[180:183], v[40:43]
v_exp_f32 v55, v55
v_mfma_f32_16x16x32_bf16 v[44:47], a[164:167], v[196:199], v[44:47]
v_cvt_pk_bf16_f32 v101, v54, v55
v_mfma_f32_16x16x32_bf16 v[32:35], a[168:171], v[152:155], v[32:35]
v_exp_f32 v68, v68
v_mfma_f32_16x16x32_bf16 v[36:39], a[168:171], v[168:171], v[36:39]
buffer_load_dwordx4 v248, s[16:19], s41 offen offset:0 lds
v_mfma_f32_16x16x32_bf16 v[40:43], a[168:171], v[184:187], v[40:43]
v_exp_f32 v69, v69
v_mfma_f32_16x16x32_bf16 v[44:47], a[168:171], v[200:203], v[44:47]
v_cvt_pk_bf16_f32 v102, v68, v69
v_mfma_f32_16x16x32_bf16 v[32:35], a[172:175], v[156:159], v[32:35]
v_exp_f32 v70, v70
v_mfma_f32_16x16x32_bf16 v[36:39], a[172:175], v[172:175], v[36:39]
v_mfma_f32_16x16x32_bf16 v[40:43], a[172:175], v[188:191], v[40:43]
v_exp_f32 v71, v71
v_mfma_f32_16x16x32_bf16 v[44:47], a[172:175], v[204:207], v[44:47]
v_cvt_pk_bf16_f32 v103, v70, v71
v_mfma_f32_16x16x32_bf16 a[128:131], a[208:211], v[80:83], a[128:131]
v_mfma_f32_16x16x32_bf16 a[132:135], a[208:211], v[84:87], a[132:135]
v_exp_f32 v56, v56
v_mfma_f32_16x16x32_bf16 a[136:139], a[208:211], v[88:91], a[136:139]
buffer_load_dwordx4 v248, s[16:19], s41 offen offset:1024 lds
v_mfma_f32_16x16x32_bf16 a[140:143], a[208:211], v[92:95], a[140:143]
v_exp_f32 v57, v57
s_waitcnt lgkmcnt(0)
v_mfma_f32_16x16x32_bf16 a[0:3], a[176:179], v[80:83], a[0:3]
ds_read_b128 a[144:147], v2 offset:16384
v_cvt_pk_bf16_f32 v104, v56, v57
v_mfma_f32_16x16x32_bf16 a[32:35], a[176:179], v[84:87], a[32:35]
v_exp_f32 v58, v58
v_mfma_f32_16x16x32_bf16 a[64:67], a[176:179], v[88:91], a[64:67]
ds_read_b128 a[148:151], v2 offset:17408
ds_read_b128 a[152:155], v2 offset:20480
v_mfma_f32_16x16x32_bf16 a[96:99], a[176:179], v[92:95], a[96:99]
v_exp_f32 v59, v59
v_mfma_f32_16x16x32_bf16 a[4:7], a[180:183], v[80:83], a[4:7]
ds_read_b128 a[156:159], v2 offset:21504
v_cvt_pk_bf16_f32 v105, v58, v59
v_mfma_f32_16x16x32_bf16 a[36:39], a[180:183], v[84:87], a[36:39]
v_exp_f32 v72, v72
v_mfma_f32_16x16x32_bf16 a[68:71], a[180:183], v[88:91], a[68:71]
buffer_load_dwordx4 v248, s[16:19], s41 offen offset:2048 lds
v_mfma_f32_16x16x32_bf16 a[100:103], a[180:183], v[92:95], a[100:103]
v_exp_f32 v73, v73
v_mfma_f32_16x16x32_bf16 a[8:11], a[184:187], v[80:83], a[8:11]
ds_read_b128 a[160:163], v2 offset:24576
v_cvt_pk_bf16_f32 v106, v72, v73
v_mfma_f32_16x16x32_bf16 a[40:43], a[184:187], v[84:87], a[40:43]
v_exp_f32 v74, v74
v_mfma_f32_16x16x32_bf16 a[72:75], a[184:187], v[88:91], a[72:75]
ds_read_b128 a[164:167], v2 offset:25600
ds_read_b128 a[168:171], v2 offset:28672
v_mfma_f32_16x16x32_bf16 a[104:107], a[184:187], v[92:95], a[104:107]
v_exp_f32 v75, v75
v_mfma_f32_16x16x32_bf16 a[12:15], a[188:191], v[80:83], a[12:15]
ds_read_b128 a[172:175], v2 offset:29696
v_cvt_pk_bf16_f32 v107, v74, v75
v_mfma_f32_16x16x32_bf16 a[44:47], a[188:191], v[84:87], a[44:47]
v_exp_f32 v60, v60
v_mfma_f32_16x16x32_bf16 a[76:79], a[188:191], v[88:91], a[76:79]
buffer_load_dwordx4 v248, s[16:19], s41 offen offset:3072 lds
v_mfma_f32_16x16x32_bf16 a[108:111], a[188:191], v[92:95], a[108:111]
v_exp_f32 v61, v61
v_mfma_f32_16x16x32_bf16 a[16:19], a[192:195], v[80:83], a[16:19]
v_cvt_pk_bf16_f32 v108, v60, v61
v_mfma_f32_16x16x32_bf16 a[48:51], a[192:195], v[84:87], a[48:51]
v_exp_f32 v62, v62
v_mfma_f32_16x16x32_bf16 a[80:83], a[192:195], v[88:91], a[80:83]
v_mfma_f32_16x16x32_bf16 a[112:115], a[192:195], v[92:95], a[112:115]
v_exp_f32 v63, v63
v_mfma_f32_16x16x32_bf16 a[20:23], a[196:199], v[80:83], a[20:23]
v_cvt_pk_bf16_f32 v109, v62, v63
v_mfma_f32_16x16x32_bf16 a[52:55], a[196:199], v[84:87], a[52:55]
v_exp_f32 v76, v76
v_mfma_f32_16x16x32_bf16 a[84:87], a[196:199], v[88:91], a[84:87]
v_mfma_f32_16x16x32_bf16 a[116:119], a[196:199], v[92:95], a[116:119]
v_exp_f32 v77, v77
v_mfma_f32_16x16x32_bf16 a[24:27], a[200:203], v[80:83], a[24:27]
v_cvt_pk_bf16_f32 v110, v76, v77
v_mfma_f32_16x16x32_bf16 a[56:59], a[200:203], v[84:87], a[56:59]
v_exp_f32 v78, v78
v_mfma_f32_16x16x32_bf16 a[88:91], a[200:203], v[88:91], a[88:91]
v_mfma_f32_16x16x32_bf16 a[120:123], a[200:203], v[92:95], a[120:123]
v_exp_f32 v79, v79
v_mfma_f32_16x16x32_bf16 a[28:31], a[204:207], v[80:83], a[28:31]
v_cvt_pk_bf16_f32 v111, v78, v79
v_mfma_f32_16x16x32_bf16 a[60:63], a[204:207], v[84:87], a[60:63]
v_mfma_f32_16x16x32_bf16 a[92:95], a[204:207], v[88:91], a[92:95]
v_mfma_f32_16x16x32_bf16 a[124:127], a[204:207], v[92:95], a[124:127]
s_waitcnt lgkmcnt(0)
v_mfma_f32_16x16x32_bf16 v[48:51], a[144:147], v[144:147], v[112:115]
v_exp_f32 v16, v16
v_mfma_f32_16x16x32_bf16 v[52:55], a[144:147], v[160:163], v[116:119]
ds_read_b128 a[176:179], v3 offset:51200
ds_read_b128 a[180:183], v3 offset:52224
v_mfma_f32_16x16x32_bf16 v[56:59], a[144:147], v[176:179], v[120:123]
v_exp_f32 v17, v17
v_mfma_f32_16x16x32_bf16 v[60:63], a[144:147], v[192:195], v[124:127]
ds_read_b128 a[184:187], v3 offset:55296
ds_read_b128 a[188:191], v3 offset:56320
v_mfma_f32_16x16x32_bf16 v[48:51], a[148:151], v[148:151], v[48:51]
v_exp_f32 v18, v18
v_mfma_f32_16x16x32_bf16 v[52:55], a[148:151], v[164:167], v[52:55]
ds_read_b128 a[192:195], v3 offset:59392
ds_read_b128 a[196:199], v3 offset:60416
v_mfma_f32_16x16x32_bf16 v[56:59], a[148:151], v[180:183], v[56:59]
v_exp_f32 v19, v19
v_mfma_f32_16x16x32_bf16 v[60:63], a[148:151], v[196:199], v[60:63]
ds_read_b128 a[200:203], v3 offset:63488
ds_read_b128 a[204:207], v3 offset:64512
v_mfma_f32_16x16x32_bf16 v[48:51], a[152:155], v[152:155], v[48:51]
v_exp_f32 v32, v32
v_mfma_f32_16x16x32_bf16 v[52:55], a[152:155], v[168:171], v[52:55]
v_cvt_pk_bf16_f32 v80, v16, v17
v_cvt_pk_bf16_f32 v81, v18, v19
v_mfma_f32_16x16x32_bf16 v[56:59], a[152:155], v[184:187], v[56:59]
v_exp_f32 v33, v33
v_mfma_f32_16x16x32_bf16 v[60:63], a[152:155], v[200:203], v[60:63]
v_cvt_pk_bf16_f32 v82, v32, v33
v_mfma_f32_16x16x32_bf16 v[48:51], a[156:159], v[156:159], v[48:51]
v_exp_f32 v34, v34
v_mfma_f32_16x16x32_bf16 v[52:55], a[156:159], v[172:175], v[52:55]
v_mfma_f32_16x16x32_bf16 v[56:59], a[156:159], v[188:191], v[56:59]
v_exp_f32 v35, v35
v_mfma_f32_16x16x32_bf16 v[60:63], a[156:159], v[204:207], v[60:63]
v_cvt_pk_bf16_f32 v83, v34, v35
v_mfma_f32_16x16x32_bf16 v[64:67], a[160:163], v[144:147], v[128:131]
v_exp_f32 v20, v20
v_mfma_f32_16x16x32_bf16 v[68:71], a[160:163], v[160:163], v[132:135]
s_waitcnt vmcnt(12)
v_mfma_f32_16x16x32_bf16 v[72:75], a[160:163], v[176:179], v[136:139]
v_exp_f32 v21, v21
v_mfma_f32_16x16x32_bf16 v[76:79], a[160:163], v[192:195], v[140:143]
v_cvt_pk_bf16_f32 v84, v20, v21
s_barrier
v_mfma_f32_16x16x32_bf16 v[64:67], a[164:167], v[148:151], v[64:67]
v_exp_f32 v22, v22
v_mfma_f32_16x16x32_bf16 v[68:71], a[164:167], v[164:167], v[68:71]
s_add_u32 m0, s40, 32768
v_mfma_f32_16x16x32_bf16 v[72:75], a[164:167], v[180:183], v[72:75]
v_exp_f32 v23, v23
v_mfma_f32_16x16x32_bf16 v[76:79], a[164:167], v[196:199], v[76:79]
v_cvt_pk_bf16_f32 v85, v22, v23
v_mfma_f32_16x16x32_bf16 v[64:67], a[168:171], v[152:155], v[64:67]
v_exp_f32 v36, v36
v_mfma_f32_16x16x32_bf16 v[68:71], a[168:171], v[168:171], v[68:71]
buffer_load_dwordx4 v249, s[16:19], s41 offen offset:0 lds
v_mfma_f32_16x16x32_bf16 v[72:75], a[168:171], v[184:187], v[72:75]
v_exp_f32 v37, v37
v_mfma_f32_16x16x32_bf16 v[76:79], a[168:171], v[200:203], v[76:79]
v_cvt_pk_bf16_f32 v86, v36, v37
v_mfma_f32_16x16x32_bf16 v[64:67], a[172:175], v[156:159], v[64:67]
v_exp_f32 v38, v38
v_mfma_f32_16x16x32_bf16 v[68:71], a[172:175], v[172:175], v[68:71]
v_mfma_f32_16x16x32_bf16 v[72:75], a[172:175], v[188:191], v[72:75]
v_exp_f32 v39, v39
v_mfma_f32_16x16x32_bf16 v[76:79], a[172:175], v[204:207], v[76:79]
v_cvt_pk_bf16_f32 v87, v38, v39
v_mfma_f32_16x16x32_bf16 a[128:131], a[208:211], v[96:99], a[128:131]
v_mfma_f32_16x16x32_bf16 a[132:135], a[208:211], v[100:103], a[132:135]
v_exp_f32 v24, v24
v_mfma_f32_16x16x32_bf16 a[136:139], a[208:211], v[104:107], a[136:139]
buffer_load_dwordx4 v249, s[16:19], s41 offen offset:1024 lds
v_mfma_f32_16x16x32_bf16 a[140:143], a[208:211], v[108:111], a[140:143]
v_exp_f32 v25, v25
s_waitcnt lgkmcnt(0)
v_mfma_f32_16x16x32_bf16 a[0:3], a[176:179], v[96:99], a[0:3]
ds_read_b128 a[144:147], v2 offset:32768
v_cvt_pk_bf16_f32 v88, v24, v25
v_mfma_f32_16x16x32_bf16 a[32:35], a[176:179], v[100:103], a[32:35]
v_exp_f32 v26, v26
v_mfma_f32_16x16x32_bf16 a[64:67], a[176:179], v[104:107], a[64:67]
ds_read_b128 a[148:151], v2 offset:33792
ds_read_b128 a[152:155], v2 offset:36864
v_mfma_f32_16x16x32_bf16 a[96:99], a[176:179], v[108:111], a[96:99]
v_exp_f32 v27, v27
v_mfma_f32_16x16x32_bf16 a[4:7], a[180:183], v[96:99], a[4:7]
ds_read_b128 a[156:159], v2 offset:37888
v_cvt_pk_bf16_f32 v89, v26, v27
v_mfma_f32_16x16x32_bf16 a[36:39], a[180:183], v[100:103], a[36:39]
v_exp_f32 v40, v40
v_mfma_f32_16x16x32_bf16 a[68:71], a[180:183], v[104:107], a[68:71]
buffer_load_dwordx4 v249, s[16:19], s41 offen offset:2048 lds
v_mfma_f32_16x16x32_bf16 a[100:103], a[180:183], v[108:111], a[100:103]
v_exp_f32 v41, v41
v_mfma_f32_16x16x32_bf16 a[8:11], a[184:187], v[96:99], a[8:11]
ds_read_b128 a[160:163], v2 offset:40960
v_cvt_pk_bf16_f32 v90, v40, v41
v_mfma_f32_16x16x32_bf16 a[40:43], a[184:187], v[100:103], a[40:43]
v_exp_f32 v42, v42
v_mfma_f32_16x16x32_bf16 a[72:75], a[184:187], v[104:107], a[72:75]
ds_read_b128 a[164:167], v2 offset:41984
ds_read_b128 a[168:171], v2 offset:45056
v_mfma_f32_16x16x32_bf16 a[104:107], a[184:187], v[108:111], a[104:107]
v_exp_f32 v43, v43
v_mfma_f32_16x16x32_bf16 a[12:15], a[188:191], v[96:99], a[12:15]
ds_read_b128 a[172:175], v2 offset:46080
v_cvt_pk_bf16_f32 v91, v42, v43
v_mfma_f32_16x16x32_bf16 a[44:47], a[188:191], v[100:103], a[44:47]
v_exp_f32 v28, v28
v_mfma_f32_16x16x32_bf16 a[76:79], a[188:191], v[104:107], a[76:79]
buffer_load_dwordx4 v249, s[16:19], s41 offen offset:3072 lds
v_mfma_f32_16x16x32_bf16 a[108:111], a[188:191], v[108:111], a[108:111]
v_exp_f32 v29, v29
v_mfma_f32_16x16x32_bf16 a[16:19], a[192:195], v[96:99], a[16:19]
v_cvt_pk_bf16_f32 v92, v28, v29
v_mfma_f32_16x16x32_bf16 a[48:51], a[192:195], v[100:103], a[48:51]
v_exp_f32 v30, v30
v_mfma_f32_16x16x32_bf16 a[80:83], a[192:195], v[104:107], a[80:83]
v_mfma_f32_16x16x32_bf16 a[112:115], a[192:195], v[108:111], a[112:115]
v_exp_f32 v31, v31
v_mfma_f32_16x16x32_bf16 a[20:23], a[196:199], v[96:99], a[20:23]
v_cvt_pk_bf16_f32 v93, v30, v31
v_mfma_f32_16x16x32_bf16 a[52:55], a[196:199], v[100:103], a[52:55]
v_exp_f32 v44, v44
v_mfma_f32_16x16x32_bf16 a[84:87], a[196:199], v[104:107], a[84:87]
v_mfma_f32_16x16x32_bf16 a[116:119], a[196:199], v[108:111], a[116:119]
v_exp_f32 v45, v45
v_mfma_f32_16x16x32_bf16 a[24:27], a[200:203], v[96:99], a[24:27]
v_cvt_pk_bf16_f32 v94, v44, v45
v_mfma_f32_16x16x32_bf16 a[56:59], a[200:203], v[100:103], a[56:59]
v_exp_f32 v46, v46
v_mfma_f32_16x16x32_bf16 a[88:91], a[200:203], v[104:107], a[88:91]
v_mfma_f32_16x16x32_bf16 a[120:123], a[200:203], v[108:111], a[120:123]
v_exp_f32 v47, v47
v_mfma_f32_16x16x32_bf16 a[28:31], a[204:207], v[96:99], a[28:31]
v_cvt_pk_bf16_f32 v95, v46, v47
v_mfma_f32_16x16x32_bf16 a[60:63], a[204:207], v[100:103], a[60:63]
v_mfma_f32_16x16x32_bf16 a[92:95], a[204:207], v[104:107], a[92:95]
v_mfma_f32_16x16x32_bf16 a[124:127], a[204:207], v[108:111], a[124:127]
s_waitcnt lgkmcnt(0)
v_mfma_f32_16x16x32_bf16 v[16:19], a[144:147], v[144:147], v[112:115]
v_exp_f32 v48, v48
v_mfma_f32_16x16x32_bf16 v[20:23], a[144:147], v[160:163], v[116:119]
ds_read_b128 a[176:179], v2 offset:2048
ds_read_b128 a[180:183], v2 offset:3072
v_mfma_f32_16x16x32_bf16 v[24:27], a[144:147], v[176:179], v[120:123]
v_exp_f32 v49, v49
v_mfma_f32_16x16x32_bf16 v[28:31], a[144:147], v[192:195], v[124:127]
ds_read_b128 a[184:187], v2 offset:6144
ds_read_b128 a[188:191], v2 offset:7168
v_mfma_f32_16x16x32_bf16 v[16:19], a[148:151], v[148:151], v[16:19]
v_exp_f32 v50, v50
v_mfma_f32_16x16x32_bf16 v[20:23], a[148:151], v[164:167], v[20:23]
ds_read_b128 a[192:195], v2 offset:10240
ds_read_b128 a[196:199], v2 offset:11264
v_mfma_f32_16x16x32_bf16 v[24:27], a[148:151], v[180:183], v[24:27]
v_exp_f32 v51, v51
v_mfma_f32_16x16x32_bf16 v[28:31], a[148:151], v[196:199], v[28:31]
ds_read_b128 a[200:203], v2 offset:14336
ds_read_b128 a[204:207], v2 offset:15360
v_mfma_f32_16x16x32_bf16 v[16:19], a[152:155], v[152:155], v[16:19]
v_exp_f32 v64, v64
v_mfma_f32_16x16x32_bf16 v[20:23], a[152:155], v[168:171], v[20:23]
v_cvt_pk_bf16_f32 v96, v48, v49
v_cvt_pk_bf16_f32 v97, v50, v51
v_mfma_f32_16x16x32_bf16 v[24:27], a[152:155], v[184:187], v[24:27]
v_exp_f32 v65, v65
v_mfma_f32_16x16x32_bf16 v[28:31], a[152:155], v[200:203], v[28:31]
v_cvt_pk_bf16_f32 v98, v64, v65
v_mfma_f32_16x16x32_bf16 v[16:19], a[156:159], v[156:159], v[16:19]
v_exp_f32 v66, v66
v_mfma_f32_16x16x32_bf16 v[20:23], a[156:159], v[172:175], v[20:23]
v_mfma_f32_16x16x32_bf16 v[24:27], a[156:159], v[188:191], v[24:27]
v_exp_f32 v67, v67
v_mfma_f32_16x16x32_bf16 v[28:31], a[156:159], v[204:207], v[28:31]
v_cvt_pk_bf16_f32 v99, v66, v67
v_mfma_f32_16x16x32_bf16 v[32:35], a[160:163], v[144:147], v[128:131]
v_exp_f32 v52, v52
v_mfma_f32_16x16x32_bf16 v[36:39], a[160:163], v[160:163], v[132:135]
s_waitcnt vmcnt(12)
v_mfma_f32_16x16x32_bf16 v[40:43], a[160:163], v[176:179], v[136:139]
v_exp_f32 v53, v53
v_mfma_f32_16x16x32_bf16 v[44:47], a[160:163], v[192:195], v[140:143]
v_cvt_pk_bf16_f32 v100, v52, v53
s_barrier
v_mfma_f32_16x16x32_bf16 v[32:35], a[164:167], v[148:151], v[32:35]
v_exp_f32 v54, v54
v_mfma_f32_16x16x32_bf16 v[36:39], a[164:167], v[164:167], v[36:39]
s_add_u32 m0, s40, 49152
v_mfma_f32_16x16x32_bf16 v[40:43], a[164:167], v[180:183], v[40:43]
v_exp_f32 v55, v55
v_mfma_f32_16x16x32_bf16 v[44:47], a[164:167], v[196:199], v[44:47]
v_cvt_pk_bf16_f32 v101, v54, v55
v_mfma_f32_16x16x32_bf16 v[32:35], a[168:171], v[152:155], v[32:35]
v_exp_f32 v68, v68
v_mfma_f32_16x16x32_bf16 v[36:39], a[168:171], v[168:171], v[36:39]
buffer_load_dwordx4 v250, s[16:19], s41 offen offset:0 lds
v_mfma_f32_16x16x32_bf16 v[40:43], a[168:171], v[184:187], v[40:43]
v_exp_f32 v69, v69
v_mfma_f32_16x16x32_bf16 v[44:47], a[168:171], v[200:203], v[44:47]
v_cvt_pk_bf16_f32 v102, v68, v69
v_mfma_f32_16x16x32_bf16 v[32:35], a[172:175], v[156:159], v[32:35]
v_exp_f32 v70, v70
v_mfma_f32_16x16x32_bf16 v[36:39], a[172:175], v[172:175], v[36:39]
v_mfma_f32_16x16x32_bf16 v[40:43], a[172:175], v[188:191], v[40:43]
v_exp_f32 v71, v71
v_mfma_f32_16x16x32_bf16 v[44:47], a[172:175], v[204:207], v[44:47]
v_cvt_pk_bf16_f32 v103, v70, v71
v_mfma_f32_16x16x32_bf16 a[128:131], a[208:211], v[80:83], a[128:131]
v_mfma_f32_16x16x32_bf16 a[132:135], a[208:211], v[84:87], a[132:135]
v_exp_f32 v56, v56
v_mfma_f32_16x16x32_bf16 a[136:139], a[208:211], v[88:91], a[136:139]
buffer_load_dwordx4 v250, s[16:19], s41 offen offset:1024 lds
v_mfma_f32_16x16x32_bf16 a[140:143], a[208:211], v[92:95], a[140:143]
v_exp_f32 v57, v57
s_waitcnt lgkmcnt(0)
v_mfma_f32_16x16x32_bf16 a[0:3], a[176:179], v[80:83], a[0:3]
ds_read_b128 a[144:147], v2 offset:49152
v_cvt_pk_bf16_f32 v104, v56, v57
v_mfma_f32_16x16x32_bf16 a[32:35], a[176:179], v[84:87], a[32:35]
v_exp_f32 v58, v58
v_mfma_f32_16x16x32_bf16 a[64:67], a[176:179], v[88:91], a[64:67]
ds_read_b128 a[148:151], v2 offset:50176
ds_read_b128 a[152:155], v2 offset:53248
v_mfma_f32_16x16x32_bf16 a[96:99], a[176:179], v[92:95], a[96:99]
v_exp_f32 v59, v59
v_mfma_f32_16x16x32_bf16 a[4:7], a[180:183], v[80:83], a[4:7]
ds_read_b128 a[156:159], v2 offset:54272
v_cvt_pk_bf16_f32 v105, v58, v59
v_mfma_f32_16x16x32_bf16 a[36:39], a[180:183], v[84:87], a[36:39]
v_exp_f32 v72, v72
v_mfma_f32_16x16x32_bf16 a[68:71], a[180:183], v[88:91], a[68:71]
buffer_load_dwordx4 v250, s[16:19], s41 offen offset:2048 lds
v_mfma_f32_16x16x32_bf16 a[100:103], a[180:183], v[92:95], a[100:103]
v_exp_f32 v73, v73
v_mfma_f32_16x16x32_bf16 a[8:11], a[184:187], v[80:83], a[8:11]
ds_read_b128 a[160:163], v2 offset:57344
v_cvt_pk_bf16_f32 v106, v72, v73
v_mfma_f32_16x16x32_bf16 a[40:43], a[184:187], v[84:87], a[40:43]
v_exp_f32 v74, v74
v_mfma_f32_16x16x32_bf16 a[72:75], a[184:187], v[88:91], a[72:75]
ds_read_b128 a[164:167], v2 offset:58368
ds_read_b128 a[168:171], v2 offset:61440
v_mfma_f32_16x16x32_bf16 a[104:107], a[184:187], v[92:95], a[104:107]
v_exp_f32 v75, v75
v_mfma_f32_16x16x32_bf16 a[12:15], a[188:191], v[80:83], a[12:15]
ds_read_b128 a[172:175], v2 offset:62464
v_cvt_pk_bf16_f32 v107, v74, v75
v_mfma_f32_16x16x32_bf16 a[44:47], a[188:191], v[84:87], a[44:47]
v_exp_f32 v60, v60
v_mfma_f32_16x16x32_bf16 a[76:79], a[188:191], v[88:91], a[76:79]
buffer_load_dwordx4 v250, s[16:19], s41 offen offset:3072 lds
v_mfma_f32_16x16x32_bf16 a[108:111], a[188:191], v[92:95], a[108:111]
v_exp_f32 v61, v61
v_mfma_f32_16x16x32_bf16 a[16:19], a[192:195], v[80:83], a[16:19]
v_cvt_pk_bf16_f32 v108, v60, v61
v_mfma_f32_16x16x32_bf16 a[48:51], a[192:195], v[84:87], a[48:51]
v_exp_f32 v62, v62
v_mfma_f32_16x16x32_bf16 a[80:83], a[192:195], v[88:91], a[80:83]
v_mfma_f32_16x16x32_bf16 a[112:115], a[192:195], v[92:95], a[112:115]
v_exp_f32 v63, v63
v_mfma_f32_16x16x32_bf16 a[20:23], a[196:199], v[80:83], a[20:23]
v_cvt_pk_bf16_f32 v109, v62, v63
v_mfma_f32_16x16x32_bf16 a[52:55], a[196:199], v[84:87], a[52:55]
v_exp_f32 v76, v76
v_mfma_f32_16x16x32_bf16 a[84:87], a[196:199], v[88:91], a[84:87]
v_mfma_f32_16x16x32_bf16 a[116:119], a[196:199], v[92:95], a[116:119]
v_exp_f32 v77, v77
v_mfma_f32_16x16x32_bf16 a[24:27], a[200:203], v[80:83], a[24:27]
v_cvt_pk_bf16_f32 v110, v76, v77
v_mfma_f32_16x16x32_bf16 a[56:59], a[200:203], v[84:87], a[56:59]
v_exp_f32 v78, v78
v_mfma_f32_16x16x32_bf16 a[88:91], a[200:203], v[88:91], a[88:91]
v_mfma_f32_16x16x32_bf16 a[120:123], a[200:203], v[92:95], a[120:123]
v_exp_f32 v79, v79
v_mfma_f32_16x16x32_bf16 a[28:31], a[204:207], v[80:83], a[28:31]
v_cvt_pk_bf16_f32 v111, v78, v79
v_mfma_f32_16x16x32_bf16 a[60:63], a[204:207], v[84:87], a[60:63]
v_mfma_f32_16x16x32_bf16 a[92:95], a[204:207], v[88:91], a[92:95]
v_mfma_f32_16x16x32_bf16 a[124:127], a[204:207], v[92:95], a[124:127]
s_waitcnt lgkmcnt(0)
v_mfma_f32_16x16x32_bf16 v[48:51], a[144:147], v[144:147], v[112:115]
v_exp_f32 v16, v16
v_mfma_f32_16x16x32_bf16 v[52:55], a[144:147], v[160:163], v[116:119]
ds_read_b128 a[176:179], v2 offset:18432
ds_read_b128 a[180:183], v2 offset:19456
v_mfma_f32_16x16x32_bf16 v[56:59], a[144:147], v[176:179], v[120:123]
v_exp_f32 v17, v17
v_mfma_f32_16x16x32_bf16 v[60:63], a[144:147], v[192:195], v[124:127]
ds_read_b128 a[184:187], v2 offset:22528
ds_read_b128 a[188:191], v2 offset:23552
v_mfma_f32_16x16x32_bf16 v[48:51], a[148:151], v[148:151], v[48:51]
v_exp_f32 v18, v18
v_mfma_f32_16x16x32_bf16 v[52:55], a[148:151], v[164:167], v[52:55]
ds_read_b128 a[192:195], v2 offset:26624
ds_read_b128 a[196:199], v2 offset:27648
v_mfma_f32_16x16x32_bf16 v[56:59], a[148:151], v[180:183], v[56:59]
v_exp_f32 v19, v19
v_mfma_f32_16x16x32_bf16 v[60:63], a[148:151], v[196:199], v[60:63]
ds_read_b128 a[200:203], v2 offset:30720
ds_read_b128 a[204:207], v2 offset:31744
v_mfma_f32_16x16x32_bf16 v[48:51], a[152:155], v[152:155], v[48:51]
v_exp_f32 v32, v32
v_mfma_f32_16x16x32_bf16 v[52:55], a[152:155], v[168:171], v[52:55]
v_cvt_pk_bf16_f32 v80, v16, v17
v_cvt_pk_bf16_f32 v81, v18, v19
v_mfma_f32_16x16x32_bf16 v[56:59], a[152:155], v[184:187], v[56:59]
v_exp_f32 v33, v33
v_mfma_f32_16x16x32_bf16 v[60:63], a[152:155], v[200:203], v[60:63]
v_cvt_pk_bf16_f32 v82, v32, v33
v_mfma_f32_16x16x32_bf16 v[48:51], a[156:159], v[156:159], v[48:51]
v_exp_f32 v34, v34
v_mfma_f32_16x16x32_bf16 v[52:55], a[156:159], v[172:175], v[52:55]
v_mfma_f32_16x16x32_bf16 v[56:59], a[156:159], v[188:191], v[56:59]
v_exp_f32 v35, v35
v_mfma_f32_16x16x32_bf16 v[60:63], a[156:159], v[204:207], v[60:63]
v_cvt_pk_bf16_f32 v83, v34, v35
v_mfma_f32_16x16x32_bf16 v[64:67], a[160:163], v[144:147], v[128:131]
v_exp_f32 v20, v20
v_mfma_f32_16x16x32_bf16 v[68:71], a[160:163], v[160:163], v[132:135]
s_waitcnt vmcnt(12)
v_mfma_f32_16x16x32_bf16 v[72:75], a[160:163], v[176:179], v[136:139]
v_exp_f32 v21, v21
v_mfma_f32_16x16x32_bf16 v[76:79], a[160:163], v[192:195], v[140:143]
v_cvt_pk_bf16_f32 v84, v20, v21
s_barrier
v_mfma_f32_16x16x32_bf16 v[64:67], a[164:167], v[148:151], v[64:67]
v_exp_f32 v22, v22
v_mfma_f32_16x16x32_bf16 v[68:71], a[164:167], v[164:167], v[68:71]
s_add_u32 m0, s39, 0
v_mfma_f32_16x16x32_bf16 v[72:75], a[164:167], v[180:183], v[72:75]
v_exp_f32 v23, v23
v_mfma_f32_16x16x32_bf16 v[76:79], a[164:167], v[196:199], v[76:79]
v_cvt_pk_bf16_f32 v85, v22, v23
v_mfma_f32_16x16x32_bf16 v[64:67], a[168:171], v[152:155], v[64:67]
v_exp_f32 v36, v36
v_mfma_f32_16x16x32_bf16 v[68:71], a[168:171], v[168:171], v[68:71]
buffer_load_dwordx4 v251, s[16:19], s41 offen offset:0 lds
v_mfma_f32_16x16x32_bf16 v[72:75], a[168:171], v[184:187], v[72:75]
v_exp_f32 v37, v37
v_mfma_f32_16x16x32_bf16 v[76:79], a[168:171], v[200:203], v[76:79]
v_cvt_pk_bf16_f32 v86, v36, v37
v_mfma_f32_16x16x32_bf16 v[64:67], a[172:175], v[156:159], v[64:67]
v_exp_f32 v38, v38
v_mfma_f32_16x16x32_bf16 v[68:71], a[172:175], v[172:175], v[68:71]
v_mfma_f32_16x16x32_bf16 v[72:75], a[172:175], v[188:191], v[72:75]
v_exp_f32 v39, v39
v_mfma_f32_16x16x32_bf16 v[76:79], a[172:175], v[204:207], v[76:79]
v_cvt_pk_bf16_f32 v87, v38, v39
v_mfma_f32_16x16x32_bf16 a[128:131], a[208:211], v[96:99], a[128:131]
v_mfma_f32_16x16x32_bf16 a[132:135], a[208:211], v[100:103], a[132:135]
v_exp_f32 v24, v24
v_mfma_f32_16x16x32_bf16 a[136:139], a[208:211], v[104:107], a[136:139]
buffer_load_dwordx4 v251, s[16:19], s41 offen offset:1024 lds
v_mfma_f32_16x16x32_bf16 a[140:143], a[208:211], v[108:111], a[140:143]
v_exp_f32 v25, v25
s_waitcnt lgkmcnt(0)
v_mfma_f32_16x16x32_bf16 a[0:3], a[176:179], v[96:99], a[0:3]
ds_read_b128 a[144:147], v3 offset:0
v_cvt_pk_bf16_f32 v88, v24, v25
v_mfma_f32_16x16x32_bf16 a[32:35], a[176:179], v[100:103], a[32:35]
v_exp_f32 v26, v26
v_mfma_f32_16x16x32_bf16 a[64:67], a[176:179], v[104:107], a[64:67]
ds_read_b128 a[148:151], v3 offset:1024
ds_read_b128 a[152:155], v3 offset:4096
v_mfma_f32_16x16x32_bf16 a[96:99], a[176:179], v[108:111], a[96:99]
v_exp_f32 v27, v27
v_mfma_f32_16x16x32_bf16 a[4:7], a[180:183], v[96:99], a[4:7]
ds_read_b128 a[156:159], v3 offset:5120
v_cvt_pk_bf16_f32 v89, v26, v27
v_mfma_f32_16x16x32_bf16 a[36:39], a[180:183], v[100:103], a[36:39]
v_exp_f32 v40, v40
v_mfma_f32_16x16x32_bf16 a[68:71], a[180:183], v[104:107], a[68:71]
buffer_load_dwordx4 v251, s[16:19], s41 offen offset:2048 lds
v_mfma_f32_16x16x32_bf16 a[100:103], a[180:183], v[108:111], a[100:103]
v_exp_f32 v41, v41
v_mfma_f32_16x16x32_bf16 a[8:11], a[184:187], v[96:99], a[8:11]
ds_read_b128 a[160:163], v3 offset:8192
v_cvt_pk_bf16_f32 v90, v40, v41
v_mfma_f32_16x16x32_bf16 a[40:43], a[184:187], v[100:103], a[40:43]
v_exp_f32 v42, v42
v_mfma_f32_16x16x32_bf16 a[72:75], a[184:187], v[104:107], a[72:75]
ds_read_b128 a[164:167], v3 offset:9216
ds_read_b128 a[168:171], v3 offset:12288
v_mfma_f32_16x16x32_bf16 a[104:107], a[184:187], v[108:111], a[104:107]
v_exp_f32 v43, v43
v_mfma_f32_16x16x32_bf16 a[12:15], a[188:191], v[96:99], a[12:15]
ds_read_b128 a[172:175], v3 offset:13312
v_cvt_pk_bf16_f32 v91, v42, v43
v_mfma_f32_16x16x32_bf16 a[44:47], a[188:191], v[100:103], a[44:47]
v_exp_f32 v28, v28
v_mfma_f32_16x16x32_bf16 a[76:79], a[188:191], v[104:107], a[76:79]
buffer_load_dwordx4 v251, s[16:19], s41 offen offset:3072 lds
v_mfma_f32_16x16x32_bf16 a[108:111], a[188:191], v[108:111], a[108:111]
v_exp_f32 v29, v29
v_mfma_f32_16x16x32_bf16 a[16:19], a[192:195], v[96:99], a[16:19]
v_cvt_pk_bf16_f32 v92, v28, v29
v_mfma_f32_16x16x32_bf16 a[48:51], a[192:195], v[100:103], a[48:51]
v_exp_f32 v30, v30
v_mfma_f32_16x16x32_bf16 a[80:83], a[192:195], v[104:107], a[80:83]
v_mfma_f32_16x16x32_bf16 a[112:115], a[192:195], v[108:111], a[112:115]
v_exp_f32 v31, v31
v_mfma_f32_16x16x32_bf16 a[20:23], a[196:199], v[96:99], a[20:23]
v_cvt_pk_bf16_f32 v93, v30, v31
v_mfma_f32_16x16x32_bf16 a[52:55], a[196:199], v[100:103], a[52:55]
v_exp_f32 v44, v44
v_mfma_f32_16x16x32_bf16 a[84:87], a[196:199], v[104:107], a[84:87]
v_mfma_f32_16x16x32_bf16 a[116:119], a[196:199], v[108:111], a[116:119]
v_exp_f32 v45, v45
v_mfma_f32_16x16x32_bf16 a[24:27], a[200:203], v[96:99], a[24:27]
v_cvt_pk_bf16_f32 v94, v44, v45
v_mfma_f32_16x16x32_bf16 a[56:59], a[200:203], v[100:103], a[56:59]
v_exp_f32 v46, v46
v_mfma_f32_16x16x32_bf16 a[88:91], a[200:203], v[104:107], a[88:91]
v_mfma_f32_16x16x32_bf16 a[120:123], a[200:203], v[108:111], a[120:123]
v_exp_f32 v47, v47
v_mfma_f32_16x16x32_bf16 a[28:31], a[204:207], v[96:99], a[28:31]
v_cvt_pk_bf16_f32 v95, v46, v47
v_mfma_f32_16x16x32_bf16 a[60:63], a[204:207], v[100:103], a[60:63]
v_xor_b32 v2, 0x10000, v2
v_xor_b32 v3, 0x10000, v3
v_mfma_f32_16x16x32_bf16 a[92:95], a[204:207], v[104:107], a[92:95]
s_xor_b32 s39, s39, 0x10000
s_xor_b32 s40, s40, 0x10000
v_mfma_f32_16x16x32_bf16 a[124:127], a[204:207], v[108:111], a[124:127]
s_waitcnt lgkmcnt(0)
s_add_u32 s41, s41, 65536
s_sub_u32 s42, s42, 1
s_cmp_lg_u32 s42, 0
s_cbranch_scc1 K2_DUAL
s_branch K2_DUALM
.p2align 6
K2_DUAL_B:
v_mfma_f32_16x16x32_bf16 v[16:19], a[144:147], v[144:147], v[112:115]
v_exp_f32 v48, v48
v_mfma_f32_16x16x32_bf16 v[20:23], a[144:147], v[160:163], v[116:119]
ds_read_b128 a[176:179], v3 offset:34816
ds_read_b128 a[180:183], v3 offset:35840
v_mfma_f32_16x16x32_bf16 v[24:27], a[144:147], v[176:179], v[120:123]
v_exp_f32 v49, v49
v_mfma_f32_16x16x32_bf16 v[28:31], a[144:147], v[192:195], v[124:127]
ds_read_b128 a[184:187], v3 offset:38912
ds_read_b128 a[188:191], v3 offset:39936
v_mfma_f32_16x16x32_bf16 v[16:19], a[148:151], v[148:151], v[16:19]
v_exp_f32 v50, v50
v_mfma_f32_16x16x32_bf16 v[20:23], a[148:151], v[164:167], v[20:23]
ds_read_b128 a[192:195], v3 offset:43008
ds_read_b128 a[196:199], v3 offset:44032
v_mfma_f32_16x16x32_bf16 v[24:27], a[148:151], v[180:183], v[24:27]
v_exp_f32 v51, v51
v_mfma_f32_16x16x32_bf16 v[28:31], a[148:151], v[196:199], v[28:31]
ds_read_b128 a[200:203], v3 offset:47104
ds_read_b128 a[204:207], v3 offset:48128
v_mfma_f32_16x16x32_bf16 v[16:19], a[152:155], v[152:155], v[16:19]
v_exp_f32 v64, v64
v_mfma_f32_16x16x32_bf16 v[20:23], a[152:155], v[168:171], v[20:23]
v_cvt_pk_bf16_f32 v96, v48, v49
v_cvt_pk_bf16_f32 v97, v50, v51
v_mfma_f32_16x16x32_bf16 v[24:27], a[152:155], v[184:187], v[24:27]
v_exp_f32 v65, v65
v_mfma_f32_16x16x32_bf16 v[28:31], a[152:155], v[200:203], v[28:31]
v_cvt_pk_bf16_f32 v98, v64, v65
v_mfma_f32_16x16x32_bf16 v[16:19], a[156:159], v[156:159], v[16:19]
v_exp_f32 v66, v66
v_mfma_f32_16x16x32_bf16 v[20:23], a[156:159], v[172:175], v[20:23]
v_mfma_f32_16x16x32_bf16 v[24:27], a[156:159], v[188:191], v[24:27]
v_exp_f32 v67, v67
v_mfma_f32_16x16x32_bf16 v[28:31], a[156:159], v[204:207], v[28:31]
v_cvt_pk_bf16_f32 v99, v66, v67
v_mfma_f32_16x16x32_bf16 v[32:35], a[160:163], v[144:147], v[128:131]
v_exp_f32 v52, v52
v_mfma_f32_16x16x32_bf16 v[36:39], a[160:163], v[160:163], v[132:135]
v_mfma_f32_16x16x32_bf16 v[40:43], a[160:163], v[176:179], v[136:139]
v_exp_f32 v53, v53
v_mfma_f32_16x16x32_bf16 v[44:47], a[160:163], v[192:195], v[140:143]
v_cvt_pk_bf16_f32 v100, v52, v53
v_mfma_f32_16x16x32_bf16 v[32:35], a[164:167], v[148:151], v[32:35]
v_exp_f32 v54, v54
v_mfma_f32_16x16x32_bf16 v[36:39], a[164:167], v[164:167], v[36:39]
s_waitcnt vmcnt(12)
v_mfma_f32_16x16x32_bf16 v[40:43], a[164:167], v[180:183], v[40:43]
v_exp_f32 v55, v55
v_mfma_f32_16x16x32_bf16 v[44:47], a[164:167], v[196:199], v[44:47]
v_cvt_pk_bf16_f32 v101, v54, v55
s_barrier
v_mfma_f32_16x16x32_bf16 v[32:35], a[168:171], v[152:155], v[32:35]
v_exp_f32 v68, v68
v_mfma_f32_16x16x32_bf16 v[36:39], a[168:171], v[168:171], v[36:39]
s_add_u32 m0, s40, 16384
v_mfma_f32_16x16x32_bf16 v[40:43], a[168:171], v[184:187], v[40:43]
v_exp_f32 v69, v69
v_mfma_f32_16x16x32_bf16 v[44:47], a[168:171], v[200:203], v[44:47]
v_cvt_pk_bf16_f32 v102, v68, v69
v_mfma_f32_16x16x32_bf16 v[32:35], a[172:175], v[156:159], v[32:35]
v_exp_f32 v70, v70
v_mfma_f32_16x16x32_bf16 v[36:39], a[172:175], v[172:175], v[36:39]
buffer_load_dwordx4 v248, s[16:19], s41 offen offset:0 lds
v_mfma_f32_16x16x32_bf16 v[40:43], a[172:175], v[188:191], v[40:43]
v_exp_f32 v71, v71
v_mfma_f32_16x16x32_bf16 v[44:47], a[172:175], v[204:207], v[44:47]
v_cvt_pk_bf16_f32 v103, v70, v71
v_mfma_f32_16x16x32_bf16 a[128:131], a[208:211], v[80:83], a[128:131]
v_mfma_f32_16x16x32_bf16 a[132:135], a[208:211], v[84:87], a[132:135]
v_exp_f32 v56, v56
v_mfma_f32_16x16x32_bf16 a[136:139], a[208:211], v[88:91], a[136:139]
v_mfma_f32_16x16x32_bf16 a[140:143], a[208:211], v[92:95], a[140:143]
v_exp_f32 v57, v57
s_waitcnt lgkmcnt(0)
v_mfma_f32_16x16x32_bf16 a[0:3], a[176:179], v[80:83], a[0:3]
ds_read_b128 a[144:147], v2 offset:16384
v_cvt_pk_bf16_f32 v104, v56, v57
v_mfma_f32_16x16x32_bf16 a[32:35], a[176:179], v[84:87], a[32:35]
v_exp_f32 v58, v58
v_mfma_f32_16x16x32_bf16 a[64:67], a[176:179], v[88:91], a[64:67]
buffer_load_dwordx4 v248, s[16:19], s41 offen offset:1024 lds
v_mfma_f32_16x16x32_bf16 a[96:99], a[176:179], v[92:95], a[96:99]
v_exp_f32 v59, v59
v_mfma_f32_16x16x32_bf16 a[4:7], a[180:183], v[80:83], a[4:7]
ds_read_b128 a[148:151], v2 offset:17408
v_cvt_pk_bf16_f32 v105, v58, v59
v_mfma_f32_16x16x32_bf16 a[36:39], a[180:183], v[84:87], a[36:39]
v_exp_f32 v72, v72
v_mfma_f32_16x16x32_bf16 a[68:71], a[180:183], v[88:91], a[68:71]
ds_read_b128 a[152:155], v2 offset:20480
ds_read_b128 a[156:159], v2 offset:21504
v_mfma_f32_16x16x32_bf16 a[100:103], a[180:183], v[92:95], a[100:103]
v_exp_f32 v73, v73
v_mfma_f32_16x16x32_bf16 a[8:11], a[184:187], v[80:83], a[8:11]
ds_read_b128 a[160:163], v2 offset:24576
v_cvt_pk_bf16_f32 v106, v72, v73
v_mfma_f32_16x16x32_bf16 a[40:43], a[184:187], v[84:87], a[40:43]
v_exp_f32 v74, v74
v_mfma_f32_16x16x32_bf16 a[72:75], a[184:187], v[88:91], a[72:75]
buffer_load_dwordx4 v248, s[16:19], s41 offen offset:2048 lds
v_mfma_f32_16x16x32_bf16 a[104:107], a[184:187], v[92:95], a[104:107]
v_exp_f32 v75, v75
v_mfma_f32_16x16x32_bf16 a[12:15], a[188:191], v[80:83], a[12:15]
ds_read_b128 a[164:167], v2 offset:25600
v_cvt_pk_bf16_f32 v107, v74, v75
v_mfma_f32_16x16x32_bf16 a[44:47], a[188:191], v[84:87], a[44:47]
v_exp_f32 v60, v60
v_mfma_f32_16x16x32_bf16 a[76:79], a[188:191], v[88:91], a[76:79]
ds_read_b128 a[168:171], v2 offset:28672
ds_read_b128 a[172:175], v2 offset:29696
v_mfma_f32_16x16x32_bf16 a[108:111], a[188:191], v[92:95], a[108:111]
v_exp_f32 v61, v61
v_mfma_f32_16x16x32_bf16 a[16:19], a[192:195], v[80:83], a[16:19]
v_cvt_pk_bf16_f32 v108, v60, v61
v_mfma_f32_16x16x32_bf16 a[48:51], a[192:195], v[84:87], a[48:51]
v_exp_f32 v62, v62
v_mfma_f32_16x16x32_bf16 a[80:83], a[192:195], v[88:91], a[80:83]
buffer_load_dwordx4 v248, s[16:19], s41 offen offset:3072 lds
v_mfma_f32_16x16x32_bf16 a[112:115], a[192:195], v[92:95], a[112:115]
v_exp_f32 v63, v63
v_mfma_f32_16x16x32_bf16 a[20:23], a[196:199], v[80:83], a[20:23]
v_cvt_pk_bf16_f32 v109, v62, v63
v_mfma_f32_16x16x32_bf16 a[52:55], a[196:199], v[84:87], a[52:55]
v_exp_f32 v76, v76
v_mfma_f32_16x16x32_bf16 a[84:87], a[196:199], v[88:91], a[84:87]
v_mfma_f32_16x16x32_bf16 a[116:119], a[196:199], v[92:95], a[116:119]
v_exp_f32 v77, v77
v_mfma_f32_16x16x32_bf16 a[24:27], a[200:203], v[80:83], a[24:27]
v_cvt_pk_bf16_f32 v110, v76, v77
v_mfma_f32_16x16x32_bf16 a[56:59], a[200:203], v[84:87], a[56:59]
v_exp_f32 v78, v78
v_mfma_f32_16x16x32_bf16 a[88:91], a[200:203], v[88:91], a[88:91]
v_mfma_f32_16x16x32_bf16 a[120:123], a[200:203], v[92:95], a[120:123]
v_exp_f32 v79, v79
v_mfma_f32_16x16x32_bf16 a[28:31], a[204:207], v[80:83], a[28:31]
v_cvt_pk_bf16_f32 v111, v78, v79
v_mfma_f32_16x16x32_bf16 a[60:63], a[204:207], v[84:87], a[60:63]
v_mfma_f32_16x16x32_bf16 a[92:95], a[204:207], v[88:91], a[92:95]
v_mfma_f32_16x16x32_bf16 a[124:127], a[204:207], v[92:95], a[124:127]
s_waitcnt lgkmcnt(0)
v_mfma_f32_16x16x32_bf16 v[48:51], a[144:147], v[144:147], v[112:115]
v_exp_f32 v16, v16
v_mfma_f32_16x16x32_bf16 v[52:55], a[144:147], v[160:163], v[116:119]
ds_read_b128 a[176:179], v3 offset:51200
ds_read_b128 a[180:183], v3 offset:52224
v_mfma_f32_16x16x32_bf16 v[56:59], a[144:147], v[176:179], v[120:123]
v_exp_f32 v17, v17
v_mfma_f32_16x16x32_bf16 v[60:63], a[144:147], v[192:195], v[124:127]
ds_read_b128 a[184:187], v3 offset:55296
ds_read_b128 a[188:191], v3 offset:56320
v_mfma_f32_16x16x32_bf16 v[48:51], a[148:151], v[148:151], v[48:51]
v_exp_f32 v18, v18
v_mfma_f32_16x16x32_bf16 v[52:55], a[148:151], v[164:167], v[52:55]
ds_read_b128 a[192:195], v3 offset:59392
ds_read_b128 a[196:199], v3 offset:60416
v_mfma_f32_16x16x32_bf16 v[56:59], a[148:151], v[180:183], v[56:59]
v_exp_f32 v19, v19
v_mfma_f32_16x16x32_bf16 v[60:63], a[148:151], v[196:199], v[60:63]
ds_read_b128 a[200:203], v3 offset:63488
ds_read_b128 a[204:207], v3 offset:64512
v_mfma_f32_16x16x32_bf16 v[48:51], a[152:155], v[152:155], v[48:51]
v_exp_f32 v32, v32
v_mfma_f32_16x16x32_bf16 v[52:55], a[152:155], v[168:171], v[52:55]
v_cvt_pk_bf16_f32 v80, v16, v17
v_cvt_pk_bf16_f32 v81, v18, v19
v_mfma_f32_16x16x32_bf16 v[56:59], a[152:155], v[184:187], v[56:59]
v_exp_f32 v33, v33
v_mfma_f32_16x16x32_bf16 v[60:63], a[152:155], v[200:203], v[60:63]
v_cvt_pk_bf16_f32 v82, v32, v33
v_mfma_f32_16x16x32_bf16 v[48:51], a[156:159], v[156:159], v[48:51]
v_exp_f32 v34, v34
v_mfma_f32_16x16x32_bf16 v[52:55], a[156:159], v[172:175], v[52:55]
v_mfma_f32_16x16x32_bf16 v[56:59], a[156:159], v[188:191], v[56:59]
v_exp_f32 v35, v35
v_mfma_f32_16x16x32_bf16 v[60:63], a[156:159], v[204:207], v[60:63]
v_cvt_pk_bf16_f32 v83, v34, v35
v_mfma_f32_16x16x32_bf16 v[64:67], a[160:163], v[144:147], v[128:131]
v_exp_f32 v20, v20
v_mfma_f32_16x16x32_bf16 v[68:71], a[160:163], v[160:163], v[132:135]
v_mfma_f32_16x16x32_bf16 v[72:75], a[160:163], v[176:179], v[136:139]
v_exp_f32 v21, v21
v_mfma_f32_16x16x32_bf16 v[76:79], a[160:163], v[192:195], v[140:143]
v_cvt_pk_bf16_f32 v84, v20, v21
v_mfma_f32_16x16x32_bf16 v[64:67], a[164:167], v[148:151], v[64:67]
v_exp_f32 v22, v22
v_mfma_f32_16x16x32_bf16 v[68:71], a[164:167], v[164:167], v[68:71]
s_waitcnt vmcnt(12)
v_mfma_f32_16x16x32_bf16 v[72:75], a[164:167], v[180:183], v[72:75]
v_exp_f32 v23, v23
v_mfma_f32_16x16x32_bf16 v[76:79], a[164:167], v[196:199], v[76:79]
v_cvt_pk_bf16_f32 v85, v22, v23
s_barrier
v_mfma_f32_16x16x32_bf16 v[64:67], a[168:171], v[152:155], v[64:67]
v_exp_f32 v36, v36
v_mfma_f32_16x16x32_bf16 v[68:71], a[168:171], v[168:171], v[68:71]
s_add_u32 m0, s40, 32768
v_mfma_f32_16x16x32_bf16 v[72:75], a[168:171], v[184:187], v[72:75]
v_exp_f32 v37, v37
v_mfma_f32_16x16x32_bf16 v[76:79], a[168:171], v[200:203], v[76:79]
v_cvt_pk_bf16_f32 v86, v36, v37
v_mfma_f32_16x16x32_bf16 v[64:67], a[172:175], v[156:159], v[64:67]
v_exp_f32 v38, v38
v_mfma_f32_16x16x32_bf16 v[68:71], a[172:175], v[172:175], v[68:71]
buffer_load_dwordx4 v249, s[16:19], s41 offen offset:0 lds
v_mfma_f32_16x16x32_bf16 v[72:75], a[172:175], v[188:191], v[72:75]
v_exp_f32 v39, v39
v_mfma_f32_16x16x32_bf16 v[76:79], a[172:175], v[204:207], v[76:79]
v_cvt_pk_bf16_f32 v87, v38, v39
v_mfma_f32_16x16x32_bf16 a[128:131], a[208:211], v[96:99], a[128:131]
v_mfma_f32_16x16x32_bf16 a[132:135], a[208:211], v[100:103], a[132:135]
v_exp_f32 v24, v24
v_mfma_f32_16x16x32_bf16 a[136:139], a[208:211], v[104:107], a[136:139]
v_mfma_f32_16x16x32_bf16 a[140:143], a[208:211], v[108:111], a[140:143]
v_exp_f32 v25, v25
s_waitcnt lgkmcnt(0)
v_mfma_f32_16x16x32_bf16 a[0:3], a[176:179], v[96:99], a[0:3]
ds_read_b128 a[144:147], v2 offset:32768
v_cvt_pk_bf16_f32 v88, v24, v25
v_mfma_f32_16x16x32_bf16 a[32:35], a[176:179], v[100:103], a[32:35]
v_exp_f32 v26, v26
v_mfma_f32_16x16x32_bf16 a[64:67], a[176:179], v[104:107], a[64:67]
buffer_load_dwordx4 v249, s[16:19], s41 offen offset:1024 lds
v_mfma_f32_16x16x32_bf16 a[96:99], a[176:179], v[108:111], a[96:99]
v_exp_f32 v27, v27
v_mfma_f32_16x16x32_bf16 a[4:7], a[180:183], v[96:99], a[4:7]
ds_read_b128 a[148:151], v2 offset:33792
v_cvt_pk_bf16_f32 v89, v26, v27
v_mfma_f32_16x16x32_bf16 a[36:39], a[180:183], v[100:103], a[36:39]
v_exp_f32 v40, v40
v_mfma_f32_16x16x32_bf16 a[68:71], a[180:183], v[104:107], a[68:71]
ds_read_b128 a[152:155], v2 offset:36864
ds_read_b128 a[156:159], v2 offset:37888
v_mfma_f32_16x16x32_bf16 a[100:103], a[180:183], v[108:111], a[100:103]
v_exp_f32 v41, v41
v_mfma_f32_16x16x32_bf16 a[8:11], a[184:187], v[96:99], a[8:11]
ds_read_b128 a[160:163], v2 offset:40960
v_cvt_pk_bf16_f32 v90, v40, v41
v_mfma_f32_16x16x32_bf16 a[40:43], a[184:187], v[100:103], a[40:43]
v_exp_f32 v42, v42
v_mfma_f32_16x16x32_bf16 a[72:75], a[184:187], v[104:107], a[72:75]
buffer_load_dwordx4 v249, s[16:19], s41 offen offset:2048 lds
v_mfma_f32_16x16x32_bf16 a[104:107], a[184:187], v[108:111], a[104:107]
v_exp_f32 v43, v43
v_mfma_f32_16x16x32_bf16 a[12:15], a[188:191], v[96:99], a[12:15]
ds_read_b128 a[164:167], v2 offset:41984
v_cvt_pk_bf16_f32 v91, v42, v43
v_mfma_f32_16x16x32_bf16 a[44:47], a[188:191], v[100:103], a[44:47]
v_exp_f32 v28, v28
v_mfma_f32_16x16x32_bf16 a[76:79], a[188:191], v[104:107], a[76:79]
ds_read_b128 a[168:171], v2 offset:45056
ds_read_b128 a[172:175], v2 offset:46080
v_mfma_f32_16x16x32_bf16 a[108:111], a[188:191], v[108:111], a[108:111]
v_exp_f32 v29, v29
v_mfma_f32_16x16x32_bf16 a[16:19], a[192:195], v[96:99], a[16:19]
v_cvt_pk_bf16_f32 v92, v28, v29
v_mfma_f32_16x16x32_bf16 a[48:51], a[192:195], v[100:103], a[48:51]
v_exp_f32 v30, v30
v_mfma_f32_16x16x32_bf16 a[80:83], a[192:195], v[104:107], a[80:83]
buffer_load_dwordx4 v249, s[16:19], s41 offen offset:3072 lds
v_mfma_f32_16x16x32_bf16 a[112:115], a[192:195], v[108:111], a[112:115]
v_exp_f32 v31, v31
v_mfma_f32_16x16x32_bf16 a[20:23], a[196:199], v[96:99], a[20:23]
v_cvt_pk_bf16_f32 v93, v30, v31
v_mfma_f32_16x16x32_bf16 a[52:55], a[196:199], v[100:103], a[52:55]
v_exp_f32 v44, v44
v_mfma_f32_16x16x32_bf16 a[84:87], a[196:199], v[104:107], a[84:87]
v_mfma_f32_16x16x32_bf16 a[116:119], a[196:199], v[108:111], a[116:119]
v_exp_f32 v45, v45
v_mfma_f32_16x16x32_bf16 a[24:27], a[200:203], v[96:99], a[24:27]
v_cvt_pk_bf16_f32 v94, v44, v45
v_mfma_f32_16x16x32_bf16 a[56:59], a[200:203], v[100:103], a[56:59]
v_exp_f32 v46, v46
v_mfma_f32_16x16x32_bf16 a[88:91], a[200:203], v[104:107], a[88:91]
v_mfma_f32_16x16x32_bf16 a[120:123], a[200:203], v[108:111], a[120:123]
v_exp_f32 v47, v47
v_mfma_f32_16x16x32_bf16 a[28:31], a[204:207], v[96:99], a[28:31]
v_cvt_pk_bf16_f32 v95, v46, v47
v_mfma_f32_16x16x32_bf16 a[60:63], a[204:207], v[100:103], a[60:63]
v_mfma_f32_16x16x32_bf16 a[92:95], a[204:207], v[104:107], a[92:95]
v_mfma_f32_16x16x32_bf16 a[124:127], a[204:207], v[108:111], a[124:127]
s_waitcnt lgkmcnt(0)
v_mfma_f32_16x16x32_bf16 v[16:19], a[144:147], v[144:147], v[112:115]
v_exp_f32 v48, v48
v_mfma_f32_16x16x32_bf16 v[20:23], a[144:147], v[160:163], v[116:119]
ds_read_b128 a[176:179], v2 offset:2048
ds_read_b128 a[180:183], v2 offset:3072
v_mfma_f32_16x16x32_bf16 v[24:27], a[144:147], v[176:179], v[120:123]
v_exp_f32 v49, v49
v_mfma_f32_16x16x32_bf16 v[28:31], a[144:147], v[192:195], v[124:127]
ds_read_b128 a[184:187], v2 offset:6144
ds_read_b128 a[188:191], v2 offset:7168
v_mfma_f32_16x16x32_bf16 v[16:19], a[148:151], v[148:151], v[16:19]
v_exp_f32 v50, v50
v_mfma_f32_16x16x32_bf16 v[20:23], a[148:151], v[164:167], v[20:23]
ds_read_b128 a[192:195], v2 offset:10240
ds_read_b128 a[196:199], v2 offset:11264
v_mfma_f32_16x16x32_bf16 v[24:27], a[148:151], v[180:183], v[24:27]
v_exp_f32 v51, v51
v_mfma_f32_16x16x32_bf16 v[28:31], a[148:151], v[196:199], v[28:31]
ds_read_b128 a[200:203], v2 offset:14336
ds_read_b128 a[204:207], v2 offset:15360
v_mfma_f32_16x16x32_bf16 v[16:19], a[152:155], v[152:155], v[16:19]
v_exp_f32 v64, v64
v_mfma_f32_16x16x32_bf16 v[20:23], a[152:155], v[168:171], v[20:23]
v_cvt_pk_bf16_f32 v96, v48, v49
v_cvt_pk_bf16_f32 v97, v50, v51
v_mfma_f32_16x16x32_bf16 v[24:27], a[152:155], v[184:187], v[24:27]
v_exp_f32 v65, v65
v_mfma_f32_16x16x32_bf16 v[28:31], a[152:155], v[200:203], v[28:31]
v_cvt_pk_bf16_f32 v98, v64, v65
v_mfma_f32_16x16x32_bf16 v[16:19], a[156:159], v[156:159], v[16:19]
v_exp_f32 v66, v66
v_mfma_f32_16x16x32_bf16 v[20:23], a[156:159], v[172:175], v[20:23]
v_mfma_f32_16x16x32_bf16 v[24:27], a[156:159], v[188:191], v[24:27]
v_exp_f32 v67, v67
v_mfma_f32_16x16x32_bf16 v[28:31], a[156:159], v[204:207], v[28:31]
v_cvt_pk_bf16_f32 v99, v66, v67
v_mfma_f32_16x16x32_bf16 v[32:35], a[160:163], v[144:147], v[128:131]
v_exp_f32 v52, v52
v_mfma_f32_16x16x32_bf16 v[36:39], a[160:163], v[160:163], v[132:135]
v_mfma_f32_16x16x32_bf16 v[40:43], a[160:163], v[176:179], v[136:139]
v_exp_f32 v53, v53
v_mfma_f32_16x16x32_bf16 v[44:47], a[160:163], v[192:195], v[140:143]
v_cvt_pk_bf16_f32 v100, v52, v53
v_mfma_f32_16x16x32_bf16 v[32:35], a[164:167], v[148:151], v[32:35]
v_exp_f32 v54, v54
v_mfma_f32_16x16x32_bf16 v[36:39], a[164:167], v[164:167], v[36:39]
s_waitcnt vmcnt(12)
v_mfma_f32_16x16x32_bf16 v[40:43], a[164:167], v[180:183], v[40:43]
v_exp_f32 v55, v55
v_mfma_f32_16x16x32_bf16 v[44:47], a[164:167], v[196:199], v[44:47]
v_cvt_pk_bf16_f32 v101, v54, v55
s_barrier
v_mfma_f32_16x16x32_bf16 v[32:35], a[168:171], v[152:155], v[32:35]
v_exp_f32 v68, v68
v_mfma_f32_16x16x32_bf16 v[36:39], a[168:171], v[168:171], v[36:39]
s_add_u32 m0, s40, 49152
v_mfma_f32_16x16x32_bf16 v[40:43], a[168:171], v[184:187], v[40:43]
v_exp_f32 v69, v69
v_mfma_f32_16x16x32_bf16 v[44:47], a[168:171], v[200:203], v[44:47]
v_cvt_pk_bf16_f32 v102, v68, v69
v_mfma_f32_16x16x32_bf16 v[32:35], a[172:175], v[156:159], v[32:35]
v_exp_f32 v70, v70
v_mfma_f32_16x16x32_bf16 v[36:39], a[172:175], v[172:175], v[36:39]
buffer_load_dwordx4 v250, s[16:19], s41 offen offset:0 lds
v_mfma_f32_16x16x32_bf16 v[40:43], a[172:175], v[188:191], v[40:43]
v_exp_f32 v71, v71
v_mfma_f32_16x16x32_bf16 v[44:47], a[172:175], v[204:207], v[44:47]
v_cvt_pk_bf16_f32 v103, v70, v71
v_mfma_f32_16x16x32_bf16 a[128:131], a[208:211], v[80:83], a[128:131]
v_mfma_f32_16x16x32_bf16 a[132:135], a[208:211], v[84:87], a[132:135]
v_exp_f32 v56, v56
v_mfma_f32_16x16x32_bf16 a[136:139], a[208:211], v[88:91], a[136:139]
v_mfma_f32_16x16x32_bf16 a[140:143], a[208:211], v[92:95], a[140:143]
v_exp_f32 v57, v57
s_waitcnt lgkmcnt(0)
v_mfma_f32_16x16x32_bf16 a[0:3], a[176:179], v[80:83], a[0:3]
ds_read_b128 a[144:147], v2 offset:49152
v_cvt_pk_bf16_f32 v104, v56, v57
v_mfma_f32_16x16x32_bf16 a[32:35], a[176:179], v[84:87], a[32:35]
v_exp_f32 v58, v58
v_mfma_f32_16x16x32_bf16 a[64:67], a[176:179], v[88:91], a[64:67]
buffer_load_dwordx4 v250, s[16:19], s41 offen offset:1024 lds
v_mfma_f32_16x16x32_bf16 a[96:99], a[176:179], v[92:95], a[96:99]
v_exp_f32 v59, v59
v_mfma_f32_16x16x32_bf16 a[4:7], a[180:183], v[80:83], a[4:7]
ds_read_b128 a[148:151], v2 offset:50176
v_cvt_pk_bf16_f32 v105, v58, v59
v_mfma_f32_16x16x32_bf16 a[36:39], a[180:183], v[84:87], a[36:39]
v_exp_f32 v72, v72
v_mfma_f32_16x16x32_bf16 a[68:71], a[180:183], v[88:91], a[68:71]
ds_read_b128 a[152:155], v2 offset:53248
ds_read_b128 a[156:159], v2 offset:54272
v_mfma_f32_16x16x32_bf16 a[100:103], a[180:183], v[92:95], a[100:103]
v_exp_f32 v73, v73
v_mfma_f32_16x16x32_bf16 a[8:11], a[184:187], v[80:83], a[8:11]
ds_read_b128 a[160:163], v2 offset:57344
v_cvt_pk_bf16_f32 v106, v72, v73
v_mfma_f32_16x16x32_bf16 a[40:43], a[184:187], v[84:87], a[40:43]
v_exp_f32 v74, v74
v_mfma_f32_16x16x32_bf16 a[72:75], a[184:187], v[88:91], a[72:75]
buffer_load_dwordx4 v250, s[16:19], s41 offen offset:2048 lds
v_mfma_f32_16x16x32_bf16 a[104:107], a[184:187], v[92:95], a[104:107]
v_exp_f32 v75, v75
v_mfma_f32_16x16x32_bf16 a[12:15], a[188:191], v[80:83], a[12:15]
ds_read_b128 a[164:167], v2 offset:58368
v_cvt_pk_bf16_f32 v107, v74, v75
v_mfma_f32_16x16x32_bf16 a[44:47], a[188:191], v[84:87], a[44:47]
v_exp_f32 v60, v60
v_mfma_f32_16x16x32_bf16 a[76:79], a[188:191], v[88:91], a[76:79]
ds_read_b128 a[168:171], v2 offset:61440
ds_read_b128 a[172:175], v2 offset:62464
v_mfma_f32_16x16x32_bf16 a[108:111], a[188:191], v[92:95], a[108:111]
v_exp_f32 v61, v61
v_mfma_f32_16x16x32_bf16 a[16:19], a[192:195], v[80:83], a[16:19]
v_cvt_pk_bf16_f32 v108, v60, v61
v_mfma_f32_16x16x32_bf16 a[48:51], a[192:195], v[84:87], a[48:51]
v_exp_f32 v62, v62
v_mfma_f32_16x16x32_bf16 a[80:83], a[192:195], v[88:91], a[80:83]
buffer_load_dwordx4 v250, s[16:19], s41 offen offset:3072 lds
v_mfma_f32_16x16x32_bf16 a[112:115], a[192:195], v[92:95], a[112:115]
v_exp_f32 v63, v63
v_mfma_f32_16x16x32_bf16 a[20:23], a[196:199], v[80:83], a[20:23]
v_cvt_pk_bf16_f32 v109, v62, v63
v_mfma_f32_16x16x32_bf16 a[52:55], a[196:199], v[84:87], a[52:55]
v_exp_f32 v76, v76
v_mfma_f32_16x16x32_bf16 a[84:87], a[196:199], v[88:91], a[84:87]
v_mfma_f32_16x16x32_bf16 a[116:119], a[196:199], v[92:95], a[116:119]
v_exp_f32 v77, v77
v_mfma_f32_16x16x32_bf16 a[24:27], a[200:203], v[80:83], a[24:27]
v_cvt_pk_bf16_f32 v110, v76, v77
v_mfma_f32_16x16x32_bf16 a[56:59], a[200:203], v[84:87], a[56:59]
v_exp_f32 v78, v78
v_mfma_f32_16x16x32_bf16 a[88:91], a[200:203], v[88:91], a[88:91]
v_mfma_f32_16x16x32_bf16 a[120:123], a[200:203], v[92:95], a[120:123]
v_exp_f32 v79, v79
v_mfma_f32_16x16x32_bf16 a[28:31], a[204:207], v[80:83], a[28:31]
v_cvt_pk_bf16_f32 v111, v78, v79
v_mfma_f32_16x16x32_bf16 a[60:63], a[204:207], v[84:87], a[60:63]
v_mfma_f32_16x16x32_bf16 a[92:95], a[204:207], v[88:91], a[92:95]
v_mfma_f32_16x16x32_bf16 a[124:127], a[204:207], v[92:95], a[124:127]
s_waitcnt lgkmcnt(0)
v_mfma_f32_16x16x32_bf16 v[48:51], a[144:147], v[144:147], v[112:115]
v_exp_f32 v16, v16
v_mfma_f32_16x16x32_bf16 v[52:55], a[144:147], v[160:163], v[116:119]
ds_read_b128 a[176:179], v2 offset:18432
ds_read_b128 a[180:183], v2 offset:19456
v_mfma_f32_16x16x32_bf16 v[56:59], a[144:147], v[176:179], v[120:123]
v_exp_f32 v17, v17
v_mfma_f32_16x16x32_bf16 v[60:63], a[144:147], v[192:195], v[124:127]
ds_read_b128 a[184:187], v2 offset:22528
ds_read_b128 a[188:191], v2 offset:23552
v_mfma_f32_16x16x32_bf16 v[48:51], a[148:151], v[148:151], v[48:51]
v_exp_f32 v18, v18
v_mfma_f32_16x16x32_bf16 v[52:55], a[148:151], v[164:167], v[52:55]
ds_read_b128 a[192:195], v2 offset:26624
ds_read_b128 a[196:199], v2 offset:27648
v_mfma_f32_16x16x32_bf16 v[56:59], a[148:151], v[180:183], v[56:59]
v_exp_f32 v19, v19
v_mfma_f32_16x16x32_bf16 v[60:63], a[148:151], v[196:199], v[60:63]
ds_read_b128 a[200:203], v2 offset:30720
ds_read_b128 a[204:207], v2 offset:31744
v_mfma_f32_16x16x32_bf16 v[48:51], a[152:155], v[152:155], v[48:51]
v_exp_f32 v32, v32
v_mfma_f32_16x16x32_bf16 v[52:55], a[152:155], v[168:171], v[52:55]
v_cvt_pk_bf16_f32 v80, v16, v17
v_cvt_pk_bf16_f32 v81, v18, v19
v_mfma_f32_16x16x32_bf16 v[56:59], a[152:155], v[184:187], v[56:59]
v_exp_f32 v33, v33
v_mfma_f32_16x16x32_bf16 v[60:63], a[152:155], v[200:203], v[60:63]
v_cvt_pk_bf16_f32 v82, v32, v33
v_mfma_f32_16x16x32_bf16 v[48:51], a[156:159], v[156:159], v[48:51]
v_exp_f32 v34, v34
v_mfma_f32_16x16x32_bf16 v[52:55], a[156:159], v[172:175], v[52:55]
v_mfma_f32_16x16x32_bf16 v[56:59], a[156:159], v[188:191], v[56:59]
v_exp_f32 v35, v35
v_mfma_f32_16x16x32_bf16 v[60:63], a[156:159], v[204:207], v[60:63]
v_cvt_pk_bf16_f32 v83, v34, v35
v_mfma_f32_16x16x32_bf16 v[64:67], a[160:163], v[144:147], v[128:131]
v_exp_f32 v20, v20
v_mfma_f32_16x16x32_bf16 v[68:71], a[160:163], v[160:163], v[132:135]
v_mfma_f32_16x16x32_bf16 v[72:75], a[160:163], v[176:179], v[136:139]
v_exp_f32 v21, v21
v_mfma_f32_16x16x32_bf16 v[76:79], a[160:163], v[192:195], v[140:143]
v_cvt_pk_bf16_f32 v84, v20, v21
v_mfma_f32_16x16x32_bf16 v[64:67], a[164:167], v[148:151], v[64:67]
v_exp_f32 v22, v22
v_mfma_f32_16x16x32_bf16 v[68:71], a[164:167], v[164:167], v[68:71]
s_waitcnt vmcnt(12)
v_mfma_f32_16x16x32_bf16 v[72:75], a[164:167], v[180:183], v[72:75]
v_exp_f32 v23, v23
v_mfma_f32_16x16x32_bf16 v[76:79], a[164:167], v[196:199], v[76:79]
v_cvt_pk_bf16_f32 v85, v22, v23
s_barrier
v_mfma_f32_16x16x32_bf16 v[64:67], a[168:171], v[152:155], v[64:67]
v_exp_f32 v36, v36
v_mfma_f32_16x16x32_bf16 v[68:71], a[168:171], v[168:171], v[68:71]
s_add_u32 m0, s39, 0
v_mfma_f32_16x16x32_bf16 v[72:75], a[168:171], v[184:187], v[72:75]
v_exp_f32 v37, v37
v_mfma_f32_16x16x32_bf16 v[76:79], a[168:171], v[200:203], v[76:79]
v_cvt_pk_bf16_f32 v86, v36, v37
v_mfma_f32_16x16x32_bf16 v[64:67], a[172:175], v[156:159], v[64:67]
v_exp_f32 v38, v38
v_mfma_f32_16x16x32_bf16 v[68:71], a[172:175], v[172:175], v[68:71]
buffer_load_dwordx4 v251, s[16:19], s41 offen offset:0 lds
v_mfma_f32_16x16x32_bf16 v[72:75], a[172:175], v[188:191], v[72:75]
v_exp_f32 v39, v39
v_mfma_f32_16x16x32_bf16 v[76:79], a[172:175], v[204:207], v[76:79]
v_cvt_pk_bf16_f32 v87, v38, v39
v_mfma_f32_16x16x32_bf16 a[128:131], a[208:211], v[96:99], a[128:131]
v_mfma_f32_16x16x32_bf16 a[132:135], a[208:211], v[100:103], a[132:135]
v_exp_f32 v24, v24
v_mfma_f32_16x16x32_bf16 a[136:139], a[208:211], v[104:107], a[136:139]
v_mfma_f32_16x16x32_bf16 a[140:143], a[208:211], v[108:111], a[140:143]
v_exp_f32 v25, v25
s_waitcnt lgkmcnt(0)
v_mfma_f32_16x16x32_bf16 a[0:3], a[176:179], v[96:99], a[0:3]
ds_read_b128 a[144:147], v3 offset:0
v_cvt_pk_bf16_f32 v88, v24, v25
v_mfma_f32_16x16x32_bf16 a[32:35], a[176:179], v[100:103], a[32:35]
v_exp_f32 v26, v26
v_mfma_f32_16x16x32_bf16 a[64:67], a[176:179], v[104:107], a[64:67]
buffer_load_dwordx4 v251, s[16:19], s41 offen offset:1024 lds
v_mfma_f32_16x16x32_bf16 a[96:99], a[176:179], v[108:111], a[96:99]
v_exp_f32 v27, v27
v_mfma_f32_16x16x32_bf16 a[4:7], a[180:183], v[96:99], a[4:7]
ds_read_b128 a[148:151], v3 offset:1024
v_cvt_pk_bf16_f32 v89, v26, v27
v_mfma_f32_16x16x32_bf16 a[36:39], a[180:183], v[100:103], a[36:39]
v_exp_f32 v40, v40
v_mfma_f32_16x16x32_bf16 a[68:71], a[180:183], v[104:107], a[68:71]
ds_read_b128 a[152:155], v3 offset:4096
ds_read_b128 a[156:159], v3 offset:5120
v_mfma_f32_16x16x32_bf16 a[100:103], a[180:183], v[108:111], a[100:103]
v_exp_f32 v41, v41
v_mfma_f32_16x16x32_bf16 a[8:11], a[184:187], v[96:99], a[8:11]
ds_read_b128 a[160:163], v3 offset:8192
v_cvt_pk_bf16_f32 v90, v40, v41
v_mfma_f32_16x16x32_bf16 a[40:43], a[184:187], v[100:103], a[40:43]
v_exp_f32 v42, v42
v_mfma_f32_16x16x32_bf16 a[72:75], a[184:187], v[104:107], a[72:75]
buffer_load_dwordx4 v251, s[16:19], s41 offen offset:2048 lds
v_mfma_f32_16x16x32_bf16 a[104:107], a[184:187], v[108:111], a[104:107]
v_exp_f32 v43, v43
v_mfma_f32_16x16x32_bf16 a[12:15], a[188:191], v[96:99], a[12:15]
ds_read_b128 a[164:167], v3 offset:9216
v_cvt_pk_bf16_f32 v91, v42, v43
v_mfma_f32_16x16x32_bf16 a[44:47], a[188:191], v[100:103], a[44:47]
v_exp_f32 v28, v28
v_mfma_f32_16x16x32_bf16 a[76:79], a[188:191], v[104:107], a[76:79]
ds_read_b128 a[168:171], v3 offset:12288
ds_read_b128 a[172:175], v3 offset:13312
v_mfma_f32_16x16x32_bf16 a[108:111], a[188:191], v[108:111], a[108:111]
v_exp_f32 v29, v29
v_mfma_f32_16x16x32_bf16 a[16:19], a[192:195], v[96:99], a[16:19]
v_cvt_pk_bf16_f32 v92, v28, v29
v_mfma_f32_16x16x32_bf16 a[48:51], a[192:195], v[100:103], a[48:51]
v_exp_f32 v30, v30
v_mfma_f32_16x16x32_bf16 a[80:83], a[192:195], v[104:107], a[80:83]
buffer_load_dwordx4 v251, s[16:19], s41 offen offset:3072 lds
v_mfma_f32_16x16x32_bf16 a[112:115], a[192:195], v[108:111], a[112:115]
v_exp_f32 v31, v31
v_mfma_f32_16x16x32_bf16 a[20:23], a[196:199], v[96:99], a[20:23]
v_cvt_pk_bf16_f32 v93, v30, v31
v_mfma_f32_16x16x32_bf16 a[52:55], a[196:199], v[100:103], a[52:55]
v_exp_f32 v44, v44
v_mfma_f32_16x16x32_bf16 a[84:87], a[196:199], v[104:107], a[84:87]
v_mfma_f32_16x16x32_bf16 a[116:119], a[196:199], v[108:111], a[116:119]
v_exp_f32 v45, v45
v_mfma_f32_16x16x32_bf16 a[24:27], a[200:203], v[96:99], a[24:27]
v_cvt_pk_bf16_f32 v94, v44, v45
v_mfma_f32_16x16x32_bf16 a[56:59], a[200:203], v[100:103], a[56:59]
v_exp_f32 v46, v46
v_mfma_f32_16x16x32_bf16 a[88:91], a[200:203], v[104:107], a[88:91]
v_mfma_f32_16x16x32_bf16 a[120:123], a[200:203], v[108:111], a[120:123]
v_exp_f32 v47, v47
v_mfma_f32_16x16x32_bf16 a[28:31], a[204:207], v[96:99], a[28:31]
v_cvt_pk_bf16_f32 v95, v46, v47
v_mfma_f32_16x16x32_bf16 a[60:63], a[204:207], v[100:103], a[60:63]
v_xor_b32 v2, 0x10000, v2
v_xor_b32 v3, 0x10000, v3
v_mfma_f32_16x16x32_bf16 a[92:95], a[204:207], v[104:107], a[92:95]
s_xor_b32 s39, s39, 0x10000
s_xor_b32 s40, s40, 0x10000
v_mfma_f32_16x16x32_bf16 a[124:127], a[204:207], v[108:111], a[124:127]
s_waitcnt lgkmcnt(0)
s_add_u32 s41, s41, 65536
s_sub_u32 s42, s42, 1
s_cmp_lg_u32 s42, 0
s_cbranch_scc1 K2_DUAL_B
K2_DUALM:
s_cmp_eq_u32 s37, 0
s_cbranch_scc1 K2_TRANS
s_cmp_eq_u32 s36, 0
s_cbranch_scc0 K2_MK11
v_cndmask_b32 v112, v216, v208, s[60:61]
v_cndmask_b32 v113, v216, v208, s[62:63]
v_cndmask_b32 v114, v216, v208, s[64:65]
v_cndmask_b32 v115, v216, v208, s[66:67]
K2_MK11:
s_cmp_eq_u32 s36, 1
s_cbranch_scc0 K2_MK12
v_cndmask_b32 v128, v216, v208, s[60:61]
v_cndmask_b32 v129, v216, v208, s[62:63]
v_cndmask_b32 v130, v216, v208, s[64:65]
v_cndmask_b32 v131, v216, v208, s[66:67]
K2_MK12:
s_cmp_lt_u32 s36, 1
s_cbranch_scc0 K2_ML12
v_mov_b32 v128, v216
v_mov_b32 v129, v216
v_mov_b32 v130, v216
v_mov_b32 v131, v216
K2_ML12:
s_nop 1
v_mfma_f32_16x16x32_bf16 v[16:19], a[144:147], v[144:147], v[112:115]
v_exp_f32 v48, v48
v_mfma_f32_16x16x32_bf16 v[20:23], a[144:147], v[160:163], v[116:119]
ds_read_b128 a[176:179], v3 offset:34816
ds_read_b128 a[180:183], v3 offset:35840
v_mfma_f32_16x16x32_bf16 v[24:27], a[144:147], v[176:179], v[120:123]
v_exp_f32 v49, v49
v_mfma_f32_16x16x32_bf16 v[28:31], a[144:147], v[192:195], v[124:127]
ds_read_b128 a[184:187], v3 offset:38912
ds_read_b128 a[188:191], v3 offset:39936
v_mfma_f32_16x16x32_bf16 v[16:19], a[148:151], v[148:151], v[16:19]
v_exp_f32 v50, v50
v_mfma_f32_16x16x32_bf16 v[20:23], a[148:151], v[164:167], v[20:23]
ds_read_b128 a[192:195], v3 offset:43008
ds_read_b128 a[196:199], v3 offset:44032
v_mfma_f32_16x16x32_bf16 v[24:27], a[148:151], v[180:183], v[24:27]
v_exp_f32 v51, v51
v_mfma_f32_16x16x32_bf16 v[28:31], a[148:151], v[196:199], v[28:31]
ds_read_b128 a[200:203], v3 offset:47104
ds_read_b128 a[204:207], v3 offset:48128
v_mfma_f32_16x16x32_bf16 v[16:19], a[152:155], v[152:155], v[16:19]
v_exp_f32 v64, v64
v_mfma_f32_16x16x32_bf16 v[20:23], a[152:155], v[168:171], v[20:23]
v_cvt_pk_bf16_f32 v96, v48, v49
v_cvt_pk_bf16_f32 v97, v50, v51
v_mfma_f32_16x16x32_bf16 v[24:27], a[152:155], v[184:187], v[24:27]
v_exp_f32 v65, v65
v_mfma_f32_16x16x32_bf16 v[28:31], a[152:155], v[200:203], v[28:31]
v_cvt_pk_bf16_f32 v98, v64, v65
v_mfma_f32_16x16x32_bf16 v[16:19], a[156:159], v[156:159], v[16:19]
v_exp_f32 v66, v66
v_mfma_f32_16x16x32_bf16 v[20:23], a[156:159], v[172:175], v[20:23]
v_mfma_f32_16x16x32_bf16 v[24:27], a[156:159], v[188:191], v[24:27]
v_exp_f32 v67, v67
v_mfma_f32_16x16x32_bf16 v[28:31], a[156:159], v[204:207], v[28:31]
v_cvt_pk_bf16_f32 v99, v66, v67
v_mfma_f32_16x16x32_bf16 v[32:35], a[160:163], v[144:147], v[128:131]
v_exp_f32 v52, v52
v_mfma_f32_16x16x32_bf16 v[36:39], a[160:163], v[160:163], v[132:135]
s_waitcnt vmcnt(12)
v_mfma_f32_16x16x32_bf16 v[40:43], a[160:163], v[176:179], v[136:139]
v_exp_f32 v53, v53
v_mfma_f32_16x16x32_bf16 v[44:47], a[160:163], v[192:195], v[140:143]
v_cvt_pk_bf16_f32 v100, v52, v53
s_barrier
v_mfma_f32_16x16x32_bf16 v[32:35], a[164:167], v[148:151], v[32:35]
v_exp_f32 v54, v54
v_mfma_f32_16x16x32_bf16 v[36:39], a[164:167], v[164:167], v[36:39]
s_add_u32 m0, s40, 16384
v_mfma_f32_16x16x32_bf16 v[40:43], a[164:167], v[180:183], v[40:43]
v_exp_f32 v55, v55
v_mfma_f32_16x16x32_bf16 v[44:47], a[164:167], v[196:199], v[44:47]
v_cvt_pk_bf16_f32 v101, v54, v55
v_mfma_f32_16x16x32_bf16 v[32:35], a[168:171], v[152:155], v[32:35]
v_exp_f32 v68, v68
v_mfma_f32_16x16x32_bf16 v[36:39], a[168:171], v[168:171], v[36:39]
buffer_load_dwordx4 v248, s[16:19], s41 offen offset:0 lds
v_mfma_f32_16x16x32_bf16 v[40:43], a[168:171], v[184:187], v[40:43]
v_exp_f32 v69, v69
v_mfma_f32_16x16x32_bf16 v[44:47], a[168:171], v[200:203], v[44:47]
v_cvt_pk_bf16_f32 v102, v68, v69
v_mfma_f32_16x16x32_bf16 v[32:35], a[172:175], v[156:159], v[32:35]
v_exp_f32 v70, v70
v_mfma_f32_16x16x32_bf16 v[36:39], a[172:175], v[172:175], v[36:39]
v_mfma_f32_16x16x32_bf16 v[40:43], a[172:175], v[188:191], v[40:43]
v_exp_f32 v71, v71
v_mfma_f32_16x16x32_bf16 v[44:47], a[172:175], v[204:207], v[44:47]
v_cvt_pk_bf16_f32 v103, v70, v71
v_mfma_f32_16x16x32_bf16 a[128:131], a[208:211], v[80:83], a[128:131]
v_mfma_f32_16x16x32_bf16 a[132:135], a[208:211], v[84:87], a[132:135]
v_exp_f32 v56, v56
v_mfma_f32_16x16x32_bf16 a[136:139], a[208:211], v[88:91], a[136:139]
buffer_load_dwordx4 v248, s[16:19], s41 offen offset:1024 lds
v_mfma_f32_16x16x32_bf16 a[140:143], a[208:211], v[92:95], a[140:143]
v_exp_f32 v57, v57
s_waitcnt lgkmcnt(0)
v_mfma_f32_16x16x32_bf16 a[0:3], a[176:179], v[80:83], a[0:3]
ds_read_b128 a[144:147], v2 offset:16384
v_cvt_pk_bf16_f32 v104, v56, v57
v_mfma_f32_16x16x32_bf16 a[32:35], a[176:179], v[84:87], a[32:35]
v_exp_f32 v58, v58
v_mfma_f32_16x16x32_bf16 a[64:67], a[176:179], v[88:91], a[64:67]
ds_read_b128 a[148:151], v2 offset:17408
ds_read_b128 a[152:155], v2 offset:20480
v_mfma_f32_16x16x32_bf16 a[96:99], a[176:179], v[92:95], a[96:99]
v_exp_f32 v59, v59
v_mfma_f32_16x16x32_bf16 a[4:7], a[180:183], v[80:83], a[4:7]
ds_read_b128 a[156:159], v2 offset:21504
v_cvt_pk_bf16_f32 v105, v58, v59
v_mfma_f32_16x16x32_bf16 a[36:39], a[180:183], v[84:87], a[36:39]
v_exp_f32 v72, v72
v_mfma_f32_16x16x32_bf16 a[68:71], a[180:183], v[88:91], a[68:71]
buffer_load_dwordx4 v248, s[16:19], s41 offen offset:2048 lds
v_mfma_f32_16x16x32_bf16 a[100:103], a[180:183], v[92:95], a[100:103]
v_exp_f32 v73, v73
v_mfma_f32_16x16x32_bf16 a[8:11], a[184:187], v[80:83], a[8:11]
ds_read_b128 a[160:163], v2 offset:24576
v_cvt_pk_bf16_f32 v106, v72, v73
v_mfma_f32_16x16x32_bf16 a[40:43], a[184:187], v[84:87], a[40:43]
v_exp_f32 v74, v74
v_mfma_f32_16x16x32_bf16 a[72:75], a[184:187], v[88:91], a[72:75]
ds_read_b128 a[164:167], v2 offset:25600
ds_read_b128 a[168:171], v2 offset:28672
v_mfma_f32_16x16x32_bf16 a[104:107], a[184:187], v[92:95], a[104:107]
v_exp_f32 v75, v75
v_mfma_f32_16x16x32_bf16 a[12:15], a[188:191], v[80:83], a[12:15]
ds_read_b128 a[172:175], v2 offset:29696
v_cvt_pk_bf16_f32 v107, v74, v75
v_mfma_f32_16x16x32_bf16 a[44:47], a[188:191], v[84:87], a[44:47]
v_exp_f32 v60, v60
v_mfma_f32_16x16x32_bf16 a[76:79], a[188:191], v[88:91], a[76:79]
buffer_load_dwordx4 v248, s[16:19], s41 offen offset:3072 lds
v_mfma_f32_16x16x32_bf16 a[108:111], a[188:191], v[92:95], a[108:111]
v_exp_f32 v61, v61
v_mfma_f32_16x16x32_bf16 a[16:19], a[192:195], v[80:83], a[16:19]
v_cvt_pk_bf16_f32 v108, v60, v61
v_mfma_f32_16x16x32_bf16 a[48:51], a[192:195], v[84:87], a[48:51]
v_exp_f32 v62, v62
v_mfma_f32_16x16x32_bf16 a[80:83], a[192:195], v[88:91], a[80:83]
v_mfma_f32_16x16x32_bf16 a[112:115], a[192:195], v[92:95], a[112:115]
v_exp_f32 v63, v63
v_mfma_f32_16x16x32_bf16 a[20:23], a[196:199], v[80:83], a[20:23]
v_cvt_pk_bf16_f32 v109, v62, v63
v_mfma_f32_16x16x32_bf16 a[52:55], a[196:199], v[84:87], a[52:55]
v_exp_f32 v76, v76
v_mfma_f32_16x16x32_bf16 a[84:87], a[196:199], v[88:91], a[84:87]
v_mfma_f32_16x16x32_bf16 a[116:119], a[196:199], v[92:95], a[116:119]
v_exp_f32 v77, v77
v_mfma_f32_16x16x32_bf16 a[24:27], a[200:203], v[80:83], a[24:27]
v_cvt_pk_bf16_f32 v110, v76, v77
v_mfma_f32_16x16x32_bf16 a[56:59], a[200:203], v[84:87], a[56:59]
v_exp_f32 v78, v78
v_mfma_f32_16x16x32_bf16 a[88:91], a[200:203], v[88:91], a[88:91]
v_mfma_f32_16x16x32_bf16 a[120:123], a[200:203], v[92:95], a[120:123]
v_exp_f32 v79, v79
v_mfma_f32_16x16x32_bf16 a[28:31], a[204:207], v[80:83], a[28:31]
v_cvt_pk_bf16_f32 v111, v78, v79
v_mfma_f32_16x16x32_bf16 a[60:63], a[204:207], v[84:87], a[60:63]
v_mfma_f32_16x16x32_bf16 a[92:95], a[204:207], v[88:91], a[92:95]
v_mfma_f32_16x16x32_bf16 a[124:127], a[204:207], v[92:95], a[124:127]
s_waitcnt lgkmcnt(0)
s_cmp_eq_u32 s36, 2
s_cbranch_scc0 K2_MK13
v_cndmask_b32 v112, v216, v208, s[60:61]
v_cndmask_b32 v113, v216, v208, s[62:63]
v_cndmask_b32 v114, v216, v208, s[64:65]
v_cndmask_b32 v115, v216, v208, s[66:67]
K2_MK13:
s_cmp_lt_u32 s36, 2
s_cbranch_scc0 K2_ML13
v_mov_b32 v112, v216
v_mov_b32 v113, v216
v_mov_b32 v114, v216
v_mov_b32 v115, v216
K2_ML13:
s_cmp_eq_u32 s36, 3
s_cbranch_scc0 K2_MK14
v_cndmask_b32 v128, v216, v208, s[60:61]
v_cndmask_b32 v129, v216, v208, s[62:63]
v_cndmask_b32 v130, v216, v208, s[64:65]
v_cndmask_b32 v131, v216, v208, s[66:67]
K2_MK14:
s_cmp_lt_u32 s36, 3
s_cbranch_scc0 K2_ML14
v_mov_b32 v128, v216
v_mov_b32 v129, v216
v_mov_b32 v130, v216
v_mov_b32 v131, v216
K2_ML14:
s_nop 1
v_mfma_f32_16x16x32_bf16 v[48:51], a[144:147], v[144:147], v[112:115]
v_exp_f32 v16, v16
v_mfma_f32_16x16x32_bf16 v[52:55], a[144:147], v[160:163], v[116:119]
ds_read_b128 a[176:179], v3 offset:51200
ds_read_b128 a[180:183], v3 offset:52224
v_mfma_f32_16x16x32_bf16 v[56:59], a[144:147], v[176:179], v[120:123]
v_exp_f32 v17, v17
v_mfma_f32_16x16x32_bf16 v[60:63], a[144:147], v[192:195], v[124:127]
ds_read_b128 a[184:187], v3 offset:55296
ds_read_b128 a[188:191], v3 offset:56320
v_mfma_f32_16x16x32_bf16 v[48:51], a[148:151], v[148:151], v[48:51]
v_exp_f32 v18, v18
v_mfma_f32_16x16x32_bf16 v[52:55], a[148:151], v[164:167], v[52:55]
ds_read_b128 a[192:195], v3 offset:59392
ds_read_b128 a[196:199], v3 offset:60416
v_mfma_f32_16x16x32_bf16 v[56:59], a[148:151], v[180:183], v[56:59]
v_exp_f32 v19, v19
v_mfma_f32_16x16x32_bf16 v[60:63], a[148:151], v[196:199], v[60:63]
ds_read_b128 a[200:203], v3 offset:63488
ds_read_b128 a[204:207], v3 offset:64512
v_mfma_f32_16x16x32_bf16 v[48:51], a[152:155], v[152:155], v[48:51]
v_exp_f32 v32, v32
v_mfma_f32_16x16x32_bf16 v[52:55], a[152:155], v[168:171], v[52:55]
v_cvt_pk_bf16_f32 v80, v16, v17
v_cvt_pk_bf16_f32 v81, v18, v19
v_mfma_f32_16x16x32_bf16 v[56:59], a[152:155], v[184:187], v[56:59]
v_exp_f32 v33, v33
v_mfma_f32_16x16x32_bf16 v[60:63], a[152:155], v[200:203], v[60:63]
v_cvt_pk_bf16_f32 v82, v32, v33
v_mfma_f32_16x16x32_bf16 v[48:51], a[156:159], v[156:159], v[48:51]
v_exp_f32 v34, v34
v_mfma_f32_16x16x32_bf16 v[52:55], a[156:159], v[172:175], v[52:55]
v_mfma_f32_16x16x32_bf16 v[56:59], a[156:159], v[188:191], v[56:59]
v_exp_f32 v35, v35
v_mfma_f32_16x16x32_bf16 v[60:63], a[156:159], v[204:207], v[60:63]
v_cvt_pk_bf16_f32 v83, v34, v35
v_mfma_f32_16x16x32_bf16 v[64:67], a[160:163], v[144:147], v[128:131]
v_exp_f32 v20, v20
v_mfma_f32_16x16x32_bf16 v[68:71], a[160:163], v[160:163], v[132:135]
s_waitcnt vmcnt(12)
v_mfma_f32_16x16x32_bf16 v[72:75], a[160:163], v[176:179], v[136:139]
v_exp_f32 v21, v21
v_mfma_f32_16x16x32_bf16 v[76:79], a[160:163], v[192:195], v[140:143]
v_cvt_pk_bf16_f32 v84, v20, v21
s_barrier
v_mfma_f32_16x16x32_bf16 v[64:67], a[164:167], v[148:151], v[64:67]
v_exp_f32 v22, v22
v_mfma_f32_16x16x32_bf16 v[68:71], a[164:167], v[164:167], v[68:71]
s_add_u32 m0, s40, 32768
v_mfma_f32_16x16x32_bf16 v[72:75], a[164:167], v[180:183], v[72:75]
v_exp_f32 v23, v23
v_mfma_f32_16x16x32_bf16 v[76:79], a[164:167], v[196:199], v[76:79]
v_cvt_pk_bf16_f32 v85, v22, v23
v_mfma_f32_16x16x32_bf16 v[64:67], a[168:171], v[152:155], v[64:67]
v_exp_f32 v36, v36
v_mfma_f32_16x16x32_bf16 v[68:71], a[168:171], v[168:171], v[68:71]
buffer_load_dwordx4 v249, s[16:19], s41 offen offset:0 lds
v_mfma_f32_16x16x32_bf16 v[72:75], a[168:171], v[184:187], v[72:75]
v_exp_f32 v37, v37
v_mfma_f32_16x16x32_bf16 v[76:79], a[168:171], v[200:203], v[76:79]
v_cvt_pk_bf16_f32 v86, v36, v37
v_mfma_f32_16x16x32_bf16 v[64:67], a[172:175], v[156:159], v[64:67]
v_exp_f32 v38, v38
v_mfma_f32_16x16x32_bf16 v[68:71], a[172:175], v[172:175], v[68:71]
v_mfma_f32_16x16x32_bf16 v[72:75], a[172:175], v[188:191], v[72:75]
v_exp_f32 v39, v39
v_mfma_f32_16x16x32_bf16 v[76:79], a[172:175], v[204:207], v[76:79]
v_cvt_pk_bf16_f32 v87, v38, v39
v_mfma_f32_16x16x32_bf16 a[128:131], a[208:211], v[96:99], a[128:131]
v_mfma_f32_16x16x32_bf16 a[132:135], a[208:211], v[100:103], a[132:135]
v_exp_f32 v24, v24
v_mfma_f32_16x16x32_bf16 a[136:139], a[208:211], v[104:107], a[136:139]
buffer_load_dwordx4 v249, s[16:19], s41 offen offset:1024 lds
v_mfma_f32_16x16x32_bf16 a[140:143], a[208:211], v[108:111], a[140:143]
v_exp_f32 v25, v25
s_waitcnt lgkmcnt(0)
v_mfma_f32_16x16x32_bf16 a[0:3], a[176:179], v[96:99], a[0:3]
ds_read_b128 a[144:147], v2 offset:32768
v_cvt_pk_bf16_f32 v88, v24, v25
v_mfma_f32_16x16x32_bf16 a[32:35], a[176:179], v[100:103], a[32:35]
v_exp_f32 v26, v26
v_mfma_f32_16x16x32_bf16 a[64:67], a[176:179], v[104:107], a[64:67]
ds_read_b128 a[148:151], v2 offset:33792
ds_read_b128 a[152:155], v2 offset:36864
v_mfma_f32_16x16x32_bf16 a[96:99], a[176:179], v[108:111], a[96:99]
v_exp_f32 v27, v27
v_mfma_f32_16x16x32_bf16 a[4:7], a[180:183], v[96:99], a[4:7]
ds_read_b128 a[156:159], v2 offset:37888
v_cvt_pk_bf16_f32 v89, v26, v27
v_mfma_f32_16x16x32_bf16 a[36:39], a[180:183], v[100:103], a[36:39]
v_exp_f32 v40, v40
v_mfma_f32_16x16x32_bf16 a[68:71], a[180:183], v[104:107], a[68:71]
buffer_load_dwordx4 v249, s[16:19], s41 offen offset:2048 lds
v_mfma_f32_16x16x32_bf16 a[100:103], a[180:183], v[108:111], a[100:103]
v_exp_f32 v41, v41
v_mfma_f32_16x16x32_bf16 a[8:11], a[184:187], v[96:99], a[8:11]
ds_read_b128 a[160:163], v2 offset:40960
v_cvt_pk_bf16_f32 v90, v40, v41
v_mfma_f32_16x16x32_bf16 a[40:43], a[184:187], v[100:103], a[40:43]
v_exp_f32 v42, v42
v_mfma_f32_16x16x32_bf16 a[72:75], a[184:187], v[104:107], a[72:75]
ds_read_b128 a[164:167], v2 offset:41984
ds_read_b128 a[168:171], v2 offset:45056
v_mfma_f32_16x16x32_bf16 a[104:107], a[184:187], v[108:111], a[104:107]
v_exp_f32 v43, v43
v_mfma_f32_16x16x32_bf16 a[12:15], a[188:191], v[96:99], a[12:15]
ds_read_b128 a[172:175], v2 offset:46080
v_cvt_pk_bf16_f32 v91, v42, v43
v_mfma_f32_16x16x32_bf16 a[44:47], a[188:191], v[100:103], a[44:47]
v_exp_f32 v28, v28
v_mfma_f32_16x16x32_bf16 a[76:79], a[188:191], v[104:107], a[76:79]
buffer_load_dwordx4 v249, s[16:19], s41 offen offset:3072 lds
v_mfma_f32_16x16x32_bf16 a[108:111], a[188:191], v[108:111], a[108:111]
v_exp_f32 v29, v29
v_mfma_f32_16x16x32_bf16 a[16:19], a[192:195], v[96:99], a[16:19]
v_cvt_pk_bf16_f32 v92, v28, v29
v_mfma_f32_16x16x32_bf16 a[48:51], a[192:195], v[100:103], a[48:51]
v_exp_f32 v30, v30
v_mfma_f32_16x16x32_bf16 a[80:83], a[192:195], v[104:107], a[80:83]
v_mfma_f32_16x16x32_bf16 a[112:115], a[192:195], v[108:111], a[112:115]
v_exp_f32 v31, v31
v_mfma_f32_16x16x32_bf16 a[20:23], a[196:199], v[96:99], a[20:23]
v_cvt_pk_bf16_f32 v93, v30, v31
v_mfma_f32_16x16x32_bf16 a[52:55], a[196:199], v[100:103], a[52:55]
v_exp_f32 v44, v44
v_mfma_f32_16x16x32_bf16 a[84:87], a[196:199], v[104:107], a[84:87]
v_mfma_f32_16x16x32_bf16 a[116:119], a[196:199], v[108:111], a[116:119]
v_exp_f32 v45, v45
v_mfma_f32_16x16x32_bf16 a[24:27], a[200:203], v[96:99], a[24:27]
v_cvt_pk_bf16_f32 v94, v44, v45
v_mfma_f32_16x16x32_bf16 a[56:59], a[200:203], v[100:103], a[56:59]
v_exp_f32 v46, v46
v_mfma_f32_16x16x32_bf16 a[88:91], a[200:203], v[104:107], a[88:91]
v_mfma_f32_16x16x32_bf16 a[120:123], a[200:203], v[108:111], a[120:123]
v_exp_f32 v47, v47
v_mfma_f32_16x16x32_bf16 a[28:31], a[204:207], v[96:99], a[28:31]
v_cvt_pk_bf16_f32 v95, v46, v47
v_mfma_f32_16x16x32_bf16 a[60:63], a[204:207], v[100:103], a[60:63]
v_mfma_f32_16x16x32_bf16 a[92:95], a[204:207], v[104:107], a[92:95]
v_mfma_f32_16x16x32_bf16 a[124:127], a[204:207], v[108:111], a[124:127]
s_waitcnt lgkmcnt(0)
s_cmp_eq_u32 s36, 3
s_cbranch_scc0 K2_MK15
v_cndmask_b32 v116, v216, v209, s[60:61]
v_cndmask_b32 v117, v216, v209, s[62:63]
v_cndmask_b32 v118, v216, v209, s[64:65]
v_cndmask_b32 v119, v216, v209, s[66:67]
K2_MK15:
s_cmp_eq_u32 s36, 2
s_cbranch_scc0 K2_MK16
v_cndmask_b32 v132, v216, v209, s[60:61]
v_cndmask_b32 v133, v216, v209, s[62:63]
v_cndmask_b32 v134, v216, v209, s[64:65]
v_cndmask_b32 v135, v216, v209, s[66:67]
K2_MK16:
s_cmp_gt_u32 s36, 2
s_cbranch_scc0 K2_ML16
v_mov_b32 v132, v216
v_mov_b32 v133, v216
v_mov_b32 v134, v216
v_mov_b32 v135, v216
K2_ML16:
s_nop 1
v_mfma_f32_16x16x32_bf16 v[20:23], a[144:147], v[160:163], v[116:119]
v_exp_f32 v48, v48
v_mfma_f32_16x16x32_bf16 v[24:27], a[144:147], v[176:179], v[120:123]
ds_read_b128 a[176:179], v2 offset:2048
ds_read_b128 a[180:183], v2 offset:3072
v_mfma_f32_16x16x32_bf16 v[28:31], a[144:147], v[192:195], v[124:127]
v_exp_f32 v49, v49
v_mfma_f32_16x16x32_bf16 v[20:23], a[148:151], v[164:167], v[20:23]
ds_read_b128 a[184:187], v2 offset:6144
ds_read_b128 a[188:191], v2 offset:7168
v_mfma_f32_16x16x32_bf16 v[24:27], a[148:151], v[180:183], v[24:27]
v_exp_f32 v50, v50
v_mfma_f32_16x16x32_bf16 v[28:31], a[148:151], v[196:199], v[28:31]
ds_read_b128 a[192:195], v2 offset:10240
ds_read_b128 a[196:199], v2 offset:11264
v_mfma_f32_16x16x32_bf16 v[20:23], a[152:155], v[168:171], v[20:23]
v_exp_f32 v51, v51
v_mfma_f32_16x16x32_bf16 v[24:27], a[152:155], v[184:187], v[24:27]
ds_read_b128 a[200:203], v2 offset:14336
ds_read_b128 a[204:207], v2 offset:15360
v_mfma_f32_16x16x32_bf16 v[28:31], a[152:155], v[200:203], v[28:31]
v_exp_f32 v64, v64
v_mfma_f32_16x16x32_bf16 v[20:23], a[156:159], v[172:175], v[20:23]
v_exp_f32 v65, v65
v_mfma_f32_16x16x32_bf16 v[24:27], a[156:159], v[188:191], v[24:27]
v_exp_f32 v66, v66
v_mfma_f32_16x16x32_bf16 v[28:31], a[156:159], v[204:207], v[28:31]
v_cvt_pk_bf16_f32 v96, v48, v49
v_cvt_pk_bf16_f32 v97, v50, v51
v_mfma_f32_16x16x32_bf16 v[36:39], a[160:163], v[160:163], v[132:135]
v_exp_f32 v67, v67
v_mfma_f32_16x16x32_bf16 v[40:43], a[160:163], v[176:179], v[136:139]
v_cvt_pk_bf16_f32 v98, v64, v65
v_cvt_pk_bf16_f32 v99, v66, v67
v_mfma_f32_16x16x32_bf16 v[44:47], a[160:163], v[192:195], v[140:143]
v_exp_f32 v52, v52
v_mfma_f32_16x16x32_bf16 v[36:39], a[164:167], v[164:167], v[36:39]
s_waitcnt vmcnt(12)
v_mfma_f32_16x16x32_bf16 v[40:43], a[164:167], v[180:183], v[40:43]
v_exp_f32 v53, v53
v_mfma_f32_16x16x32_bf16 v[44:47], a[164:167], v[196:199], v[44:47]
v_cvt_pk_bf16_f32 v100, v52, v53
s_barrier
v_mfma_f32_16x16x32_bf16 v[36:39], a[168:171], v[168:171], v[36:39]
v_exp_f32 v54, v54
v_mfma_f32_16x16x32_bf16 v[40:43], a[168:171], v[184:187], v[40:43]
v_exp_f32 v55, v55
v_mfma_f32_16x16x32_bf16 v[44:47], a[168:171], v[200:203], v[44:47]
v_cvt_pk_bf16_f32 v101, v54, v55
s_add_u32 m0, s40, 49152
v_mfma_f32_16x16x32_bf16 v[36:39], a[172:175], v[172:175], v[36:39]
v_exp_f32 v68, v68
v_mfma_f32_16x16x32_bf16 v[40:43], a[172:175], v[188:191], v[40:43]
buffer_load_dwordx4 v250, s[16:19], s41 offen offset:0 lds
v_mfma_f32_16x16x32_bf16 v[44:47], a[172:175], v[204:207], v[44:47]
v_exp_f32 v69, v69
v_mfma_f32_16x16x32_bf16 a[128:131], a[208:211], v[80:83], a[128:131]
v_cvt_pk_bf16_f32 v102, v68, v69
v_mfma_f32_16x16x32_bf16 a[132:135], a[208:211], v[84:87], a[132:135]
v_exp_f32 v70, v70
v_mfma_f32_16x16x32_bf16 a[136:139], a[208:211], v[88:91], a[136:139]
v_mfma_f32_16x16x32_bf16 a[140:143], a[208:211], v[92:95], a[140:143]
v_exp_f32 v71, v71
s_waitcnt lgkmcnt(0)
v_mfma_f32_16x16x32_bf16 a[0:3], a[176:179], v[80:83], a[0:3]
ds_read_b128 a[144:147], v2 offset:49152
v_cvt_pk_bf16_f32 v103, v70, v71
v_mfma_f32_16x16x32_bf16 a[32:35], a[176:179], v[84:87], a[32:35]
v_exp_f32 v56, v56
v_mfma_f32_16x16x32_bf16 a[64:67], a[176:179], v[88:91], a[64:67]
v_exp_f32 v57, v57
v_mfma_f32_16x16x32_bf16 a[96:99], a[176:179], v[92:95], a[96:99]
ds_read_b128 a[148:151], v2 offset:50176
v_cvt_pk_bf16_f32 v104, v56, v57
v_mfma_f32_16x16x32_bf16 a[4:7], a[180:183], v[80:83], a[4:7]
v_exp_f32 v58, v58
v_mfma_f32_16x16x32_bf16 a[36:39], a[180:183], v[84:87], a[36:39]
buffer_load_dwordx4 v250, s[16:19], s41 offen offset:1024 lds
v_mfma_f32_16x16x32_bf16 a[68:71], a[180:183], v[88:91], a[68:71]
v_exp_f32 v59, v59
v_mfma_f32_16x16x32_bf16 a[100:103], a[180:183], v[92:95], a[100:103]
ds_read_b128 a[152:155], v2 offset:53248
v_cvt_pk_bf16_f32 v105, v58, v59
v_mfma_f32_16x16x32_bf16 a[8:11], a[184:187], v[80:83], a[8:11]
v_exp_f32 v72, v72
v_mfma_f32_16x16x32_bf16 a[40:43], a[184:187], v[84:87], a[40:43]
ds_read_b128 a[156:159], v2 offset:54272
ds_read_b128 a[160:163], v2 offset:57344
v_mfma_f32_16x16x32_bf16 a[72:75], a[184:187], v[88:91], a[72:75]
v_exp_f32 v73, v73
v_mfma_f32_16x16x32_bf16 a[104:107], a[184:187], v[92:95], a[104:107]
v_exp_f32 v74, v74
v_mfma_f32_16x16x32_bf16 a[12:15], a[188:191], v[80:83], a[12:15]
ds_read_b128 a[164:167], v2 offset:58368
v_cvt_pk_bf16_f32 v106, v72, v73
v_mfma_f32_16x16x32_bf16 a[44:47], a[188:191], v[84:87], a[44:47]
v_exp_f32 v75, v75
v_mfma_f32_16x16x32_bf16 a[76:79], a[188:191], v[88:91], a[76:79]
ds_read_b128 a[168:171], v2 offset:61440
v_cvt_pk_bf16_f32 v107, v74, v75
v_mfma_f32_16x16x32_bf16 a[108:111], a[188:191], v[92:95], a[108:111]
v_exp_f32 v60, v60
v_mfma_f32_16x16x32_bf16 a[16:19], a[192:195], v[80:83], a[16:19]
buffer_load_dwordx4 v250, s[16:19], s41 offen offset:2048 lds
v_mfma_f32_16x16x32_bf16 a[48:51], a[192:195], v[84:87], a[48:51]
v_exp_f32 v61, v61
v_mfma_f32_16x16x32_bf16 a[80:83], a[192:195], v[88:91], a[80:83]
ds_read_b128 a[172:175], v2 offset:62464
v_cvt_pk_bf16_f32 v108, v60, v61
v_mfma_f32_16x16x32_bf16 a[112:115], a[192:195], v[92:95], a[112:115]
v_exp_f32 v62, v62
v_mfma_f32_16x16x32_bf16 a[20:23], a[196:199], v[80:83], a[20:23]
v_exp_f32 v63, v63
v_mfma_f32_16x16x32_bf16 a[52:55], a[196:199], v[84:87], a[52:55]
v_cvt_pk_bf16_f32 v109, v62, v63
v_mfma_f32_16x16x32_bf16 a[84:87], a[196:199], v[88:91], a[84:87]
v_exp_f32 v76, v76
v_mfma_f32_16x16x32_bf16 a[116:119], a[196:199], v[92:95], a[116:119]
buffer_load_dwordx4 v250, s[16:19], s41 offen offset:3072 lds
v_mfma_f32_16x16x32_bf16 a[24:27], a[200:203], v[80:83], a[24:27]
v_exp_f32 v77, v77
v_mfma_f32_16x16x32_bf16 a[56:59], a[200:203], v[84:87], a[56:59]
v_cvt_pk_bf16_f32 v110, v76, v77
v_mfma_f32_16x16x32_bf16 a[88:91], a[200:203], v[88:91], a[88:91]
v_exp_f32 v78, v78
v_mfma_f32_16x16x32_bf16 a[120:123], a[200:203], v[92:95], a[120:123]
v_mfma_f32_16x16x32_bf16 a[28:31], a[204:207], v[80:83], a[28:31]
v_exp_f32 v79, v79
v_mfma_f32_16x16x32_bf16 a[60:63], a[204:207], v[84:87], a[60:63]
v_cvt_pk_bf16_f32 v111, v78, v79
v_mfma_f32_16x16x32_bf16 a[92:95], a[204:207], v[88:91], a[92:95]
v_mfma_f32_16x16x32_bf16 a[124:127], a[204:207], v[92:95], a[124:127]
s_waitcnt lgkmcnt(0)
s_cmp_eq_u32 s36, 1
s_cbranch_scc0 K2_MK17
v_cndmask_b32 v116, v216, v209, s[60:61]
v_cndmask_b32 v117, v216, v209, s[62:63]
v_cndmask_b32 v118, v216, v209, s[64:65]
v_cndmask_b32 v119, v216, v209, s[66:67]
K2_MK17:
s_cmp_gt_u32 s36, 1
s_cbranch_scc0 K2_ML17
v_mov_b32 v116, v216
v_mov_b32 v117, v216
v_mov_b32 v118, v216
v_mov_b32 v119, v216
K2_ML17:
s_cmp_eq_u32 s36, 0
s_cbranch_scc0 K2_MK18
v_cndmask_b32 v132, v216, v209, s[60:61]
v_cndmask_b32 v133, v216, v209, s[62:63]
v_cndmask_b32 v134, v216, v209, s[64:65]
v_cndmask_b32 v135, v216, v209, s[66:67]
K2_MK18:
s_cmp_gt_u32 s36, 0
s_cbranch_scc0 K2_ML18
v_mov_b32 v132, v216
v_mov_b32 v133, v216
v_mov_b32 v134, v216
v_mov_b32 v135, v216
K2_ML18:
s_nop 1
v_mfma_f32_16x16x32_bf16 v[52:55], a[144:147], v[160:163], v[116:119]
v_exp_f32 v20, v20
v_mfma_f32_16x16x32_bf16 v[56:59], a[144:147], v[176:179], v[120:123]
ds_read_b128 a[176:179], v2 offset:18432
ds_read_b128 a[180:183], v2 offset:19456
v_mfma_f32_16x16x32_bf16 v[60:63], a[144:147], v[192:195], v[124:127]
v_exp_f32 v21, v21
v_mfma_f32_16x16x32_bf16 v[52:55], a[148:151], v[164:167], v[52:55]
ds_read_b128 a[184:187], v2 offset:22528
ds_read_b128 a[188:191], v2 offset:23552
v_mfma_f32_16x16x32_bf16 v[56:59], a[148:151], v[180:183], v[56:59]
v_exp_f32 v22, v22
v_mfma_f32_16x16x32_bf16 v[60:63], a[148:151], v[196:199], v[60:63]
ds_read_b128 a[192:195], v2 offset:26624
ds_read_b128 a[196:199], v2 offset:27648
v_mfma_f32_16x16x32_bf16 v[52:55], a[152:155], v[168:171], v[52:55]
v_cvt_pk_bf16_f32 v84, v20, v21
v_mfma_f32_16x16x32_bf16 v[56:59], a[152:155], v[184:187], v[56:59]
ds_read_b128 a[200:203], v2 offset:30720
ds_read_b128 a[204:207], v2 offset:31744
v_mfma_f32_16x16x32_bf16 v[60:63], a[152:155], v[200:203], v[60:63]
v_exp_f32 v23, v23
v_mfma_f32_16x16x32_bf16 v[52:55], a[156:159], v[172:175], v[52:55]
v_exp_f32 v36, v36
v_mfma_f32_16x16x32_bf16 v[56:59], a[156:159], v[188:191], v[56:59]
v_cvt_pk_bf16_f32 v85, v22, v23
v_mfma_f32_16x16x32_bf16 v[60:63], a[156:159], v[204:207], v[60:63]
v_mfma_f32_16x16x32_bf16 v[68:71], a[160:163], v[160:163], v[132:135]
v_exp_f32 v37, v37
v_mfma_f32_16x16x32_bf16 v[72:75], a[160:163], v[176:179], v[136:139]
v_cvt_pk_bf16_f32 v86, v36, v37
v_mfma_f32_16x16x32_bf16 v[76:79], a[160:163], v[192:195], v[140:143]
v_exp_f32 v38, v38
v_mfma_f32_16x16x32_bf16 v[68:71], a[164:167], v[164:167], v[68:71]
s_waitcnt vmcnt(12)
v_mfma_f32_16x16x32_bf16 v[72:75], a[164:167], v[180:183], v[72:75]
v_exp_f32 v39, v39
v_mfma_f32_16x16x32_bf16 v[76:79], a[164:167], v[196:199], v[76:79]
v_cvt_pk_bf16_f32 v87, v38, v39
s_barrier
v_mfma_f32_16x16x32_bf16 v[68:71], a[168:171], v[168:171], v[68:71]
s_add_u32 m0, s39, 0
v_mfma_f32_16x16x32_bf16 v[72:75], a[168:171], v[184:187], v[72:75]
v_exp_f32 v24, v24
v_mfma_f32_16x16x32_bf16 v[76:79], a[168:171], v[200:203], v[76:79]
buffer_load_dwordx4 v251, s[16:19], s41 offen offset:0 lds
v_mfma_f32_16x16x32_bf16 v[68:71], a[172:175], v[172:175], v[68:71]
v_exp_f32 v25, v25
v_mfma_f32_16x16x32_bf16 v[72:75], a[172:175], v[188:191], v[72:75]
v_cvt_pk_bf16_f32 v88, v24, v25
v_mfma_f32_16x16x32_bf16 v[76:79], a[172:175], v[204:207], v[76:79]
v_mfma_f32_16x16x32_bf16 a[128:131], a[208:211], v[96:99], a[128:131]
v_exp_f32 v26, v26
v_mfma_f32_16x16x32_bf16 a[132:135], a[208:211], v[100:103], a[132:135]
v_mfma_f32_16x16x32_bf16 a[136:139], a[208:211], v[104:107], a[136:139]
v_exp_f32 v27, v27
v_mfma_f32_16x16x32_bf16 a[140:143], a[208:211], v[108:111], a[140:143]
v_cvt_pk_bf16_f32 v89, v26, v27
s_waitcnt lgkmcnt(0)
v_mfma_f32_16x16x32_bf16 a[0:3], a[176:179], v[96:99], a[0:3]
buffer_load_dwordx4 v251, s[16:19], s41 offen offset:1024 lds
v_mfma_f32_16x16x32_bf16 a[32:35], a[176:179], v[100:103], a[32:35]
v_exp_f32 v40, v40
v_mfma_f32_16x16x32_bf16 a[64:67], a[176:179], v[104:107], a[64:67]
ds_read_b128 a[144:147], v3 offset:0
ds_read_b128 a[148:151], v3 offset:1024
v_mfma_f32_16x16x32_bf16 a[96:99], a[176:179], v[108:111], a[96:99]
v_exp_f32 v41, v41
v_mfma_f32_16x16x32_bf16 a[4:7], a[180:183], v[96:99], a[4:7]
ds_read_b128 a[152:155], v3 offset:4096
v_cvt_pk_bf16_f32 v90, v40, v41
v_mfma_f32_16x16x32_bf16 a[36:39], a[180:183], v[100:103], a[36:39]
v_exp_f32 v42, v42
v_mfma_f32_16x16x32_bf16 a[68:71], a[180:183], v[104:107], a[68:71]
ds_read_b128 a[156:159], v3 offset:5120
ds_read_b128 a[160:163], v3 offset:8192
v_mfma_f32_16x16x32_bf16 a[100:103], a[180:183], v[108:111], a[100:103]
buffer_load_dwordx4 v251, s[16:19], s41 offen offset:2048 lds
v_mfma_f32_16x16x32_bf16 a[8:11], a[184:187], v[96:99], a[8:11]
v_exp_f32 v43, v43
v_mfma_f32_16x16x32_bf16 a[40:43], a[184:187], v[100:103], a[40:43]
ds_read_b128 a[164:167], v3 offset:9216
v_cvt_pk_bf16_f32 v91, v42, v43
v_mfma_f32_16x16x32_bf16 a[72:75], a[184:187], v[104:107], a[72:75]
v_exp_f32 v28, v28
v_mfma_f32_16x16x32_bf16 a[104:107], a[184:187], v[108:111], a[104:107]
ds_read_b128 a[168:171], v3 offset:12288
ds_read_b128 a[172:175], v3 offset:13312
v_mfma_f32_16x16x32_bf16 a[12:15], a[188:191], v[96:99], a[12:15]
v_mfma_f32_16x16x32_bf16 a[44:47], a[188:191], v[100:103], a[44:47]
v_exp_f32 v29, v29
v_mfma_f32_16x16x32_bf16 a[76:79], a[188:191], v[104:107], a[76:79]
v_cvt_pk_bf16_f32 v92, v28, v29
v_mfma_f32_16x16x32_bf16 a[108:111], a[188:191], v[108:111], a[108:111]
v_exp_f32 v30, v30
v_mfma_f32_16x16x32_bf16 a[16:19], a[192:195], v[96:99], a[16:19]
buffer_load_dwordx4 v251, s[16:19], s41 offen offset:3072 lds
v_mfma_f32_16x16x32_bf16 a[48:51], a[192:195], v[100:103], a[48:51]
v_exp_f32 v31, v31
v_mfma_f32_16x16x32_bf16 a[80:83], a[192:195], v[104:107], a[80:83]
v_cvt_pk_bf16_f32 v93, v30, v31
v_mfma_f32_16x16x32_bf16 a[112:115], a[192:195], v[108:111], a[112:115]
v_mfma_f32_16x16x32_bf16 a[20:23], a[196:199], v[96:99], a[20:23]
v_exp_f32 v44, v44
v_mfma_f32_16x16x32_bf16 a[52:55], a[196:199], v[100:103], a[52:55]
v_mfma_f32_16x16x32_bf16 a[84:87], a[196:199], v[104:107], a[84:87]
v_exp_f32 v45, v45
v_mfma_f32_16x16x32_bf16 a[116:119], a[196:199], v[108:111], a[116:119]
v_cvt_pk_bf16_f32 v94, v44, v45
v_mfma_f32_16x16x32_bf16 a[24:27], a[200:203], v[96:99], a[24:27]
v_mfma_f32_16x16x32_bf16 a[56:59], a[200:203], v[100:103], a[56:59]
v_exp_f32 v46, v46
v_mfma_f32_16x16x32_bf16 a[88:91], a[200:203], v[104:107], a[88:91]
v_mfma_f32_16x16x32_bf16 a[120:123], a[200:203], v[108:111], a[120:123]
v_exp_f32 v47, v47
v_mfma_f32_16x16x32_bf16 a[28:31], a[204:207], v[96:99], a[28:31]
v_cvt_pk_bf16_f32 v95, v46, v47
v_mfma_f32_16x16x32_bf16 a[60:63], a[204:207], v[100:103], a[60:63]
v_xor_b32 v2, 0x10000, v2
v_xor_b32 v3, 0x10000, v3
v_mfma_f32_16x16x32_bf16 a[92:95], a[204:207], v[104:107], a[92:95]
s_xor_b32 s39, s39, 0x10000
s_xor_b32 s40, s40, 0x10000
v_mfma_f32_16x16x32_bf16 a[124:127], a[204:207], v[108:111], a[124:127]
s_waitcnt lgkmcnt(0)
s_add_u32 s41, s41, 65536
K2_TRANS:
s_cmp_eq_u32 s37, 7
s_cbranch_scc0 trans_NM0_2
s_cmp_eq_u32 s36, 0
s_cbranch_scc0 K2_MK19
v_cndmask_b32 v120, v216, v210, s[60:61]
v_cndmask_b32 v121, v216, v210, s[62:63]
v_cndmask_b32 v122, v216, v210, s[64:65]
v_cndmask_b32 v123, v216, v210, s[66:67]
K2_MK19:
s_cmp_eq_u32 s36, 1
s_cbranch_scc0 K2_MK20
v_cndmask_b32 v136, v216, v210, s[60:61]
v_cndmask_b32 v137, v216, v210, s[62:63]
v_cndmask_b32 v138, v216, v210, s[64:65]
v_cndmask_b32 v139, v216, v210, s[66:67]
K2_MK20:
s_cmp_lt_u32 s36, 1
s_cbranch_scc0 K2_ML20
v_mov_b32 v136, v216
v_mov_b32 v137, v216
v_mov_b32 v138, v216
v_mov_b32 v139, v216
K2_ML20:
trans_NM0_2:
s_nop 1
v_mfma_f32_16x16x32_bf16 v[24:27], a[144:147], v[176:179], v[120:123]
v_exp_f32 v52, v52
v_mfma_f32_16x16x32_bf16 v[28:31], a[144:147], v[192:195], v[124:127]
ds_read_b128 a[176:179], v3 offset:34816
ds_read_b128 a[180:183], v3 offset:35840
v_mfma_f32_16x16x32_bf16 v[24:27], a[148:151], v[180:183], v[24:27]
v_exp_f32 v53, v53
v_mfma_f32_16x16x32_bf16 v[28:31], a[148:151], v[196:199], v[28:31]
ds_read_b128 a[184:187], v3 offset:38912
ds_read_b128 a[188:191], v3 offset:39936
v_mfma_f32_16x16x32_bf16 v[24:27], a[152:155], v[184:187], v[24:27]
v_exp_f32 v54, v54
v_mfma_f32_16x16x32_bf16 v[28:31], a[152:155], v[200:203], v[28:31]
ds_read_b128 a[192:195], v3 offset:43008
ds_read_b128 a[196:199], v3 offset:44032
v_mfma_f32_16x16x32_bf16 v[24:27], a[156:159], v[188:191], v[24:27]
v_exp_f32 v55, v55
v_mfma_f32_16x16x32_bf16 v[28:31], a[156:159], v[204:207], v[28:31]
ds_read_b128 a[200:203], v3 offset:47104
ds_read_b128 a[204:207], v3 offset:48128
v_mfma_f32_16x16x32_bf16 v[40:43], a[160:163], v[176:179], v[136:139]
v_exp_f32 v68, v68
v_mfma_f32_16x16x32_bf16 v[44:47], a[160:163], v[192:195], v[140:143]
v_exp_f32 v69, v69
v_mfma_f32_16x16x32_bf16 v[40:43], a[164:167], v[180:183], v[40:43]
v_exp_f32 v70, v70
v_mfma_f32_16x16x32_bf16 v[44:47], a[164:167], v[196:199], v[44:47]
v_exp_f32 v71, v71
v_mfma_f32_16x16x32_bf16 v[40:43], a[168:171], v[184:187], v[40:43]
v_cvt_pk_bf16_f32 v100, v52, v53
v_cvt_pk_bf16_f32 v101, v54, v55
v_mfma_f32_16x16x32_bf16 v[44:47], a[168:171], v[200:203], v[44:47]
v_exp_f32 v56, v56
v_mfma_f32_16x16x32_bf16 v[40:43], a[172:175], v[188:191], v[40:43]
v_cvt_pk_bf16_f32 v102, v68, v69
v_cvt_pk_bf16_f32 v103, v70, v71
v_mfma_f32_16x16x32_bf16 v[44:47], a[172:175], v[204:207], v[44:47]
v_exp_f32 v57, v57
v_mfma_f32_16x16x32_bf16 a[132:135], a[208:211], v[84:87], a[132:135]
v_cvt_pk_bf16_f32 v104, v56, v57
s_waitcnt vmcnt(12)
v_mfma_f32_16x16x32_bf16 a[136:139], a[208:211], v[88:91], a[136:139]
v_exp_f32 v58, v58
v_mfma_f32_16x16x32_bf16 a[140:143], a[208:211], v[92:95], a[140:143]
v_exp_f32 v59, v59
s_waitcnt lgkmcnt(0)
v_mfma_f32_16x16x32_bf16 a[32:35], a[176:179], v[84:87], a[32:35]
v_cvt_pk_bf16_f32 v105, v58, v59
s_barrier
v_mfma_f32_16x16x32_bf16 a[64:67], a[176:179], v[88:91], a[64:67]
v_exp_f32 v72, v72
v_mfma_f32_16x16x32_bf16 a[96:99], a[176:179], v[92:95], a[96:99]
s_add_u32 m0, s40, 16384
ds_read_b128 a[144:147], v2 offset:16384
v_mfma_f32_16x16x32_bf16 a[36:39], a[180:183], v[84:87], a[36:39]
v_exp_f32 v73, v73
v_mfma_f32_16x16x32_bf16 a[68:71], a[180:183], v[88:91], a[68:71]
v_exp_f32 v74, v74
v_mfma_f32_16x16x32_bf16 a[100:103], a[180:183], v[92:95], a[100:103]
ds_read_b128 a[148:151], v2 offset:17408
v_cvt_pk_bf16_f32 v106, v72, v73
v_mfma_f32_16x16x32_bf16 a[40:43], a[184:187], v[84:87], a[40:43]
v_exp_f32 v75, v75
v_mfma_f32_16x16x32_bf16 a[72:75], a[184:187], v[88:91], a[72:75]
ds_read_b128 a[152:155], v2 offset:20480
v_cvt_pk_bf16_f32 v107, v74, v75
v_mfma_f32_16x16x32_bf16 a[104:107], a[184:187], v[92:95], a[104:107]
v_exp_f32 v60, v60
v_mfma_f32_16x16x32_bf16 a[44:47], a[188:191], v[84:87], a[44:47]
buffer_load_dwordx4 v248, s[16:19], s41 offen offset:0 lds
v_mfma_f32_16x16x32_bf16 a[76:79], a[188:191], v[88:91], a[76:79]
v_exp_f32 v61, v61
v_mfma_f32_16x16x32_bf16 a[108:111], a[188:191], v[92:95], a[108:111]
v_exp_f32 v62, v62
v_mfma_f32_16x16x32_bf16 a[48:51], a[192:195], v[84:87], a[48:51]
ds_read_b128 a[156:159], v2 offset:21504
v_cvt_pk_bf16_f32 v108, v60, v61
v_mfma_f32_16x16x32_bf16 a[80:83], a[192:195], v[88:91], a[80:83]
v_exp_f32 v63, v63
v_mfma_f32_16x16x32_bf16 a[112:115], a[192:195], v[92:95], a[112:115]
ds_read_b128 a[160:163], v2 offset:24576
v_cvt_pk_bf16_f32 v109, v62, v63
v_mfma_f32_16x16x32_bf16 a[52:55], a[196:199], v[84:87], a[52:55]
v_exp_f32 v76, v76
v_mfma_f32_16x16x32_bf16 a[84:87], a[196:199], v[88:91], a[84:87]
v_exp_f32 v77, v77
v_mfma_f32_16x16x32_bf16 a[116:119], a[196:199], v[92:95], a[116:119]
ds_read_b128 a[164:167], v2 offset:25600
ds_read_b128 a[168:171], v2 offset:28672
v_cvt_pk_bf16_f32 v110, v76, v77
v_mfma_f32_16x16x32_bf16 a[56:59], a[200:203], v[84:87], a[56:59]
ds_read_b128 a[172:175], v2 offset:29696
v_exp_f32 v78, v78
v_mfma_f32_16x16x32_bf16 a[88:91], a[200:203], v[88:91], a[88:91]
buffer_load_dwordx4 v248, s[16:19], s41 offen offset:1024 lds
v_mfma_f32_16x16x32_bf16 a[120:123], a[200:203], v[92:95], a[120:123]
v_exp_f32 v79, v79
v_mfma_f32_16x16x32_bf16 a[60:63], a[204:207], v[84:87], a[60:63]
v_cvt_pk_bf16_f32 v111, v78, v79
v_mfma_f32_16x16x32_bf16 a[92:95], a[204:207], v[88:91], a[92:95]
buffer_load_dwordx4 v248, s[16:19], s41 offen offset:2048 lds
v_mfma_f32_16x16x32_bf16 a[124:127], a[204:207], v[92:95], a[124:127]
buffer_load_dwordx4 v248, s[16:19], s41 offen offset:3072 lds
s_waitcnt lgkmcnt(0)
s_cmp_eq_u32 s37, 7
s_cbranch_scc0 trans_NM1_2
s_cmp_eq_u32 s36, 2
s_cbranch_scc0 K2_MK21
v_cndmask_b32 v120, v216, v210, s[60:61]
v_cndmask_b32 v121, v216, v210, s[62:63]
v_cndmask_b32 v122, v216, v210, s[64:65]
v_cndmask_b32 v123, v216, v210, s[66:67]
K2_MK21:
s_cmp_lt_u32 s36, 2
s_cbranch_scc0 K2_ML21
v_mov_b32 v120, v216
v_mov_b32 v121, v216
v_mov_b32 v122, v216
v_mov_b32 v123, v216
K2_ML21:
s_cmp_eq_u32 s36, 3
s_cbranch_scc0 K2_MK22
v_cndmask_b32 v136, v216, v210, s[60:61]
v_cndmask_b32 v137, v216, v210, s[62:63]
v_cndmask_b32 v138, v216, v210, s[64:65]
v_cndmask_b32 v139, v216, v210, s[66:67]
K2_MK22:
s_cmp_lt_u32 s36, 3
s_cbranch_scc0 K2_ML22
v_mov_b32 v136, v216
v_mov_b32 v137, v216
v_mov_b32 v138, v216
v_mov_b32 v139, v216
K2_ML22:
trans_NM1_2:
s_nop 1
v_mfma_f32_16x16x32_bf16 v[56:59], a[144:147], v[176:179], v[120:123]
v_exp_f32 v24, v24
v_mfma_f32_16x16x32_bf16 v[60:63], a[144:147], v[192:195], v[124:127]
ds_read_b128 a[176:179], v3 offset:51200
ds_read_b128 a[180:183], v3 offset:52224
v_mfma_f32_16x16x32_bf16 v[56:59], a[148:151], v[180:183], v[56:59]
v_exp_f32 v25, v25
v_mfma_f32_16x16x32_bf16 v[60:63], a[148:151], v[196:199], v[60:63]
ds_read_b128 a[184:187], v3 offset:55296
ds_read_b128 a[188:191], v3 offset:56320
v_mfma_f32_16x16x32_bf16 v[56:59], a[152:155], v[184:187], v[56:59]
v_cvt_pk_bf16_f32 v88, v24, v25
v_mfma_f32_16x16x32_bf16 v[60:63], a[152:155], v[200:203], v[60:63]
ds_read_b128 a[192:195], v3 offset:59392
ds_read_b128 a[196:199], v3 offset:60416
v_mfma_f32_16x16x32_bf16 v[56:59], a[156:159], v[188:191], v[56:59]
v_exp_f32 v26, v26
v_mfma_f32_16x16x32_bf16 v[60:63], a[156:159], v[204:207], v[60:63]
ds_read_b128 a[200:203], v3 offset:63488
ds_read_b128 a[204:207], v3 offset:64512
v_mfma_f32_16x16x32_bf16 v[72:75], a[160:163], v[176:179], v[136:139]
v_exp_f32 v27, v27
v_mfma_f32_16x16x32_bf16 v[76:79], a[160:163], v[192:195], v[140:143]
v_cvt_pk_bf16_f32 v89, v26, v27
v_mfma_f32_16x16x32_bf16 v[72:75], a[164:167], v[180:183], v[72:75]
v_exp_f32 v40, v40
v_mfma_f32_16x16x32_bf16 v[76:79], a[164:167], v[196:199], v[76:79]
s_waitcnt vmcnt(12)
v_mfma_f32_16x16x32_bf16 v[72:75], a[168:171], v[184:187], v[72:75]
v_exp_f32 v41, v41
v_mfma_f32_16x16x32_bf16 v[76:79], a[168:171], v[200:203], v[76:79]
v_cvt_pk_bf16_f32 v90, v40, v41
s_barrier
v_mfma_f32_16x16x32_bf16 v[72:75], a[172:175], v[188:191], v[72:75]
s_add_u32 m0, s40, 32768
v_mfma_f32_16x16x32_bf16 v[76:79], a[172:175], v[204:207], v[76:79]
v_exp_f32 v42, v42
v_mfma_f32_16x16x32_bf16 a[132:135], a[208:211], v[100:103], a[132:135]
buffer_load_dwordx4 v249, s[16:19], s41 offen offset:0 lds
v_mfma_f32_16x16x32_bf16 a[136:139], a[208:211], v[104:107], a[136:139]
v_exp_f32 v43, v43
v_mfma_f32_16x16x32_bf16 a[140:143], a[208:211], v[108:111], a[140:143]
v_cvt_pk_bf16_f32 v91, v42, v43
s_waitcnt lgkmcnt(0)
v_mfma_f32_16x16x32_bf16 a[32:35], a[176:179], v[100:103], a[32:35]
ds_read_b128 a[144:147], v2 offset:32768
ds_read_b128 a[148:151], v2 offset:33792
v_mfma_f32_16x16x32_bf16 a[64:67], a[176:179], v[104:107], a[64:67]
v_exp_f32 v28, v28
v_mfma_f32_16x16x32_bf16 a[96:99], a[176:179], v[108:111], a[96:99]
buffer_load_dwordx4 v249, s[16:19], s41 offen offset:1024 lds
v_mfma_f32_16x16x32_bf16 a[36:39], a[180:183], v[100:103], a[36:39]
ds_read_b128 a[152:155], v2 offset:36864
ds_read_b128 a[156:159], v2 offset:37888
v_mfma_f32_16x16x32_bf16 a[68:71], a[180:183], v[104:107], a[68:71]
v_exp_f32 v29, v29
v_mfma_f32_16x16x32_bf16 a[100:103], a[180:183], v[108:111], a[100:103]
ds_read_b128 a[160:163], v2 offset:40960
v_cvt_pk_bf16_f32 v92, v28, v29
v_mfma_f32_16x16x32_bf16 a[40:43], a[184:187], v[100:103], a[40:43]
v_exp_f32 v30, v30
v_mfma_f32_16x16x32_bf16 a[72:75], a[184:187], v[104:107], a[72:75]
buffer_load_dwordx4 v249, s[16:19], s41 offen offset:2048 lds
v_mfma_f32_16x16x32_bf16 a[104:107], a[184:187], v[108:111], a[104:107]
ds_read_b128 a[164:167], v2 offset:41984
ds_read_b128 a[168:171], v2 offset:45056
v_mfma_f32_16x16x32_bf16 a[44:47], a[188:191], v[100:103], a[44:47]
v_exp_f32 v31, v31
v_mfma_f32_16x16x32_bf16 a[76:79], a[188:191], v[104:107], a[76:79]
ds_read_b128 a[172:175], v2 offset:46080
v_cvt_pk_bf16_f32 v93, v30, v31
v_mfma_f32_16x16x32_bf16 a[108:111], a[188:191], v[108:111], a[108:111]
v_exp_f32 v44, v44
v_mfma_f32_16x16x32_bf16 a[48:51], a[192:195], v[100:103], a[48:51]
buffer_load_dwordx4 v249, s[16:19], s41 offen offset:3072 lds
v_mfma_f32_16x16x32_bf16 a[80:83], a[192:195], v[104:107], a[80:83]
v_mfma_f32_16x16x32_bf16 a[112:115], a[192:195], v[108:111], a[112:115]
v_exp_f32 v45, v45
v_mfma_f32_16x16x32_bf16 a[52:55], a[196:199], v[100:103], a[52:55]
v_cvt_pk_bf16_f32 v94, v44, v45
v_mfma_f32_16x16x32_bf16 a[84:87], a[196:199], v[104:107], a[84:87]
v_exp_f32 v46, v46
v_mfma_f32_16x16x32_bf16 a[116:119], a[196:199], v[108:111], a[116:119]
v_mfma_f32_16x16x32_bf16 a[56:59], a[200:203], v[100:103], a[56:59]
v_mfma_f32_16x16x32_bf16 a[88:91], a[200:203], v[104:107], a[88:91]
v_exp_f32 v47, v47
v_mfma_f32_16x16x32_bf16 a[120:123], a[200:203], v[108:111], a[120:123]
v_cvt_pk_bf16_f32 v95, v46, v47
v_mfma_f32_16x16x32_bf16 a[60:63], a[204:207], v[100:103], a[60:63]
v_mfma_f32_16x16x32_bf16 a[92:95], a[204:207], v[104:107], a[92:95]
v_mfma_f32_16x16x32_bf16 a[124:127], a[204:207], v[108:111], a[124:127]
s_waitcnt lgkmcnt(0)
s_cmp_eq_u32 s37, 7
s_cbranch_scc0 trans_NM2_2
s_cmp_eq_u32 s36, 3
s_cbranch_scc0 K2_MK23
v_cndmask_b32 v124, v216, v211, s[60:61]
v_cndmask_b32 v125, v216, v211, s[62:63]
v_cndmask_b32 v126, v216, v211, s[64:65]
v_cndmask_b32 v127, v216, v211, s[66:67]
K2_MK23:
s_cmp_eq_u32 s36, 2
s_cbranch_scc0 K2_MK24
v_cndmask_b32 v140, v216, v211, s[60:61]
v_cndmask_b32 v141, v216, v211, s[62:63]
v_cndmask_b32 v142, v216, v211, s[64:65]
v_cndmask_b32 v143, v216, v211, s[66:67]
K2_MK24:
s_cmp_gt_u32 s36, 2
s_cbranch_scc0 K2_ML24
v_mov_b32 v140, v216
v_mov_b32 v141, v216
v_mov_b32 v142, v216
v_mov_b32 v143, v216
K2_ML24:
trans_NM2_2:
s_nop 1
v_mfma_f32_16x16x32_bf16 v[24:27], a[144:147], v[176:179], v[120:123]
v_exp_f32 v56, v56
v_mfma_f32_16x16x32_bf16 v[28:31], a[144:147], v[192:195], v[124:127]
ds_read_b128 a[176:179], v2 offset:2048
ds_read_b128 a[180:183], v2 offset:3072
v_mfma_f32_16x16x32_bf16 v[24:27], a[148:151], v[180:183], v[24:27]
v_exp_f32 v57, v57
v_mfma_f32_16x16x32_bf16 v[28:31], a[148:151], v[196:199], v[28:31]
ds_read_b128 a[184:187], v2 offset:6144
ds_read_b128 a[188:191], v2 offset:7168
v_mfma_f32_16x16x32_bf16 v[24:27], a[152:155], v[184:187], v[24:27]
v_exp_f32 v58, v58
v_mfma_f32_16x16x32_bf16 v[28:31], a[152:155], v[200:203], v[28:31]
ds_read_b128 a[192:195], v2 offset:10240
ds_read_b128 a[196:199], v2 offset:11264
v_mfma_f32_16x16x32_bf16 v[24:27], a[156:159], v[188:191], v[24:27]
v_exp_f32 v59, v59
v_mfma_f32_16x16x32_bf16 v[28:31], a[156:159], v[204:207], v[28:31]
ds_read_b128 a[200:203], v2 offset:14336
ds_read_b128 a[204:207], v2 offset:15360
v_mfma_f32_16x16x32_bf16 v[40:43], a[160:163], v[176:179], v[136:139]
v_exp_f32 v72, v72
v_mfma_f32_16x16x32_bf16 v[44:47], a[160:163], v[192:195], v[140:143]
v_cvt_pk_bf16_f32 v104, v56, v57
s_waitcnt vmcnt(12)
v_mfma_f32_16x16x32_bf16 v[40:43], a[164:167], v[180:183], v[40:43]
v_exp_f32 v73, v73
v_mfma_f32_16x16x32_bf16 v[44:47], a[164:167], v[196:199], v[44:47]
v_cvt_pk_bf16_f32 v105, v58, v59
s_barrier
s_add_u32 m0, s40, 49152
v_mfma_f32_16x16x32_bf16 v[40:43], a[168:171], v[184:187], v[40:43]
v_exp_f32 v74, v74
v_mfma_f32_16x16x32_bf16 v[44:47], a[168:171], v[200:203], v[44:47]
buffer_load_dwordx4 v250, s[16:19], s41 offen offset:0 lds
v_mfma_f32_16x16x32_bf16 v[40:43], a[172:175], v[188:191], v[40:43]
v_exp_f32 v75, v75
v_mfma_f32_16x16x32_bf16 v[44:47], a[172:175], v[204:207], v[44:47]
ds_read_b128 a[144:147], v2 offset:49152
ds_read_b128 a[148:151], v2 offset:50176
v_mfma_f32_16x16x32_bf16 a[136:139], a[208:211], v[88:91], a[136:139]
v_exp_f32 v60, v60
v_mfma_f32_16x16x32_bf16 a[140:143], a[208:211], v[92:95], a[140:143]
ds_read_b128 a[152:155], v2 offset:53248
ds_read_b128 a[156:159], v2 offset:54272
s_waitcnt lgkmcnt(4)
v_mfma_f32_16x16x32_bf16 a[64:67], a[176:179], v[88:91], a[64:67]
v_exp_f32 v61, v61
v_mfma_f32_16x16x32_bf16 a[96:99], a[176:179], v[92:95], a[96:99]
buffer_load_dwordx4 v250, s[16:19], s41 offen offset:1024 lds
v_mfma_f32_16x16x32_bf16 a[68:71], a[180:183], v[88:91], a[68:71]
v_exp_f32 v62, v62
v_mfma_f32_16x16x32_bf16 a[100:103], a[180:183], v[92:95], a[100:103]
ds_read_b128 a[160:163], v2 offset:57344
ds_read_b128 a[164:167], v2 offset:58368
v_mfma_f32_16x16x32_bf16 a[72:75], a[184:187], v[88:91], a[72:75]
v_exp_f32 v63, v63
v_mfma_f32_16x16x32_bf16 a[104:107], a[184:187], v[92:95], a[104:107]
ds_read_b128 a[168:171], v2 offset:61440
ds_read_b128 a[172:175], v2 offset:62464
v_mfma_f32_16x16x32_bf16 a[76:79], a[188:191], v[88:91], a[76:79]
v_exp_f32 v76, v76
v_mfma_f32_16x16x32_bf16 a[108:111], a[188:191], v[92:95], a[108:111]
buffer_load_dwordx4 v250, s[16:19], s41 offen offset:2048 lds
v_mfma_f32_16x16x32_bf16 a[80:83], a[192:195], v[88:91], a[80:83]
v_exp_f32 v77, v77
v_mfma_f32_16x16x32_bf16 a[112:115], a[192:195], v[92:95], a[112:115]
v_cvt_pk_bf16_f32 v106, v72, v73
v_cvt_pk_bf16_f32 v107, v74, v75
v_mfma_f32_16x16x32_bf16 a[84:87], a[196:199], v[88:91], a[84:87]
v_exp_f32 v78, v78
v_mfma_f32_16x16x32_bf16 a[116:119], a[196:199], v[92:95], a[116:119]
v_cvt_pk_bf16_f32 v108, v60, v61
v_cvt_pk_bf16_f32 v109, v62, v63
v_mfma_f32_16x16x32_bf16 a[88:91], a[200:203], v[88:91], a[88:91]
v_exp_f32 v79, v79
v_mfma_f32_16x16x32_bf16 a[120:123], a[200:203], v[92:95], a[120:123]
buffer_load_dwordx4 v250, s[16:19], s41 offen offset:3072 lds
v_mfma_f32_16x16x32_bf16 a[92:95], a[204:207], v[88:91], a[92:95]
v_cvt_pk_bf16_f32 v110, v76, v77
v_mfma_f32_16x16x32_bf16 a[124:127], a[204:207], v[92:95], a[124:127]
v_cvt_pk_bf16_f32 v111, v78, v79
s_waitcnt lgkmcnt(0)
s_cmp_eq_u32 s37, 7
s_cbranch_scc0 trans_NM3_2
s_cmp_eq_u32 s36, 1
s_cbranch_scc0 K2_MK25
v_cndmask_b32 v124, v216, v211, s[60:61]
v_cndmask_b32 v125, v216, v211, s[62:63]
v_cndmask_b32 v126, v216, v211, s[64:65]
v_cndmask_b32 v127, v216, v211, s[66:67]
K2_MK25:
s_cmp_gt_u32 s36, 1
s_cbranch_scc0 K2_ML25
v_mov_b32 v124, v216
v_mov_b32 v125, v216
v_mov_b32 v126, v216
v_mov_b32 v127, v216
K2_ML25:
s_cmp_eq_u32 s36, 0
s_cbranch_scc0 K2_MK26
v_cndmask_b32 v140, v216, v211, s[60:61]
v_cndmask_b32 v141, v216, v211, s[62:63]
v_cndmask_b32 v142, v216, v211, s[64:65]
v_cndmask_b32 v143, v216, v211, s[66:67]
K2_MK26:
s_cmp_gt_u32 s36, 0
s_cbranch_scc0 K2_ML26
v_mov_b32 v140, v216
v_mov_b32 v141, v216
v_mov_b32 v142, v216
v_mov_b32 v143, v216
K2_ML26:
trans_NM3_2:
s_nop 1
v_mfma_f32_16x16x32_bf16 v[56:59], a[144:147], v[176:179], v[120:123]
v_exp_f32 v24, v24
v_mfma_f32_16x16x32_bf16 v[60:63], a[144:147], v[192:195], v[124:127]
ds_read_b128 a[176:179], v2 offset:18432
ds_read_b128 a[180:183], v2 offset:19456
v_mfma_f32_16x16x32_bf16 v[56:59], a[148:151], v[180:183], v[56:59]
v_exp_f32 v25, v25
v_mfma_f32_16x16x32_bf16 v[60:63], a[148:151], v[196:199], v[60:63]
ds_read_b128 a[184:187], v2 offset:22528
ds_read_b128 a[188:191], v2 offset:23552
v_mfma_f32_16x16x32_bf16 v[56:59], a[152:155], v[184:187], v[56:59]
v_exp_f32 v26, v26
v_mfma_f32_16x16x32_bf16 v[60:63], a[152:155], v[200:203], v[60:63]
ds_read_b128 a[192:195], v2 offset:26624
ds_read_b128 a[196:199], v2 offset:27648
v_mfma_f32_16x16x32_bf16 v[56:59], a[156:159], v[188:191], v[56:59]
v_exp_f32 v27, v27
v_mfma_f32_16x16x32_bf16 v[60:63], a[156:159], v[204:207], v[60:63]
ds_read_b128 a[200:203], v2 offset:30720
ds_read_b128 a[204:207], v2 offset:31744
v_mfma_f32_16x16x32_bf16 v[72:75], a[160:163], v[176:179], v[136:139]
v_exp_f32 v40, v40
v_mfma_f32_16x16x32_bf16 v[76:79], a[160:163], v[192:195], v[140:143]
v_cvt_pk_bf16_f32 v88, v24, v25
s_waitcnt vmcnt(12)
v_mfma_f32_16x16x32_bf16 v[72:75], a[164:167], v[180:183], v[72:75]
v_exp_f32 v41, v41
v_mfma_f32_16x16x32_bf16 v[76:79], a[164:167], v[196:199], v[76:79]
v_cvt_pk_bf16_f32 v89, v26, v27
s_barrier
s_add_u32 m0, s39, 0
v_mfma_f32_16x16x32_bf16 v[72:75], a[168:171], v[184:187], v[72:75]
v_exp_f32 v42, v42
v_mfma_f32_16x16x32_bf16 v[76:79], a[168:171], v[200:203], v[76:79]
buffer_load_dwordx4 v251, s[16:19], s41 offen offset:0 lds
v_mfma_f32_16x16x32_bf16 v[72:75], a[172:175], v[188:191], v[72:75]
v_exp_f32 v43, v43
v_mfma_f32_16x16x32_bf16 v[76:79], a[172:175], v[204:207], v[76:79]
ds_read_b128 a[144:147], v3 offset:0
ds_read_b128 a[148:151], v3 offset:1024
v_mfma_f32_16x16x32_bf16 a[136:139], a[208:211], v[104:107], a[136:139]
v_exp_f32 v28, v28
v_mfma_f32_16x16x32_bf16 a[140:143], a[208:211], v[108:111], a[140:143]
ds_read_b128 a[152:155], v3 offset:4096
ds_read_b128 a[156:159], v3 offset:5120
s_waitcnt lgkmcnt(4)
v_mfma_f32_16x16x32_bf16 a[64:67], a[176:179], v[104:107], a[64:67]
v_exp_f32 v29, v29
v_mfma_f32_16x16x32_bf16 a[96:99], a[176:179], v[108:111], a[96:99]
buffer_load_dwordx4 v251, s[16:19], s41 offen offset:1024 lds
v_mfma_f32_16x16x32_bf16 a[68:71], a[180:183], v[104:107], a[68:71]
v_exp_f32 v30, v30
v_mfma_f32_16x16x32_bf16 a[100:103], a[180:183], v[108:111], a[100:103]
ds_read_b128 a[160:163], v3 offset:8192
ds_read_b128 a[164:167], v3 offset:9216
v_mfma_f32_16x16x32_bf16 a[72:75], a[184:187], v[104:107], a[72:75]
v_exp_f32 v31, v31
v_mfma_f32_16x16x32_bf16 a[104:107], a[184:187], v[108:111], a[104:107]
ds_read_b128 a[168:171], v3 offset:12288
ds_read_b128 a[172:175], v3 offset:13312
v_mfma_f32_16x16x32_bf16 a[76:79], a[188:191], v[104:107], a[76:79]
v_exp_f32 v44, v44
v_mfma_f32_16x16x32_bf16 a[108:111], a[188:191], v[108:111], a[108:111]
buffer_load_dwordx4 v251, s[16:19], s41 offen offset:2048 lds
v_mfma_f32_16x16x32_bf16 a[80:83], a[192:195], v[104:107], a[80:83]
v_exp_f32 v45, v45
v_mfma_f32_16x16x32_bf16 a[112:115], a[192:195], v[108:111], a[112:115]
v_cvt_pk_bf16_f32 v90, v40, v41
v_cvt_pk_bf16_f32 v91, v42, v43
v_mfma_f32_16x16x32_bf16 a[84:87], a[196:199], v[104:107], a[84:87]
v_exp_f32 v46, v46
v_mfma_f32_16x16x32_bf16 a[116:119], a[196:199], v[108:111], a[116:119]
v_cvt_pk_bf16_f32 v92, v28, v29
v_cvt_pk_bf16_f32 v93, v30, v31
v_mfma_f32_16x16x32_bf16 a[88:91], a[200:203], v[104:107], a[88:91]
v_exp_f32 v47, v47
v_mfma_f32_16x16x32_bf16 a[120:123], a[200:203], v[108:111], a[120:123]
buffer_load_dwordx4 v251, s[16:19], s41 offen offset:3072 lds
v_mfma_f32_16x16x32_bf16 a[92:95], a[204:207], v[104:107], a[92:95]
v_cvt_pk_bf16_f32 v94, v44, v45
v_mfma_f32_16x16x32_bf16 a[124:127], a[204:207], v[108:111], a[124:127]
v_cvt_pk_bf16_f32 v95, v46, v47
s_waitcnt lgkmcnt(0)
v_xor_b32 v2, 0x10000, v2
v_xor_b32 v3, 0x10000, v3
s_xor_b32 s39, s39, 0x10000
s_xor_b32 s40, s40, 0x10000
s_add_u32 s41, s41, 65536
s_cmp_eq_u32 s71, 1
s_cbranch_scc1 K2_RPDONE
ds_read_b64_tr_b16 v[224:225], v14 offset:0
ds_read_b64_tr_b16 v[226:227], v14 offset:2048
ds_read_b64_tr_b16 v[228:229], v14 offset:32
ds_read_b64_tr_b16 v[230:231], v14 offset:2080
ds_read_b64_tr_b16 v[232:233], v14 offset:64
ds_read_b64_tr_b16 v[234:235], v14 offset:2112
ds_read_b64_tr_b16 v[236:237], v14 offset:96
ds_read_b64_tr_b16 v[238:239], v14 offset:2144
s_waitcnt lgkmcnt(0)
buffer_store_dwordx4 v[224:227], v1, s[56:59], s76 offen offset:0 sc0 sc1
buffer_store_dwordx4 v[228:231], v1, s[56:59], s76 offen offset:1024 sc0 sc1
buffer_store_dwordx4 v[232:235], v1, s[56:59], s76 offen offset:2048 sc0 sc1
buffer_store_dwordx4 v[236:239], v1, s[56:59], s76 offen offset:3072 sc0 sc1
s_cmp_eq_u32 s78, 0
s_cbranch_scc0 K2_RPF_WD
s_nop 1
ds_read_b64_tr_b16 v[224:225], v15 offset:4096
ds_read_b64_tr_b16 v[226:227], v15 offset:4608
ds_read_b64_tr_b16 v[228:229], v15 offset:4128
ds_read_b64_tr_b16 v[230:231], v15 offset:4640
ds_read_b64_tr_b16 v[232:233], v15 offset:4160
ds_read_b64_tr_b16 v[234:235], v15 offset:4672
ds_read_b64_tr_b16 v[236:237], v15 offset:4192
ds_read_b64_tr_b16 v[238:239], v15 offset:4704
s_waitcnt lgkmcnt(0)
buffer_store_dwordx4 v[224:227], v1, s[56:59], s77 offen offset:0 sc0 sc1
buffer_store_dwordx4 v[228:231], v1, s[56:59], s77 offen offset:1024 sc0 sc1
buffer_store_dwordx4 v[232:235], v1, s[56:59], s77 offen offset:2048 sc0 sc1
buffer_store_dwordx4 v[236:239], v1, s[56:59], s77 offen offset:3072 sc0 sc1
s_branch K2_RPF_J
K2_RPF_WD:
s_nop 1
ds_read_b64_tr_b16 v[224:225], v14 offset:4096
ds_read_b64_tr_b16 v[226:227], v14 offset:6144
ds_read_b64_tr_b16 v[228:229], v14 offset:4128
ds_read_b64_tr_b16 v[230:231], v14 offset:6176
ds_read_b64_tr_b16 v[232:233], v14 offset:4160
ds_read_b64_tr_b16 v[234:235], v14 offset:6208
ds_read_b64_tr_b16 v[236:237], v14 offset:4192
ds_read_b64_tr_b16 v[238:239], v14 offset:6240
s_waitcnt lgkmcnt(0)
buffer_store_dwordx4 v[224:227], v1, s[56:59], s77 offen offset:0 sc0 sc1
buffer_store_dwordx4 v[228:231], v1, s[56:59], s77 offen offset:1024 sc0 sc1
buffer_store_dwordx4 v[232:235], v1, s[56:59], s77 offen offset:2048 sc0 sc1
buffer_store_dwordx4 v[236:239], v1, s[56:59], s77 offen offset:3072 sc0 sc1
K2_RPF_J:
K2_RPDONE:
s_nop 7
v_accvgpr_read_b32 v217, a128
s_nop 0
v_cmp_nle_f32 vcc, v217, v220
s_nop 3
s_or_b64 s[48:49], s[48:49], vcc
v_rcp_f32 v217, v217
v_accvgpr_read_b32 v218, a132
s_nop 0
v_cmp_nle_f32 vcc, v218, v220
s_nop 3
s_or_b64 s[48:49], s[48:49], vcc
v_rcp_f32 v218, v218
v_mov_b32 v222, v217
v_mov_b32 v223, v217
s_lshl_b32 s43, s45, 17
s_lshl_b32 s44, s38, 12
s_add_u32 s43, s43, s44
v_accvgpr_read_b32 v224, a0
v_accvgpr_read_b32 v225, a1
v_accvgpr_read_b32 v226, a2
v_accvgpr_read_b32 v227, a3
v_accvgpr_read_b32 v228, a4
v_accvgpr_read_b32 v229, a5
v_accvgpr_read_b32 v230, a6
v_accvgpr_read_b32 v231, a7
v_pk_mul_f32 v[224:225], v[224:225], v[222:223]
v_pk_mul_f32 v[226:227], v[226:227], v[222:223]
v_pk_mul_f32 v[228:229], v[228:229], v[222:223]
v_pk_mul_f32 v[230:231], v[230:231], v[222:223]
v_cvt_pk_bf16_f32 v232, v224, v225
v_cvt_pk_bf16_f32 v233, v226, v227
v_cvt_pk_bf16_f32 v234, v228, v229
v_cvt_pk_bf16_f32 v235, v230, v231
buffer_store_dwordx4 v[232:235], v1, s[28:31], s43 offen offset:0 sc0 sc1
v_accvgpr_read_b32 v236, a8
v_accvgpr_read_b32 v237, a9
v_accvgpr_read_b32 v238, a10
v_accvgpr_read_b32 v239, a11
v_accvgpr_read_b32 v240, a12
v_accvgpr_read_b32 v241, a13
v_accvgpr_read_b32 v242, a14
v_accvgpr_read_b32 v243, a15
v_pk_mul_f32 v[236:237], v[236:237], v[222:223]
v_pk_mul_f32 v[238:239], v[238:239], v[222:223]
v_pk_mul_f32 v[240:241], v[240:241], v[222:223]
v_pk_mul_f32 v[242:243], v[242:243], v[222:223]
v_cvt_pk_bf16_f32 v244, v236, v237
v_cvt_pk_bf16_f32 v245, v238, v239
v_cvt_pk_bf16_f32 v246, v240, v241
v_cvt_pk_bf16_f32 v247, v242, v243
buffer_store_dwordx4 v[244:247], v1, s[28:31], s43 offen offset:1024 sc0 sc1
v_accvgpr_read_b32 v224, a16
v_accvgpr_read_b32 v225, a17
v_accvgpr_read_b32 v226, a18
v_accvgpr_read_b32 v227, a19
v_accvgpr_read_b32 v228, a20
v_accvgpr_read_b32 v229, a21
v_accvgpr_read_b32 v230, a22
v_accvgpr_read_b32 v231, a23
v_pk_mul_f32 v[224:225], v[224:225], v[222:223]
v_pk_mul_f32 v[226:227], v[226:227], v[222:223]
v_pk_mul_f32 v[228:229], v[228:229], v[222:223]
v_pk_mul_f32 v[230:231], v[230:231], v[222:223]
v_cvt_pk_bf16_f32 v232, v224, v225
v_cvt_pk_bf16_f32 v233, v226, v227
v_cvt_pk_bf16_f32 v234, v228, v229
v_cvt_pk_bf16_f32 v235, v230, v231
buffer_store_dwordx4 v[232:235], v1, s[28:31], s43 offen offset:2048 sc0 sc1
v_accvgpr_read_b32 v236, a24
v_accvgpr_read_b32 v237, a25
v_accvgpr_read_b32 v238, a26
v_accvgpr_read_b32 v239, a27
v_accvgpr_read_b32 v240, a28
v_accvgpr_read_b32 v241, a29
v_accvgpr_read_b32 v242, a30
v_accvgpr_read_b32 v243, a31
v_pk_mul_f32 v[236:237], v[236:237], v[222:223]
v_pk_mul_f32 v[238:239], v[238:239], v[222:223]
v_pk_mul_f32 v[240:241], v[240:241], v[222:223]
v_pk_mul_f32 v[242:243], v[242:243], v[222:223]
v_cvt_pk_bf16_f32 v244, v236, v237
v_cvt_pk_bf16_f32 v245, v238, v239
v_cvt_pk_bf16_f32 v246, v240, v241
v_cvt_pk_bf16_f32 v247, v242, v243
buffer_store_dwordx4 v[244:247], v1, s[28:31], s43 offen offset:3072 sc0 sc1
v_mov_b32 v222, v218
v_mov_b32 v223, v218
s_lshl_b32 s43, s47, 17
s_lshl_b32 s44, s38, 12
s_add_u32 s43, s43, s44
v_accvgpr_read_b32 v224, a32
v_accvgpr_read_b32 v225, a33
v_accvgpr_read_b32 v226, a34
v_accvgpr_read_b32 v227, a35
v_accvgpr_read_b32 v228, a36
v_accvgpr_read_b32 v229, a37
v_accvgpr_read_b32 v230, a38
v_accvgpr_read_b32 v231, a39
v_pk_mul_f32 v[224:225], v[224:225], v[222:223]
v_pk_mul_f32 v[226:227], v[226:227], v[222:223]
v_pk_mul_f32 v[228:229], v[228:229], v[222:223]
v_pk_mul_f32 v[230:231], v[230:231], v[222:223]
v_cvt_pk_bf16_f32 v232, v224, v225
v_cvt_pk_bf16_f32 v233, v226, v227
v_cvt_pk_bf16_f32 v234, v228, v229
v_cvt_pk_bf16_f32 v235, v230, v231
buffer_store_dwordx4 v[232:235], v1, s[28:31], s43 offen offset:0 sc0 sc1
v_accvgpr_read_b32 v236, a40
v_accvgpr_read_b32 v237, a41
v_accvgpr_read_b32 v238, a42
v_accvgpr_read_b32 v239, a43
v_accvgpr_read_b32 v240, a44
v_accvgpr_read_b32 v241, a45
v_accvgpr_read_b32 v242, a46
v_accvgpr_read_b32 v243, a47
v_pk_mul_f32 v[236:237], v[236:237], v[222:223]
v_pk_mul_f32 v[238:239], v[238:239], v[222:223]
v_pk_mul_f32 v[240:241], v[240:241], v[222:223]
v_pk_mul_f32 v[242:243], v[242:243], v[222:223]
v_cvt_pk_bf16_f32 v244, v236, v237
v_cvt_pk_bf16_f32 v245, v238, v239
v_cvt_pk_bf16_f32 v246, v240, v241
v_cvt_pk_bf16_f32 v247, v242, v243
buffer_store_dwordx4 v[244:247], v1, s[28:31], s43 offen offset:1024 sc0 sc1
v_accvgpr_read_b32 v224, a48
v_accvgpr_read_b32 v225, a49
v_accvgpr_read_b32 v226, a50
v_accvgpr_read_b32 v227, a51
v_accvgpr_read_b32 v228, a52
v_accvgpr_read_b32 v229, a53
v_accvgpr_read_b32 v230, a54
v_accvgpr_read_b32 v231, a55
v_pk_mul_f32 v[224:225], v[224:225], v[222:223]
v_pk_mul_f32 v[226:227], v[226:227], v[222:223]
v_pk_mul_f32 v[228:229], v[228:229], v[222:223]
v_pk_mul_f32 v[230:231], v[230:231], v[222:223]
v_cvt_pk_bf16_f32 v232, v224, v225
v_cvt_pk_bf16_f32 v233, v226, v227
v_cvt_pk_bf16_f32 v234, v228, v229
v_cvt_pk_bf16_f32 v235, v230, v231
buffer_store_dwordx4 v[232:235], v1, s[28:31], s43 offen offset:2048 sc0 sc1
v_accvgpr_read_b32 v236, a56
v_accvgpr_read_b32 v237, a57
v_accvgpr_read_b32 v238, a58
v_accvgpr_read_b32 v239, a59
v_accvgpr_read_b32 v240, a60
v_accvgpr_read_b32 v241, a61
v_accvgpr_read_b32 v242, a62
v_accvgpr_read_b32 v243, a63
v_pk_mul_f32 v[236:237], v[236:237], v[222:223]
v_pk_mul_f32 v[238:239], v[238:239], v[222:223]
v_pk_mul_f32 v[240:241], v[240:241], v[222:223]
v_pk_mul_f32 v[242:243], v[242:243], v[222:223]
v_cvt_pk_bf16_f32 v244, v236, v237
v_cvt_pk_bf16_f32 v245, v238, v239
v_cvt_pk_bf16_f32 v246, v240, v241
v_cvt_pk_bf16_f32 v247, v242, v243
buffer_store_dwordx4 v[244:247], v1, s[28:31], s43 offen offset:3072 sc0 sc1
s_cmp_eq_u32 s37, 7
s_cbranch_scc1 K2_DRAIN
s_lshl_b32 s42, s37, 1
s_sub_u32 s42, 13, s42
s_bitcmp1_b32 s36, 0
s_cbranch_scc1 K2_SINGLE_B
.p2align 6
K2_SINGLE:
v_mfma_f32_16x16x32_bf16 v[24:27], a[144:147], v[176:179], v[120:123]
v_exp_f32 v56, v56
v_mfma_f32_16x16x32_bf16 v[28:31], a[144:147], v[192:195], v[124:127]
ds_read_b128 a[176:179], v3 offset:34816
ds_read_b128 a[180:183], v3 offset:35840
v_mfma_f32_16x16x32_bf16 v[24:27], a[148:151], v[180:183], v[24:27]
v_exp_f32 v57, v57
v_mfma_f32_16x16x32_bf16 v[28:31], a[148:151], v[196:199], v[28:31]
ds_read_b128 a[184:187], v3 offset:38912
ds_read_b128 a[188:191], v3 offset:39936
v_mfma_f32_16x16x32_bf16 v[24:27], a[152:155], v[184:187], v[24:27]
v_exp_f32 v58, v58
v_mfma_f32_16x16x32_bf16 v[28:31], a[152:155], v[200:203], v[28:31]
ds_read_b128 a[192:195], v3 offset:43008
ds_read_b128 a[196:199], v3 offset:44032
v_mfma_f32_16x16x32_bf16 v[24:27], a[156:159], v[188:191], v[24:27]
v_exp_f32 v59, v59
v_mfma_f32_16x16x32_bf16 v[28:31], a[156:159], v[204:207], v[28:31]
ds_read_b128 a[200:203], v3 offset:47104
ds_read_b128 a[204:207], v3 offset:48128
v_mfma_f32_16x16x32_bf16 v[40:43], a[160:163], v[176:179], v[136:139]
v_exp_f32 v72, v72
v_mfma_f32_16x16x32_bf16 v[44:47], a[160:163], v[192:195], v[140:143]
v_cvt_pk_bf16_f32 v104, v56, v57
s_waitcnt vmcnt(12)
v_mfma_f32_16x16x32_bf16 v[40:43], a[164:167], v[180:183], v[40:43]
v_exp_f32 v73, v73
v_mfma_f32_16x16x32_bf16 v[44:47], a[164:167], v[196:199], v[44:47]
v_cvt_pk_bf16_f32 v105, v58, v59
s_barrier
s_add_u32 m0, s40, 16384
v_mfma_f32_16x16x32_bf16 v[40:43], a[168:171], v[184:187], v[40:43]
v_exp_f32 v74, v74
v_mfma_f32_16x16x32_bf16 v[44:47], a[168:171], v[200:203], v[44:47]
buffer_load_dwordx4 v248, s[16:19], s41 offen offset:0 lds
v_mfma_f32_16x16x32_bf16 v[40:43], a[172:175], v[188:191], v[40:43]
v_exp_f32 v75, v75
v_mfma_f32_16x16x32_bf16 v[44:47], a[172:175], v[204:207], v[44:47]
ds_read_b128 a[144:147], v2 offset:16384
ds_read_b128 a[148:151], v2 offset:17408
v_mfma_f32_16x16x32_bf16 a[136:139], a[208:211], v[88:91], a[136:139]
v_exp_f32 v60, v60
v_mfma_f32_16x16x32_bf16 a[140:143], a[208:211], v[92:95], a[140:143]
ds_read_b128 a[152:155], v2 offset:20480
ds_read_b128 a[156:159], v2 offset:21504
s_waitcnt lgkmcnt(4)
v_mfma_f32_16x16x32_bf16 a[64:67], a[176:179], v[88:91], a[64:67]
v_exp_f32 v61, v61
v_mfma_f32_16x16x32_bf16 a[96:99], a[176:179], v[92:95], a[96:99]
buffer_load_dwordx4 v248, s[16:19], s41 offen offset:1024 lds
v_mfma_f32_16x16x32_bf16 a[68:71], a[180:183], v[88:91], a[68:71]
v_exp_f32 v62, v62
v_mfma_f32_16x16x32_bf16 a[100:103], a[180:183], v[92:95], a[100:103]
ds_read_b128 a[160:163], v2 offset:24576
ds_read_b128 a[164:167], v2 offset:25600
v_mfma_f32_16x16x32_bf16 a[72:75], a[184:187], v[88:91], a[72:75]
v_exp_f32 v63, v63
v_mfma_f32_16x16x32_bf16 a[104:107], a[184:187], v[92:95], a[104:107]
ds_read_b128 a[168:171], v2 offset:28672
ds_read_b128 a[172:175], v2 offset:29696
v_mfma_f32_16x16x32_bf16 a[76:79], a[188:191], v[88:91], a[76:79]
v_exp_f32 v76, v76
v_mfma_f32_16x16x32_bf16 a[108:111], a[188:191], v[92:95], a[108:111]
buffer_load_dwordx4 v248, s[16:19], s41 offen offset:2048 lds
v_mfma_f32_16x16x32_bf16 a[80:83], a[192:195], v[88:91], a[80:83]
v_exp_f32 v77, v77
v_mfma_f32_16x16x32_bf16 a[112:115], a[192:195], v[92:95], a[112:115]
v_cvt_pk_bf16_f32 v106, v72, v73
v_cvt_pk_bf16_f32 v107, v74, v75
v_mfma_f32_16x16x32_bf16 a[84:87], a[196:199], v[88:91], a[84:87]
v_exp_f32 v78, v78
v_mfma_f32_16x16x32_bf16 a[116:119], a[196:199], v[92:95], a[116:119]
v_cvt_pk_bf16_f32 v108, v60, v61
v_cvt_pk_bf16_f32 v109, v62, v63
v_mfma_f32_16x16x32_bf16 a[88:91], a[200:203], v[88:91], a[88:91]
v_exp_f32 v79, v79
v_mfma_f32_16x16x32_bf16 a[120:123], a[200:203], v[92:95], a[120:123]
buffer_load_dwordx4 v248, s[16:19], s41 offen offset:3072 lds
v_mfma_f32_16x16x32_bf16 a[92:95], a[204:207], v[88:91], a[92:95]
v_cvt_pk_bf16_f32 v110, v76, v77
v_mfma_f32_16x16x32_bf16 a[124:127], a[204:207], v[92:95], a[124:127]
v_cvt_pk_bf16_f32 v111, v78, v79
s_waitcnt lgkmcnt(0)
v_mfma_f32_16x16x32_bf16 v[56:59], a[144:147], v[176:179], v[120:123]
v_exp_f32 v24, v24
v_mfma_f32_16x16x32_bf16 v[60:63], a[144:147], v[192:195], v[124:127]
ds_read_b128 a[176:179], v3 offset:51200
ds_read_b128 a[180:183], v3 offset:52224
v_mfma_f32_16x16x32_bf16 v[56:59], a[148:151], v[180:183], v[56:59]
v_exp_f32 v25, v25
v_mfma_f32_16x16x32_bf16 v[60:63], a[148:151], v[196:199], v[60:63]
ds_read_b128 a[184:187], v3 offset:55296
ds_read_b128 a[188:191], v3 offset:56320
v_mfma_f32_16x16x32_bf16 v[56:59], a[152:155], v[184:187], v[56:59]
v_exp_f32 v26, v26
v_mfma_f32_16x16x32_bf16 v[60:63], a[152:155], v[200:203], v[60:63]
ds_read_b128 a[192:195], v3 offset:59392
ds_read_b128 a[196:199], v3 offset:60416
v_mfma_f32_16x16x32_bf16 v[56:59], a[156:159], v[188:191], v[56:59]
v_exp_f32 v27, v27
v_mfma_f32_16x16x32_bf16 v[60:63], a[156:159], v[204:207], v[60:63]
ds_read_b128 a[200:203], v3 offset:63488
ds_read_b128 a[204:207], v3 offset:64512
v_mfma_f32_16x16x32_bf16 v[72:75], a[160:163], v[176:179], v[136:139]
v_exp_f32 v40, v40
v_mfma_f32_16x16x32_bf16 v[76:79], a[160:163], v[192:195], v[140:143]
v_cvt_pk_bf16_f32 v88, v24, v25
s_waitcnt vmcnt(12)
v_mfma_f32_16x16x32_bf16 v[72:75], a[164:167], v[180:183], v[72:75]
v_exp_f32 v41, v41
v_mfma_f32_16x16x32_bf16 v[76:79], a[164:167], v[196:199], v[76:79]
v_cvt_pk_bf16_f32 v89, v26, v27
s_barrier
s_add_u32 m0, s40, 32768
v_mfma_f32_16x16x32_bf16 v[72:75], a[168:171], v[184:187], v[72:75]
v_exp_f32 v42, v42
v_mfma_f32_16x16x32_bf16 v[76:79], a[168:171], v[200:203], v[76:79]
buffer_load_dwordx4 v249, s[16:19], s41 offen offset:0 lds
v_mfma_f32_16x16x32_bf16 v[72:75], a[172:175], v[188:191], v[72:75]
v_exp_f32 v43, v43
v_mfma_f32_16x16x32_bf16 v[76:79], a[172:175], v[204:207], v[76:79]
ds_read_b128 a[144:147], v2 offset:32768
ds_read_b128 a[148:151], v2 offset:33792
v_mfma_f32_16x16x32_bf16 a[136:139], a[208:211], v[104:107], a[136:139]
v_exp_f32 v28, v28
v_mfma_f32_16x16x32_bf16 a[140:143], a[208:211], v[108:111], a[140:143]
ds_read_b128 a[152:155], v2 offset:36864
ds_read_b128 a[156:159], v2 offset:37888
s_waitcnt lgkmcnt(4)
v_mfma_f32_16x16x32_bf16 a[64:67], a[176:179], v[104:107], a[64:67]
v_exp_f32 v29, v29
v_mfma_f32_16x16x32_bf16 a[96:99], a[176:179], v[108:111], a[96:99]
buffer_load_dwordx4 v249, s[16:19], s41 offen offset:1024 lds
v_mfma_f32_16x16x32_bf16 a[68:71], a[180:183], v[104:107], a[68:71]
v_exp_f32 v30, v30
v_mfma_f32_16x16x32_bf16 a[100:103], a[180:183], v[108:111], a[100:103]
ds_read_b128 a[160:163], v2 offset:40960
ds_read_b128 a[164:167], v2 offset:41984
v_mfma_f32_16x16x32_bf16 a[72:75], a[184:187], v[104:107], a[72:75]
v_exp_f32 v31, v31
v_mfma_f32_16x16x32_bf16 a[104:107], a[184:187], v[108:111], a[104:107]
ds_read_b128 a[168:171], v2 offset:45056
ds_read_b128 a[172:175], v2 offset:46080
v_mfma_f32_16x16x32_bf16 a[76:79], a[188:191], v[104:107], a[76:79]
v_exp_f32 v44, v44
v_mfma_f32_16x16x32_bf16 a[108:111], a[188:191], v[108:111], a[108:111]
buffer_load_dwordx4 v249, s[16:19], s41 offen offset:2048 lds
v_mfma_f32_16x16x32_bf16 a[80:83], a[192:195], v[104:107], a[80:83]
v_exp_f32 v45, v45
v_mfma_f32_16x16x32_bf16 a[112:115], a[192:195], v[108:111], a[112:115]
v_cvt_pk_bf16_f32 v90, v40, v41
v_cvt_pk_bf16_f32 v91, v42, v43
v_mfma_f32_16x16x32_bf16 a[84:87], a[196:199], v[104:107], a[84:87]
v_exp_f32 v46, v46
v_mfma_f32_16x16x32_bf16 a[116:119], a[196:199], v[108:111], a[116:119]
v_cvt_pk_bf16_f32 v92, v28, v29
v_cvt_pk_bf16_f32 v93, v30, v31
v_mfma_f32_16x16x32_bf16 a[88:91], a[200:203], v[104:107], a[88:91]
v_exp_f32 v47, v47
v_mfma_f32_16x16x32_bf16 a[120:123], a[200:203], v[108:111], a[120:123]
buffer_load_dwordx4 v249, s[16:19], s41 offen offset:3072 lds
v_mfma_f32_16x16x32_bf16 a[92:95], a[204:207], v[104:107], a[92:95]
v_cvt_pk_bf16_f32 v94, v44, v45
v_mfma_f32_16x16x32_bf16 a[124:127], a[204:207], v[108:111], a[124:127]
v_cvt_pk_bf16_f32 v95, v46, v47
s_waitcnt lgkmcnt(0)
v_mfma_f32_16x16x32_bf16 v[24:27], a[144:147], v[176:179], v[120:123]
v_exp_f32 v56, v56
v_mfma_f32_16x16x32_bf16 v[28:31], a[144:147], v[192:195], v[124:127]
ds_read_b128 a[176:179], v2 offset:2048
ds_read_b128 a[180:183], v2 offset:3072
v_mfma_f32_16x16x32_bf16 v[24:27], a[148:151], v[180:183], v[24:27]
v_exp_f32 v57, v57
v_mfma_f32_16x16x32_bf16 v[28:31], a[148:151], v[196:199], v[28:31]
ds_read_b128 a[184:187], v2 offset:6144
ds_read_b128 a[188:191], v2 offset:7168
v_mfma_f32_16x16x32_bf16 v[24:27], a[152:155], v[184:187], v[24:27]
v_exp_f32 v58, v58
v_mfma_f32_16x16x32_bf16 v[28:31], a[152:155], v[200:203], v[28:31]
ds_read_b128 a[192:195], v2 offset:10240
ds_read_b128 a[196:199], v2 offset:11264
v_mfma_f32_16x16x32_bf16 v[24:27], a[156:159], v[188:191], v[24:27]
v_exp_f32 v59, v59
v_mfma_f32_16x16x32_bf16 v[28:31], a[156:159], v[204:207], v[28:31]
ds_read_b128 a[200:203], v2 offset:14336
ds_read_b128 a[204:207], v2 offset:15360
v_mfma_f32_16x16x32_bf16 v[40:43], a[160:163], v[176:179], v[136:139]
v_exp_f32 v72, v72
v_mfma_f32_16x16x32_bf16 v[44:47], a[160:163], v[192:195], v[140:143]
v_cvt_pk_bf16_f32 v104, v56, v57
s_waitcnt vmcnt(12)
v_mfma_f32_16x16x32_bf16 v[40:43], a[164:167], v[180:183], v[40:43]
v_exp_f32 v73, v73
v_mfma_f32_16x16x32_bf16 v[44:47], a[164:167], v[196:199], v[44:47]
v_cvt_pk_bf16_f32 v105, v58, v59
s_barrier
s_add_u32 m0, s40, 49152
v_mfma_f32_16x16x32_bf16 v[40:43], a[168:171], v[184:187], v[40:43]
v_exp_f32 v74, v74
v_mfma_f32_16x16x32_bf16 v[44:47], a[168:171], v[200:203], v[44:47]
buffer_load_dwordx4 v250, s[16:19], s41 offen offset:0 lds
v_mfma_f32_16x16x32_bf16 v[40:43], a[172:175], v[188:191], v[40:43]
v_exp_f32 v75, v75
v_mfma_f32_16x16x32_bf16 v[44:47], a[172:175], v[204:207], v[44:47]
ds_read_b128 a[144:147], v2 offset:49152
ds_read_b128 a[148:151], v2 offset:50176
v_mfma_f32_16x16x32_bf16 a[136:139], a[208:211], v[88:91], a[136:139]
v_exp_f32 v60, v60
v_mfma_f32_16x16x32_bf16 a[140:143], a[208:211], v[92:95], a[140:143]
ds_read_b128 a[152:155], v2 offset:53248
ds_read_b128 a[156:159], v2 offset:54272
s_waitcnt lgkmcnt(4)
v_mfma_f32_16x16x32_bf16 a[64:67], a[176:179], v[88:91], a[64:67]
v_exp_f32 v61, v61
v_mfma_f32_16x16x32_bf16 a[96:99], a[176:179], v[92:95], a[96:99]
buffer_load_dwordx4 v250, s[16:19], s41 offen offset:1024 lds
v_mfma_f32_16x16x32_bf16 a[68:71], a[180:183], v[88:91], a[68:71]
v_exp_f32 v62, v62
v_mfma_f32_16x16x32_bf16 a[100:103], a[180:183], v[92:95], a[100:103]
ds_read_b128 a[160:163], v2 offset:57344
ds_read_b128 a[164:167], v2 offset:58368
v_mfma_f32_16x16x32_bf16 a[72:75], a[184:187], v[88:91], a[72:75]
v_exp_f32 v63, v63
v_mfma_f32_16x16x32_bf16 a[104:107], a[184:187], v[92:95], a[104:107]
ds_read_b128 a[168:171], v2 offset:61440
ds_read_b128 a[172:175], v2 offset:62464
v_mfma_f32_16x16x32_bf16 a[76:79], a[188:191], v[88:91], a[76:79]
v_exp_f32 v76, v76
v_mfma_f32_16x16x32_bf16 a[108:111], a[188:191], v[92:95], a[108:111]
buffer_load_dwordx4 v250, s[16:19], s41 offen offset:2048 lds
v_mfma_f32_16x16x32_bf16 a[80:83], a[192:195], v[88:91], a[80:83]
v_exp_f32 v77, v77
v_mfma_f32_16x16x32_bf16 a[112:115], a[192:195], v[92:95], a[112:115]
v_cvt_pk_bf16_f32 v106, v72, v73
v_cvt_pk_bf16_f32 v107, v74, v75
v_mfma_f32_16x16x32_bf16 a[84:87], a[196:199], v[88:91], a[84:87]
v_exp_f32 v78, v78
v_mfma_f32_16x16x32_bf16 a[116:119], a[196:199], v[92:95], a[116:119]
v_cvt_pk_bf16_f32 v108, v60, v61
v_cvt_pk_bf16_f32 v109, v62, v63
v_mfma_f32_16x16x32_bf16 a[88:91], a[200:203], v[88:91], a[88:91]
v_exp_f32 v79, v79
v_mfma_f32_16x16x32_bf16 a[120:123], a[200:203], v[92:95], a[120:123]
buffer_load_dwordx4 v250, s[16:19], s41 offen offset:3072 lds
v_mfma_f32_16x16x32_bf16 a[92:95], a[204:207], v[88:91], a[92:95]
v_cvt_pk_bf16_f32 v110, v76, v77
v_mfma_f32_16x16x32_bf16 a[124:127], a[204:207], v[92:95], a[124:127]
v_cvt_pk_bf16_f32 v111, v78, v79
s_waitcnt lgkmcnt(0)
v_mfma_f32_16x16x32_bf16 v[56:59], a[144:147], v[176:179], v[120:123]
v_exp_f32 v24, v24
v_mfma_f32_16x16x32_bf16 v[60:63], a[144:147], v[192:195], v[124:127]
ds_read_b128 a[176:179], v2 offset:18432
ds_read_b128 a[180:183], v2 offset:19456
v_mfma_f32_16x16x32_bf16 v[56:59], a[148:151], v[180:183], v[56:59]
v_exp_f32 v25, v25
v_mfma_f32_16x16x32_bf16 v[60:63], a[148:151], v[196:199], v[60:63]
ds_read_b128 a[184:187], v2 offset:22528
ds_read_b128 a[188:191], v2 offset:23552
v_mfma_f32_16x16x32_bf16 v[56:59], a[152:155], v[184:187], v[56:59]
v_exp_f32 v26, v26
v_mfma_f32_16x16x32_bf16 v[60:63], a[152:155], v[200:203], v[60:63]
ds_read_b128 a[192:195], v2 offset:26624
ds_read_b128 a[196:199], v2 offset:27648
v_mfma_f32_16x16x32_bf16 v[56:59], a[156:159], v[188:191], v[56:59]
v_exp_f32 v27, v27
v_mfma_f32_16x16x32_bf16 v[60:63], a[156:159], v[204:207], v[60:63]
ds_read_b128 a[200:203], v2 offset:30720
ds_read_b128 a[204:207], v2 offset:31744
v_mfma_f32_16x16x32_bf16 v[72:75], a[160:163], v[176:179], v[136:139]
v_exp_f32 v40, v40
v_mfma_f32_16x16x32_bf16 v[76:79], a[160:163], v[192:195], v[140:143]
v_cvt_pk_bf16_f32 v88, v24, v25
s_waitcnt vmcnt(12)
v_mfma_f32_16x16x32_bf16 v[72:75], a[164:167], v[180:183], v[72:75]
v_exp_f32 v41, v41
v_mfma_f32_16x16x32_bf16 v[76:79], a[164:167], v[196:199], v[76:79]
v_cvt_pk_bf16_f32 v89, v26, v27
s_barrier
s_add_u32 m0, s39, 0
v_mfma_f32_16x16x32_bf16 v[72:75], a[168:171], v[184:187], v[72:75]
v_exp_f32 v42, v42
v_mfma_f32_16x16x32_bf16 v[76:79], a[168:171], v[200:203], v[76:79]
buffer_load_dwordx4 v251, s[16:19], s41 offen offset:0 lds
v_mfma_f32_16x16x32_bf16 v[72:75], a[172:175], v[188:191], v[72:75]
v_exp_f32 v43, v43
v_mfma_f32_16x16x32_bf16 v[76:79], a[172:175], v[204:207], v[76:79]
ds_read_b128 a[144:147], v3 offset:0
ds_read_b128 a[148:151], v3 offset:1024
v_mfma_f32_16x16x32_bf16 a[136:139], a[208:211], v[104:107], a[136:139]
v_exp_f32 v28, v28
v_mfma_f32_16x16x32_bf16 a[140:143], a[208:211], v[108:111], a[140:143]
ds_read_b128 a[152:155], v3 offset:4096
ds_read_b128 a[156:159], v3 offset:5120
s_waitcnt lgkmcnt(4)
v_mfma_f32_16x16x32_bf16 a[64:67], a[176:179], v[104:107], a[64:67]
v_exp_f32 v29, v29
v_mfma_f32_16x16x32_bf16 a[96:99], a[176:179], v[108:111], a[96:99]
buffer_load_dwordx4 v251, s[16:19], s41 offen offset:1024 lds
v_mfma_f32_16x16x32_bf16 a[68:71], a[180:183], v[104:107], a[68:71]
v_exp_f32 v30, v30
v_mfma_f32_16x16x32_bf16 a[100:103], a[180:183], v[108:111], a[100:103]
ds_read_b128 a[160:163], v3 offset:8192
ds_read_b128 a[164:167], v3 offset:9216
v_mfma_f32_16x16x32_bf16 a[72:75], a[184:187], v[104:107], a[72:75]
v_exp_f32 v31, v31
v_mfma_f32_16x16x32_bf16 a[104:107], a[184:187], v[108:111], a[104:107]
ds_read_b128 a[168:171], v3 offset:12288
ds_read_b128 a[172:175], v3 offset:13312
v_mfma_f32_16x16x32_bf16 a[76:79], a[188:191], v[104:107], a[76:79]
v_exp_f32 v44, v44
v_mfma_f32_16x16x32_bf16 a[108:111], a[188:191], v[108:111], a[108:111]
buffer_load_dwordx4 v251, s[16:19], s41 offen offset:2048 lds
v_mfma_f32_16x16x32_bf16 a[80:83], a[192:195], v[104:107], a[80:83]
v_exp_f32 v45, v45
v_mfma_f32_16x16x32_bf16 a[112:115], a[192:195], v[108:111], a[112:115]
v_cvt_pk_bf16_f32 v90, v40, v41
v_cvt_pk_bf16_f32 v91, v42, v43
v_mfma_f32_16x16x32_bf16 a[84:87], a[196:199], v[104:107], a[84:87]
v_exp_f32 v46, v46
v_mfma_f32_16x16x32_bf16 a[116:119], a[196:199], v[108:111], a[116:119]
v_cvt_pk_bf16_f32 v92, v28, v29
v_cvt_pk_bf16_f32 v93, v30, v31
v_mfma_f32_16x16x32_bf16 a[88:91], a[200:203], v[104:107], a[88:91]
v_exp_f32 v47, v47
v_mfma_f32_16x16x32_bf16 a[120:123], a[200:203], v[108:111], a[120:123]
buffer_load_dwordx4 v251, s[16:19], s41 offen offset:3072 lds
v_mfma_f32_16x16x32_bf16 a[92:95], a[204:207], v[104:107], a[92:95]
v_cvt_pk_bf16_f32 v94, v44, v45
v_mfma_f32_16x16x32_bf16 a[124:127], a[204:207], v[108:111], a[124:127]
v_cvt_pk_bf16_f32 v95, v46, v47
s_waitcnt lgkmcnt(0)
v_xor_b32 v2, 0x10000, v2
v_xor_b32 v3, 0x10000, v3
s_xor_b32 s39, s39, 0x10000
s_xor_b32 s40, s40, 0x10000
s_add_u32 s41, s41, 65536
s_sub_u32 s42, s42, 1
s_cmp_lg_u32 s42, 0
s_cbranch_scc1 K2_SINGLE
s_branch K2_SINGLEM
.p2align 6
K2_SINGLE_B:
v_mfma_f32_16x16x32_bf16 v[24:27], a[144:147], v[176:179], v[120:123]
v_exp_f32 v56, v56
v_mfma_f32_16x16x32_bf16 v[28:31], a[144:147], v[192:195], v[124:127]
ds_read_b128 a[176:179], v3 offset:34816
ds_read_b128 a[180:183], v3 offset:35840
v_mfma_f32_16x16x32_bf16 v[24:27], a[148:151], v[180:183], v[24:27]
v_exp_f32 v57, v57
v_mfma_f32_16x16x32_bf16 v[28:31], a[148:151], v[196:199], v[28:31]
ds_read_b128 a[184:187], v3 offset:38912
ds_read_b128 a[188:191], v3 offset:39936
v_mfma_f32_16x16x32_bf16 v[24:27], a[152:155], v[184:187], v[24:27]
v_exp_f32 v58, v58
v_mfma_f32_16x16x32_bf16 v[28:31], a[152:155], v[200:203], v[28:31]
v_cvt_pk_bf16_f32 v104, v56, v57
s_waitcnt vmcnt(12)
v_mfma_f32_16x16x32_bf16 v[24:27], a[156:159], v[188:191], v[24:27]
v_exp_f32 v59, v59
v_mfma_f32_16x16x32_bf16 v[28:31], a[156:159], v[204:207], v[28:31]
v_cvt_pk_bf16_f32 v105, v58, v59
s_barrier
s_add_u32 m0, s40, 16384
v_mfma_f32_16x16x32_bf16 v[40:43], a[160:163], v[176:179], v[136:139]
v_exp_f32 v72, v72
v_mfma_f32_16x16x32_bf16 v[44:47], a[160:163], v[192:195], v[140:143]
ds_read_b128 a[192:195], v3 offset:43008
ds_read_b128 a[196:199], v3 offset:44032
v_mfma_f32_16x16x32_bf16 v[40:43], a[164:167], v[180:183], v[40:43]
v_exp_f32 v73, v73
v_mfma_f32_16x16x32_bf16 v[44:47], a[164:167], v[196:199], v[44:47]
ds_read_b128 a[200:203], v3 offset:47104
ds_read_b128 a[204:207], v3 offset:48128
v_mfma_f32_16x16x32_bf16 v[40:43], a[168:171], v[184:187], v[40:43]
v_exp_f32 v74, v74
v_mfma_f32_16x16x32_bf16 v[44:47], a[168:171], v[200:203], v[44:47]
buffer_load_dwordx4 v248, s[16:19], s41 offen offset:0 lds
v_mfma_f32_16x16x32_bf16 v[40:43], a[172:175], v[188:191], v[40:43]
v_exp_f32 v75, v75
v_mfma_f32_16x16x32_bf16 v[44:47], a[172:175], v[204:207], v[44:47]
ds_read_b128 a[144:147], v2 offset:16384
ds_read_b128 a[148:151], v2 offset:17408
v_mfma_f32_16x16x32_bf16 a[136:139], a[208:211], v[88:91], a[136:139]
v_exp_f32 v60, v60
v_mfma_f32_16x16x32_bf16 a[140:143], a[208:211], v[92:95], a[140:143]
ds_read_b128 a[152:155], v2 offset:20480
ds_read_b128 a[156:159], v2 offset:21504
s_waitcnt lgkmcnt(4)
v_mfma_f32_16x16x32_bf16 a[64:67], a[176:179], v[88:91], a[64:67]
v_exp_f32 v61, v61
v_mfma_f32_16x16x32_bf16 a[96:99], a[176:179], v[92:95], a[96:99]
buffer_load_dwordx4 v248, s[16:19], s41 offen offset:1024 lds
v_mfma_f32_16x16x32_bf16 a[68:71], a[180:183], v[88:91], a[68:71]
v_exp_f32 v62, v62
v_mfma_f32_16x16x32_bf16 a[100:103], a[180:183], v[92:95], a[100:103]
ds_read_b128 a[160:163], v2 offset:24576
ds_read_b128 a[164:167], v2 offset:25600
v_mfma_f32_16x16x32_bf16 a[72:75], a[184:187], v[88:91], a[72:75]
v_exp_f32 v63, v63
v_mfma_f32_16x16x32_bf16 a[104:107], a[184:187], v[92:95], a[104:107]
ds_read_b128 a[168:171], v2 offset:28672
ds_read_b128 a[172:175], v2 offset:29696
v_mfma_f32_16x16x32_bf16 a[76:79], a[188:191], v[88:91], a[76:79]
v_exp_f32 v76, v76
v_mfma_f32_16x16x32_bf16 a[108:111], a[188:191], v[92:95], a[108:111]
buffer_load_dwordx4 v248, s[16:19], s41 offen offset:2048 lds
v_mfma_f32_16x16x32_bf16 a[80:83], a[192:195], v[88:91], a[80:83]
v_exp_f32 v77, v77
v_mfma_f32_16x16x32_bf16 a[112:115], a[192:195], v[92:95], a[112:115]
v_cvt_pk_bf16_f32 v106, v72, v73
v_cvt_pk_bf16_f32 v107, v74, v75
v_mfma_f32_16x16x32_bf16 a[84:87], a[196:199], v[88:91], a[84:87]
v_exp_f32 v78, v78
v_mfma_f32_16x16x32_bf16 a[116:119], a[196:199], v[92:95], a[116:119]
v_cvt_pk_bf16_f32 v108, v60, v61
v_cvt_pk_bf16_f32 v109, v62, v63
v_mfma_f32_16x16x32_bf16 a[88:91], a[200:203], v[88:91], a[88:91]
v_exp_f32 v79, v79
v_mfma_f32_16x16x32_bf16 a[120:123], a[200:203], v[92:95], a[120:123]
buffer_load_dwordx4 v248, s[16:19], s41 offen offset:3072 lds
v_mfma_f32_16x16x32_bf16 a[92:95], a[204:207], v[88:91], a[92:95]
v_cvt_pk_bf16_f32 v110, v76, v77
v_mfma_f32_16x16x32_bf16 a[124:127], a[204:207], v[92:95], a[124:127]
v_cvt_pk_bf16_f32 v111, v78, v79
s_waitcnt lgkmcnt(0)
v_mfma_f32_16x16x32_bf16 v[56:59], a[144:147], v[176:179], v[120:123]
v_exp_f32 v24, v24
v_mfma_f32_16x16x32_bf16 v[60:63], a[144:147], v[192:195], v[124:127]
ds_read_b128 a[176:179], v3 offset:51200
ds_read_b128 a[180:183], v3 offset:52224
v_mfma_f32_16x16x32_bf16 v[56:59], a[148:151], v[180:183], v[56:59]
v_exp_f32 v25, v25
v_mfma_f32_16x16x32_bf16 v[60:63], a[148:151], v[196:199], v[60:63]
ds_read_b128 a[184:187], v3 offset:55296
ds_read_b128 a[188:191], v3 offset:56320
v_mfma_f32_16x16x32_bf16 v[56:59], a[152:155], v[184:187], v[56:59]
v_exp_f32 v26, v26
v_mfma_f32_16x16x32_bf16 v[60:63], a[152:155], v[200:203], v[60:63]
v_cvt_pk_bf16_f32 v88, v24, v25
s_waitcnt vmcnt(12)
v_mfma_f32_16x16x32_bf16 v[56:59], a[156:159], v[188:191], v[56:59]
v_exp_f32 v27, v27
v_mfma_f32_16x16x32_bf16 v[60:63], a[156:159], v[204:207], v[60:63]
v_cvt_pk_bf16_f32 v89, v26, v27
s_barrier
s_add_u32 m0, s40, 32768
v_mfma_f32_16x16x32_bf16 v[72:75], a[160:163], v[176:179], v[136:139]
v_exp_f32 v40, v40
v_mfma_f32_16x16x32_bf16 v[76:79], a[160:163], v[192:195], v[140:143]
ds_read_b128 a[192:195], v3 offset:59392
ds_read_b128 a[196:199], v3 offset:60416
v_mfma_f32_16x16x32_bf16 v[72:75], a[164:167], v[180:183], v[72:75]
v_exp_f32 v41, v41
v_mfma_f32_16x16x32_bf16 v[76:79], a[164:167], v[196:199], v[76:79]
ds_read_b128 a[200:203], v3 offset:63488
ds_read_b128 a[204:207], v3 offset:64512
v_mfma_f32_16x16x32_bf16 v[72:75], a[168:171], v[184:187], v[72:75]
v_exp_f32 v42, v42
v_mfma_f32_16x16x32_bf16 v[76:79], a[168:171], v[200:203], v[76:79]
buffer_load_dwordx4 v249, s[16:19], s41 offen offset:0 lds
v_mfma_f32_16x16x32_bf16 v[72:75], a[172:175], v[188:191], v[72:75]
v_exp_f32 v43, v43
v_mfma_f32_16x16x32_bf16 v[76:79], a[172:175], v[204:207], v[76:79]
ds_read_b128 a[144:147], v2 offset:32768
ds_read_b128 a[148:151], v2 offset:33792
v_mfma_f32_16x16x32_bf16 a[136:139], a[208:211], v[104:107], a[136:139]
v_exp_f32 v28, v28
v_mfma_f32_16x16x32_bf16 a[140:143], a[208:211], v[108:111], a[140:143]
ds_read_b128 a[152:155], v2 offset:36864
ds_read_b128 a[156:159], v2 offset:37888
s_waitcnt lgkmcnt(4)
v_mfma_f32_16x16x32_bf16 a[64:67], a[176:179], v[104:107], a[64:67]
v_exp_f32 v29, v29
v_mfma_f32_16x16x32_bf16 a[96:99], a[176:179], v[108:111], a[96:99]
buffer_load_dwordx4 v249, s[16:19], s41 offen offset:1024 lds
v_mfma_f32_16x16x32_bf16 a[68:71], a[180:183], v[104:107], a[68:71]
v_exp_f32 v30, v30
v_mfma_f32_16x16x32_bf16 a[100:103], a[180:183], v[108:111], a[100:103]
ds_read_b128 a[160:163], v2 offset:40960
ds_read_b128 a[164:167], v2 offset:41984
v_mfma_f32_16x16x32_bf16 a[72:75], a[184:187], v[104:107], a[72:75]
v_exp_f32 v31, v31
v_mfma_f32_16x16x32_bf16 a[104:107], a[184:187], v[108:111], a[104:107]
ds_read_b128 a[168:171], v2 offset:45056
ds_read_b128 a[172:175], v2 offset:46080
v_mfma_f32_16x16x32_bf16 a[76:79], a[188:191], v[104:107], a[76:79]
v_exp_f32 v44, v44
v_mfma_f32_16x16x32_bf16 a[108:111], a[188:191], v[108:111], a[108:111]
buffer_load_dwordx4 v249, s[16:19], s41 offen offset:2048 lds
v_mfma_f32_16x16x32_bf16 a[80:83], a[192:195], v[104:107], a[80:83]
v_exp_f32 v45, v45
v_mfma_f32_16x16x32_bf16 a[112:115], a[192:195], v[108:111], a[112:115]
v_cvt_pk_bf16_f32 v90, v40, v41
v_cvt_pk_bf16_f32 v91, v42, v43
v_mfma_f32_16x16x32_bf16 a[84:87], a[196:199], v[104:107], a[84:87]
v_exp_f32 v46, v46
v_mfma_f32_16x16x32_bf16 a[116:119], a[196:199], v[108:111], a[116:119]
v_cvt_pk_bf16_f32 v92, v28, v29
v_cvt_pk_bf16_f32 v93, v30, v31
v_mfma_f32_16x16x32_bf16 a[88:91], a[200:203], v[104:107], a[88:91]
v_exp_f32 v47, v47
v_mfma_f32_16x16x32_bf16 a[120:123], a[200:203], v[108:111], a[120:123]
buffer_load_dwordx4 v249, s[16:19], s41 offen offset:3072 lds
v_mfma_f32_16x16x32_bf16 a[92:95], a[204:207], v[104:107], a[92:95]
v_cvt_pk_bf16_f32 v94, v44, v45
v_mfma_f32_16x16x32_bf16 a[124:127], a[204:207], v[108:111], a[124:127]
v_cvt_pk_bf16_f32 v95, v46, v47
s_waitcnt lgkmcnt(0)
v_mfma_f32_16x16x32_bf16 v[24:27], a[144:147], v[176:179], v[120:123]
v_exp_f32 v56, v56
v_mfma_f32_16x16x32_bf16 v[28:31], a[144:147], v[192:195], v[124:127]
ds_read_b128 a[176:179], v2 offset:2048
ds_read_b128 a[180:183], v2 offset:3072
v_mfma_f32_16x16x32_bf16 v[24:27], a[148:151], v[180:183], v[24:27]
v_exp_f32 v57, v57
v_mfma_f32_16x16x32_bf16 v[28:31], a[148:151], v[196:199], v[28:31]
ds_read_b128 a[184:187], v2 offset:6144
ds_read_b128 a[188:191], v2 offset:7168
v_mfma_f32_16x16x32_bf16 v[24:27], a[152:155], v[184:187], v[24:27]
v_exp_f32 v58, v58
v_mfma_f32_16x16x32_bf16 v[28:31], a[152:155], v[200:203], v[28:31]
v_cvt_pk_bf16_f32 v104, v56, v57
s_waitcnt vmcnt(12)
v_mfma_f32_16x16x32_bf16 v[24:27], a[156:159], v[188:191], v[24:27]
v_exp_f32 v59, v59
v_mfma_f32_16x16x32_bf16 v[28:31], a[156:159], v[204:207], v[28:31]
v_cvt_pk_bf16_f32 v105, v58, v59
s_barrier
s_add_u32 m0, s40, 49152
v_mfma_f32_16x16x32_bf16 v[40:43], a[160:163], v[176:179], v[136:139]
v_exp_f32 v72, v72
v_mfma_f32_16x16x32_bf16 v[44:47], a[160:163], v[192:195], v[140:143]
ds_read_b128 a[192:195], v2 offset:10240
ds_read_b128 a[196:199], v2 offset:11264
v_mfma_f32_16x16x32_bf16 v[40:43], a[164:167], v[180:183], v[40:43]
v_exp_f32 v73, v73
v_mfma_f32_16x16x32_bf16 v[44:47], a[164:167], v[196:199], v[44:47]
ds_read_b128 a[200:203], v2 offset:14336
ds_read_b128 a[204:207], v2 offset:15360
v_mfma_f32_16x16x32_bf16 v[40:43], a[168:171], v[184:187], v[40:43]
v_exp_f32 v74, v74
v_mfma_f32_16x16x32_bf16 v[44:47], a[168:171], v[200:203], v[44:47]
buffer_load_dwordx4 v250, s[16:19], s41 offen offset:0 lds
v_mfma_f32_16x16x32_bf16 v[40:43], a[172:175], v[188:191], v[40:43]
v_exp_f32 v75, v75
v_mfma_f32_16x16x32_bf16 v[44:47], a[172:175], v[204:207], v[44:47]
ds_read_b128 a[144:147], v2 offset:49152
ds_read_b128 a[148:151], v2 offset:50176
v_mfma_f32_16x16x32_bf16 a[136:139], a[208:211], v[88:91], a[136:139]
v_exp_f32 v60, v60
v_mfma_f32_16x16x32_bf16 a[140:143], a[208:211], v[92:95], a[140:143]
ds_read_b128 a[152:155], v2 offset:53248
ds_read_b128 a[156:159], v2 offset:54272
s_waitcnt lgkmcnt(4)
v_mfma_f32_16x16x32_bf16 a[64:67], a[176:179], v[88:91], a[64:67]
v_exp_f32 v61, v61
v_mfma_f32_16x16x32_bf16 a[96:99], a[176:179], v[92:95], a[96:99]
buffer_load_dwordx4 v250, s[16:19], s41 offen offset:1024 lds
v_mfma_f32_16x16x32_bf16 a[68:71], a[180:183], v[88:91], a[68:71]
v_exp_f32 v62, v62
v_mfma_f32_16x16x32_bf16 a[100:103], a[180:183], v[92:95], a[100:103]
ds_read_b128 a[160:163], v2 offset:57344
ds_read_b128 a[164:167], v2 offset:58368
v_mfma_f32_16x16x32_bf16 a[72:75], a[184:187], v[88:91], a[72:75]
v_exp_f32 v63, v63
v_mfma_f32_16x16x32_bf16 a[104:107], a[184:187], v[92:95], a[104:107]
ds_read_b128 a[168:171], v2 offset:61440
ds_read_b128 a[172:175], v2 offset:62464
v_mfma_f32_16x16x32_bf16 a[76:79], a[188:191], v[88:91], a[76:79]
v_exp_f32 v76, v76
v_mfma_f32_16x16x32_bf16 a[108:111], a[188:191], v[92:95], a[108:111]
buffer_load_dwordx4 v250, s[16:19], s41 offen offset:2048 lds
v_mfma_f32_16x16x32_bf16 a[80:83], a[192:195], v[88:91], a[80:83]
v_exp_f32 v77, v77
v_mfma_f32_16x16x32_bf16 a[112:115], a[192:195], v[92:95], a[112:115]
v_cvt_pk_bf16_f32 v106, v72, v73
v_cvt_pk_bf16_f32 v107, v74, v75
v_mfma_f32_16x16x32_bf16 a[84:87], a[196:199], v[88:91], a[84:87]
v_exp_f32 v78, v78
v_mfma_f32_16x16x32_bf16 a[116:119], a[196:199], v[92:95], a[116:119]
v_cvt_pk_bf16_f32 v108, v60, v61
v_cvt_pk_bf16_f32 v109, v62, v63
v_mfma_f32_16x16x32_bf16 a[88:91], a[200:203], v[88:91], a[88:91]
v_exp_f32 v79, v79
v_mfma_f32_16x16x32_bf16 a[120:123], a[200:203], v[92:95], a[120:123]
buffer_load_dwordx4 v250, s[16:19], s41 offen offset:3072 lds
v_mfma_f32_16x16x32_bf16 a[92:95], a[204:207], v[88:91], a[92:95]
v_cvt_pk_bf16_f32 v110, v76, v77
v_mfma_f32_16x16x32_bf16 a[124:127], a[204:207], v[92:95], a[124:127]
v_cvt_pk_bf16_f32 v111, v78, v79
s_waitcnt lgkmcnt(0)
v_mfma_f32_16x16x32_bf16 v[56:59], a[144:147], v[176:179], v[120:123]
v_exp_f32 v24, v24
v_mfma_f32_16x16x32_bf16 v[60:63], a[144:147], v[192:195], v[124:127]
ds_read_b128 a[176:179], v2 offset:18432
ds_read_b128 a[180:183], v2 offset:19456
v_mfma_f32_16x16x32_bf16 v[56:59], a[148:151], v[180:183], v[56:59]
v_exp_f32 v25, v25
v_mfma_f32_16x16x32_bf16 v[60:63], a[148:151], v[196:199], v[60:63]
ds_read_b128 a[184:187], v2 offset:22528
ds_read_b128 a[188:191], v2 offset:23552
v_mfma_f32_16x16x32_bf16 v[56:59], a[152:155], v[184:187], v[56:59]
v_exp_f32 v26, v26
v_mfma_f32_16x16x32_bf16 v[60:63], a[152:155], v[200:203], v[60:63]
v_cvt_pk_bf16_f32 v88, v24, v25
s_waitcnt vmcnt(12)
v_mfma_f32_16x16x32_bf16 v[56:59], a[156:159], v[188:191], v[56:59]
v_exp_f32 v27, v27
v_mfma_f32_16x16x32_bf16 v[60:63], a[156:159], v[204:207], v[60:63]
v_cvt_pk_bf16_f32 v89, v26, v27
s_barrier
s_add_u32 m0, s39, 0
v_mfma_f32_16x16x32_bf16 v[72:75], a[160:163], v[176:179], v[136:139]
v_exp_f32 v40, v40
v_mfma_f32_16x16x32_bf16 v[76:79], a[160:163], v[192:195], v[140:143]
ds_read_b128 a[192:195], v2 offset:26624
ds_read_b128 a[196:199], v2 offset:27648
v_mfma_f32_16x16x32_bf16 v[72:75], a[164:167], v[180:183], v[72:75]
v_exp_f32 v41, v41
v_mfma_f32_16x16x32_bf16 v[76:79], a[164:167], v[196:199], v[76:79]
ds_read_b128 a[200:203], v2 offset:30720
ds_read_b128 a[204:207], v2 offset:31744
v_mfma_f32_16x16x32_bf16 v[72:75], a[168:171], v[184:187], v[72:75]
v_exp_f32 v42, v42
v_mfma_f32_16x16x32_bf16 v[76:79], a[168:171], v[200:203], v[76:79]
buffer_load_dwordx4 v251, s[16:19], s41 offen offset:0 lds
v_mfma_f32_16x16x32_bf16 v[72:75], a[172:175], v[188:191], v[72:75]
v_exp_f32 v43, v43
v_mfma_f32_16x16x32_bf16 v[76:79], a[172:175], v[204:207], v[76:79]
ds_read_b128 a[144:147], v3 offset:0
ds_read_b128 a[148:151], v3 offset:1024
v_mfma_f32_16x16x32_bf16 a[136:139], a[208:211], v[104:107], a[136:139]
v_exp_f32 v28, v28
v_mfma_f32_16x16x32_bf16 a[140:143], a[208:211], v[108:111], a[140:143]
ds_read_b128 a[152:155], v3 offset:4096
ds_read_b128 a[156:159], v3 offset:5120
s_waitcnt lgkmcnt(4)
v_mfma_f32_16x16x32_bf16 a[64:67], a[176:179], v[104:107], a[64:67]
v_exp_f32 v29, v29
v_mfma_f32_16x16x32_bf16 a[96:99], a[176:179], v[108:111], a[96:99]
buffer_load_dwordx4 v251, s[16:19], s41 offen offset:1024 lds
v_mfma_f32_16x16x32_bf16 a[68:71], a[180:183], v[104:107], a[68:71]
v_exp_f32 v30, v30
v_mfma_f32_16x16x32_bf16 a[100:103], a[180:183], v[108:111], a[100:103]
ds_read_b128 a[160:163], v3 offset:8192
ds_read_b128 a[164:167], v3 offset:9216
v_mfma_f32_16x16x32_bf16 a[72:75], a[184:187], v[104:107], a[72:75]
v_exp_f32 v31, v31
v_mfma_f32_16x16x32_bf16 a[104:107], a[184:187], v[108:111], a[104:107]
ds_read_b128 a[168:171], v3 offset:12288
ds_read_b128 a[172:175], v3 offset:13312
v_mfma_f32_16x16x32_bf16 a[76:79], a[188:191], v[104:107], a[76:79]
v_exp_f32 v44, v44
v_mfma_f32_16x16x32_bf16 a[108:111], a[188:191], v[108:111], a[108:111]
buffer_load_dwordx4 v251, s[16:19], s41 offen offset:2048 lds
v_mfma_f32_16x16x32_bf16 a[80:83], a[192:195], v[104:107], a[80:83]
v_exp_f32 v45, v45
v_mfma_f32_16x16x32_bf16 a[112:115], a[192:195], v[108:111], a[112:115]
v_cvt_pk_bf16_f32 v90, v40, v41
v_cvt_pk_bf16_f32 v91, v42, v43
v_mfma_f32_16x16x32_bf16 a[84:87], a[196:199], v[104:107], a[84:87]
v_exp_f32 v46, v46
v_mfma_f32_16x16x32_bf16 a[116:119], a[196:199], v[108:111], a[116:119]
v_cvt_pk_bf16_f32 v92, v28, v29
v_cvt_pk_bf16_f32 v93, v30, v31
v_mfma_f32_16x16x32_bf16 a[88:91], a[200:203], v[104:107], a[88:91]
v_exp_f32 v47, v47
v_mfma_f32_16x16x32_bf16 a[120:123], a[200:203], v[108:111], a[120:123]
buffer_load_dwordx4 v251, s[16:19], s41 offen offset:3072 lds
v_mfma_f32_16x16x32_bf16 a[92:95], a[204:207], v[104:107], a[92:95]
v_cvt_pk_bf16_f32 v94, v44, v45
v_mfma_f32_16x16x32_bf16 a[124:127], a[204:207], v[108:111], a[124:127]
v_cvt_pk_bf16_f32 v95, v46, v47
s_waitcnt lgkmcnt(0)
v_xor_b32 v2, 0x10000, v2
v_xor_b32 v3, 0x10000, v3
s_xor_b32 s39, s39, 0x10000
s_xor_b32 s40, s40, 0x10000
s_add_u32 s41, s41, 65536
s_sub_u32 s42, s42, 1
s_cmp_lg_u32 s42, 0
s_cbranch_scc1 K2_SINGLE_B
K2_SINGLEM:
s_cmp_eq_u32 s36, 0
s_cbranch_scc0 K2_MK27
v_cndmask_b32 v120, v216, v210, s[60:61]
v_cndmask_b32 v121, v216, v210, s[62:63]
v_cndmask_b32 v122, v216, v210, s[64:65]
v_cndmask_b32 v123, v216, v210, s[66:67]
K2_MK27:
s_cmp_eq_u32 s36, 1
s_cbranch_scc0 K2_MK28
v_cndmask_b32 v136, v216, v210, s[60:61]
v_cndmask_b32 v137, v216, v210, s[62:63]
v_cndmask_b32 v138, v216, v210, s[64:65]
v_cndmask_b32 v139, v216, v210, s[66:67]
K2_MK28:
s_cmp_lt_u32 s36, 1
s_cbranch_scc0 K2_ML28
v_mov_b32 v136, v216
v_mov_b32 v137, v216
v_mov_b32 v138, v216
v_mov_b32 v139, v216
K2_ML28:
s_nop 1
v_mfma_f32_16x16x32_bf16 v[24:27], a[144:147], v[176:179], v[120:123]
v_exp_f32 v56, v56
v_mfma_f32_16x16x32_bf16 v[28:31], a[144:147], v[192:195], v[124:127]
ds_read_b128 a[176:179], v3 offset:34816
ds_read_b128 a[180:183], v3 offset:35840
v_mfma_f32_16x16x32_bf16 v[24:27], a[148:151], v[180:183], v[24:27]
v_exp_f32 v57, v57
v_mfma_f32_16x16x32_bf16 v[28:31], a[148:151], v[196:199], v[28:31]
ds_read_b128 a[184:187], v3 offset:38912
ds_read_b128 a[188:191], v3 offset:39936
v_mfma_f32_16x16x32_bf16 v[24:27], a[152:155], v[184:187], v[24:27]
v_exp_f32 v58, v58
v_mfma_f32_16x16x32_bf16 v[28:31], a[152:155], v[200:203], v[28:31]
ds_read_b128 a[192:195], v3 offset:43008
ds_read_b128 a[196:199], v3 offset:44032
v_mfma_f32_16x16x32_bf16 v[24:27], a[156:159], v[188:191], v[24:27]
v_exp_f32 v59, v59
v_mfma_f32_16x16x32_bf16 v[28:31], a[156:159], v[204:207], v[28:31]
ds_read_b128 a[200:203], v3 offset:47104
ds_read_b128 a[204:207], v3 offset:48128
v_mfma_f32_16x16x32_bf16 v[40:43], a[160:163], v[176:179], v[136:139]
v_exp_f32 v72, v72
v_mfma_f32_16x16x32_bf16 v[44:47], a[160:163], v[192:195], v[140:143]
v_cvt_pk_bf16_f32 v104, v56, v57
s_waitcnt vmcnt(12)
v_mfma_f32_16x16x32_bf16 v[40:43], a[164:167], v[180:183], v[40:43]
v_exp_f32 v73, v73
v_mfma_f32_16x16x32_bf16 v[44:47], a[164:167], v[196:199], v[44:47]
v_cvt_pk_bf16_f32 v105, v58, v59
s_barrier
v_mfma_f32_16x16x32_bf16 v[40:43], a[168:171], v[184:187], v[40:43]
v_exp_f32 v74, v74
v_mfma_f32_16x16x32_bf16 v[44:47], a[168:171], v[200:203], v[44:47]
v_mfma_f32_16x16x32_bf16 v[40:43], a[172:175], v[188:191], v[40:43]
v_exp_f32 v75, v75
v_mfma_f32_16x16x32_bf16 v[44:47], a[172:175], v[204:207], v[44:47]
ds_read_b128 a[144:147], v2 offset:16384
ds_read_b128 a[148:151], v2 offset:17408
v_mfma_f32_16x16x32_bf16 a[136:139], a[208:211], v[88:91], a[136:139]
v_exp_f32 v60, v60
v_mfma_f32_16x16x32_bf16 a[140:143], a[208:211], v[92:95], a[140:143]
ds_read_b128 a[152:155], v2 offset:20480
ds_read_b128 a[156:159], v2 offset:21504
s_waitcnt lgkmcnt(4)
v_mfma_f32_16x16x32_bf16 a[64:67], a[176:179], v[88:91], a[64:67]
v_exp_f32 v61, v61
v_mfma_f32_16x16x32_bf16 a[96:99], a[176:179], v[92:95], a[96:99]
v_mfma_f32_16x16x32_bf16 a[68:71], a[180:183], v[88:91], a[68:71]
v_exp_f32 v62, v62
v_mfma_f32_16x16x32_bf16 a[100:103], a[180:183], v[92:95], a[100:103]
ds_read_b128 a[160:163], v2 offset:24576
ds_read_b128 a[164:167], v2 offset:25600
v_mfma_f32_16x16x32_bf16 a[72:75], a[184:187], v[88:91], a[72:75]
v_exp_f32 v63, v63
v_mfma_f32_16x16x32_bf16 a[104:107], a[184:187], v[92:95], a[104:107]
ds_read_b128 a[168:171], v2 offset:28672
ds_read_b128 a[172:175], v2 offset:29696
v_mfma_f32_16x16x32_bf16 a[76:79], a[188:191], v[88:91], a[76:79]
v_exp_f32 v76, v76
v_mfma_f32_16x16x32_bf16 a[108:111], a[188:191], v[92:95], a[108:111]
v_mfma_f32_16x16x32_bf16 a[80:83], a[192:195], v[88:91], a[80:83]
v_exp_f32 v77, v77
v_mfma_f32_16x16x32_bf16 a[112:115], a[192:195], v[92:95], a[112:115]
v_cvt_pk_bf16_f32 v106, v72, v73
v_cvt_pk_bf16_f32 v107, v74, v75
v_mfma_f32_16x16x32_bf16 a[84:87], a[196:199], v[88:91], a[84:87]
v_exp_f32 v78, v78
v_mfma_f32_16x16x32_bf16 a[116:119], a[196:199], v[92:95], a[116:119]
v_cvt_pk_bf16_f32 v108, v60, v61
v_cvt_pk_bf16_f32 v109, v62, v63
v_mfma_f32_16x16x32_bf16 a[88:91], a[200:203], v[88:91], a[88:91]
v_exp_f32 v79, v79
v_mfma_f32_16x16x32_bf16 a[120:123], a[200:203], v[92:95], a[120:123]
v_mfma_f32_16x16x32_bf16 a[92:95], a[204:207], v[88:91], a[92:95]
v_cvt_pk_bf16_f32 v110, v76, v77
v_mfma_f32_16x16x32_bf16 a[124:127], a[204:207], v[92:95], a[124:127]
v_cvt_pk_bf16_f32 v111, v78, v79
s_waitcnt lgkmcnt(0)
s_cmp_eq_u32 s36, 2
s_cbranch_scc0 K2_MK29
v_cndmask_b32 v120, v216, v210, s[60:61]
v_cndmask_b32 v121, v216, v210, s[62:63]
v_cndmask_b32 v122, v216, v210, s[64:65]
v_cndmask_b32 v123, v216, v210, s[66:67]
K2_MK29:
s_cmp_lt_u32 s36, 2
s_cbranch_scc0 K2_ML29
v_mov_b32 v120, v216
v_mov_b32 v121, v216
v_mov_b32 v122, v216
v_mov_b32 v123, v216
K2_ML29:
s_cmp_eq_u32 s36, 3
s_cbranch_scc0 K2_MK30
v_cndmask_b32 v136, v216, v210, s[60:61]
v_cndmask_b32 v137, v216, v210, s[62:63]
v_cndmask_b32 v138, v216, v210, s[64:65]
v_cndmask_b32 v139, v216, v210, s[66:67]
K2_MK30:
s_cmp_lt_u32 s36, 3
s_cbranch_scc0 K2_ML30
v_mov_b32 v136, v216
v_mov_b32 v137, v216
v_mov_b32 v138, v216
v_mov_b32 v139, v216
K2_ML30:
s_nop 1
v_mfma_f32_16x16x32_bf16 v[56:59], a[144:147], v[176:179], v[120:123]
v_exp_f32 v24, v24
v_mfma_f32_16x16x32_bf16 v[60:63], a[144:147], v[192:195], v[124:127]
ds_read_b128 a[176:179], v3 offset:51200
ds_read_b128 a[180:183], v3 offset:52224
v_mfma_f32_16x16x32_bf16 v[56:59], a[148:151], v[180:183], v[56:59]
v_exp_f32 v25, v25
v_mfma_f32_16x16x32_bf16 v[60:63], a[148:151], v[196:199], v[60:63]
ds_read_b128 a[184:187], v3 offset:55296
ds_read_b128 a[188:191], v3 offset:56320
v_mfma_f32_16x16x32_bf16 v[56:59], a[152:155], v[184:187], v[56:59]
v_exp_f32 v26, v26
v_mfma_f32_16x16x32_bf16 v[60:63], a[152:155], v[200:203], v[60:63]
ds_read_b128 a[192:195], v3 offset:59392
ds_read_b128 a[196:199], v3 offset:60416
v_mfma_f32_16x16x32_bf16 v[56:59], a[156:159], v[188:191], v[56:59]
v_exp_f32 v27, v27
v_mfma_f32_16x16x32_bf16 v[60:63], a[156:159], v[204:207], v[60:63]
ds_read_b128 a[200:203], v3 offset:63488
ds_read_b128 a[204:207], v3 offset:64512
v_mfma_f32_16x16x32_bf16 v[72:75], a[160:163], v[176:179], v[136:139]
v_exp_f32 v40, v40
v_mfma_f32_16x16x32_bf16 v[76:79], a[160:163], v[192:195], v[140:143]
v_cvt_pk_bf16_f32 v88, v24, v25
s_waitcnt vmcnt(8)
v_mfma_f32_16x16x32_bf16 v[72:75], a[164:167], v[180:183], v[72:75]
v_exp_f32 v41, v41
v_mfma_f32_16x16x32_bf16 v[76:79], a[164:167], v[196:199], v[76:79]
v_cvt_pk_bf16_f32 v89, v26, v27
s_barrier
v_mfma_f32_16x16x32_bf16 v[72:75], a[168:171], v[184:187], v[72:75]
v_exp_f32 v42, v42
v_mfma_f32_16x16x32_bf16 v[76:79], a[168:171], v[200:203], v[76:79]
v_mfma_f32_16x16x32_bf16 v[72:75], a[172:175], v[188:191], v[72:75]
v_exp_f32 v43, v43
v_mfma_f32_16x16x32_bf16 v[76:79], a[172:175], v[204:207], v[76:79]
ds_read_b128 a[144:147], v2 offset:32768
ds_read_b128 a[148:151], v2 offset:33792
v_mfma_f32_16x16x32_bf16 a[136:139], a[208:211], v[104:107], a[136:139]
v_exp_f32 v28, v28
v_mfma_f32_16x16x32_bf16 a[140:143], a[208:211], v[108:111], a[140:143]
ds_read_b128 a[152:155], v2 offset:36864
ds_read_b128 a[156:159], v2 offset:37888
s_waitcnt lgkmcnt(4)
v_mfma_f32_16x16x32_bf16 a[64:67], a[176:179], v[104:107], a[64:67]
v_exp_f32 v29, v29
v_mfma_f32_16x16x32_bf16 a[96:99], a[176:179], v[108:111], a[96:99]
v_mfma_f32_16x16x32_bf16 a[68:71], a[180:183], v[104:107], a[68:71]
v_exp_f32 v30, v30
v_mfma_f32_16x16x32_bf16 a[100:103], a[180:183], v[108:111], a[100:103]
ds_read_b128 a[160:163], v2 offset:40960
ds_read_b128 a[164:167], v2 offset:41984
v_mfma_f32_16x16x32_bf16 a[72:75], a[184:187], v[104:107], a[72:75]
v_exp_f32 v31, v31
v_mfma_f32_16x16x32_bf16 a[104:107], a[184:187], v[108:111], a[104:107]
ds_read_b128 a[168:171], v2 offset:45056
ds_read_b128 a[172:175], v2 offset:46080
v_mfma_f32_16x16x32_bf16 a[76:79], a[188:191], v[104:107], a[76:79]
v_exp_f32 v44, v44
v_mfma_f32_16x16x32_bf16 a[108:111], a[188:191], v[108:111], a[108:111]
v_mfma_f32_16x16x32_bf16 a[80:83], a[192:195], v[104:107], a[80:83]
v_exp_f32 v45, v45
v_mfma_f32_16x16x32_bf16 a[112:115], a[192:195], v[108:111], a[112:115]
v_cvt_pk_bf16_f32 v90, v40, v41
v_cvt_pk_bf16_f32 v91, v42, v43
v_mfma_f32_16x16x32_bf16 a[84:87], a[196:199], v[104:107], a[84:87]
v_exp_f32 v46, v46
v_mfma_f32_16x16x32_bf16 a[116:119], a[196:199], v[108:111], a[116:119]
v_cvt_pk_bf16_f32 v92, v28, v29
v_cvt_pk_bf16_f32 v93, v30, v31
v_mfma_f32_16x16x32_bf16 a[88:91], a[200:203], v[104:107], a[88:91]
v_exp_f32 v47, v47
v_mfma_f32_16x16x32_bf16 a[120:123], a[200:203], v[108:111], a[120:123]
v_mfma_f32_16x16x32_bf16 a[92:95], a[204:207], v[104:107], a[92:95]
v_cvt_pk_bf16_f32 v94, v44, v45
v_mfma_f32_16x16x32_bf16 a[124:127], a[204:207], v[108:111], a[124:127]
v_cvt_pk_bf16_f32 v95, v46, v47
s_waitcnt lgkmcnt(0)
s_cmp_eq_u32 s36, 3
s_cbranch_scc0 K2_MK31
v_cndmask_b32 v124, v216, v211, s[60:61]
v_cndmask_b32 v125, v216, v211, s[62:63]
v_cndmask_b32 v126, v216, v211, s[64:65]
v_cndmask_b32 v127, v216, v211, s[66:67]
K2_MK31:
s_cmp_eq_u32 s36, 2
s_cbranch_scc0 K2_MK32
v_cndmask_b32 v140, v216, v211, s[60:61]
v_cndmask_b32 v141, v216, v211, s[62:63]
v_cndmask_b32 v142, v216, v211, s[64:65]
v_cndmask_b32 v143, v216, v211, s[66:67]
K2_MK32:
s_cmp_gt_u32 s36, 2
s_cbranch_scc0 K2_ML32
v_mov_b32 v140, v216
v_mov_b32 v141, v216
v_mov_b32 v142, v216
v_mov_b32 v143, v216
K2_ML32:
s_nop 1
ds_read_b128 a[176:179], v2 offset:2048
ds_read_b128 a[180:183], v2 offset:3072
ds_read_b128 a[184:187], v2 offset:6144
ds_read_b128 a[188:191], v2 offset:7168
ds_read_b128 a[192:195], v2 offset:10240
ds_read_b128 a[196:199], v2 offset:11264
ds_read_b128 a[200:203], v2 offset:14336
ds_read_b128 a[204:207], v2 offset:15360
s_waitcnt lgkmcnt(0)
v_mfma_f32_16x16x32_bf16 v[28:31], a[144:147], v[192:195], v[124:127]
v_exp_f32 v56, v56
v_mfma_f32_16x16x32_bf16 v[28:31], a[148:151], v[196:199], v[28:31]
v_exp_f32 v57, v57
v_mfma_f32_16x16x32_bf16 v[28:31], a[152:155], v[200:203], v[28:31]
v_cvt_pk_bf16_f32 v104, v56, v57
v_mfma_f32_16x16x32_bf16 v[28:31], a[156:159], v[204:207], v[28:31]
v_exp_f32 v58, v58
v_mfma_f32_16x16x32_bf16 v[44:47], a[160:163], v[192:195], v[140:143]
v_exp_f32 v59, v59
v_mfma_f32_16x16x32_bf16 v[44:47], a[164:167], v[196:199], v[44:47]
v_cvt_pk_bf16_f32 v105, v58, v59
v_mfma_f32_16x16x32_bf16 v[44:47], a[168:171], v[200:203], v[44:47]
v_exp_f32 v72, v72
v_mfma_f32_16x16x32_bf16 v[44:47], a[172:175], v[204:207], v[44:47]
v_exp_f32 v73, v73
v_mfma_f32_16x16x32_bf16 a[136:139], a[208:211], v[88:91], a[136:139]
v_cvt_pk_bf16_f32 v106, v72, v73
s_waitcnt vmcnt(4)
v_mfma_f32_16x16x32_bf16 a[140:143], a[208:211], v[92:95], a[140:143]
v_exp_f32 v74, v74
v_mfma_f32_16x16x32_bf16 a[64:67], a[176:179], v[88:91], a[64:67]
v_exp_f32 v75, v75
v_mfma_f32_16x16x32_bf16 a[96:99], a[176:179], v[92:95], a[96:99]
v_cvt_pk_bf16_f32 v107, v74, v75
s_barrier
v_mfma_f32_16x16x32_bf16 a[68:71], a[180:183], v[88:91], a[68:71]
v_exp_f32 v60, v60
v_mfma_f32_16x16x32_bf16 a[100:103], a[180:183], v[92:95], a[100:103]
v_exp_f32 v61, v61
v_mfma_f32_16x16x32_bf16 a[72:75], a[184:187], v[88:91], a[72:75]
ds_read_b128 a[144:147], v2 offset:49152
v_cvt_pk_bf16_f32 v108, v60, v61
v_mfma_f32_16x16x32_bf16 a[104:107], a[184:187], v[92:95], a[104:107]
v_exp_f32 v62, v62
v_mfma_f32_16x16x32_bf16 a[76:79], a[188:191], v[88:91], a[76:79]
v_exp_f32 v63, v63
v_mfma_f32_16x16x32_bf16 a[108:111], a[188:191], v[92:95], a[108:111]
ds_read_b128 a[148:151], v2 offset:50176
v_cvt_pk_bf16_f32 v109, v62, v63
v_mfma_f32_16x16x32_bf16 a[80:83], a[192:195], v[88:91], a[80:83]
v_exp_f32 v76, v76
v_mfma_f32_16x16x32_bf16 a[112:115], a[192:195], v[92:95], a[112:115]
v_exp_f32 v77, v77
v_mfma_f32_16x16x32_bf16 a[84:87], a[196:199], v[88:91], a[84:87]
ds_read_b128 a[152:155], v2 offset:53248
ds_read_b128 a[156:159], v2 offset:54272
v_cvt_pk_bf16_f32 v110, v76, v77
v_mfma_f32_16x16x32_bf16 a[116:119], a[196:199], v[92:95], a[116:119]
ds_read_b128 a[160:163], v2 offset:57344
v_exp_f32 v78, v78
v_mfma_f32_16x16x32_bf16 a[88:91], a[200:203], v[88:91], a[88:91]
ds_read_b128 a[164:167], v2 offset:58368
ds_read_b128 a[168:171], v2 offset:61440
ds_read_b128 a[172:175], v2 offset:62464
v_exp_f32 v79, v79
v_mfma_f32_16x16x32_bf16 a[120:123], a[200:203], v[92:95], a[120:123]
v_cvt_pk_bf16_f32 v111, v78, v79
v_mfma_f32_16x16x32_bf16 a[92:95], a[204:207], v[88:91], a[92:95]
v_mfma_f32_16x16x32_bf16 a[124:127], a[204:207], v[92:95], a[124:127]
s_waitcnt lgkmcnt(0)
s_cmp_eq_u32 s36, 1
s_cbranch_scc0 K2_MK33
v_cndmask_b32 v124, v216, v211, s[60:61]
v_cndmask_b32 v125, v216, v211, s[62:63]
v_cndmask_b32 v126, v216, v211, s[64:65]
v_cndmask_b32 v127, v216, v211, s[66:67]
K2_MK33:
s_cmp_gt_u32 s36, 1
s_cbranch_scc0 K2_ML33
v_mov_b32 v124, v216
v_mov_b32 v125, v216
v_mov_b32 v126, v216
v_mov_b32 v127, v216
K2_ML33:
s_cmp_eq_u32 s36, 0
s_cbranch_scc0 K2_MK34
v_cndmask_b32 v140, v216, v211, s[60:61]
v_cndmask_b32 v141, v216, v211, s[62:63]
v_cndmask_b32 v142, v216, v211, s[64:65]
v_cndmask_b32 v143, v216, v211, s[66:67]
K2_MK34:
s_cmp_gt_u32 s36, 0
s_cbranch_scc0 K2_ML34
v_mov_b32 v140, v216
v_mov_b32 v141, v216
v_mov_b32 v142, v216
v_mov_b32 v143, v216
K2_ML34:
s_nop 1
ds_read_b128 a[176:179], v2 offset:18432
ds_read_b128 a[180:183], v2 offset:19456
ds_read_b128 a[184:187], v2 offset:22528
ds_read_b128 a[188:191], v2 offset:23552
ds_read_b128 a[192:195], v2 offset:26624
ds_read_b128 a[196:199], v2 offset:27648
ds_read_b128 a[200:203], v2 offset:30720
ds_read_b128 a[204:207], v2 offset:31744
s_waitcnt lgkmcnt(0)
v_mfma_f32_16x16x32_bf16 v[60:63], a[144:147], v[192:195], v[124:127]
v_exp_f32 v28, v28
v_mfma_f32_16x16x32_bf16 v[60:63], a[148:151], v[196:199], v[60:63]
v_mfma_f32_16x16x32_bf16 v[60:63], a[152:155], v[200:203], v[60:63]
v_mfma_f32_16x16x32_bf16 v[60:63], a[156:159], v[204:207], v[60:63]
v_exp_f32 v29, v29
v_mfma_f32_16x16x32_bf16 v[76:79], a[160:163], v[192:195], v[140:143]
v_cvt_pk_bf16_f32 v92, v28, v29
v_mfma_f32_16x16x32_bf16 v[76:79], a[164:167], v[196:199], v[76:79]
v_mfma_f32_16x16x32_bf16 v[76:79], a[168:171], v[200:203], v[76:79]
v_exp_f32 v30, v30
v_mfma_f32_16x16x32_bf16 v[76:79], a[172:175], v[204:207], v[76:79]
v_mfma_f32_16x16x32_bf16 a[136:139], a[208:211], v[104:107], a[136:139]
v_mfma_f32_16x16x32_bf16 a[140:143], a[208:211], v[108:111], a[140:143]
v_exp_f32 v31, v31
v_mfma_f32_16x16x32_bf16 a[64:67], a[176:179], v[104:107], a[64:67]
v_cvt_pk_bf16_f32 v93, v30, v31
v_mfma_f32_16x16x32_bf16 a[96:99], a[176:179], v[108:111], a[96:99]
v_mfma_f32_16x16x32_bf16 a[68:71], a[180:183], v[104:107], a[68:71]
v_exp_f32 v44, v44
v_mfma_f32_16x16x32_bf16 a[100:103], a[180:183], v[108:111], a[100:103]
v_mfma_f32_16x16x32_bf16 a[72:75], a[184:187], v[104:107], a[72:75]
v_mfma_f32_16x16x32_bf16 a[104:107], a[184:187], v[108:111], a[104:107]
v_exp_f32 v45, v45
v_mfma_f32_16x16x32_bf16 a[76:79], a[188:191], v[104:107], a[76:79]
v_cvt_pk_bf16_f32 v94, v44, v45
v_mfma_f32_16x16x32_bf16 a[108:111], a[188:191], v[108:111], a[108:111]
v_mfma_f32_16x16x32_bf16 a[80:83], a[192:195], v[104:107], a[80:83]
v_exp_f32 v46, v46
v_mfma_f32_16x16x32_bf16 a[112:115], a[192:195], v[108:111], a[112:115]
v_mfma_f32_16x16x32_bf16 a[84:87], a[196:199], v[104:107], a[84:87]
v_mfma_f32_16x16x32_bf16 a[116:119], a[196:199], v[108:111], a[116:119]
v_exp_f32 v47, v47
v_mfma_f32_16x16x32_bf16 a[88:91], a[200:203], v[104:107], a[88:91]
v_cvt_pk_bf16_f32 v95, v46, v47
v_mfma_f32_16x16x32_bf16 a[120:123], a[200:203], v[108:111], a[120:123]
v_xor_b32 v2, 0x10000, v2
v_xor_b32 v3, 0x10000, v3
v_mfma_f32_16x16x32_bf16 a[92:95], a[204:207], v[104:107], a[92:95]
s_xor_b32 s39, s39, 0x10000
s_xor_b32 s40, s40, 0x10000
v_mfma_f32_16x16x32_bf16 a[124:127], a[204:207], v[108:111], a[124:127]
K2_DRAIN:
ds_read_b128 a[176:179], v3 offset:34816
ds_read_b128 a[180:183], v3 offset:35840
ds_read_b128 a[184:187], v3 offset:38912
ds_read_b128 a[188:191], v3 offset:39936
ds_read_b128 a[192:195], v3 offset:43008
ds_read_b128 a[196:199], v3 offset:44032
ds_read_b128 a[200:203], v3 offset:47104
ds_read_b128 a[204:207], v3 offset:48128
s_waitcnt lgkmcnt(0)
v_mfma_f32_16x16x32_bf16 a[140:143], a[208:211], v[92:95], a[140:143]
v_exp_f32 v60, v60
v_mfma_f32_16x16x32_bf16 a[96:99], a[176:179], v[92:95], a[96:99]
v_exp_f32 v61, v61
v_mfma_f32_16x16x32_bf16 a[100:103], a[180:183], v[92:95], a[100:103]
v_exp_f32 v62, v62
v_mfma_f32_16x16x32_bf16 a[104:107], a[184:187], v[92:95], a[104:107]
v_exp_f32 v63, v63
v_mfma_f32_16x16x32_bf16 a[108:111], a[188:191], v[92:95], a[108:111]
v_exp_f32 v76, v76
v_mfma_f32_16x16x32_bf16 a[112:115], a[192:195], v[92:95], a[112:115]
v_exp_f32 v77, v77
v_mfma_f32_16x16x32_bf16 a[116:119], a[196:199], v[92:95], a[116:119]
v_exp_f32 v78, v78
v_cvt_pk_bf16_f32 v110, v76, v77
v_mfma_f32_16x16x32_bf16 a[120:123], a[200:203], v[92:95], a[120:123]
v_exp_f32 v79, v79
v_mfma_f32_16x16x32_bf16 a[124:127], a[204:207], v[92:95], a[124:127]
v_cvt_pk_bf16_f32 v108, v60, v61
v_cvt_pk_bf16_f32 v109, v62, v63
v_cvt_pk_bf16_f32 v111, v78, v79
ds_read_b128 a[176:179], v3 offset:51200
ds_read_b128 a[180:183], v3 offset:52224
ds_read_b128 a[184:187], v3 offset:55296
ds_read_b128 a[188:191], v3 offset:56320
ds_read_b128 a[192:195], v3 offset:59392
ds_read_b128 a[196:199], v3 offset:60416
ds_read_b128 a[200:203], v3 offset:63488
ds_read_b128 a[204:207], v3 offset:64512
s_waitcnt lgkmcnt(0)
v_mfma_f32_16x16x32_bf16 a[140:143], a[208:211], v[108:111], a[140:143]
v_mfma_f32_16x16x32_bf16 a[96:99], a[176:179], v[108:111], a[96:99]
v_mfma_f32_16x16x32_bf16 a[100:103], a[180:183], v[108:111], a[100:103]
v_mfma_f32_16x16x32_bf16 a[104:107], a[184:187], v[108:111], a[104:107]
v_mfma_f32_16x16x32_bf16 a[108:111], a[188:191], v[108:111], a[108:111]
v_mfma_f32_16x16x32_bf16 a[112:115], a[192:195], v[108:111], a[112:115]
v_mfma_f32_16x16x32_bf16 a[116:119], a[196:199], v[108:111], a[116:119]
v_mfma_f32_16x16x32_bf16 a[120:123], a[200:203], v[108:111], a[120:123]
v_mfma_f32_16x16x32_bf16 a[124:127], a[204:207], v[108:111], a[124:127]
s_nop 7
v_accvgpr_read_b32 v217, a136
s_nop 0
v_cmp_nle_f32 vcc, v217, v220
s_nop 3
s_or_b64 s[48:49], s[48:49], vcc
v_rcp_f32 v217, v217
v_accvgpr_read_b32 v218, a140
s_nop 0
v_cmp_nle_f32 vcc, v218, v220
s_nop 3
s_or_b64 s[48:49], s[48:49], vcc
v_rcp_f32 v218, v218
v_mov_b32 v222, v217
v_mov_b32 v223, v217
s_lshl_b32 s43, s46, 17
s_lshl_b32 s44, s38, 12
s_add_u32 s43, s43, s44
v_accvgpr_read_b32 v224, a64
v_accvgpr_read_b32 v225, a65
v_accvgpr_read_b32 v226, a66
v_accvgpr_read_b32 v227, a67
v_accvgpr_read_b32 v228, a68
v_accvgpr_read_b32 v229, a69
v_accvgpr_read_b32 v230, a70
v_accvgpr_read_b32 v231, a71
v_pk_mul_f32 v[224:225], v[224:225], v[222:223]
v_pk_mul_f32 v[226:227], v[226:227], v[222:223]
v_pk_mul_f32 v[228:229], v[228:229], v[222:223]
v_pk_mul_f32 v[230:231], v[230:231], v[222:223]
v_cvt_pk_bf16_f32 v232, v224, v225
v_cvt_pk_bf16_f32 v233, v226, v227
v_cvt_pk_bf16_f32 v234, v228, v229
v_cvt_pk_bf16_f32 v235, v230, v231
buffer_store_dwordx4 v[232:235], v1, s[28:31], s43 offen offset:0 sc0 sc1
v_accvgpr_read_b32 v236, a72
v_accvgpr_read_b32 v237, a73
v_accvgpr_read_b32 v238, a74
v_accvgpr_read_b32 v239, a75
v_accvgpr_read_b32 v240, a76
v_accvgpr_read_b32 v241, a77
v_accvgpr_read_b32 v242, a78
v_accvgpr_read_b32 v243, a79
v_pk_mul_f32 v[236:237], v[236:237], v[222:223]
v_pk_mul_f32 v[238:239], v[238:239], v[222:223]
v_pk_mul_f32 v[240:241], v[240:241], v[222:223]
v_pk_mul_f32 v[242:243], v[242:243], v[222:223]
v_cvt_pk_bf16_f32 v244, v236, v237
v_cvt_pk_bf16_f32 v245, v238, v239
v_cvt_pk_bf16_f32 v246, v240, v241
v_cvt_pk_bf16_f32 v247, v242, v243
buffer_store_dwordx4 v[244:247], v1, s[28:31], s43 offen offset:1024 sc0 sc1
v_accvgpr_read_b32 v224, a80
v_accvgpr_read_b32 v225, a81
v_accvgpr_read_b32 v226, a82
v_accvgpr_read_b32 v227, a83
v_accvgpr_read_b32 v228, a84
v_accvgpr_read_b32 v229, a85
v_accvgpr_read_b32 v230, a86
v_accvgpr_read_b32 v231, a87
v_pk_mul_f32 v[224:225], v[224:225], v[222:223]
v_pk_mul_f32 v[226:227], v[226:227], v[222:223]
v_pk_mul_f32 v[228:229], v[228:229], v[222:223]
v_pk_mul_f32 v[230:231], v[230:231], v[222:223]
v_cvt_pk_bf16_f32 v232, v224, v225
v_cvt_pk_bf16_f32 v233, v226, v227
v_cvt_pk_bf16_f32 v234, v228, v229
v_cvt_pk_bf16_f32 v235, v230, v231
buffer_store_dwordx4 v[232:235], v1, s[28:31], s43 offen offset:2048 sc0 sc1
v_accvgpr_read_b32 v236, a88
v_accvgpr_read_b32 v237, a89
v_accvgpr_read_b32 v238, a90
v_accvgpr_read_b32 v239, a91
v_accvgpr_read_b32 v240, a92
v_accvgpr_read_b32 v241, a93
v_accvgpr_read_b32 v242, a94
v_accvgpr_read_b32 v243, a95
v_pk_mul_f32 v[236:237], v[236:237], v[222:223]
v_pk_mul_f32 v[238:239], v[238:239], v[222:223]
v_pk_mul_f32 v[240:241], v[240:241], v[222:223]
v_pk_mul_f32 v[242:243], v[242:243], v[222:223]
v_cvt_pk_bf16_f32 v244, v236, v237
v_cvt_pk_bf16_f32 v245, v238, v239
v_cvt_pk_bf16_f32 v246, v240, v241
v_cvt_pk_bf16_f32 v247, v242, v243
buffer_store_dwordx4 v[244:247], v1, s[28:31], s43 offen offset:3072 sc0 sc1
v_mov_b32 v222, v218
v_mov_b32 v223, v218
s_lshl_b32 s43, s79, 17
s_lshl_b32 s44, s38, 12
s_add_u32 s43, s43, s44
v_accvgpr_read_b32 v224, a96
v_accvgpr_read_b32 v225, a97
v_accvgpr_read_b32 v226, a98
v_accvgpr_read_b32 v227, a99
v_accvgpr_read_b32 v228, a100
v_accvgpr_read_b32 v229, a101
v_accvgpr_read_b32 v230, a102
v_accvgpr_read_b32 v231, a103
v_pk_mul_f32 v[224:225], v[224:225], v[222:223]
v_pk_mul_f32 v[226:227], v[226:227], v[222:223]
v_pk_mul_f32 v[228:229], v[228:229], v[222:223]
v_pk_mul_f32 v[230:231], v[230:231], v[222:223]
v_cvt_pk_bf16_f32 v232, v224, v225
v_cvt_pk_bf16_f32 v233, v226, v227
v_cvt_pk_bf16_f32 v234, v228, v229
v_cvt_pk_bf16_f32 v235, v230, v231
buffer_store_dwordx4 v[232:235], v1, s[28:31], s43 offen offset:0 sc0 sc1
v_accvgpr_read_b32 v236, a104
v_accvgpr_read_b32 v237, a105
v_accvgpr_read_b32 v238, a106
v_accvgpr_read_b32 v239, a107
v_accvgpr_read_b32 v240, a108
v_accvgpr_read_b32 v241, a109
v_accvgpr_read_b32 v242, a110
v_accvgpr_read_b32 v243, a111
v_pk_mul_f32 v[236:237], v[236:237], v[222:223]
v_pk_mul_f32 v[238:239], v[238:239], v[222:223]
v_pk_mul_f32 v[240:241], v[240:241], v[222:223]
v_pk_mul_f32 v[242:243], v[242:243], v[222:223]
v_cvt_pk_bf16_f32 v244, v236, v237
v_cvt_pk_bf16_f32 v245, v238, v239
v_cvt_pk_bf16_f32 v246, v240, v241
v_cvt_pk_bf16_f32 v247, v242, v243
buffer_store_dwordx4 v[244:247], v1, s[28:31], s43 offen offset:1024 sc0 sc1
v_accvgpr_read_b32 v224, a112
v_accvgpr_read_b32 v225, a113
v_accvgpr_read_b32 v226, a114
v_accvgpr_read_b32 v227, a115
v_accvgpr_read_b32 v228, a116
v_accvgpr_read_b32 v229, a117
v_accvgpr_read_b32 v230, a118
v_accvgpr_read_b32 v231, a119
v_pk_mul_f32 v[224:225], v[224:225], v[222:223]
v_pk_mul_f32 v[226:227], v[226:227], v[222:223]
v_pk_mul_f32 v[228:229], v[228:229], v[222:223]
v_pk_mul_f32 v[230:231], v[230:231], v[222:223]
v_cvt_pk_bf16_f32 v232, v224, v225
v_cvt_pk_bf16_f32 v233, v226, v227
v_cvt_pk_bf16_f32 v234, v228, v229
v_cvt_pk_bf16_f32 v235, v230, v231
buffer_store_dwordx4 v[232:235], v1, s[28:31], s43 offen offset:2048 sc0 sc1
v_accvgpr_read_b32 v236, a120
v_accvgpr_read_b32 v237, a121
v_accvgpr_read_b32 v238, a122
v_accvgpr_read_b32 v239, a123
v_accvgpr_read_b32 v240, a124
v_accvgpr_read_b32 v241, a125
v_accvgpr_read_b32 v242, a126
v_accvgpr_read_b32 v243, a127
v_pk_mul_f32 v[236:237], v[236:237], v[222:223]
v_pk_mul_f32 v[238:239], v[238:239], v[222:223]
v_pk_mul_f32 v[240:241], v[240:241], v[222:223]
v_pk_mul_f32 v[242:243], v[242:243], v[222:223]
v_cvt_pk_bf16_f32 v244, v236, v237
v_cvt_pk_bf16_f32 v245, v238, v239
v_cvt_pk_bf16_f32 v246, v240, v241
v_cvt_pk_bf16_f32 v247, v242, v243
buffer_store_dwordx4 v[244:247], v1, s[28:31], s43 offen offset:3072 sc0 sc1
s_cmp_eq_u32 s71, 1
s_cbranch_scc1 K2_OK
s_cmp_lg_u64 s[48:49], 0
s_cselect_b32 s43, 1, 0
v_mov_b32 v224, s43
s_lshl_b32 s44, s36, 2
s_add_u32 s44, s44, 131072
v_mov_b32 v225, s44
ds_write_b32 v225, v224
s_waitcnt lgkmcnt(0)
s_barrier
v_mov_b32 v225, 131072
ds_read_b128 v[228:231], v225
s_waitcnt lgkmcnt(0)
v_or3_b32 v228, v228, v229, v230
v_or_b32 v228, v228, v231
s_nop 0
v_readfirstlane_b32 s43, v228
s_nop 3
s_cmp_eq_u32 s43, 0
s_cbranch_scc1 K2_OK
s_waitcnt vmcnt(0)
s_barrier
v_mov_b32 v224, 0xff61b1e6
v_mov_b32 v208, 0
v_mov_b32 v112, 0
v_mov_b32 v113, 0
v_mov_b32 v114, 0
v_mov_b32 v115, 0
v_mov_b32 v128, 0
v_mov_b32 v129, 0
v_mov_b32 v130, 0
v_mov_b32 v131, 0
v_mov_b32 v225, 0xff61b1e6
v_mov_b32 v209, 0
v_mov_b32 v116, 0
v_mov_b32 v117, 0
v_mov_b32 v118, 0
v_mov_b32 v119, 0
v_mov_b32 v132, 0
v_mov_b32 v133, 0
v_mov_b32 v134, 0
v_mov_b32 v135, 0
v_mov_b32 v226, 0xff61b1e6
v_mov_b32 v210, 0
v_mov_b32 v120, 0
v_mov_b32 v121, 0
v_mov_b32 v122, 0
v_mov_b32 v123, 0
v_mov_b32 v136, 0
v_mov_b32 v137, 0
v_mov_b32 v138, 0
v_mov_b32 v139, 0
v_mov_b32 v227, 0xff61b1e6
v_mov_b32 v211, 0
v_mov_b32 v124, 0
v_mov_b32 v125, 0
v_mov_b32 v126, 0
v_mov_b32 v127, 0
v_mov_b32 v140, 0
v_mov_b32 v141, 0
v_mov_b32 v142, 0
v_mov_b32 v143, 0
s_mov_b32 s72, 0
s_sub_u32 s73, 16, s37
s_lshl_b32 s73, s73, 2
K2_FB_LOOP:
s_lshl_b32 s74, s37, 2
s_sub_i32 s74, s72, s74
s_mov_b32 s75, s36
s_lshl_b32 s43, s74, 1
s_add_i32 s43, s43, 0
s_cmp_eq_i32 s43, s75
s_cbranch_scc0 K2_FB_B00a
v_cndmask_b32 v112, v216, v208, s[60:61]
v_cndmask_b32 v113, v216, v208, s[62:63]
v_cndmask_b32 v114, v216, v208, s[64:65]
v_cndmask_b32 v115, v216, v208, s[66:67]
K2_FB_B00a:
s_cmp_gt_i32 s43, s75
s_cbranch_scc0 K2_FB_B00b
v_mov_b32 v112, v216
v_mov_b32 v113, v216
v_mov_b32 v114, v216
v_mov_b32 v115, v216
K2_FB_B00b:
s_lshl_b32 s43, s74, 1
s_add_i32 s43, s43, 1
s_cmp_eq_i32 s43, s75
s_cbranch_scc0 K2_FB_B01a
v_cndmask_b32 v128, v216, v208, s[60:61]
v_cndmask_b32 v129, v216, v208, s[62:63]
v_cndmask_b32 v130, v216, v208, s[64:65]
v_cndmask_b32 v131, v216, v208, s[66:67]
K2_FB_B01a:
s_cmp_gt_i32 s43, s75
s_cbranch_scc0 K2_FB_B01b
v_mov_b32 v128, v216
v_mov_b32 v129, v216
v_mov_b32 v130, v216
v_mov_b32 v131, v216
K2_FB_B01b:
s_sub_u32 s75, 7, s36
s_lshl_b32 s43, s74, 1
s_add_i32 s43, s43, 0
s_cmp_eq_i32 s43, s75
s_cbranch_scc0 K2_FB_B10a
v_cndmask_b32 v116, v216, v209, s[60:61]
v_cndmask_b32 v117, v216, v209, s[62:63]
v_cndmask_b32 v118, v216, v209, s[64:65]
v_cndmask_b32 v119, v216, v209, s[66:67]
K2_FB_B10a:
s_cmp_gt_i32 s43, s75
s_cbranch_scc0 K2_FB_B10b
v_mov_b32 v116, v216
v_mov_b32 v117, v216
v_mov_b32 v118, v216
v_mov_b32 v119, v216
K2_FB_B10b:
s_lshl_b32 s43, s74, 1
s_add_i32 s43, s43, 1
s_cmp_eq_i32 s43, s75
s_cbranch_scc0 K2_FB_B11a
v_cndmask_b32 v132, v216, v209, s[60:61]
v_cndmask_b32 v133, v216, v209, s[62:63]
v_cndmask_b32 v134, v216, v209, s[64:65]
v_cndmask_b32 v135, v216, v209, s[66:67]
K2_FB_B11a:
s_cmp_gt_i32 s43, s75
s_cbranch_scc0 K2_FB_B11b
v_mov_b32 v132, v216
v_mov_b32 v133, v216
v_mov_b32 v134, v216
v_mov_b32 v135, v216
K2_FB_B11b:
s_sub_u32 s74, 15, s37
s_lshl_b32 s74, s74, 2
s_sub_i32 s74, s72, s74
s_mov_b32 s75, s36
s_lshl_b32 s43, s74, 1
s_add_i32 s43, s43, 0
s_cmp_eq_i32 s43, s75
s_cbranch_scc0 K2_FB_A00a
v_cndmask_b32 v120, v216, v210, s[60:61]
v_cndmask_b32 v121, v216, v210, s[62:63]
v_cndmask_b32 v122, v216, v210, s[64:65]
v_cndmask_b32 v123, v216, v210, s[66:67]
K2_FB_A00a:
s_cmp_gt_i32 s43, s75
s_cbranch_scc0 K2_FB_A00b
v_mov_b32 v120, v216
v_mov_b32 v121, v216
v_mov_b32 v122, v216
v_mov_b32 v123, v216
K2_FB_A00b:
s_lshl_b32 s43, s74, 1
s_add_i32 s43, s43, 1
s_cmp_eq_i32 s43, s75
s_cbranch_scc0 K2_FB_A01a
v_cndmask_b32 v136, v216, v210, s[60:61]
v_cndmask_b32 v137, v216, v210, s[62:63]
v_cndmask_b32 v138, v216, v210, s[64:65]
v_cndmask_b32 v139, v216, v210, s[66:67]
K2_FB_A01a:
s_cmp_gt_i32 s43, s75
s_cbranch_scc0 K2_FB_A01b
v_mov_b32 v136, v216
v_mov_b32 v137, v216
v_mov_b32 v138, v216
v_mov_b32 v139, v216
K2_FB_A01b:
s_sub_u32 s75, 7, s36
s_lshl_b32 s43, s74, 1
s_add_i32 s43, s43, 0
s_cmp_eq_i32 s43, s75
s_cbranch_scc0 K2_FB_A10a
v_cndmask_b32 v124, v216, v211, s[60:61]
v_cndmask_b32 v125, v216, v211, s[62:63]
v_cndmask_b32 v126, v216, v211, s[64:65]
v_cndmask_b32 v127, v216, v211, s[66:67]
K2_FB_A10a:
s_cmp_gt_i32 s43, s75
s_cbranch_scc0 K2_FB_A10b
v_mov_b32 v124, v216
v_mov_b32 v125, v216
v_mov_b32 v126, v216
v_mov_b32 v127, v216
K2_FB_A10b:
s_lshl_b32 s43, s74, 1
s_add_i32 s43, s43, 1
s_cmp_eq_i32 s43, s75
s_cbranch_scc0 K2_FB_A11a
v_cndmask_b32 v140, v216, v211, s[60:61]
v_cndmask_b32 v141, v216, v211, s[62:63]
v_cndmask_b32 v142, v216, v211, s[64:65]
v_cndmask_b32 v143, v216, v211, s[66:67]
K2_FB_A11a:
s_cmp_gt_i32 s43, s75
s_cbranch_scc0 K2_FB_A11b
v_mov_b32 v140, v216
v_mov_b32 v141, v216
v_mov_b32 v142, v216
v_mov_b32 v143, v216
K2_FB_A11b:
s_lshl_b32 s43, s38, 6
s_add_u32 s43, s43, s72
s_lshl_b32 s43, s43, 14
buffer_load_dwordx4 a[144:147], v1, s[16:19], s43 offen offset:0
buffer_load_dwordx4 a[148:151], v1, s[16:19], s43 offen offset:1024
s_add_u32 s43, s43, 4096
buffer_load_dwordx4 a[152:155], v1, s[16:19], s43 offen offset:0
buffer_load_dwordx4 a[156:159], v1, s[16:19], s43 offen offset:1024
s_add_u32 s43, s43, 4096
buffer_load_dwordx4 a[160:163], v1, s[16:19], s43 offen offset:0
buffer_load_dwordx4 a[164:167], v1, s[16:19], s43 offen offset:1024
s_add_u32 s43, s43, 4096
buffer_load_dwordx4 a[168:171], v1, s[16:19], s43 offen offset:0
buffer_load_dwordx4 a[172:175], v1, s[16:19], s43 offen offset:1024
s_waitcnt vmcnt(0)
v_mfma_f32_16x16x32_bf16 v[16:19], a[144:147], v[144:147], v[112:115]
v_mfma_f32_16x16x32_bf16 v[20:23], a[144:147], v[160:163], v[116:119]
v_mfma_f32_16x16x32_bf16 v[24:27], a[144:147], v[176:179], v[120:123]
v_mfma_f32_16x16x32_bf16 v[28:31], a[144:147], v[192:195], v[124:127]
v_mfma_f32_16x16x32_bf16 v[16:19], a[148:151], v[148:151], v[16:19]
v_mfma_f32_16x16x32_bf16 v[20:23], a[148:151], v[164:167], v[20:23]
v_mfma_f32_16x16x32_bf16 v[24:27], a[148:151], v[180:183], v[24:27]
v_mfma_f32_16x16x32_bf16 v[28:31], a[148:151], v[196:199], v[28:31]
v_mfma_f32_16x16x32_bf16 v[16:19], a[152:155], v[152:155], v[16:19]
v_mfma_f32_16x16x32_bf16 v[20:23], a[152:155], v[168:171], v[20:23]
v_mfma_f32_16x16x32_bf16 v[24:27], a[152:155], v[184:187], v[24:27]
v_mfma_f32_16x16x32_bf16 v[28:31], a[152:155], v[200:203], v[28:31]
v_mfma_f32_16x16x32_bf16 v[16:19], a[156:159], v[156:159], v[16:19]
v_mfma_f32_16x16x32_bf16 v[20:23], a[156:159], v[172:175], v[20:23]
v_mfma_f32_16x16x32_bf16 v[24:27], a[156:159], v[188:191], v[24:27]
v_mfma_f32_16x16x32_bf16 v[28:31], a[156:159], v[204:207], v[28:31]
v_mfma_f32_16x16x32_bf16 v[32:35], a[160:163], v[144:147], v[128:131]
v_mfma_f32_16x16x32_bf16 v[36:39], a[160:163], v[160:163], v[132:135]
v_mfma_f32_16x16x32_bf16 v[40:43], a[160:163], v[176:179], v[136:139]
v_mfma_f32_16x16x32_bf16 v[44:47], a[160:163], v[192:195], v[140:143]
v_mfma_f32_16x16x32_bf16 v[32:35], a[164:167], v[148:151], v[32:35]
v_mfma_f32_16x16x32_bf16 v[36:39], a[164:167], v[164:167], v[36:39]
v_mfma_f32_16x16x32_bf16 v[40:43], a[164:167], v[180:183], v[40:43]
v_mfma_f32_16x16x32_bf16 v[44:47], a[164:167], v[196:199], v[44:47]
v_mfma_f32_16x16x32_bf16 v[32:35], a[168:171], v[152:155], v[32:35]
v_mfma_f32_16x16x32_bf16 v[36:39], a[168:171], v[168:171], v[36:39]
v_mfma_f32_16x16x32_bf16 v[40:43], a[168:171], v[184:187], v[40:43]
v_mfma_f32_16x16x32_bf16 v[44:47], a[168:171], v[200:203], v[44:47]
v_mfma_f32_16x16x32_bf16 v[32:35], a[172:175], v[156:159], v[32:35]
v_mfma_f32_16x16x32_bf16 v[36:39], a[172:175], v[172:175], v[36:39]
v_mfma_f32_16x16x32_bf16 v[40:43], a[172:175], v[188:191], v[40:43]
v_mfma_f32_16x16x32_bf16 v[44:47], a[172:175], v[204:207], v[44:47]
s_nop 7
s_nop 1
v_max3_f32 v224, v224, v16, v17
v_max3_f32 v224, v224, v18, v19
v_max3_f32 v224, v224, v32, v33
v_max3_f32 v224, v224, v34, v35
v_max3_f32 v225, v225, v20, v21
v_max3_f32 v225, v225, v22, v23
v_max3_f32 v225, v225, v36, v37
v_max3_f32 v225, v225, v38, v39
v_max3_f32 v226, v226, v24, v25
v_max3_f32 v226, v226, v26, v27
v_max3_f32 v226, v226, v40, v41
v_max3_f32 v226, v226, v42, v43
v_max3_f32 v227, v227, v28, v29
v_max3_f32 v227, v227, v30, v31
v_max3_f32 v227, v227, v44, v45
v_max3_f32 v227, v227, v46, v47
s_add_u32 s72, s72, 1
s_cmp_lt_u32 s72, s73
s_cbranch_scc1 K2_FB_LOOP
v_mov_b32 v228, v224
v_mov_b32 v229, v225
v_mov_b32 v230, v226
v_mov_b32 v231, v227
s_nop 1
v_permlane16_swap_b32 v224, v228
v_permlane16_swap_b32 v225, v229
v_permlane16_swap_b32 v226, v230
v_permlane16_swap_b32 v227, v231
s_nop 1
v_max_f32 v224, v224, v228
v_max_f32 v225, v225, v229
v_max_f32 v226, v226, v230
v_max_f32 v227, v227, v231
v_mov_b32 v228, v224
v_mov_b32 v229, v225
v_mov_b32 v230, v226
v_mov_b32 v231, v227
s_nop 1
v_permlane32_swap_b32 v224, v228
v_permlane32_swap_b32 v225, v229
v_permlane32_swap_b32 v226, v230
v_permlane32_swap_b32 v227, v231
s_nop 1
v_max_f32 v224, v224, v228
v_max_f32 v225, v225, v229
v_max_f32 v226, v226, v230
v_max_f32 v227, v227, v231
v_sub_f32 v208, 0, v224
v_mov_b32 v112, v208
v_mov_b32 v113, v208
v_mov_b32 v114, v208
v_mov_b32 v115, v208
v_mov_b32 v128, v208
v_mov_b32 v129, v208
v_mov_b32 v130, v208
v_mov_b32 v131, v208
v_sub_f32 v209, 0, v225
v_mov_b32 v116, v209
v_mov_b32 v117, v209
v_mov_b32 v118, v209
v_mov_b32 v119, v209
v_mov_b32 v132, v209
v_mov_b32 v133, v209
v_mov_b32 v134, v209
v_mov_b32 v135, v209
v_sub_f32 v210, 0, v226
v_mov_b32 v120, v210
v_mov_b32 v121, v210
v_mov_b32 v122, v210
v_mov_b32 v123, v210
v_mov_b32 v136, v210
v_mov_b32 v137, v210
v_mov_b32 v138, v210
v_mov_b32 v139, v210
v_sub_f32 v211, 0, v227
v_mov_b32 v124, v211
v_mov_b32 v125, v211
v_mov_b32 v126, v211
v_mov_b32 v127, v211
v_mov_b32 v140, v211
v_mov_b32 v141, v211
v_mov_b32 v142, v211
v_mov_b32 v143, v211
s_lshl_b32 s43, s36, 12
s_mov_b32 s39, s43
s_add_u32 s40, s43, 0x10000
v_mov_b32 v2, v1
v_add_u32 v3, 0x10000, v1
s_lshl_b32 s41, s38, 20
s_add_u32 m0, s39, 0
s_add_u32 s53, s41, 0
buffer_load_dwordx4 v4, s[16:19], s53 offen offset:0 lds
buffer_load_dwordx4 v4, s[16:19], s53 offen offset:1024 lds
buffer_load_dwordx4 v4, s[16:19], s53 offen offset:2048 lds
buffer_load_dwordx4 v4, s[16:19], s53 offen offset:3072 lds
s_add_u32 m0, s39, 16384
s_add_u32 s53, s41, 16384
buffer_load_dwordx4 v4, s[16:19], s53 offen offset:0 lds
buffer_load_dwordx4 v4, s[16:19], s53 offen offset:1024 lds
buffer_load_dwordx4 v4, s[16:19], s53 offen offset:2048 lds
buffer_load_dwordx4 v4, s[16:19], s53 offen offset:3072 lds
s_add_u32 m0, s39, 32768
s_add_u32 s53, s41, 32768
buffer_load_dwordx4 v4, s[16:19], s53 offen offset:0 lds
buffer_load_dwordx4 v4, s[16:19], s53 offen offset:1024 lds
buffer_load_dwordx4 v4, s[16:19], s53 offen offset:2048 lds
buffer_load_dwordx4 v4, s[16:19], s53 offen offset:3072 lds
s_add_u32 m0, s39, 49152
s_add_u32 s53, s41, 49152
buffer_load_dwordx4 v4, s[16:19], s53 offen offset:0 lds
buffer_load_dwordx4 v4, s[16:19], s53 offen offset:1024 lds
buffer_load_dwordx4 v4, s[16:19], s53 offen offset:2048 lds
buffer_load_dwordx4 v4, s[16:19], s53 offen offset:3072 lds
s_waitcnt vmcnt(0)
s_mov_b64 s[48:49], 0
s_mov_b32 s71, 1
s_branch K2_U0
K2_OK:
s_sub_u32 s70, s54, 896
s_cmp_lt_u32 s70, 24
s_cbranch_scc0 K2_RP3_SKIP
s_add_u32 s70, s70, 320
s_mov_b32 s60, s14
s_mov_b32 s61, s15
s_mov_b32 s62, 1409024
s_mov_b32 s63, 0x00020000
s_mul_hi_u32 s43, s70, 99882961
s_mul_i32 s44, s43, 43
s_sub_u32 s44, s70, s44
s_lshl_b32 s68, s44, 15
s_lshl_b32 s69, s43, 7
s_add_u32 s68, s68, s69
s_mul_i32 s77, s43, 44
s_add_u32 s77, s77, s44
s_lshl_b32 s77, s77, 12
s_add_u32 s77, s77, 4194304
s_add_u32 m0, s55, 4096
s_add_u32 s67, s68, 0
buffer_load_dwordx4 v12, s[60:63], s67 offen lds
s_add_u32 m0, s55, 5120
s_add_u32 s67, s68, 8192
buffer_load_dwordx4 v12, s[60:63], s67 offen lds
s_add_u32 m0, s55, 6144
s_add_u32 s67, s68, 16384
buffer_load_dwordx4 v12, s[60:63], s67 offen lds
s_add_u32 m0, s55, 7168
s_add_u32 s67, s68, 24576
buffer_load_dwordx4 v12, s[60:63], s67 offen lds
s_waitcnt vmcnt(0)
ds_read_b64_tr_b16 v[224:225], v14 offset:4096
ds_read_b64_tr_b16 v[226:227], v14 offset:6144
ds_read_b64_tr_b16 v[228:229], v14 offset:4128
ds_read_b64_tr_b16 v[230:231], v14 offset:6176
ds_read_b64_tr_b16 v[232:233], v14 offset:4160
ds_read_b64_tr_b16 v[234:235], v14 offset:6208
ds_read_b64_tr_b16 v[236:237], v14 offset:4192
ds_read_b64_tr_b16 v[238:239], v14 offset:6240
s_waitcnt lgkmcnt(0)
buffer_store_dwordx4 v[224:227], v1, s[56:59], s77 offen offset:0 sc0 sc1
buffer_store_dwordx4 v[228:231], v1, s[56:59], s77 offen offset:1024 sc0 sc1
buffer_store_dwordx4 v[232:235], v1, s[56:59], s77 offen offset:2048 sc0 sc1
buffer_store_dwordx4 v[236:239], v1, s[56:59], s77 offen offset:3072 sc0 sc1
K2_RP3_SKIP:
K2_END:
s_endpgm
.text
.globl k3_kernel
.p2align 8
.type k3_kernel,@function
k3_kernel:
s_cmp_ge_u32 s2, 256
s_cbranch_scc1 K3_END
s_load_dwordx2 s[4:5], s[0:1], 40
s_load_dwordx2 s[12:13], s[0:1], 96
s_load_dwordx2 s[6:7], s[0:1], 0
v_and_b32 v1, 63, v0
v_lshrrev_b32 v2, 6, v0
s_nop 0
v_readfirstlane_b32 s36, v2
s_lshr_b32 s39, s2, 3
s_and_b32 s38, s39, 7
s_lshr_b32 s39, s39, 3
s_and_b32 s37, s2, 7
s_lshl_b32 s37, s37, 2
s_add_u32 s37, s37, s39
s_waitcnt lgkmcnt(0)
s_cmp_lt_u32 s2, 8
s_cbranch_scc0 CPF5_X
s_cmp_eq_u32 s36, 3
s_cbranch_scc0 CPF5_X
s_getpc_b64 s[64:65]
CPF5_P:
s_add_u32 s64, s64, k3_kernel-CPF5_P
s_addc_u32 s65, s65, ((k3_kernel-CPF5_P)>>32)&0xffffffff
s_mov_b32 s66, K3_END-k3_kernel
s_mov_b32 s67, 0x00020000
v_lshlrev_b32 v60, 7, v1
s_mov_b32 s68, 0
CPF5_L:
buffer_load_dword v61, v60, s[64:67], s68 offen
s_add_u32 s68, s68, 8192
s_cmp_lt_u32 s68, s66
s_cbranch_scc1 CPF5_L
CPF5_X:
s_add_u32 s20, s12, 67108864
s_addc_u32 s21, s13, 0
s_mov_b32 s22, 4194304
s_mov_b32 s23, 0x00020000
s_add_u32 s16, s12, 35651584
s_addc_u32 s17, s13, 0
s_mov_b32 s18, 16777216
s_mov_b32 s19, 0x00020000
s_mov_b32 s24, s6
s_mov_b32 s25, s7
s_mov_b32 s26, 2097152
s_mov_b32 s27, 0x00020000
s_add_u32 s28, s12, 54525952
s_addc_u32 s29, s13, 0
s_mov_b32 s30, 2097152
s_mov_b32 s31, 0x00020000
s_add_u32 s32, s12, 52428800
s_addc_u32 s33, s13, 0
s_mov_b32 s34, 2097152
s_mov_b32 s35, 0x00020000
s_add_u32 s56, s12, 56623104
s_addc_u32 s57, s13, 0
s_mov_b32 s58, 131072
s_mov_b32 s59, 0x00020000
v_lshlrev_b32 v2, 4, v1
v_add_u32 v3, 131072, v2
v_add_u32 v4, 262144, v2
v_add_u32 v5, 393216, v2
s_lshl_b32 s41, s36, 5
s_lshl_b32 s39, s37, 2
s_mul_i32 s42, s39, 131072
s_lshl_b32 s39, s41, 10
s_add_u32 s42, s42, s39
s_mul_i32 s43, s38, 128
s_add_u32 s43, s43, s41
s_lshl_b32 s43, s43, 12
buffer_load_dwordx4 a[16:19], v2, s[20:23], s43 offen offset:0
buffer_load_dwordx4 a[20:23], v2, s[20:23], s43 offen offset:1024
buffer_load_dwordx4 a[24:27], v2, s[20:23], s43 offen offset:2048
buffer_load_dwordx4 a[28:31], v2, s[20:23], s43 offen offset:3072
buffer_load_dwordx4 a[0:3], v2, s[16:19], s42 offen
buffer_load_dwordx4 a[4:7], v3, s[16:19], s42 offen
buffer_load_dwordx4 a[8:11], v4, s[16:19], s42 offen
buffer_load_dwordx4 a[12:15], v5, s[16:19], s42 offen
s_add_u32 s43, s43, 4096
s_add_u32 s42, s42, 1024
buffer_load_dwordx4 a[48:51], v2, s[20:23], s43 offen offset:0
buffer_load_dwordx4 a[52:55], v2, s[20:23], s43 offen offset:1024
buffer_load_dwordx4 a[56:59], v2, s[20:23], s43 offen offset:2048
buffer_load_dwordx4 a[60:63], v2, s[20:23], s43 offen offset:3072
buffer_load_dwordx4 a[32:35], v2, s[16:19], s42 offen
buffer_load_dwordx4 a[36:39], v3, s[16:19], s42 offen
buffer_load_dwordx4 a[40:43], v4, s[16:19], s42 offen
buffer_load_dwordx4 a[44:47], v5, s[16:19], s42 offen
s_add_u32 s43, s43, 4096
s_add_u32 s42, s42, 1024
buffer_load_dwordx4 a[80:83], v2, s[20:23], s43 offen offset:0
buffer_load_dwordx4 a[84:87], v2, s[20:23], s43 offen offset:1024
buffer_load_dwordx4 a[88:91], v2, s[20:23], s43 offen offset:2048
buffer_load_dwordx4 a[92:95], v2, s[20:23], s43 offen offset:3072
buffer_load_dwordx4 a[64:67], v2, s[16:19], s42 offen
buffer_load_dwordx4 a[68:71], v3, s[16:19], s42 offen
buffer_load_dwordx4 a[72:75], v4, s[16:19], s42 offen
buffer_load_dwordx4 a[76:79], v5, s[16:19], s42 offen
s_add_u32 s43, s43, 4096
s_add_u32 s42, s42, 1024
buffer_load_dwordx4 a[112:115], v2, s[20:23], s43 offen offset:0
buffer_load_dwordx4 a[116:119], v2, s[20:23], s43 offen offset:1024
buffer_load_dwordx4 a[120:123], v2, s[20:23], s43 offen offset:2048
buffer_load_dwordx4 a[124:127], v2, s[20:23], s43 offen offset:3072
buffer_load_dwordx4 a[96:99], v2, s[16:19], s42 offen
buffer_load_dwordx4 a[100:103], v3, s[16:19], s42 offen
buffer_load_dwordx4 a[104:107], v4, s[16:19], s42 offen
buffer_load_dwordx4 a[108:111], v5, s[16:19], s42 offen
s_add_u32 s43, s43, 4096
s_add_u32 s42, s42, 1024
buffer_load_dwordx4 a[144:147], v2, s[20:23], s43 offen offset:0
buffer_load_dwordx4 a[148:151], v2, s[20:23], s43 offen offset:1024
buffer_load_dwordx4 a[152:155], v2, s[20:23], s43 offen offset:2048
buffer_load_dwordx4 a[156:159], v2, s[20:23], s43 offen offset:3072
buffer_load_dwordx4 a[128:131], v2, s[16:19], s42 offen
buffer_load_dwordx4 a[132:135], v3, s[16:19], s42 offen
buffer_load_dwordx4 a[136:139], v4, s[16:19], s42 offen
buffer_load_dwordx4 a[140:143], v5, s[16:19], s42 offen
s_add_u32 s43, s43, 4096
s_add_u32 s42, s42, 1024
buffer_load_dwordx4 a[176:179], v2, s[20:23], s43 offen offset:0
buffer_load_dwordx4 a[180:183], v2, s[20:23], s43 offen offset:1024
buffer_load_dwordx4 a[184:187], v2, s[20:23], s43 offen offset:2048
buffer_load_dwordx4 a[188:191], v2, s[20:23], s43 offen offset:3072
buffer_load_dwordx4 a[160:163], v2, s[16:19], s42 offen
buffer_load_dwordx4 a[164:167], v3, s[16:19], s42 offen
buffer_load_dwordx4 a[168:171], v4, s[16:19], s42 offen
buffer_load_dwordx4 a[172:175], v5, s[16:19], s42 offen
s_add_u32 s43, s43, 4096
s_add_u32 s42, s42, 1024
buffer_load_dwordx4 a[208:211], v2, s[20:23], s43 offen offset:0
buffer_load_dwordx4 a[212:215], v2, s[20:23], s43 offen offset:1024
buffer_load_dwordx4 a[216:219], v2, s[20:23], s43 offen offset:2048
buffer_load_dwordx4 a[220:223], v2, s[20:23], s43 offen offset:3072
buffer_load_dwordx4 a[192:195], v2, s[16:19], s42 offen
buffer_load_dwordx4 a[196:199], v3, s[16:19], s42 offen
buffer_load_dwordx4 a[200:203], v4, s[16:19], s42 offen
buffer_load_dwordx4 a[204:207], v5, s[16:19], s42 offen
s_add_u32 s43, s43, 4096
s_add_u32 s42, s42, 1024
v_lshrrev_b32 v22, 3, v0
v_and_b32 v23, 7, v0
v_lshlrev_b32 v64, 10, v22
v_lshl_add_u32 v64, v23, 4, v64
s_lshl_b32 s39, s37, 16
s_lshl_b32 s40, s38, 7
s_add_u32 s46, s39, s40
s_add_u32 s47, s46, 32768
buffer_load_dwordx4 v[14:17], v64, s[24:27], s46 offen
buffer_load_dwordx4 v[18:21], v64, s[24:27], s47 offen
s_waitcnt vmcnt(50)
v_mfma_f32_16x16x32_bf16 v[24:27], a[16:19], a[0:3], 0
buffer_load_dwordx4 a[240:243], v2, s[20:23], s43 offen offset:0
v_mfma_f32_16x16x32_bf16 v[40:43], a[20:23], a[0:3], 0
buffer_load_dwordx4 a[244:247], v2, s[20:23], s43 offen offset:1024
v_mfma_f32_16x16x32_bf16 v[56:59], a[24:27], a[0:3], 0
buffer_load_dwordx4 a[248:251], v2, s[20:23], s43 offen offset:2048
v_mfma_f32_16x16x32_bf16 v[72:75], a[28:31], a[0:3], 0
buffer_load_dwordx4 a[252:255], v2, s[20:23], s43 offen offset:3072
v_mfma_f32_16x16x32_bf16 v[28:31], a[16:19], a[4:7], 0
buffer_load_dwordx4 a[224:227], v2, s[16:19], s42 offen
v_mfma_f32_16x16x32_bf16 v[44:47], a[20:23], a[4:7], 0
buffer_load_dwordx4 a[228:231], v3, s[16:19], s42 offen
v_mfma_f32_16x16x32_bf16 v[60:63], a[24:27], a[4:7], 0
buffer_load_dwordx4 a[232:235], v4, s[16:19], s42 offen
v_mfma_f32_16x16x32_bf16 v[76:79], a[28:31], a[4:7], 0
buffer_load_dwordx4 a[236:239], v5, s[16:19], s42 offen
v_mfma_f32_16x16x32_bf16 v[32:35], a[16:19], a[8:11], 0
s_add_u32 s43, s43, 4096
s_add_u32 s42, s42, 1024
v_mfma_f32_16x16x32_bf16 v[48:51], a[20:23], a[8:11], 0
v_mfma_f32_16x16x32_bf16 v[64:67], a[24:27], a[8:11], 0
v_mfma_f32_16x16x32_bf16 v[80:83], a[28:31], a[8:11], 0
v_mfma_f32_16x16x32_bf16 v[36:39], a[16:19], a[12:15], 0
v_mfma_f32_16x16x32_bf16 v[52:55], a[20:23], a[12:15], 0
v_mfma_f32_16x16x32_bf16 v[68:71], a[24:27], a[12:15], 0
v_mfma_f32_16x16x32_bf16 v[84:87], a[28:31], a[12:15], 0
s_waitcnt vmcnt(50)
v_mfma_f32_16x16x32_bf16 v[24:27], a[48:51], a[32:35], v[24:27]
buffer_load_dwordx4 a[16:19], v2, s[20:23], s43 offen offset:0
v_mfma_f32_16x16x32_bf16 v[40:43], a[52:55], a[32:35], v[40:43]
buffer_load_dwordx4 a[20:23], v2, s[20:23], s43 offen offset:1024
v_mfma_f32_16x16x32_bf16 v[56:59], a[56:59], a[32:35], v[56:59]
buffer_load_dwordx4 a[24:27], v2, s[20:23], s43 offen offset:2048
v_mfma_f32_16x16x32_bf16 v[72:75], a[60:63], a[32:35], v[72:75]
buffer_load_dwordx4 a[28:31], v2, s[20:23], s43 offen offset:3072
v_mfma_f32_16x16x32_bf16 v[28:31], a[48:51], a[36:39], v[28:31]
buffer_load_dwordx4 a[0:3], v2, s[16:19], s42 offen
v_mfma_f32_16x16x32_bf16 v[44:47], a[52:55], a[36:39], v[44:47]
buffer_load_dwordx4 a[4:7], v3, s[16:19], s42 offen
v_mfma_f32_16x16x32_bf16 v[60:63], a[56:59], a[36:39], v[60:63]
buffer_load_dwordx4 a[8:11], v4, s[16:19], s42 offen
v_mfma_f32_16x16x32_bf16 v[76:79], a[60:63], a[36:39], v[76:79]
buffer_load_dwordx4 a[12:15], v5, s[16:19], s42 offen
v_mfma_f32_16x16x32_bf16 v[32:35], a[48:51], a[40:43], v[32:35]
s_add_u32 s43, s43, 4096
s_add_u32 s42, s42, 1024
v_mfma_f32_16x16x32_bf16 v[48:51], a[52:55], a[40:43], v[48:51]
v_mfma_f32_16x16x32_bf16 v[64:67], a[56:59], a[40:43], v[64:67]
v_mfma_f32_16x16x32_bf16 v[80:83], a[60:63], a[40:43], v[80:83]
v_mfma_f32_16x16x32_bf16 v[36:39], a[48:51], a[44:47], v[36:39]
v_mfma_f32_16x16x32_bf16 v[52:55], a[52:55], a[44:47], v[52:55]
v_mfma_f32_16x16x32_bf16 v[68:71], a[56:59], a[44:47], v[68:71]
v_mfma_f32_16x16x32_bf16 v[84:87], a[60:63], a[44:47], v[84:87]
s_waitcnt vmcnt(50)
v_mfma_f32_16x16x32_bf16 v[24:27], a[80:83], a[64:67], v[24:27]
buffer_load_dwordx4 a[48:51], v2, s[20:23], s43 offen offset:0
v_mfma_f32_16x16x32_bf16 v[40:43], a[84:87], a[64:67], v[40:43]
buffer_load_dwordx4 a[52:55], v2, s[20:23], s43 offen offset:1024
v_mfma_f32_16x16x32_bf16 v[56:59], a[88:91], a[64:67], v[56:59]
buffer_load_dwordx4 a[56:59], v2, s[20:23], s43 offen offset:2048
v_mfma_f32_16x16x32_bf16 v[72:75], a[92:95], a[64:67], v[72:75]
buffer_load_dwordx4 a[60:63], v2, s[20:23], s43 offen offset:3072
v_mfma_f32_16x16x32_bf16 v[28:31], a[80:83], a[68:71], v[28:31]
buffer_load_dwordx4 a[32:35], v2, s[16:19], s42 offen
v_mfma_f32_16x16x32_bf16 v[44:47], a[84:87], a[68:71], v[44:47]
buffer_load_dwordx4 a[36:39], v3, s[16:19], s42 offen
v_mfma_f32_16x16x32_bf16 v[60:63], a[88:91], a[68:71], v[60:63]
buffer_load_dwordx4 a[40:43], v4, s[16:19], s42 offen
v_mfma_f32_16x16x32_bf16 v[76:79], a[92:95], a[68:71], v[76:79]
buffer_load_dwordx4 a[44:47], v5, s[16:19], s42 offen
v_mfma_f32_16x16x32_bf16 v[32:35], a[80:83], a[72:75], v[32:35]
s_add_u32 s43, s43, 4096
s_add_u32 s42, s42, 1024
v_mfma_f32_16x16x32_bf16 v[48:51], a[84:87], a[72:75], v[48:51]
v_mfma_f32_16x16x32_bf16 v[64:67], a[88:91], a[72:75], v[64:67]
v_mfma_f32_16x16x32_bf16 v[80:83], a[92:95], a[72:75], v[80:83]
v_mfma_f32_16x16x32_bf16 v[36:39], a[80:83], a[76:79], v[36:39]
v_mfma_f32_16x16x32_bf16 v[52:55], a[84:87], a[76:79], v[52:55]
v_mfma_f32_16x16x32_bf16 v[68:71], a[88:91], a[76:79], v[68:71]
v_mfma_f32_16x16x32_bf16 v[84:87], a[92:95], a[76:79], v[84:87]
s_waitcnt vmcnt(50)
v_mfma_f32_16x16x32_bf16 v[24:27], a[112:115], a[96:99], v[24:27]
buffer_load_dwordx4 a[80:83], v2, s[20:23], s43 offen offset:0
v_mfma_f32_16x16x32_bf16 v[40:43], a[116:119], a[96:99], v[40:43]
buffer_load_dwordx4 a[84:87], v2, s[20:23], s43 offen offset:1024
v_mfma_f32_16x16x32_bf16 v[56:59], a[120:123], a[96:99], v[56:59]
buffer_load_dwordx4 a[88:91], v2, s[20:23], s43 offen offset:2048
v_mfma_f32_16x16x32_bf16 v[72:75], a[124:127], a[96:99], v[72:75]
buffer_load_dwordx4 a[92:95], v2, s[20:23], s43 offen offset:3072
v_mfma_f32_16x16x32_bf16 v[28:31], a[112:115], a[100:103], v[28:31]
buffer_load_dwordx4 a[64:67], v2, s[16:19], s42 offen
v_mfma_f32_16x16x32_bf16 v[44:47], a[116:119], a[100:103], v[44:47]
buffer_load_dwordx4 a[68:71], v3, s[16:19], s42 offen
v_mfma_f32_16x16x32_bf16 v[60:63], a[120:123], a[100:103], v[60:63]
buffer_load_dwordx4 a[72:75], v4, s[16:19], s42 offen
v_mfma_f32_16x16x32_bf16 v[76:79], a[124:127], a[100:103], v[76:79]
buffer_load_dwordx4 a[76:79], v5, s[16:19], s42 offen
v_mfma_f32_16x16x32_bf16 v[32:35], a[112:115], a[104:107], v[32:35]
s_add_u32 s43, s43, 4096
s_add_u32 s42, s42, 1024
v_mfma_f32_16x16x32_bf16 v[48:51], a[116:119], a[104:107], v[48:51]
v_mfma_f32_16x16x32_bf16 v[64:67], a[120:123], a[104:107], v[64:67]
v_mfma_f32_16x16x32_bf16 v[80:83], a[124:127], a[104:107], v[80:83]
v_mfma_f32_16x16x32_bf16 v[36:39], a[112:115], a[108:111], v[36:39]
v_mfma_f32_16x16x32_bf16 v[52:55], a[116:119], a[108:111], v[52:55]
v_mfma_f32_16x16x32_bf16 v[68:71], a[120:123], a[108:111], v[68:71]
v_mfma_f32_16x16x32_bf16 v[84:87], a[124:127], a[108:111], v[84:87]
s_waitcnt vmcnt(50)
v_mfma_f32_16x16x32_bf16 v[24:27], a[144:147], a[128:131], v[24:27]
buffer_load_dwordx4 a[112:115], v2, s[20:23], s43 offen offset:0
v_mfma_f32_16x16x32_bf16 v[40:43], a[148:151], a[128:131], v[40:43]
buffer_load_dwordx4 a[116:119], v2, s[20:23], s43 offen offset:1024
v_mfma_f32_16x16x32_bf16 v[56:59], a[152:155], a[128:131], v[56:59]
buffer_load_dwordx4 a[120:123], v2, s[20:23], s43 offen offset:2048
v_mfma_f32_16x16x32_bf16 v[72:75], a[156:159], a[128:131], v[72:75]
buffer_load_dwordx4 a[124:127], v2, s[20:23], s43 offen offset:3072
v_mfma_f32_16x16x32_bf16 v[28:31], a[144:147], a[132:135], v[28:31]
buffer_load_dwordx4 a[96:99], v2, s[16:19], s42 offen
v_mfma_f32_16x16x32_bf16 v[44:47], a[148:151], a[132:135], v[44:47]
buffer_load_dwordx4 a[100:103], v3, s[16:19], s42 offen
v_mfma_f32_16x16x32_bf16 v[60:63], a[152:155], a[132:135], v[60:63]
buffer_load_dwordx4 a[104:107], v4, s[16:19], s42 offen
v_mfma_f32_16x16x32_bf16 v[76:79], a[156:159], a[132:135], v[76:79]
buffer_load_dwordx4 a[108:111], v5, s[16:19], s42 offen
v_mfma_f32_16x16x32_bf16 v[32:35], a[144:147], a[136:139], v[32:35]
s_add_u32 s43, s43, 4096
s_add_u32 s42, s42, 1024
v_mfma_f32_16x16x32_bf16 v[48:51], a[148:151], a[136:139], v[48:51]
v_mfma_f32_16x16x32_bf16 v[64:67], a[152:155], a[136:139], v[64:67]
v_mfma_f32_16x16x32_bf16 v[80:83], a[156:159], a[136:139], v[80:83]
v_mfma_f32_16x16x32_bf16 v[36:39], a[144:147], a[140:143], v[36:39]
v_mfma_f32_16x16x32_bf16 v[52:55], a[148:151], a[140:143], v[52:55]
v_mfma_f32_16x16x32_bf16 v[68:71], a[152:155], a[140:143], v[68:71]
v_mfma_f32_16x16x32_bf16 v[84:87], a[156:159], a[140:143], v[84:87]
s_waitcnt vmcnt(50)
v_mfma_f32_16x16x32_bf16 v[24:27], a[176:179], a[160:163], v[24:27]
buffer_load_dwordx4 a[144:147], v2, s[20:23], s43 offen offset:0
v_mfma_f32_16x16x32_bf16 v[40:43], a[180:183], a[160:163], v[40:43]
buffer_load_dwordx4 a[148:151], v2, s[20:23], s43 offen offset:1024
v_mfma_f32_16x16x32_bf16 v[56:59], a[184:187], a[160:163], v[56:59]
buffer_load_dwordx4 a[152:155], v2, s[20:23], s43 offen offset:2048
v_mfma_f32_16x16x32_bf16 v[72:75], a[188:191], a[160:163], v[72:75]
buffer_load_dwordx4 a[156:159], v2, s[20:23], s43 offen offset:3072
v_mfma_f32_16x16x32_bf16 v[28:31], a[176:179], a[164:167], v[28:31]
buffer_load_dwordx4 a[128:131], v2, s[16:19], s42 offen
v_mfma_f32_16x16x32_bf16 v[44:47], a[180:183], a[164:167], v[44:47]
buffer_load_dwordx4 a[132:135], v3, s[16:19], s42 offen
v_mfma_f32_16x16x32_bf16 v[60:63], a[184:187], a[164:167], v[60:63]
buffer_load_dwordx4 a[136:139], v4, s[16:19], s42 offen
v_mfma_f32_16x16x32_bf16 v[76:79], a[188:191], a[164:167], v[76:79]
buffer_load_dwordx4 a[140:143], v5, s[16:19], s42 offen
v_mfma_f32_16x16x32_bf16 v[32:35], a[176:179], a[168:171], v[32:35]
s_add_u32 s43, s43, 4096
s_add_u32 s42, s42, 1024
v_mfma_f32_16x16x32_bf16 v[48:51], a[180:183], a[168:171], v[48:51]
v_mfma_f32_16x16x32_bf16 v[64:67], a[184:187], a[168:171], v[64:67]
v_mfma_f32_16x16x32_bf16 v[80:83], a[188:191], a[168:171], v[80:83]
v_mfma_f32_16x16x32_bf16 v[36:39], a[176:179], a[172:175], v[36:39]
v_mfma_f32_16x16x32_bf16 v[52:55], a[180:183], a[172:175], v[52:55]
v_mfma_f32_16x16x32_bf16 v[68:71], a[184:187], a[172:175], v[68:71]
v_mfma_f32_16x16x32_bf16 v[84:87], a[188:191], a[172:175], v[84:87]
s_waitcnt vmcnt(50)
v_mfma_f32_16x16x32_bf16 v[24:27], a[208:211], a[192:195], v[24:27]
buffer_load_dwordx4 a[176:179], v2, s[20:23], s43 offen offset:0
v_mfma_f32_16x16x32_bf16 v[40:43], a[212:215], a[192:195], v[40:43]
buffer_load_dwordx4 a[180:183], v2, s[20:23], s43 offen offset:1024
v_mfma_f32_16x16x32_bf16 v[56:59], a[216:219], a[192:195], v[56:59]
buffer_load_dwordx4 a[184:187], v2, s[20:23], s43 offen offset:2048
v_mfma_f32_16x16x32_bf16 v[72:75], a[220:223], a[192:195], v[72:75]
buffer_load_dwordx4 a[188:191], v2, s[20:23], s43 offen offset:3072
v_mfma_f32_16x16x32_bf16 v[28:31], a[208:211], a[196:199], v[28:31]
buffer_load_dwordx4 a[160:163], v2, s[16:19], s42 offen
v_mfma_f32_16x16x32_bf16 v[44:47], a[212:215], a[196:199], v[44:47]
buffer_load_dwordx4 a[164:167], v3, s[16:19], s42 offen
v_mfma_f32_16x16x32_bf16 v[60:63], a[216:219], a[196:199], v[60:63]
buffer_load_dwordx4 a[168:171], v4, s[16:19], s42 offen
v_mfma_f32_16x16x32_bf16 v[76:79], a[220:223], a[196:199], v[76:79]
buffer_load_dwordx4 a[172:175], v5, s[16:19], s42 offen
v_mfma_f32_16x16x32_bf16 v[32:35], a[208:211], a[200:203], v[32:35]
s_add_u32 s43, s43, 4096
s_add_u32 s42, s42, 1024
v_mfma_f32_16x16x32_bf16 v[48:51], a[212:215], a[200:203], v[48:51]
v_mfma_f32_16x16x32_bf16 v[64:67], a[216:219], a[200:203], v[64:67]
v_mfma_f32_16x16x32_bf16 v[80:83], a[220:223], a[200:203], v[80:83]
v_mfma_f32_16x16x32_bf16 v[36:39], a[208:211], a[204:207], v[36:39]
v_mfma_f32_16x16x32_bf16 v[52:55], a[212:215], a[204:207], v[52:55]
v_mfma_f32_16x16x32_bf16 v[68:71], a[216:219], a[204:207], v[68:71]
v_mfma_f32_16x16x32_bf16 v[84:87], a[220:223], a[204:207], v[84:87]
s_waitcnt vmcnt(48)
v_mfma_f32_16x16x32_bf16 v[24:27], a[240:243], a[224:227], v[24:27]
buffer_load_dwordx4 a[208:211], v2, s[20:23], s43 offen offset:0
v_mfma_f32_16x16x32_bf16 v[40:43], a[244:247], a[224:227], v[40:43]
buffer_load_dwordx4 a[212:215], v2, s[20:23], s43 offen offset:1024
v_mfma_f32_16x16x32_bf16 v[56:59], a[248:251], a[224:227], v[56:59]
buffer_load_dwordx4 a[216:219], v2, s[20:23], s43 offen offset:2048
v_mfma_f32_16x16x32_bf16 v[72:75], a[252:255], a[224:227], v[72:75]
buffer_load_dwordx4 a[220:223], v2, s[20:23], s43 offen offset:3072
v_mfma_f32_16x16x32_bf16 v[28:31], a[240:243], a[228:231], v[28:31]
buffer_load_dwordx4 a[192:195], v2, s[16:19], s42 offen
v_mfma_f32_16x16x32_bf16 v[44:47], a[244:247], a[228:231], v[44:47]
buffer_load_dwordx4 a[196:199], v3, s[16:19], s42 offen
v_mfma_f32_16x16x32_bf16 v[60:63], a[248:251], a[228:231], v[60:63]
buffer_load_dwordx4 a[200:203], v4, s[16:19], s42 offen
v_mfma_f32_16x16x32_bf16 v[76:79], a[252:255], a[228:231], v[76:79]
buffer_load_dwordx4 a[204:207], v5, s[16:19], s42 offen
v_mfma_f32_16x16x32_bf16 v[32:35], a[240:243], a[232:235], v[32:35]
s_add_u32 s43, s43, 4096
s_add_u32 s42, s42, 1024
v_mfma_f32_16x16x32_bf16 v[48:51], a[244:247], a[232:235], v[48:51]
v_mfma_f32_16x16x32_bf16 v[64:67], a[248:251], a[232:235], v[64:67]
v_mfma_f32_16x16x32_bf16 v[80:83], a[252:255], a[232:235], v[80:83]
v_mfma_f32_16x16x32_bf16 v[36:39], a[240:243], a[236:239], v[36:39]
v_mfma_f32_16x16x32_bf16 v[52:55], a[244:247], a[236:239], v[52:55]
v_mfma_f32_16x16x32_bf16 v[68:71], a[248:251], a[236:239], v[68:71]
v_mfma_f32_16x16x32_bf16 v[84:87], a[252:255], a[236:239], v[84:87]
s_mov_b32 s45, 2
K3_LOOP:
s_waitcnt vmcnt(48)
v_mfma_f32_16x16x32_bf16 v[24:27], a[16:19], a[0:3], v[24:27]
buffer_load_dwordx4 a[240:243], v2, s[20:23], s43 offen offset:0
v_mfma_f32_16x16x32_bf16 v[40:43], a[20:23], a[0:3], v[40:43]
buffer_load_dwordx4 a[244:247], v2, s[20:23], s43 offen offset:1024
v_mfma_f32_16x16x32_bf16 v[56:59], a[24:27], a[0:3], v[56:59]
buffer_load_dwordx4 a[248:251], v2, s[20:23], s43 offen offset:2048
v_mfma_f32_16x16x32_bf16 v[72:75], a[28:31], a[0:3], v[72:75]
buffer_load_dwordx4 a[252:255], v2, s[20:23], s43 offen offset:3072
v_mfma_f32_16x16x32_bf16 v[28:31], a[16:19], a[4:7], v[28:31]
buffer_load_dwordx4 a[224:227], v2, s[16:19], s42 offen
v_mfma_f32_16x16x32_bf16 v[44:47], a[20:23], a[4:7], v[44:47]
buffer_load_dwordx4 a[228:231], v3, s[16:19], s42 offen
v_mfma_f32_16x16x32_bf16 v[60:63], a[24:27], a[4:7], v[60:63]
buffer_load_dwordx4 a[232:235], v4, s[16:19], s42 offen
v_mfma_f32_16x16x32_bf16 v[76:79], a[28:31], a[4:7], v[76:79]
buffer_load_dwordx4 a[236:239], v5, s[16:19], s42 offen
v_mfma_f32_16x16x32_bf16 v[32:35], a[16:19], a[8:11], v[32:35]
s_add_u32 s43, s43, 4096
s_add_u32 s42, s42, 1024
v_mfma_f32_16x16x32_bf16 v[48:51], a[20:23], a[8:11], v[48:51]
v_mfma_f32_16x16x32_bf16 v[64:67], a[24:27], a[8:11], v[64:67]
v_mfma_f32_16x16x32_bf16 v[80:83], a[28:31], a[8:11], v[80:83]
v_mfma_f32_16x16x32_bf16 v[36:39], a[16:19], a[12:15], v[36:39]
v_mfma_f32_16x16x32_bf16 v[52:55], a[20:23], a[12:15], v[52:55]
v_mfma_f32_16x16x32_bf16 v[68:71], a[24:27], a[12:15], v[68:71]
v_mfma_f32_16x16x32_bf16 v[84:87], a[28:31], a[12:15], v[84:87]
s_waitcnt vmcnt(48)
v_mfma_f32_16x16x32_bf16 v[24:27], a[48:51], a[32:35], v[24:27]
buffer_load_dwordx4 a[16:19], v2, s[20:23], s43 offen offset:0
v_mfma_f32_16x16x32_bf16 v[40:43], a[52:55], a[32:35], v[40:43]
buffer_load_dwordx4 a[20:23], v2, s[20:23], s43 offen offset:1024
v_mfma_f32_16x16x32_bf16 v[56:59], a[56:59], a[32:35], v[56:59]
buffer_load_dwordx4 a[24:27], v2, s[20:23], s43 offen offset:2048
v_mfma_f32_16x16x32_bf16 v[72:75], a[60:63], a[32:35], v[72:75]
buffer_load_dwordx4 a[28:31], v2, s[20:23], s43 offen offset:3072
v_mfma_f32_16x16x32_bf16 v[28:31], a[48:51], a[36:39], v[28:31]
buffer_load_dwordx4 a[0:3], v2, s[16:19], s42 offen
v_mfma_f32_16x16x32_bf16 v[44:47], a[52:55], a[36:39], v[44:47]
buffer_load_dwordx4 a[4:7], v3, s[16:19], s42 offen
v_mfma_f32_16x16x32_bf16 v[60:63], a[56:59], a[36:39], v[60:63]
buffer_load_dwordx4 a[8:11], v4, s[16:19], s42 offen
v_mfma_f32_16x16x32_bf16 v[76:79], a[60:63], a[36:39], v[76:79]
buffer_load_dwordx4 a[12:15], v5, s[16:19], s42 offen
v_mfma_f32_16x16x32_bf16 v[32:35], a[48:51], a[40:43], v[32:35]
s_add_u32 s43, s43, 4096
s_add_u32 s42, s42, 1024
v_mfma_f32_16x16x32_bf16 v[48:51], a[52:55], a[40:43], v[48:51]
v_mfma_f32_16x16x32_bf16 v[64:67], a[56:59], a[40:43], v[64:67]
v_mfma_f32_16x16x32_bf16 v[80:83], a[60:63], a[40:43], v[80:83]
v_mfma_f32_16x16x32_bf16 v[36:39], a[48:51], a[44:47], v[36:39]
v_mfma_f32_16x16x32_bf16 v[52:55], a[52:55], a[44:47], v[52:55]
v_mfma_f32_16x16x32_bf16 v[68:71], a[56:59], a[44:47], v[68:71]
v_mfma_f32_16x16x32_bf16 v[84:87], a[60:63], a[44:47], v[84:87]
s_waitcnt vmcnt(48)
v_mfma_f32_16x16x32_bf16 v[24:27], a[80:83], a[64:67], v[24:27]
buffer_load_dwordx4 a[48:51], v2, s[20:23], s43 offen offset:0
v_mfma_f32_16x16x32_bf16 v[40:43], a[84:87], a[64:67], v[40:43]
buffer_load_dwordx4 a[52:55], v2, s[20:23], s43 offen offset:1024
v_mfma_f32_16x16x32_bf16 v[56:59], a[88:91], a[64:67], v[56:59]
buffer_load_dwordx4 a[56:59], v2, s[20:23], s43 offen offset:2048
v_mfma_f32_16x16x32_bf16 v[72:75], a[92:95], a[64:67], v[72:75]
buffer_load_dwordx4 a[60:63], v2, s[20:23], s43 offen offset:3072
v_mfma_f32_16x16x32_bf16 v[28:31], a[80:83], a[68:71], v[28:31]
buffer_load_dwordx4 a[32:35], v2, s[16:19], s42 offen
v_mfma_f32_16x16x32_bf16 v[44:47], a[84:87], a[68:71], v[44:47]
buffer_load_dwordx4 a[36:39], v3, s[16:19], s42 offen
v_mfma_f32_16x16x32_bf16 v[60:63], a[88:91], a[68:71], v[60:63]
buffer_load_dwordx4 a[40:43], v4, s[16:19], s42 offen
v_mfma_f32_16x16x32_bf16 v[76:79], a[92:95], a[68:71], v[76:79]
buffer_load_dwordx4 a[44:47], v5, s[16:19], s42 offen
v_mfma_f32_16x16x32_bf16 v[32:35], a[80:83], a[72:75], v[32:35]
s_add_u32 s43, s43, 4096
s_add_u32 s42, s42, 1024
v_mfma_f32_16x16x32_bf16 v[48:51], a[84:87], a[72:75], v[48:51]
v_mfma_f32_16x16x32_bf16 v[64:67], a[88:91], a[72:75], v[64:67]
v_mfma_f32_16x16x32_bf16 v[80:83], a[92:95], a[72:75], v[80:83]
v_mfma_f32_16x16x32_bf16 v[36:39], a[80:83], a[76:79], v[36:39]
v_mfma_f32_16x16x32_bf16 v[52:55], a[84:87], a[76:79], v[52:55]
v_mfma_f32_16x16x32_bf16 v[68:71], a[88:91], a[76:79], v[68:71]
v_mfma_f32_16x16x32_bf16 v[84:87], a[92:95], a[76:79], v[84:87]
s_waitcnt vmcnt(48)
v_mfma_f32_16x16x32_bf16 v[24:27], a[112:115], a[96:99], v[24:27]
buffer_load_dwordx4 a[80:83], v2, s[20:23], s43 offen offset:0
v_mfma_f32_16x16x32_bf16 v[40:43], a[116:119], a[96:99], v[40:43]
buffer_load_dwordx4 a[84:87], v2, s[20:23], s43 offen offset:1024
v_mfma_f32_16x16x32_bf16 v[56:59], a[120:123], a[96:99], v[56:59]
buffer_load_dwordx4 a[88:91], v2, s[20:23], s43 offen offset:2048
v_mfma_f32_16x16x32_bf16 v[72:75], a[124:127], a[96:99], v[72:75]
buffer_load_dwordx4 a[92:95], v2, s[20:23], s43 offen offset:3072
v_mfma_f32_16x16x32_bf16 v[28:31], a[112:115], a[100:103], v[28:31]
buffer_load_dwordx4 a[64:67], v2, s[16:19], s42 offen
v_mfma_f32_16x16x32_bf16 v[44:47], a[116:119], a[100:103], v[44:47]
buffer_load_dwordx4 a[68:71], v3, s[16:19], s42 offen
v_mfma_f32_16x16x32_bf16 v[60:63], a[120:123], a[100:103], v[60:63]
buffer_load_dwordx4 a[72:75], v4, s[16:19], s42 offen
v_mfma_f32_16x16x32_bf16 v[76:79], a[124:127], a[100:103], v[76:79]
buffer_load_dwordx4 a[76:79], v5, s[16:19], s42 offen
v_mfma_f32_16x16x32_bf16 v[32:35], a[112:115], a[104:107], v[32:35]
s_add_u32 s43, s43, 4096
s_add_u32 s42, s42, 1024
v_mfma_f32_16x16x32_bf16 v[48:51], a[116:119], a[104:107], v[48:51]
v_mfma_f32_16x16x32_bf16 v[64:67], a[120:123], a[104:107], v[64:67]
v_mfma_f32_16x16x32_bf16 v[80:83], a[124:127], a[104:107], v[80:83]
v_mfma_f32_16x16x32_bf16 v[36:39], a[112:115], a[108:111], v[36:39]
v_mfma_f32_16x16x32_bf16 v[52:55], a[116:119], a[108:111], v[52:55]
v_mfma_f32_16x16x32_bf16 v[68:71], a[120:123], a[108:111], v[68:71]
v_mfma_f32_16x16x32_bf16 v[84:87], a[124:127], a[108:111], v[84:87]
s_waitcnt vmcnt(48)
v_mfma_f32_16x16x32_bf16 v[24:27], a[144:147], a[128:131], v[24:27]
buffer_load_dwordx4 a[112:115], v2, s[20:23], s43 offen offset:0
v_mfma_f32_16x16x32_bf16 v[40:43], a[148:151], a[128:131], v[40:43]
buffer_load_dwordx4 a[116:119], v2, s[20:23], s43 offen offset:1024
v_mfma_f32_16x16x32_bf16 v[56:59], a[152:155], a[128:131], v[56:59]
buffer_load_dwordx4 a[120:123], v2, s[20:23], s43 offen offset:2048
v_mfma_f32_16x16x32_bf16 v[72:75], a[156:159], a[128:131], v[72:75]
buffer_load_dwordx4 a[124:127], v2, s[20:23], s43 offen offset:3072
v_mfma_f32_16x16x32_bf16 v[28:31], a[144:147], a[132:135], v[28:31]
buffer_load_dwordx4 a[96:99], v2, s[16:19], s42 offen
v_mfma_f32_16x16x32_bf16 v[44:47], a[148:151], a[132:135], v[44:47]
buffer_load_dwordx4 a[100:103], v3, s[16:19], s42 offen
v_mfma_f32_16x16x32_bf16 v[60:63], a[152:155], a[132:135], v[60:63]
buffer_load_dwordx4 a[104:107], v4, s[16:19], s42 offen
v_mfma_f32_16x16x32_bf16 v[76:79], a[156:159], a[132:135], v[76:79]
buffer_load_dwordx4 a[108:111], v5, s[16:19], s42 offen
v_mfma_f32_16x16x32_bf16 v[32:35], a[144:147], a[136:139], v[32:35]
s_add_u32 s43, s43, 4096
s_add_u32 s42, s42, 1024
v_mfma_f32_16x16x32_bf16 v[48:51], a[148:151], a[136:139], v[48:51]
v_mfma_f32_16x16x32_bf16 v[64:67], a[152:155], a[136:139], v[64:67]
v_mfma_f32_16x16x32_bf16 v[80:83], a[156:159], a[136:139], v[80:83]
v_mfma_f32_16x16x32_bf16 v[36:39], a[144:147], a[140:143], v[36:39]
v_mfma_f32_16x16x32_bf16 v[52:55], a[148:151], a[140:143], v[52:55]
v_mfma_f32_16x16x32_bf16 v[68:71], a[152:155], a[140:143], v[68:71]
v_mfma_f32_16x16x32_bf16 v[84:87], a[156:159], a[140:143], v[84:87]
s_waitcnt vmcnt(48)
v_mfma_f32_16x16x32_bf16 v[24:27], a[176:179], a[160:163], v[24:27]
buffer_load_dwordx4 a[144:147], v2, s[20:23], s43 offen offset:0
v_mfma_f32_16x16x32_bf16 v[40:43], a[180:183], a[160:163], v[40:43]
buffer_load_dwordx4 a[148:151], v2, s[20:23], s43 offen offset:1024
v_mfma_f32_16x16x32_bf16 v[56:59], a[184:187], a[160:163], v[56:59]
buffer_load_dwordx4 a[152:155], v2, s[20:23], s43 offen offset:2048
v_mfma_f32_16x16x32_bf16 v[72:75], a[188:191], a[160:163], v[72:75]
buffer_load_dwordx4 a[156:159], v2, s[20:23], s43 offen offset:3072
v_mfma_f32_16x16x32_bf16 v[28:31], a[176:179], a[164:167], v[28:31]
buffer_load_dwordx4 a[128:131], v2, s[16:19], s42 offen
v_mfma_f32_16x16x32_bf16 v[44:47], a[180:183], a[164:167], v[44:47]
buffer_load_dwordx4 a[132:135], v3, s[16:19], s42 offen
v_mfma_f32_16x16x32_bf16 v[60:63], a[184:187], a[164:167], v[60:63]
buffer_load_dwordx4 a[136:139], v4, s[16:19], s42 offen
v_mfma_f32_16x16x32_bf16 v[76:79], a[188:191], a[164:167], v[76:79]
buffer_load_dwordx4 a[140:143], v5, s[16:19], s42 offen
v_mfma_f32_16x16x32_bf16 v[32:35], a[176:179], a[168:171], v[32:35]
s_add_u32 s43, s43, 4096
s_add_u32 s42, s42, 1024
v_mfma_f32_16x16x32_bf16 v[48:51], a[180:183], a[168:171], v[48:51]
v_mfma_f32_16x16x32_bf16 v[64:67], a[184:187], a[168:171], v[64:67]
v_mfma_f32_16x16x32_bf16 v[80:83], a[188:191], a[168:171], v[80:83]
v_mfma_f32_16x16x32_bf16 v[36:39], a[176:179], a[172:175], v[36:39]
v_mfma_f32_16x16x32_bf16 v[52:55], a[180:183], a[172:175], v[52:55]
v_mfma_f32_16x16x32_bf16 v[68:71], a[184:187], a[172:175], v[68:71]
v_mfma_f32_16x16x32_bf16 v[84:87], a[188:191], a[172:175], v[84:87]
s_waitcnt vmcnt(48)
v_mfma_f32_16x16x32_bf16 v[24:27], a[208:211], a[192:195], v[24:27]
buffer_load_dwordx4 a[176:179], v2, s[20:23], s43 offen offset:0
v_mfma_f32_16x16x32_bf16 v[40:43], a[212:215], a[192:195], v[40:43]
buffer_load_dwordx4 a[180:183], v2, s[20:23], s43 offen offset:1024
v_mfma_f32_16x16x32_bf16 v[56:59], a[216:219], a[192:195], v[56:59]
buffer_load_dwordx4 a[184:187], v2, s[20:23], s43 offen offset:2048
v_mfma_f32_16x16x32_bf16 v[72:75], a[220:223], a[192:195], v[72:75]
buffer_load_dwordx4 a[188:191], v2, s[20:23], s43 offen offset:3072
v_mfma_f32_16x16x32_bf16 v[28:31], a[208:211], a[196:199], v[28:31]
buffer_load_dwordx4 a[160:163], v2, s[16:19], s42 offen
v_mfma_f32_16x16x32_bf16 v[44:47], a[212:215], a[196:199], v[44:47]
buffer_load_dwordx4 a[164:167], v3, s[16:19], s42 offen
v_mfma_f32_16x16x32_bf16 v[60:63], a[216:219], a[196:199], v[60:63]
buffer_load_dwordx4 a[168:171], v4, s[16:19], s42 offen
v_mfma_f32_16x16x32_bf16 v[76:79], a[220:223], a[196:199], v[76:79]
buffer_load_dwordx4 a[172:175], v5, s[16:19], s42 offen
v_mfma_f32_16x16x32_bf16 v[32:35], a[208:211], a[200:203], v[32:35]
s_add_u32 s43, s43, 4096
s_add_u32 s42, s42, 1024
v_mfma_f32_16x16x32_bf16 v[48:51], a[212:215], a[200:203], v[48:51]
v_mfma_f32_16x16x32_bf16 v[64:67], a[216:219], a[200:203], v[64:67]
v_mfma_f32_16x16x32_bf16 v[80:83], a[220:223], a[200:203], v[80:83]
v_mfma_f32_16x16x32_bf16 v[36:39], a[208:211], a[204:207], v[36:39]
v_mfma_f32_16x16x32_bf16 v[52:55], a[212:215], a[204:207], v[52:55]
v_mfma_f32_16x16x32_bf16 v[68:71], a[216:219], a[204:207], v[68:71]
v_mfma_f32_16x16x32_bf16 v[84:87], a[220:223], a[204:207], v[84:87]
s_waitcnt vmcnt(48)
v_mfma_f32_16x16x32_bf16 v[24:27], a[240:243], a[224:227], v[24:27]
buffer_load_dwordx4 a[208:211], v2, s[20:23], s43 offen offset:0
v_mfma_f32_16x16x32_bf16 v[40:43], a[244:247], a[224:227], v[40:43]
buffer_load_dwordx4 a[212:215], v2, s[20:23], s43 offen offset:1024
v_mfma_f32_16x16x32_bf16 v[56:59], a[248:251], a[224:227], v[56:59]
buffer_load_dwordx4 a[216:219], v2, s[20:23], s43 offen offset:2048
v_mfma_f32_16x16x32_bf16 v[72:75], a[252:255], a[224:227], v[72:75]
buffer_load_dwordx4 a[220:223], v2, s[20:23], s43 offen offset:3072
v_mfma_f32_16x16x32_bf16 v[28:31], a[240:243], a[228:231], v[28:31]
buffer_load_dwordx4 a[192:195], v2, s[16:19], s42 offen
v_mfma_f32_16x16x32_bf16 v[44:47], a[244:247], a[228:231], v[44:47]
buffer_load_dwordx4 a[196:199], v3, s[16:19], s42 offen
v_mfma_f32_16x16x32_bf16 v[60:63], a[248:251], a[228:231], v[60:63]
buffer_load_dwordx4 a[200:203], v4, s[16:19], s42 offen
v_mfma_f32_16x16x32_bf16 v[76:79], a[252:255], a[228:231], v[76:79]
buffer_load_dwordx4 a[204:207], v5, s[16:19], s42 offen
v_mfma_f32_16x16x32_bf16 v[32:35], a[240:243], a[232:235], v[32:35]
s_add_u32 s43, s43, 4096
s_add_u32 s42, s42, 1024
v_mfma_f32_16x16x32_bf16 v[48:51], a[244:247], a[232:235], v[48:51]
v_mfma_f32_16x16x32_bf16 v[64:67], a[248:251], a[232:235], v[64:67]
v_mfma_f32_16x16x32_bf16 v[80:83], a[252:255], a[232:235], v[80:83]
v_mfma_f32_16x16x32_bf16 v[36:39], a[240:243], a[236:239], v[36:39]
v_mfma_f32_16x16x32_bf16 v[52:55], a[244:247], a[236:239], v[52:55]
v_mfma_f32_16x16x32_bf16 v[68:71], a[248:251], a[236:239], v[68:71]
v_mfma_f32_16x16x32_bf16 v[84:87], a[252:255], a[236:239], v[84:87]
s_sub_u32 s45, s45, 1
s_cmp_lg_u32 s45, 0
s_cbranch_scc1 K3_LOOP
s_waitcnt vmcnt(48)
v_mfma_f32_16x16x32_bf16 v[24:27], a[16:19], a[0:3], v[24:27]
buffer_load_dwordx4 a[240:243], v2, s[20:23], s43 offen offset:0
v_mfma_f32_16x16x32_bf16 v[40:43], a[20:23], a[0:3], v[40:43]
buffer_load_dwordx4 a[244:247], v2, s[20:23], s43 offen offset:1024
v_mfma_f32_16x16x32_bf16 v[56:59], a[24:27], a[0:3], v[56:59]
buffer_load_dwordx4 a[248:251], v2, s[20:23], s43 offen offset:2048
v_mfma_f32_16x16x32_bf16 v[72:75], a[28:31], a[0:3], v[72:75]
buffer_load_dwordx4 a[252:255], v2, s[20:23], s43 offen offset:3072
v_mfma_f32_16x16x32_bf16 v[28:31], a[16:19], a[4:7], v[28:31]
buffer_load_dwordx4 a[224:227], v2, s[16:19], s42 offen
v_mfma_f32_16x16x32_bf16 v[44:47], a[20:23], a[4:7], v[44:47]
buffer_load_dwordx4 a[228:231], v3, s[16:19], s42 offen
v_mfma_f32_16x16x32_bf16 v[60:63], a[24:27], a[4:7], v[60:63]
buffer_load_dwordx4 a[232:235], v4, s[16:19], s42 offen
v_mfma_f32_16x16x32_bf16 v[76:79], a[28:31], a[4:7], v[76:79]
buffer_load_dwordx4 a[236:239], v5, s[16:19], s42 offen
v_mfma_f32_16x16x32_bf16 v[32:35], a[16:19], a[8:11], v[32:35]
s_add_u32 s43, s43, 4096
s_add_u32 s42, s42, 1024
v_mfma_f32_16x16x32_bf16 v[48:51], a[20:23], a[8:11], v[48:51]
v_mfma_f32_16x16x32_bf16 v[64:67], a[24:27], a[8:11], v[64:67]
v_mfma_f32_16x16x32_bf16 v[80:83], a[28:31], a[8:11], v[80:83]
v_mfma_f32_16x16x32_bf16 v[36:39], a[16:19], a[12:15], v[36:39]
v_mfma_f32_16x16x32_bf16 v[52:55], a[20:23], a[12:15], v[52:55]
v_mfma_f32_16x16x32_bf16 v[68:71], a[24:27], a[12:15], v[68:71]
v_mfma_f32_16x16x32_bf16 v[84:87], a[28:31], a[12:15], v[84:87]
s_waitcnt vmcnt(48)
v_mfma_f32_16x16x32_bf16 v[24:27], a[48:51], a[32:35], v[24:27]
v_mfma_f32_16x16x32_bf16 v[40:43], a[52:55], a[32:35], v[40:43]
v_mfma_f32_16x16x32_bf16 v[56:59], a[56:59], a[32:35], v[56:59]
v_mfma_f32_16x16x32_bf16 v[72:75], a[60:63], a[32:35], v[72:75]
v_mfma_f32_16x16x32_bf16 v[28:31], a[48:51], a[36:39], v[28:31]
v_mfma_f32_16x16x32_bf16 v[44:47], a[52:55], a[36:39], v[44:47]
v_mfma_f32_16x16x32_bf16 v[60:63], a[56:59], a[36:39], v[60:63]
v_mfma_f32_16x16x32_bf16 v[76:79], a[60:63], a[36:39], v[76:79]
v_mfma_f32_16x16x32_bf16 v[32:35], a[48:51], a[40:43], v[32:35]
v_mfma_f32_16x16x32_bf16 v[48:51], a[52:55], a[40:43], v[48:51]
v_mfma_f32_16x16x32_bf16 v[64:67], a[56:59], a[40:43], v[64:67]
v_mfma_f32_16x16x32_bf16 v[80:83], a[60:63], a[40:43], v[80:83]
v_mfma_f32_16x16x32_bf16 v[36:39], a[48:51], a[44:47], v[36:39]
v_mfma_f32_16x16x32_bf16 v[52:55], a[52:55], a[44:47], v[52:55]
v_mfma_f32_16x16x32_bf16 v[68:71], a[56:59], a[44:47], v[68:71]
v_mfma_f32_16x16x32_bf16 v[84:87], a[60:63], a[44:47], v[84:87]
s_waitcnt vmcnt(40)
v_mfma_f32_16x16x32_bf16 v[24:27], a[80:83], a[64:67], v[24:27]
v_mfma_f32_16x16x32_bf16 v[40:43], a[84:87], a[64:67], v[40:43]
v_mfma_f32_16x16x32_bf16 v[56:59], a[88:91], a[64:67], v[56:59]
v_mfma_f32_16x16x32_bf16 v[72:75], a[92:95], a[64:67], v[72:75]
v_mfma_f32_16x16x32_bf16 v[28:31], a[80:83], a[68:71], v[28:31]
v_mfma_f32_16x16x32_bf16 v[44:47], a[84:87], a[68:71], v[44:47]
v_mfma_f32_16x16x32_bf16 v[60:63], a[88:91], a[68:71], v[60:63]
v_mfma_f32_16x16x32_bf16 v[76:79], a[92:95], a[68:71], v[76:79]
v_mfma_f32_16x16x32_bf16 v[32:35], a[80:83], a[72:75], v[32:35]
v_mfma_f32_16x16x32_bf16 v[48:51], a[84:87], a[72:75], v[48:51]
v_mfma_f32_16x16x32_bf16 v[64:67], a[88:91], a[72:75], v[64:67]
v_mfma_f32_16x16x32_bf16 v[80:83], a[92:95], a[72:75], v[80:83]
v_mfma_f32_16x16x32_bf16 v[36:39], a[80:83], a[76:79], v[36:39]
v_mfma_f32_16x16x32_bf16 v[52:55], a[84:87], a[76:79], v[52:55]
v_mfma_f32_16x16x32_bf16 v[68:71], a[88:91], a[76:79], v[68:71]
v_mfma_f32_16x16x32_bf16 v[84:87], a[92:95], a[76:79], v[84:87]
s_waitcnt vmcnt(32)
v_mfma_f32_16x16x32_bf16 v[24:27], a[112:115], a[96:99], v[24:27]
v_mfma_f32_16x16x32_bf16 v[40:43], a[116:119], a[96:99], v[40:43]
v_mfma_f32_16x16x32_bf16 v[56:59], a[120:123], a[96:99], v[56:59]
v_mfma_f32_16x16x32_bf16 v[72:75], a[124:127], a[96:99], v[72:75]
v_mfma_f32_16x16x32_bf16 v[28:31], a[112:115], a[100:103], v[28:31]
v_mfma_f32_16x16x32_bf16 v[44:47], a[116:119], a[100:103], v[44:47]
v_mfma_f32_16x16x32_bf16 v[60:63], a[120:123], a[100:103], v[60:63]
v_mfma_f32_16x16x32_bf16 v[76:79], a[124:127], a[100:103], v[76:79]
v_mfma_f32_16x16x32_bf16 v[32:35], a[112:115], a[104:107], v[32:35]
v_mfma_f32_16x16x32_bf16 v[48:51], a[116:119], a[104:107], v[48:51]
v_mfma_f32_16x16x32_bf16 v[64:67], a[120:123], a[104:107], v[64:67]
v_mfma_f32_16x16x32_bf16 v[80:83], a[124:127], a[104:107], v[80:83]
v_mfma_f32_16x16x32_bf16 v[36:39], a[112:115], a[108:111], v[36:39]
v_mfma_f32_16x16x32_bf16 v[52:55], a[116:119], a[108:111], v[52:55]
v_mfma_f32_16x16x32_bf16 v[68:71], a[120:123], a[108:111], v[68:71]
v_mfma_f32_16x16x32_bf16 v[84:87], a[124:127], a[108:111], v[84:87]
s_waitcnt vmcnt(24)
v_mfma_f32_16x16x32_bf16 v[24:27], a[144:147], a[128:131], v[24:27]
v_mfma_f32_16x16x32_bf16 v[40:43], a[148:151], a[128:131], v[40:43]
v_mfma_f32_16x16x32_bf16 v[56:59], a[152:155], a[128:131], v[56:59]
v_mfma_f32_16x16x32_bf16 v[72:75], a[156:159], a[128:131], v[72:75]
v_mfma_f32_16x16x32_bf16 v[28:31], a[144:147], a[132:135], v[28:31]
v_mfma_f32_16x16x32_bf16 v[44:47], a[148:151], a[132:135], v[44:47]
v_mfma_f32_16x16x32_bf16 v[60:63], a[152:155], a[132:135], v[60:63]
v_mfma_f32_16x16x32_bf16 v[76:79], a[156:159], a[132:135], v[76:79]
v_mfma_f32_16x16x32_bf16 v[32:35], a[144:147], a[136:139], v[32:35]
v_mfma_f32_16x16x32_bf16 v[48:51], a[148:151], a[136:139], v[48:51]
v_mfma_f32_16x16x32_bf16 v[64:67], a[152:155], a[136:139], v[64:67]
v_mfma_f32_16x16x32_bf16 v[80:83], a[156:159], a[136:139], v[80:83]
v_mfma_f32_16x16x32_bf16 v[36:39], a[144:147], a[140:143], v[36:39]
v_mfma_f32_16x16x32_bf16 v[52:55], a[148:151], a[140:143], v[52:55]
v_mfma_f32_16x16x32_bf16 v[68:71], a[152:155], a[140:143], v[68:71]
v_mfma_f32_16x16x32_bf16 v[84:87], a[156:159], a[140:143], v[84:87]
s_waitcnt vmcnt(16)
v_mfma_f32_16x16x32_bf16 v[24:27], a[176:179], a[160:163], v[24:27]
v_mfma_f32_16x16x32_bf16 v[40:43], a[180:183], a[160:163], v[40:43]
v_mfma_f32_16x16x32_bf16 v[56:59], a[184:187], a[160:163], v[56:59]
v_mfma_f32_16x16x32_bf16 v[72:75], a[188:191], a[160:163], v[72:75]
v_mfma_f32_16x16x32_bf16 v[28:31], a[176:179], a[164:167], v[28:31]
v_mfma_f32_16x16x32_bf16 v[44:47], a[180:183], a[164:167], v[44:47]
v_mfma_f32_16x16x32_bf16 v[60:63], a[184:187], a[164:167], v[60:63]
v_mfma_f32_16x16x32_bf16 v[76:79], a[188:191], a[164:167], v[76:79]
v_mfma_f32_16x16x32_bf16 v[32:35], a[176:179], a[168:171], v[32:35]
v_mfma_f32_16x16x32_bf16 v[48:51], a[180:183], a[168:171], v[48:51]
v_mfma_f32_16x16x32_bf16 v[64:67], a[184:187], a[168:171], v[64:67]
v_mfma_f32_16x16x32_bf16 v[80:83], a[188:191], a[168:171], v[80:83]
v_mfma_f32_16x16x32_bf16 v[36:39], a[176:179], a[172:175], v[36:39]
v_mfma_f32_16x16x32_bf16 v[52:55], a[180:183], a[172:175], v[52:55]
v_mfma_f32_16x16x32_bf16 v[68:71], a[184:187], a[172:175], v[68:71]
v_mfma_f32_16x16x32_bf16 v[84:87], a[188:191], a[172:175], v[84:87]
s_waitcnt vmcnt(8)
v_mfma_f32_16x16x32_bf16 v[24:27], a[208:211], a[192:195], v[24:27]
v_mfma_f32_16x16x32_bf16 v[40:43], a[212:215], a[192:195], v[40:43]
v_mfma_f32_16x16x32_bf16 v[56:59], a[216:219], a[192:195], v[56:59]
v_mfma_f32_16x16x32_bf16 v[72:75], a[220:223], a[192:195], v[72:75]
v_mfma_f32_16x16x32_bf16 v[28:31], a[208:211], a[196:199], v[28:31]
v_mfma_f32_16x16x32_bf16 v[44:47], a[212:215], a[196:199], v[44:47]
v_mfma_f32_16x16x32_bf16 v[60:63], a[216:219], a[196:199], v[60:63]
v_mfma_f32_16x16x32_bf16 v[76:79], a[220:223], a[196:199], v[76:79]
v_mfma_f32_16x16x32_bf16 v[32:35], a[208:211], a[200:203], v[32:35]
v_mfma_f32_16x16x32_bf16 v[48:51], a[212:215], a[200:203], v[48:51]
v_mfma_f32_16x16x32_bf16 v[64:67], a[216:219], a[200:203], v[64:67]
v_mfma_f32_16x16x32_bf16 v[80:83], a[220:223], a[200:203], v[80:83]
v_mfma_f32_16x16x32_bf16 v[36:39], a[208:211], a[204:207], v[36:39]
v_mfma_f32_16x16x32_bf16 v[52:55], a[212:215], a[204:207], v[52:55]
v_mfma_f32_16x16x32_bf16 v[68:71], a[216:219], a[204:207], v[68:71]
v_mfma_f32_16x16x32_bf16 v[84:87], a[220:223], a[204:207], v[84:87]
s_waitcnt vmcnt(0)
v_mfma_f32_16x16x32_bf16 v[24:27], a[240:243], a[224:227], v[24:27]
v_mfma_f32_16x16x32_bf16 v[40:43], a[244:247], a[224:227], v[40:43]
v_mfma_f32_16x16x32_bf16 v[56:59], a[248:251], a[224:227], v[56:59]
v_mfma_f32_16x16x32_bf16 v[72:75], a[252:255], a[224:227], v[72:75]
v_mfma_f32_16x16x32_bf16 v[28:31], a[240:243], a[228:231], v[28:31]
v_mfma_f32_16x16x32_bf16 v[44:47], a[244:247], a[228:231], v[44:47]
v_mfma_f32_16x16x32_bf16 v[60:63], a[248:251], a[228:231], v[60:63]
v_mfma_f32_16x16x32_bf16 v[76:79], a[252:255], a[228:231], v[76:79]
v_mfma_f32_16x16x32_bf16 v[32:35], a[240:243], a[232:235], v[32:35]
v_mfma_f32_16x16x32_bf16 v[48:51], a[244:247], a[232:235], v[48:51]
v_mfma_f32_16x16x32_bf16 v[64:67], a[248:251], a[232:235], v[64:67]
v_mfma_f32_16x16x32_bf16 v[80:83], a[252:255], a[232:235], v[80:83]
v_mfma_f32_16x16x32_bf16 v[36:39], a[240:243], a[236:239], v[36:39]
v_mfma_f32_16x16x32_bf16 v[52:55], a[244:247], a[236:239], v[52:55]
v_mfma_f32_16x16x32_bf16 v[68:71], a[248:251], a[236:239], v[68:71]
v_mfma_f32_16x16x32_bf16 v[84:87], a[252:255], a[236:239], v[84:87]
s_add_u32 s60, s12, 66060288
s_addc_u32 s61, s13, 0
s_mov_b32 s62, 65536
s_mov_b32 s63, 0x00020000
v_mov_b32 v118, 0
v_lshlrev_b32 v119, 2, v1
s_lshl_b32 s64, s2, 8
buffer_store_dword v118, v119, s[60:63], s64 offen sc0 sc1
s_nop 7
v_mov_b32 v88, v22
v_mov_b32 v89, v23
v_lshlrev_b32 v92, 10, v22
v_lshl_add_u32 v92, v23, 4, v92
v_and_b32 v93, 15, v1
v_lshrrev_b32 v94, 4, v1
s_mul_i32 s39, s36, 17408
s_add_u32 s39, s39, 0
v_mul_u32_u24 v93, 272, v93
v_lshl_add_u32 v93, v94, 4, v93
v_add_u32 v93, s39, v93
ds_write_b128 v93, v[24:27] offset:0
ds_write_b128 v93, v[40:43] offset:64
ds_write_b128 v93, v[56:59] offset:128
ds_write_b128 v93, v[72:75] offset:192
ds_write_b128 v93, v[28:31] offset:4352
ds_write_b128 v93, v[44:47] offset:4416
ds_write_b128 v93, v[60:63] offset:4480
ds_write_b128 v93, v[76:79] offset:4544
ds_write_b128 v93, v[32:35] offset:8704
ds_write_b128 v93, v[48:51] offset:8768
ds_write_b128 v93, v[64:67] offset:8832
ds_write_b128 v93, v[80:83] offset:8896
ds_write_b128 v93, v[36:39] offset:13056
ds_write_b128 v93, v[52:55] offset:13120
ds_write_b128 v93, v[68:71] offset:13184
ds_write_b128 v93, v[84:87] offset:13248
s_waitcnt lgkmcnt(0)
s_barrier
v_mul_u32_u24 v93, 272, v88
v_lshl_add_u32 v93, v89, 5, v93
v_add_u32 v93, 0, v93
ds_read_b128 v[24:27], v93 offset:0
ds_read_b128 v[28:31], v93 offset:16
ds_read_b128 v[32:35], v93 offset:17408
ds_read_b128 v[36:39], v93 offset:17424
ds_read_b128 v[40:43], v93 offset:34816
ds_read_b128 v[44:47], v93 offset:34832
ds_read_b128 v[48:51], v93 offset:52224
ds_read_b128 v[52:55], v93 offset:52240
ds_read_b128 v[56:59], v93 offset:8704
ds_read_b128 v[60:63], v93 offset:8720
ds_read_b128 v[64:67], v93 offset:26112
ds_read_b128 v[68:71], v93 offset:26128
ds_read_b128 v[72:75], v93 offset:43520
ds_read_b128 v[76:79], v93 offset:43536
ds_read_b128 v[80:83], v93 offset:60928
ds_read_b128 v[84:87], v93 offset:60944
s_waitcnt vmcnt(0)
s_waitcnt lgkmcnt(8)
v_add_f32 v24, v24, v32
v_add_f32 v25, v25, v33
v_add_f32 v26, v26, v34
v_add_f32 v27, v27, v35
v_add_f32 v28, v28, v36
v_add_f32 v29, v29, v37
v_add_f32 v30, v30, v38
v_add_f32 v31, v31, v39
v_add_f32 v24, v24, v40
v_add_f32 v25, v25, v41
v_add_f32 v26, v26, v42
v_add_f32 v27, v27, v43
v_add_f32 v28, v28, v44
v_add_f32 v29, v29, v45
v_add_f32 v30, v30, v46
v_add_f32 v31, v31, v47
v_add_f32 v24, v24, v48
v_add_f32 v25, v25, v49
v_add_f32 v26, v26, v50
v_add_f32 v27, v27, v51
v_add_f32 v28, v28, v52
v_add_f32 v29, v29, v53
v_add_f32 v30, v30, v54
v_add_f32 v31, v31, v55
v_lshlrev_b32 v98, 16, v14
v_and_b32 v99, 0xffff0000, v14
v_add_f32 v24, v24, v98
v_add_f32 v25, v25, v99
v_lshlrev_b32 v98, 16, v15
v_and_b32 v99, 0xffff0000, v15
v_add_f32 v26, v26, v98
v_add_f32 v27, v27, v99
v_lshlrev_b32 v98, 16, v16
v_and_b32 v99, 0xffff0000, v16
v_add_f32 v28, v28, v98
v_add_f32 v29, v29, v99
v_lshlrev_b32 v98, 16, v17
v_and_b32 v99, 0xffff0000, v17
v_add_f32 v30, v30, v98
v_add_f32 v31, v31, v99
v_cvt_pk_bf16_f32 v32, v24, v25
v_cvt_pk_bf16_f32 v33, v26, v27
v_cvt_pk_bf16_f32 v34, v28, v29
v_cvt_pk_bf16_f32 v35, v30, v31
buffer_store_dwordx4 v[32:35], v92, s[28:31], s46 offen sc0 sc1
v_lshrrev_b32 v100, 4, v88
v_lshlrev_b32 v100, 14, v100
v_lshrrev_b32 v101, 2, v89
v_lshl_add_u32 v100, v101, 10, v100
v_and_b32 v101, 3, v89
v_lshl_add_u32 v100, v101, 8, v100
v_and_b32 v101, 15, v88
v_lshl_add_u32 v100, v101, 4, v100
s_lshl_b32 s48, s37, 16
s_lshl_b32 s39, s38, 11
s_add_u32 s48, s48, s39
s_add_u32 s49, s48, 32768
buffer_store_dwordx4 v[32:35], v100, s[32:35], s48 offen sc0 sc1
v_lshlrev_b32 v40, 16, v32
v_and_b32 v41, 0xffff0000, v32
v_lshlrev_b32 v42, 16, v33
v_and_b32 v43, 0xffff0000, v33
v_lshlrev_b32 v44, 16, v34
v_and_b32 v45, 0xffff0000, v34
v_lshlrev_b32 v46, 16, v35
v_and_b32 v47, 0xffff0000, v35
v_add_f32 v48, v40, v41
v_mul_f32 v49, v40, v40
v_fmac_f32 v49, v41, v41
v_add_f32 v48, v48, v42
v_fmac_f32 v49, v42, v42
v_add_f32 v48, v48, v43
v_fmac_f32 v49, v43, v43
v_add_f32 v48, v48, v44
v_fmac_f32 v49, v44, v44
v_add_f32 v48, v48, v45
v_fmac_f32 v49, v45, v45
v_add_f32 v48, v48, v46
v_fmac_f32 v49, v46, v46
v_add_f32 v48, v48, v47
v_fmac_f32 v49, v47, v47
s_nop 1
v_add_f32_dpp v48, v48, v48 quad_perm:[1,0,3,2] row_mask:0xf bank_mask:0xf
v_add_f32_dpp v49, v49, v49 quad_perm:[1,0,3,2] row_mask:0xf bank_mask:0xf
s_nop 1
v_add_f32_dpp v48, v48, v48 quad_perm:[2,3,0,1] row_mask:0xf bank_mask:0xf
v_add_f32_dpp v49, v49, v49 quad_perm:[2,3,0,1] row_mask:0xf bank_mask:0xf
s_nop 1
v_add_f32_dpp v48, v48, v48 row_half_mirror row_mask:0xf bank_mask:0xf
v_add_f32_dpp v49, v49, v49 row_half_mirror row_mask:0xf bank_mask:0xf
v_lshlrev_b32 v102, 6, v88
s_lshl_b32 s50, s37, 12
s_lshl_b32 s39, s38, 3
s_add_u32 s50, s50, s39
s_add_u32 s51, s50, 2048
v_cmp_eq_u32 vcc, 0, v89
s_and_saveexec_b64 s[52:53], vcc
buffer_store_dwordx2 v[48:49], v102, s[56:59], s50 offen sc0 sc1
s_mov_b64 exec, s[52:53]
s_waitcnt lgkmcnt(0)
v_add_f32 v56, v56, v64
v_add_f32 v57, v57, v65
v_add_f32 v58, v58, v66
v_add_f32 v59, v59, v67
v_add_f32 v60, v60, v68
v_add_f32 v61, v61, v69
v_add_f32 v62, v62, v70
v_add_f32 v63, v63, v71
v_add_f32 v56, v56, v72
v_add_f32 v57, v57, v73
v_add_f32 v58, v58, v74
v_add_f32 v59, v59, v75
v_add_f32 v60, v60, v76
v_add_f32 v61, v61, v77
v_add_f32 v62, v62, v78
v_add_f32 v63, v63, v79
v_add_f32 v56, v56, v80
v_add_f32 v57, v57, v81
v_add_f32 v58, v58, v82
v_add_f32 v59, v59, v83
v_add_f32 v60, v60, v84
v_add_f32 v61, v61, v85
v_add_f32 v62, v62, v86
v_add_f32 v63, v63, v87
v_lshlrev_b32 v98, 16, v18
v_and_b32 v99, 0xffff0000, v18
v_add_f32 v56, v56, v98
v_add_f32 v57, v57, v99
v_lshlrev_b32 v98, 16, v19
v_and_b32 v99, 0xffff0000, v19
v_add_f32 v58, v58, v98
v_add_f32 v59, v59, v99
v_lshlrev_b32 v98, 16, v20
v_and_b32 v99, 0xffff0000, v20
v_add_f32 v60, v60, v98
v_add_f32 v61, v61, v99
v_lshlrev_b32 v98, 16, v21
v_and_b32 v99, 0xffff0000, v21
v_add_f32 v62, v62, v98
v_add_f32 v63, v63, v99
v_cvt_pk_bf16_f32 v64, v56, v57
v_cvt_pk_bf16_f32 v65, v58, v59
v_cvt_pk_bf16_f32 v66, v60, v61
v_cvt_pk_bf16_f32 v67, v62, v63
buffer_store_dwordx4 v[64:67], v92, s[28:31], s47 offen sc0 sc1
buffer_store_dwordx4 v[64:67], v100, s[32:35], s49 offen sc0 sc1
v_lshlrev_b32 v72, 16, v64
v_and_b32 v73, 0xffff0000, v64
v_lshlrev_b32 v74, 16, v65
v_and_b32 v75, 0xffff0000, v65
v_lshlrev_b32 v76, 16, v66
v_and_b32 v77, 0xffff0000, v66
v_lshlrev_b32 v78, 16, v67
v_and_b32 v79, 0xffff0000, v67
v_add_f32 v80, v72, v73
v_mul_f32 v81, v72, v72
v_fmac_f32 v81, v73, v73
v_add_f32 v80, v80, v74
v_fmac_f32 v81, v74, v74
v_add_f32 v80, v80, v75
v_fmac_f32 v81, v75, v75
v_add_f32 v80, v80, v76
v_fmac_f32 v81, v76, v76
v_add_f32 v80, v80, v77
v_fmac_f32 v81, v77, v77
v_add_f32 v80, v80, v78
v_fmac_f32 v81, v78, v78
v_add_f32 v80, v80, v79
v_fmac_f32 v81, v79, v79
s_nop 1
v_add_f32_dpp v80, v80, v80 quad_perm:[1,0,3,2] row_mask:0xf bank_mask:0xf
v_add_f32_dpp v81, v81, v81 quad_perm:[1,0,3,2] row_mask:0xf bank_mask:0xf
s_nop 1
v_add_f32_dpp v80, v80, v80 quad_perm:[2,3,0,1] row_mask:0xf bank_mask:0xf
v_add_f32_dpp v81, v81, v81 quad_perm:[2,3,0,1] row_mask:0xf bank_mask:0xf
s_nop 1
v_add_f32_dpp v80, v80, v80 row_half_mirror row_mask:0xf bank_mask:0xf
v_add_f32_dpp v81, v81, v81 row_half_mirror row_mask:0xf bank_mask:0xf
v_cmp_eq_u32 vcc, 0, v89
s_and_saveexec_b64 s[52:53], vcc
buffer_store_dwordx2 v[80:81], v102, s[56:59], s51 offen sc0 sc1
s_mov_b64 exec, s[52:53]
K3_END:
s_endpgm
.text
.globl k45_kernel
.p2align 8
.type k45_kernel,@function
k45_kernel:
s_cmp_ge_u32 s2, 256
s_cbranch_scc1 K5_END
s_load_dwordx2 s[12:13], s[0:1], 96
s_load_dwordx2 s[6:7], s[0:1], 80
s_load_dwordx2 s[8:9], s[0:1], 88
v_and_b32 v1, 63, v0
v_lshrrev_b32 v2, 6, v0
s_nop 0
v_readfirstlane_b32 s36, v2
s_lshr_b32 s39, s2, 3
s_and_b32 s77, s39, 7
s_lshr_b32 s39, s39, 3
s_and_b32 s76, s2, 7
s_lshl_b32 s76, s76, 2
s_add_u32 s76, s76, s39
s_waitcnt lgkmcnt(0)
s_add_u32 s56, s12, 71303168
s_addc_u32 s57, s13, 0
s_mov_b32 s58, 1441792
s_mov_b32 s59, 0x00020000
s_add_u32 s60, s12, 57671680
s_addc_u32 s61, s13, 0
s_mov_b32 s62, 5767168
s_mov_b32 s63, 0x00020000
s_add_u32 s64, s12, 54525952
s_addc_u32 s65, s13, 0
s_mov_b32 s66, 2097152
s_mov_b32 s67, 0x00020000
s_mov_b32 s68, s6
s_mov_b32 s69, s7
s_mov_b32 s70, 2097152
s_mov_b32 s71, 0x00020000
s_cmp_lt_u32 s2, 8
s_cbranch_scc0 CPF6_X
s_cmp_eq_u32 s36, 3
s_cbranch_scc0 CPF6_X
s_getpc_b64 s[84:85]
CPF6_P:
s_add_u32 s84, s84, k45_kernel-CPF6_P
s_addc_u32 s85, s85, ((k45_kernel-CPF6_P)>>32)&0xffffffff
s_mov_b32 s86, K5_END-k45_kernel
s_mov_b32 s87, 0x00020000
v_lshlrev_b32 v200, 7, v1
s_mov_b32 s88, 0
CPF6_L:
buffer_load_dword v201, v200, s[84:87], s88 offen
s_add_u32 s88, s88, 8192
s_cmp_lt_u32 s88, s86
s_cbranch_scc1 CPF6_L
CPF6_X:
s_add_u32 s72, s12, 66060288
s_addc_u32 s73, s13, 0
s_mov_b32 s74, 65536
s_mov_b32 s75, 0x00020000
v_lshlrev_b32 v5, 4, v1
s_mul_i32 s39, s36, 11
s_lshl_b32 s40, s76, 2
s_mul_i32 s79, s40, 45056
s_lshl_b32 s40, s39, 10
s_add_u32 s79, s79, s40
s_mul_i32 s78, s77, 44
s_add_u32 s78, s78, s39
s_lshl_b32 s78, s78, 12
s_mov_b32 s80, 0
s_lshr_b32 s4, s2, 3
s_and_b32 s5, s2, 7
s_mul_i32 s5, s5, 31
s_add_u32 s4, s4, s5
s_cmp_ge_u32 s2, 248
s_cbranch_scc1 K45_P5
s_cmp_ge_u32 s4, 242
s_cbranch_scc1 K45_P5
s_cmp_lt_u32 s4, 176
s_cbranch_scc0 K4_T3
s_cmp_ge_u32 s4, 88
s_cselect_b32 s5, 88, 0
s_cselect_b32 s37, 4, 0
s_sub_u32 s4, s4, s5
s_lshr_b32 s38, s4, 2
s_and_b32 s4, s4, 3
s_add_u32 s37, s37, s4
s_branch K4_T4
K4_T3:
s_sub_u32 s4, s4, 176
s_mul_hi_u32 s38, s4, 1431655766
s_mul_i32 s5, s38, 3
s_sub_u32 s4, s4, s5
s_add_u32 s37, s4, 8
K4_T4:
s_lshr_b32 s41, s36, 1
s_and_b32 s42, s36, 1
s_waitcnt lgkmcnt(0)
s_add_u32 s20, s12, 73400320
s_addc_u32 s21, s13, 0
s_mov_b32 s22, 2883584
s_mov_b32 s23, 0x00020000
s_add_u32 s16, s12, 52428800
s_addc_u32 s17, s13, 0
s_mov_b32 s18, 2097152
s_mov_b32 s19, 0x00020000
s_add_u32 s24, s12, 56623104
s_addc_u32 s25, s13, 0
s_mov_b32 s26, 131072
s_mov_b32 s27, 0x00020000
s_add_u32 s28, s12, 57671680
s_addc_u32 s29, s13, 0
s_mov_b32 s30, 5767168
s_mov_b32 s31, 0x00020000
v_lshlrev_b32 v224, 4, v1
s_mul_i32 s39, s36, 49152
v_add_u32 v2, s39, v224
v_add_u32 v12, 15360, v2
v_add_u32 v13, 30720, v2
s_mul_i32 s43, s37, 196608
s_lshl_b32 s39, s36, 11
v_add_u32 v3, s39, v224
s_lshl_b32 s44, s38, 17
s_mul_i32 s46, s36, 3072
s_lshl_b32 s47, s36, 11
s_add_u32 s47, s47, 12288
s_add_u32 m0, s46, 0
s_add_u32 s48, s43, 0
buffer_load_dwordx4 v2, s[16:19], s48 offen lds
buffer_load_dwordx4 v12, s[16:19], s48 offen offset:1024 lds
buffer_load_dwordx4 v13, s[16:19], s48 offen offset:2048 lds
s_add_u32 m0, s47, 0
s_add_u32 s49, s44, 0
buffer_load_dwordx4 v3, s[20:23], s49 offen lds
buffer_load_dwordx4 v3, s[20:23], s49 offen offset:1024 lds
s_add_u32 m0, s46, 20480
s_add_u32 s48, s43, 1024
buffer_load_dwordx4 v2, s[16:19], s48 offen lds
buffer_load_dwordx4 v12, s[16:19], s48 offen offset:1024 lds
buffer_load_dwordx4 v13, s[16:19], s48 offen offset:2048 lds
s_add_u32 m0, s47, 20480
s_add_u32 s49, s44, 8192
buffer_load_dwordx4 v3, s[20:23], s49 offen lds
buffer_load_dwordx4 v3, s[20:23], s49 offen offset:1024 lds
s_add_u32 m0, s46, 40960
s_add_u32 s48, s43, 2048
buffer_load_dwordx4 v2, s[16:19], s48 offen lds
buffer_load_dwordx4 v12, s[16:19], s48 offen offset:1024 lds
buffer_load_dwordx4 v13, s[16:19], s48 offen offset:2048 lds
s_add_u32 m0, s47, 40960
s_add_u32 s49, s44, 16384
buffer_load_dwordx4 v3, s[20:23], s49 offen lds
buffer_load_dwordx4 v3, s[20:23], s49 offen offset:1024 lds
s_add_u32 m0, s46, 61440
s_add_u32 s48, s43, 3072
buffer_load_dwordx4 v2, s[16:19], s48 offen lds
buffer_load_dwordx4 v12, s[16:19], s48 offen offset:1024 lds
buffer_load_dwordx4 v13, s[16:19], s48 offen offset:2048 lds
s_add_u32 m0, s47, 61440
s_add_u32 s49, s44, 24576
buffer_load_dwordx4 v3, s[20:23], s49 offen lds
buffer_load_dwordx4 v3, s[20:23], s49 offen offset:1024 lds
s_add_u32 m0, s46, 81920
s_add_u32 s48, s43, 4096
buffer_load_dwordx4 v2, s[16:19], s48 offen lds
buffer_load_dwordx4 v12, s[16:19], s48 offen offset:1024 lds
buffer_load_dwordx4 v13, s[16:19], s48 offen offset:2048 lds
s_add_u32 m0, s47, 81920
s_add_u32 s49, s44, 32768
buffer_load_dwordx4 v3, s[20:23], s49 offen lds
buffer_load_dwordx4 v3, s[20:23], s49 offen offset:1024 lds
s_add_u32 m0, s46, 102400
s_add_u32 s48, s43, 5120
buffer_load_dwordx4 v2, s[16:19], s48 offen lds
buffer_load_dwordx4 v12, s[16:19], s48 offen offset:1024 lds
buffer_load_dwordx4 v13, s[16:19], s48 offen offset:2048 lds
s_add_u32 m0, s47, 102400
s_add_u32 s49, s44, 40960
buffer_load_dwordx4 v3, s[20:23], s49 offen lds
buffer_load_dwordx4 v3, s[20:23], s49 offen offset:1024 lds
v_and_b32 v225, 15, v1
v_lshrrev_b32 v226, 4, v1
v_lshlrev_b32 v227, 6, v225
v_lshl_add_u32 v227, v226, 4, v227
s_mul_i32 s39, s37, 12288
s_mul_i32 s40, s41, 6144
s_add_u32 s50, s39, s40
s_add_u32 s51, s50, 0
buffer_load_dwordx4 v[232:235], v227, s[24:27], s51 offen
s_add_u32 s51, s50, 1024
buffer_load_dwordx4 v[236:239], v227, s[24:27], s51 offen
s_add_u32 s51, s50, 2048
buffer_load_dwordx4 v[240:243], v227, s[24:27], s51 offen
s_add_u32 s51, s50, 3072
buffer_load_dwordx4 v[244:247], v227, s[24:27], s51 offen
s_add_u32 s51, s50, 4096
buffer_load_dwordx4 v[248:251], v227, s[24:27], s51 offen
s_add_u32 s51, s50, 5120
buffer_load_dwordx4 v[252:255], v227, s[24:27], s51 offen
s_mul_i32 s39, s41, 6144
v_add_u32 v10, s39, v224
v_add_u32 v11, 61440, v10
s_lshl_b32 s39, s42, 11
s_add_u32 s39, s39, 12288
v_add_u32 v6, s39, v224
v_add_u32 v7, 61440, v6
v_mov_b32 v230, 0x3f803f80
v_mov_b32 v208, v230
v_mov_b32 v209, v230
v_mov_b32 v210, v230
v_mov_b32 v211, v230
v_add_u32 v14, 122880, v10
v_add_u32 v15, 122880, v6
s_waitcnt vmcnt(26)
s_barrier
ds_read_b128 v[176:179], v6 offset:0
ds_read_b128 v[180:183], v6 offset:1024
ds_read_b128 v[184:187], v6 offset:4096
ds_read_b128 v[188:191], v6 offset:5120
ds_read_b128 v[128:131], v10 offset:0
ds_read_b128 v[132:135], v10 offset:1024
ds_read_b128 v[136:139], v10 offset:2048
ds_read_b128 v[140:143], v10 offset:3072
ds_read_b128 v[144:147], v10 offset:4096
ds_read_b128 v[148:151], v10 offset:5120
s_waitcnt lgkmcnt(0)
v_mfma_f32_16x16x32_bf16 v[112:115], v[176:179], v[208:211], 0
ds_read_b128 v[192:195], v6 offset:20480
ds_read_b128 v[196:199], v6 offset:21504
v_mfma_f32_16x16x32_bf16 v[16:19], v[176:179], v[128:131], 0
ds_read_b128 v[200:203], v6 offset:24576
ds_read_b128 v[204:207], v6 offset:25600
v_mfma_f32_16x16x32_bf16 v[20:23], v[176:179], v[132:135], 0
ds_read_b128 v[152:155], v10 offset:20480
ds_read_b128 v[156:159], v10 offset:21504
v_mfma_f32_16x16x32_bf16 v[24:27], v[176:179], v[136:139], 0
ds_read_b128 v[160:163], v10 offset:22528
ds_read_b128 v[164:167], v10 offset:23552
v_mfma_f32_16x16x32_bf16 v[28:31], v[176:179], v[140:143], 0
ds_read_b128 v[168:171], v10 offset:24576
ds_read_b128 v[172:175], v10 offset:25600
v_mfma_f32_16x16x32_bf16 v[32:35], v[176:179], v[144:147], 0
v_mfma_f32_16x16x32_bf16 v[36:39], v[176:179], v[148:151], 0
s_waitcnt vmcnt(21)
v_mfma_f32_16x16x32_bf16 v[116:119], v[180:183], v[208:211], 0
v_mfma_f32_16x16x32_bf16 v[40:43], v[180:183], v[128:131], 0
s_barrier
v_mfma_f32_16x16x32_bf16 v[44:47], v[180:183], v[132:135], 0
s_add_u32 m0, s46, 122880
s_add_u32 s48, s43, 6144
v_mfma_f32_16x16x32_bf16 v[48:51], v[180:183], v[136:139], 0
buffer_load_dwordx4 v2, s[16:19], s48 offen lds
v_mfma_f32_16x16x32_bf16 v[52:55], v[180:183], v[140:143], 0
buffer_load_dwordx4 v12, s[16:19], s48 offen offset:1024 lds
v_mfma_f32_16x16x32_bf16 v[56:59], v[180:183], v[144:147], 0
buffer_load_dwordx4 v13, s[16:19], s48 offen offset:2048 lds
v_mfma_f32_16x16x32_bf16 v[60:63], v[180:183], v[148:151], 0
s_add_u32 m0, s47, 122880
s_add_u32 s49, s44, 49152
v_mfma_f32_16x16x32_bf16 v[120:123], v[184:187], v[208:211], 0
buffer_load_dwordx4 v3, s[20:23], s49 offen lds
v_mfma_f32_16x16x32_bf16 v[64:67], v[184:187], v[128:131], 0
buffer_load_dwordx4 v3, s[20:23], s49 offen offset:1024 lds
v_mfma_f32_16x16x32_bf16 v[68:71], v[184:187], v[132:135], 0
v_mfma_f32_16x16x32_bf16 v[72:75], v[184:187], v[136:139], 0
v_mfma_f32_16x16x32_bf16 v[76:79], v[184:187], v[140:143], 0
v_mfma_f32_16x16x32_bf16 v[80:83], v[184:187], v[144:147], 0
v_mfma_f32_16x16x32_bf16 v[84:87], v[184:187], v[148:151], 0
v_mfma_f32_16x16x32_bf16 v[124:127], v[188:191], v[208:211], 0
v_mfma_f32_16x16x32_bf16 v[88:91], v[188:191], v[128:131], 0
v_mfma_f32_16x16x32_bf16 v[92:95], v[188:191], v[132:135], 0
v_mfma_f32_16x16x32_bf16 v[96:99], v[188:191], v[136:139], 0
v_mfma_f32_16x16x32_bf16 v[100:103], v[188:191], v[140:143], 0
v_mfma_f32_16x16x32_bf16 v[104:107], v[188:191], v[144:147], 0
v_mfma_f32_16x16x32_bf16 v[108:111], v[188:191], v[148:151], 0
s_waitcnt lgkmcnt(0)
v_mfma_f32_16x16x32_bf16 v[112:115], v[192:195], v[208:211], v[112:115]
ds_read_b128 v[176:179], v6 offset:40960
ds_read_b128 v[180:183], v6 offset:41984
v_mfma_f32_16x16x32_bf16 v[16:19], v[192:195], v[152:155], v[16:19]
ds_read_b128 v[184:187], v6 offset:45056
ds_read_b128 v[188:191], v6 offset:46080
v_mfma_f32_16x16x32_bf16 v[20:23], v[192:195], v[156:159], v[20:23]
ds_read_b128 v[128:131], v10 offset:40960
ds_read_b128 v[132:135], v10 offset:41984
v_mfma_f32_16x16x32_bf16 v[24:27], v[192:195], v[160:163], v[24:27]
ds_read_b128 v[136:139], v10 offset:43008
ds_read_b128 v[140:143], v10 offset:44032
v_mfma_f32_16x16x32_bf16 v[28:31], v[192:195], v[164:167], v[28:31]
ds_read_b128 v[144:147], v10 offset:45056
ds_read_b128 v[148:151], v10 offset:46080
v_mfma_f32_16x16x32_bf16 v[32:35], v[192:195], v[168:171], v[32:35]
v_mfma_f32_16x16x32_bf16 v[36:39], v[192:195], v[172:175], v[36:39]
s_waitcnt vmcnt(21)
v_mfma_f32_16x16x32_bf16 v[116:119], v[196:199], v[208:211], v[116:119]
v_mfma_f32_16x16x32_bf16 v[40:43], v[196:199], v[152:155], v[40:43]
s_barrier
v_mfma_f32_16x16x32_bf16 v[44:47], v[196:199], v[156:159], v[44:47]
s_add_u32 m0, s46, 0
s_add_u32 s48, s43, 7168
v_mfma_f32_16x16x32_bf16 v[48:51], v[196:199], v[160:163], v[48:51]
buffer_load_dwordx4 v2, s[16:19], s48 offen lds
v_mfma_f32_16x16x32_bf16 v[52:55], v[196:199], v[164:167], v[52:55]
buffer_load_dwordx4 v12, s[16:19], s48 offen offset:1024 lds
v_mfma_f32_16x16x32_bf16 v[56:59], v[196:199], v[168:171], v[56:59]
buffer_load_dwordx4 v13, s[16:19], s48 offen offset:2048 lds
v_mfma_f32_16x16x32_bf16 v[60:63], v[196:199], v[172:175], v[60:63]
s_add_u32 m0, s47, 0
s_add_u32 s49, s44, 57344
v_mfma_f32_16x16x32_bf16 v[120:123], v[200:203], v[208:211], v[120:123]
buffer_load_dwordx4 v3, s[20:23], s49 offen lds
v_mfma_f32_16x16x32_bf16 v[64:67], v[200:203], v[152:155], v[64:67]
buffer_load_dwordx4 v3, s[20:23], s49 offen offset:1024 lds
v_mfma_f32_16x16x32_bf16 v[68:71], v[200:203], v[156:159], v[68:71]
v_mfma_f32_16x16x32_bf16 v[72:75], v[200:203], v[160:163], v[72:75]
v_mfma_f32_16x16x32_bf16 v[76:79], v[200:203], v[164:167], v[76:79]
v_mfma_f32_16x16x32_bf16 v[80:83], v[200:203], v[168:171], v[80:83]
v_mfma_f32_16x16x32_bf16 v[84:87], v[200:203], v[172:175], v[84:87]
v_mfma_f32_16x16x32_bf16 v[124:127], v[204:207], v[208:211], v[124:127]
v_mfma_f32_16x16x32_bf16 v[88:91], v[204:207], v[152:155], v[88:91]
v_mfma_f32_16x16x32_bf16 v[92:95], v[204:207], v[156:159], v[92:95]
v_mfma_f32_16x16x32_bf16 v[96:99], v[204:207], v[160:163], v[96:99]
v_mfma_f32_16x16x32_bf16 v[100:103], v[204:207], v[164:167], v[100:103]
v_mfma_f32_16x16x32_bf16 v[104:107], v[204:207], v[168:171], v[104:107]
v_mfma_f32_16x16x32_bf16 v[108:111], v[204:207], v[172:175], v[108:111]
s_waitcnt lgkmcnt(0)
v_mfma_f32_16x16x32_bf16 v[112:115], v[176:179], v[208:211], v[112:115]
ds_read_b128 v[192:195], v7 offset:0
ds_read_b128 v[196:199], v7 offset:1024
v_mfma_f32_16x16x32_bf16 v[16:19], v[176:179], v[128:131], v[16:19]
ds_read_b128 v[200:203], v7 offset:4096
ds_read_b128 v[204:207], v7 offset:5120
v_mfma_f32_16x16x32_bf16 v[20:23], v[176:179], v[132:135], v[20:23]
ds_read_b128 v[152:155], v11 offset:0
ds_read_b128 v[156:159], v11 offset:1024
v_mfma_f32_16x16x32_bf16 v[24:27], v[176:179], v[136:139], v[24:27]
ds_read_b128 v[160:163], v11 offset:2048
ds_read_b128 v[164:167], v11 offset:3072
v_mfma_f32_16x16x32_bf16 v[28:31], v[176:179], v[140:143], v[28:31]
ds_read_b128 v[168:171], v11 offset:4096
ds_read_b128 v[172:175], v11 offset:5120
v_mfma_f32_16x16x32_bf16 v[32:35], v[176:179], v[144:147], v[32:35]
v_mfma_f32_16x16x32_bf16 v[36:39], v[176:179], v[148:151], v[36:39]
s_waitcnt vmcnt(21)
v_mfma_f32_16x16x32_bf16 v[116:119], v[180:183], v[208:211], v[116:119]
v_mfma_f32_16x16x32_bf16 v[40:43], v[180:183], v[128:131], v[40:43]
s_barrier
v_mfma_f32_16x16x32_bf16 v[44:47], v[180:183], v[132:135], v[44:47]
s_add_u32 m0, s46, 20480
s_add_u32 s48, s43, 8192
v_mfma_f32_16x16x32_bf16 v[48:51], v[180:183], v[136:139], v[48:51]
buffer_load_dwordx4 v2, s[16:19], s48 offen lds
v_mfma_f32_16x16x32_bf16 v[52:55], v[180:183], v[140:143], v[52:55]
buffer_load_dwordx4 v12, s[16:19], s48 offen offset:1024 lds
v_mfma_f32_16x16x32_bf16 v[56:59], v[180:183], v[144:147], v[56:59]
buffer_load_dwordx4 v13, s[16:19], s48 offen offset:2048 lds
v_mfma_f32_16x16x32_bf16 v[60:63], v[180:183], v[148:151], v[60:63]
s_add_u32 m0, s47, 20480
s_add_u32 s49, s44, 65536
v_mfma_f32_16x16x32_bf16 v[120:123], v[184:187], v[208:211], v[120:123]
buffer_load_dwordx4 v3, s[20:23], s49 offen lds
v_mfma_f32_16x16x32_bf16 v[64:67], v[184:187], v[128:131], v[64:67]
buffer_load_dwordx4 v3, s[20:23], s49 offen offset:1024 lds
v_mfma_f32_16x16x32_bf16 v[68:71], v[184:187], v[132:135], v[68:71]
v_mfma_f32_16x16x32_bf16 v[72:75], v[184:187], v[136:139], v[72:75]
v_mfma_f32_16x16x32_bf16 v[76:79], v[184:187], v[140:143], v[76:79]
v_mfma_f32_16x16x32_bf16 v[80:83], v[184:187], v[144:147], v[80:83]
v_mfma_f32_16x16x32_bf16 v[84:87], v[184:187], v[148:151], v[84:87]
v_mfma_f32_16x16x32_bf16 v[124:127], v[188:191], v[208:211], v[124:127]
v_mfma_f32_16x16x32_bf16 v[88:91], v[188:191], v[128:131], v[88:91]
v_mfma_f32_16x16x32_bf16 v[92:95], v[188:191], v[132:135], v[92:95]
v_mfma_f32_16x16x32_bf16 v[96:99], v[188:191], v[136:139], v[96:99]
v_mfma_f32_16x16x32_bf16 v[100:103], v[188:191], v[140:143], v[100:103]
v_mfma_f32_16x16x32_bf16 v[104:107], v[188:191], v[144:147], v[104:107]
v_mfma_f32_16x16x32_bf16 v[108:111], v[188:191], v[148:151], v[108:111]
s_waitcnt lgkmcnt(0)
v_mfma_f32_16x16x32_bf16 v[112:115], v[192:195], v[208:211], v[112:115]
ds_read_b128 v[176:179], v7 offset:20480
ds_read_b128 v[180:183], v7 offset:21504
v_mfma_f32_16x16x32_bf16 v[16:19], v[192:195], v[152:155], v[16:19]
ds_read_b128 v[184:187], v7 offset:24576
ds_read_b128 v[188:191], v7 offset:25600
v_mfma_f32_16x16x32_bf16 v[20:23], v[192:195], v[156:159], v[20:23]
ds_read_b128 v[128:131], v11 offset:20480
ds_read_b128 v[132:135], v11 offset:21504
v_mfma_f32_16x16x32_bf16 v[24:27], v[192:195], v[160:163], v[24:27]
ds_read_b128 v[136:139], v11 offset:22528
ds_read_b128 v[140:143], v11 offset:23552
v_mfma_f32_16x16x32_bf16 v[28:31], v[192:195], v[164:167], v[28:31]
ds_read_b128 v[144:147], v11 offset:24576
ds_read_b128 v[148:151], v11 offset:25600
v_mfma_f32_16x16x32_bf16 v[32:35], v[192:195], v[168:171], v[32:35]
v_mfma_f32_16x16x32_bf16 v[36:39], v[192:195], v[172:175], v[36:39]
s_waitcnt vmcnt(21)
v_mfma_f32_16x16x32_bf16 v[116:119], v[196:199], v[208:211], v[116:119]
v_mfma_f32_16x16x32_bf16 v[40:43], v[196:199], v[152:155], v[40:43]
s_barrier
v_mfma_f32_16x16x32_bf16 v[44:47], v[196:199], v[156:159], v[44:47]
s_add_u32 m0, s46, 40960
s_add_u32 s48, s43, 9216
v_mfma_f32_16x16x32_bf16 v[48:51], v[196:199], v[160:163], v[48:51]
buffer_load_dwordx4 v2, s[16:19], s48 offen lds
v_mfma_f32_16x16x32_bf16 v[52:55], v[196:199], v[164:167], v[52:55]
buffer_load_dwordx4 v12, s[16:19], s48 offen offset:1024 lds
v_mfma_f32_16x16x32_bf16 v[56:59], v[196:199], v[168:171], v[56:59]
buffer_load_dwordx4 v13, s[16:19], s48 offen offset:2048 lds
v_mfma_f32_16x16x32_bf16 v[60:63], v[196:199], v[172:175], v[60:63]
s_add_u32 m0, s47, 40960
s_add_u32 s49, s44, 73728
v_mfma_f32_16x16x32_bf16 v[120:123], v[200:203], v[208:211], v[120:123]
buffer_load_dwordx4 v3, s[20:23], s49 offen lds
v_mfma_f32_16x16x32_bf16 v[64:67], v[200:203], v[152:155], v[64:67]
buffer_load_dwordx4 v3, s[20:23], s49 offen offset:1024 lds
v_mfma_f32_16x16x32_bf16 v[68:71], v[200:203], v[156:159], v[68:71]
v_mfma_f32_16x16x32_bf16 v[72:75], v[200:203], v[160:163], v[72:75]
v_mfma_f32_16x16x32_bf16 v[76:79], v[200:203], v[164:167], v[76:79]
v_mfma_f32_16x16x32_bf16 v[80:83], v[200:203], v[168:171], v[80:83]
v_mfma_f32_16x16x32_bf16 v[84:87], v[200:203], v[172:175], v[84:87]
v_mfma_f32_16x16x32_bf16 v[124:127], v[204:207], v[208:211], v[124:127]
v_mfma_f32_16x16x32_bf16 v[88:91], v[204:207], v[152:155], v[88:91]
v_mfma_f32_16x16x32_bf16 v[92:95], v[204:207], v[156:159], v[92:95]
v_mfma_f32_16x16x32_bf16 v[96:99], v[204:207], v[160:163], v[96:99]
v_mfma_f32_16x16x32_bf16 v[100:103], v[204:207], v[164:167], v[100:103]
v_mfma_f32_16x16x32_bf16 v[104:107], v[204:207], v[168:171], v[104:107]
v_mfma_f32_16x16x32_bf16 v[108:111], v[204:207], v[172:175], v[108:111]
s_waitcnt lgkmcnt(0)
v_mfma_f32_16x16x32_bf16 v[112:115], v[176:179], v[208:211], v[112:115]
ds_read_b128 v[192:195], v7 offset:40960
ds_read_b128 v[196:199], v7 offset:41984
v_mfma_f32_16x16x32_bf16 v[16:19], v[176:179], v[128:131], v[16:19]
ds_read_b128 v[200:203], v7 offset:45056
ds_read_b128 v[204:207], v7 offset:46080
v_mfma_f32_16x16x32_bf16 v[20:23], v[176:179], v[132:135], v[20:23]
ds_read_b128 v[152:155], v11 offset:40960
ds_read_b128 v[156:159], v11 offset:41984
v_mfma_f32_16x16x32_bf16 v[24:27], v[176:179], v[136:139], v[24:27]
ds_read_b128 v[160:163], v11 offset:43008
ds_read_b128 v[164:167], v11 offset:44032
v_mfma_f32_16x16x32_bf16 v[28:31], v[176:179], v[140:143], v[28:31]
ds_read_b128 v[168:171], v11 offset:45056
ds_read_b128 v[172:175], v11 offset:46080
v_mfma_f32_16x16x32_bf16 v[32:35], v[176:179], v[144:147], v[32:35]
v_mfma_f32_16x16x32_bf16 v[36:39], v[176:179], v[148:151], v[36:39]
s_waitcnt vmcnt(15)
v_mfma_f32_16x16x32_bf16 v[116:119], v[180:183], v[208:211], v[116:119]
v_mfma_f32_16x16x32_bf16 v[40:43], v[180:183], v[128:131], v[40:43]
s_barrier
v_mfma_f32_16x16x32_bf16 v[44:47], v[180:183], v[132:135], v[44:47]
s_add_u32 m0, s46, 61440
s_add_u32 s48, s43, 10240
v_mfma_f32_16x16x32_bf16 v[48:51], v[180:183], v[136:139], v[48:51]
buffer_load_dwordx4 v2, s[16:19], s48 offen lds
v_mfma_f32_16x16x32_bf16 v[52:55], v[180:183], v[140:143], v[52:55]
buffer_load_dwordx4 v12, s[16:19], s48 offen offset:1024 lds
v_mfma_f32_16x16x32_bf16 v[56:59], v[180:183], v[144:147], v[56:59]
buffer_load_dwordx4 v13, s[16:19], s48 offen offset:2048 lds
v_mfma_f32_16x16x32_bf16 v[60:63], v[180:183], v[148:151], v[60:63]
s_add_u32 m0, s47, 61440
s_add_u32 s49, s44, 81920
v_mfma_f32_16x16x32_bf16 v[120:123], v[184:187], v[208:211], v[120:123]
buffer_load_dwordx4 v3, s[20:23], s49 offen lds
v_mfma_f32_16x16x32_bf16 v[64:67], v[184:187], v[128:131], v[64:67]
buffer_load_dwordx4 v3, s[20:23], s49 offen offset:1024 lds
v_mfma_f32_16x16x32_bf16 v[68:71], v[184:187], v[132:135], v[68:71]
v_mfma_f32_16x16x32_bf16 v[72:75], v[184:187], v[136:139], v[72:75]
v_mfma_f32_16x16x32_bf16 v[76:79], v[184:187], v[140:143], v[76:79]
v_mfma_f32_16x16x32_bf16 v[80:83], v[184:187], v[144:147], v[80:83]
v_mfma_f32_16x16x32_bf16 v[84:87], v[184:187], v[148:151], v[84:87]
v_mfma_f32_16x16x32_bf16 v[124:127], v[188:191], v[208:211], v[124:127]
v_mfma_f32_16x16x32_bf16 v[88:91], v[188:191], v[128:131], v[88:91]
v_mfma_f32_16x16x32_bf16 v[92:95], v[188:191], v[132:135], v[92:95]
v_mfma_f32_16x16x32_bf16 v[96:99], v[188:191], v[136:139], v[96:99]
v_mfma_f32_16x16x32_bf16 v[100:103], v[188:191], v[140:143], v[100:103]
v_mfma_f32_16x16x32_bf16 v[104:107], v[188:191], v[144:147], v[104:107]
v_mfma_f32_16x16x32_bf16 v[108:111], v[188:191], v[148:151], v[108:111]
s_waitcnt lgkmcnt(0)
v_mfma_f32_16x16x32_bf16 v[112:115], v[192:195], v[208:211], v[112:115]
ds_read_b128 v[176:179], v15 offset:0
ds_read_b128 v[180:183], v15 offset:1024
v_mfma_f32_16x16x32_bf16 v[16:19], v[192:195], v[152:155], v[16:19]
ds_read_b128 v[184:187], v15 offset:4096
ds_read_b128 v[188:191], v15 offset:5120
v_mfma_f32_16x16x32_bf16 v[20:23], v[192:195], v[156:159], v[20:23]
ds_read_b128 v[128:131], v14 offset:0
ds_read_b128 v[132:135], v14 offset:1024
v_mfma_f32_16x16x32_bf16 v[24:27], v[192:195], v[160:163], v[24:27]
ds_read_b128 v[136:139], v14 offset:2048
ds_read_b128 v[140:143], v14 offset:3072
v_mfma_f32_16x16x32_bf16 v[28:31], v[192:195], v[164:167], v[28:31]
ds_read_b128 v[144:147], v14 offset:4096
ds_read_b128 v[148:151], v14 offset:5120
v_mfma_f32_16x16x32_bf16 v[32:35], v[192:195], v[168:171], v[32:35]
v_mfma_f32_16x16x32_bf16 v[36:39], v[192:195], v[172:175], v[36:39]
s_waitcnt vmcnt(15)
v_mfma_f32_16x16x32_bf16 v[116:119], v[196:199], v[208:211], v[116:119]
v_mfma_f32_16x16x32_bf16 v[40:43], v[196:199], v[152:155], v[40:43]
s_barrier
v_mfma_f32_16x16x32_bf16 v[44:47], v[196:199], v[156:159], v[44:47]
s_add_u32 m0, s46, 81920
s_add_u32 s48, s43, 11264
v_mfma_f32_16x16x32_bf16 v[48:51], v[196:199], v[160:163], v[48:51]
buffer_load_dwordx4 v2, s[16:19], s48 offen lds
v_mfma_f32_16x16x32_bf16 v[52:55], v[196:199], v[164:167], v[52:55]
buffer_load_dwordx4 v12, s[16:19], s48 offen offset:1024 lds
v_mfma_f32_16x16x32_bf16 v[56:59], v[196:199], v[168:171], v[56:59]
buffer_load_dwordx4 v13, s[16:19], s48 offen offset:2048 lds
v_mfma_f32_16x16x32_bf16 v[60:63], v[196:199], v[172:175], v[60:63]
s_add_u32 m0, s47, 81920
s_add_u32 s49, s44, 90112
v_mfma_f32_16x16x32_bf16 v[120:123], v[200:203], v[208:211], v[120:123]
buffer_load_dwordx4 v3, s[20:23], s49 offen lds
v_mfma_f32_16x16x32_bf16 v[64:67], v[200:203], v[152:155], v[64:67]
buffer_load_dwordx4 v3, s[20:23], s49 offen offset:1024 lds
v_mfma_f32_16x16x32_bf16 v[68:71], v[200:203], v[156:159], v[68:71]
v_mfma_f32_16x16x32_bf16 v[72:75], v[200:203], v[160:163], v[72:75]
v_mfma_f32_16x16x32_bf16 v[76:79], v[200:203], v[164:167], v[76:79]
v_mfma_f32_16x16x32_bf16 v[80:83], v[200:203], v[168:171], v[80:83]
v_mfma_f32_16x16x32_bf16 v[84:87], v[200:203], v[172:175], v[84:87]
v_mfma_f32_16x16x32_bf16 v[124:127], v[204:207], v[208:211], v[124:127]
v_mfma_f32_16x16x32_bf16 v[88:91], v[204:207], v[152:155], v[88:91]
v_mfma_f32_16x16x32_bf16 v[92:95], v[204:207], v[156:159], v[92:95]
v_mfma_f32_16x16x32_bf16 v[96:99], v[204:207], v[160:163], v[96:99]
v_mfma_f32_16x16x32_bf16 v[100:103], v[204:207], v[164:167], v[100:103]
v_mfma_f32_16x16x32_bf16 v[104:107], v[204:207], v[168:171], v[104:107]
v_mfma_f32_16x16x32_bf16 v[108:111], v[204:207], v[172:175], v[108:111]
s_waitcnt lgkmcnt(0)
v_mfma_f32_16x16x32_bf16 v[112:115], v[176:179], v[208:211], v[112:115]
ds_read_b128 v[192:195], v6 offset:0
ds_read_b128 v[196:199], v6 offset:1024
v_mfma_f32_16x16x32_bf16 v[16:19], v[176:179], v[128:131], v[16:19]
ds_read_b128 v[200:203], v6 offset:4096
ds_read_b128 v[204:207], v6 offset:5120
v_mfma_f32_16x16x32_bf16 v[20:23], v[176:179], v[132:135], v[20:23]
ds_read_b128 v[152:155], v10 offset:0
ds_read_b128 v[156:159], v10 offset:1024
v_mfma_f32_16x16x32_bf16 v[24:27], v[176:179], v[136:139], v[24:27]
ds_read_b128 v[160:163], v10 offset:2048
ds_read_b128 v[164:167], v10 offset:3072
v_mfma_f32_16x16x32_bf16 v[28:31], v[176:179], v[140:143], v[28:31]
ds_read_b128 v[168:171], v10 offset:4096
ds_read_b128 v[172:175], v10 offset:5120
v_mfma_f32_16x16x32_bf16 v[32:35], v[176:179], v[144:147], v[32:35]
v_mfma_f32_16x16x32_bf16 v[36:39], v[176:179], v[148:151], v[36:39]
s_waitcnt vmcnt(15)
v_mfma_f32_16x16x32_bf16 v[116:119], v[180:183], v[208:211], v[116:119]
v_mfma_f32_16x16x32_bf16 v[40:43], v[180:183], v[128:131], v[40:43]
s_barrier
v_mfma_f32_16x16x32_bf16 v[44:47], v[180:183], v[132:135], v[44:47]
s_add_u32 m0, s46, 102400
s_add_u32 s48, s43, 12288
v_mfma_f32_16x16x32_bf16 v[48:51], v[180:183], v[136:139], v[48:51]
buffer_load_dwordx4 v2, s[16:19], s48 offen lds
v_mfma_f32_16x16x32_bf16 v[52:55], v[180:183], v[140:143], v[52:55]
buffer_load_dwordx4 v12, s[16:19], s48 offen offset:1024 lds
v_mfma_f32_16x16x32_bf16 v[56:59], v[180:183], v[144:147], v[56:59]
buffer_load_dwordx4 v13, s[16:19], s48 offen offset:2048 lds
v_mfma_f32_16x16x32_bf16 v[60:63], v[180:183], v[148:151], v[60:63]
s_add_u32 m0, s47, 102400
s_add_u32 s49, s44, 98304
v_mfma_f32_16x16x32_bf16 v[120:123], v[184:187], v[208:211], v[120:123]
buffer_load_dwordx4 v3, s[20:23], s49 offen lds
v_mfma_f32_16x16x32_bf16 v[64:67], v[184:187], v[128:131], v[64:67]
buffer_load_dwordx4 v3, s[20:23], s49 offen offset:1024 lds
v_mfma_f32_16x16x32_bf16 v[68:71], v[184:187], v[132:135], v[68:71]
v_mfma_f32_16x16x32_bf16 v[72:75], v[184:187], v[136:139], v[72:75]
v_mfma_f32_16x16x32_bf16 v[76:79], v[184:187], v[140:143], v[76:79]
v_mfma_f32_16x16x32_bf16 v[80:83], v[184:187], v[144:147], v[80:83]
v_mfma_f32_16x16x32_bf16 v[84:87], v[184:187], v[148:151], v[84:87]
v_mfma_f32_16x16x32_bf16 v[124:127], v[188:191], v[208:211], v[124:127]
v_mfma_f32_16x16x32_bf16 v[88:91], v[188:191], v[128:131], v[88:91]
v_mfma_f32_16x16x32_bf16 v[92:95], v[188:191], v[132:135], v[92:95]
v_mfma_f32_16x16x32_bf16 v[96:99], v[188:191], v[136:139], v[96:99]
v_mfma_f32_16x16x32_bf16 v[100:103], v[188:191], v[140:143], v[100:103]
v_mfma_f32_16x16x32_bf16 v[104:107], v[188:191], v[144:147], v[104:107]
v_mfma_f32_16x16x32_bf16 v[108:111], v[188:191], v[148:151], v[108:111]
s_waitcnt lgkmcnt(0)
v_mfma_f32_16x16x32_bf16 v[112:115], v[192:195], v[208:211], v[112:115]
ds_read_b128 v[176:179], v6 offset:20480
ds_read_b128 v[180:183], v6 offset:21504
v_mfma_f32_16x16x32_bf16 v[16:19], v[192:195], v[152:155], v[16:19]
ds_read_b128 v[184:187], v6 offset:24576
ds_read_b128 v[188:191], v6 offset:25600
v_mfma_f32_16x16x32_bf16 v[20:23], v[192:195], v[156:159], v[20:23]
ds_read_b128 v[128:131], v10 offset:20480
ds_read_b128 v[132:135], v10 offset:21504
v_mfma_f32_16x16x32_bf16 v[24:27], v[192:195], v[160:163], v[24:27]
ds_read_b128 v[136:139], v10 offset:22528
ds_read_b128 v[140:143], v10 offset:23552
v_mfma_f32_16x16x32_bf16 v[28:31], v[192:195], v[164:167], v[28:31]
ds_read_b128 v[144:147], v10 offset:24576
ds_read_b128 v[148:151], v10 offset:25600
v_mfma_f32_16x16x32_bf16 v[32:35], v[192:195], v[168:171], v[32:35]
v_mfma_f32_16x16x32_bf16 v[36:39], v[192:195], v[172:175], v[36:39]
s_waitcnt vmcnt(15)
v_mfma_f32_16x16x32_bf16 v[116:119], v[196:199], v[208:211], v[116:119]
v_mfma_f32_16x16x32_bf16 v[40:43], v[196:199], v[152:155], v[40:43]
s_barrier
v_mfma_f32_16x16x32_bf16 v[44:47], v[196:199], v[156:159], v[44:47]
s_add_u32 m0, s46, 122880
s_add_u32 s48, s43, 13312
v_mfma_f32_16x16x32_bf16 v[48:51], v[196:199], v[160:163], v[48:51]
buffer_load_dwordx4 v2, s[16:19], s48 offen lds
v_mfma_f32_16x16x32_bf16 v[52:55], v[196:199], v[164:167], v[52:55]
buffer_load_dwordx4 v12, s[16:19], s48 offen offset:1024 lds
v_mfma_f32_16x16x32_bf16 v[56:59], v[196:199], v[168:171], v[56:59]
buffer_load_dwordx4 v13, s[16:19], s48 offen offset:2048 lds
v_mfma_f32_16x16x32_bf16 v[60:63], v[196:199], v[172:175], v[60:63]
s_add_u32 m0, s47, 122880
s_add_u32 s49, s44, 106496
v_mfma_f32_16x16x32_bf16 v[120:123], v[200:203], v[208:211], v[120:123]
buffer_load_dwordx4 v3, s[20:23], s49 offen lds
v_mfma_f32_16x16x32_bf16 v[64:67], v[200:203], v[152:155], v[64:67]
buffer_load_dwordx4 v3, s[20:23], s49 offen offset:1024 lds
v_mfma_f32_16x16x32_bf16 v[68:71], v[200:203], v[156:159], v[68:71]
v_mfma_f32_16x16x32_bf16 v[72:75], v[200:203], v[160:163], v[72:75]
v_mfma_f32_16x16x32_bf16 v[76:79], v[200:203], v[164:167], v[76:79]
v_mfma_f32_16x16x32_bf16 v[80:83], v[200:203], v[168:171], v[80:83]
v_mfma_f32_16x16x32_bf16 v[84:87], v[200:203], v[172:175], v[84:87]
v_mfma_f32_16x16x32_bf16 v[124:127], v[204:207], v[208:211], v[124:127]
v_mfma_f32_16x16x32_bf16 v[88:91], v[204:207], v[152:155], v[88:91]
v_mfma_f32_16x16x32_bf16 v[92:95], v[204:207], v[156:159], v[92:95]
v_mfma_f32_16x16x32_bf16 v[96:99], v[204:207], v[160:163], v[96:99]
v_mfma_f32_16x16x32_bf16 v[100:103], v[204:207], v[164:167], v[100:103]
v_mfma_f32_16x16x32_bf16 v[104:107], v[204:207], v[168:171], v[104:107]
v_mfma_f32_16x16x32_bf16 v[108:111], v[204:207], v[172:175], v[108:111]
s_waitcnt lgkmcnt(0)
v_mfma_f32_16x16x32_bf16 v[112:115], v[176:179], v[208:211], v[112:115]
ds_read_b128 v[192:195], v6 offset:40960
ds_read_b128 v[196:199], v6 offset:41984
v_mfma_f32_16x16x32_bf16 v[16:19], v[176:179], v[128:131], v[16:19]
ds_read_b128 v[200:203], v6 offset:45056
ds_read_b128 v[204:207], v6 offset:46080
v_mfma_f32_16x16x32_bf16 v[20:23], v[176:179], v[132:135], v[20:23]
ds_read_b128 v[152:155], v10 offset:40960
ds_read_b128 v[156:159], v10 offset:41984
v_mfma_f32_16x16x32_bf16 v[24:27], v[176:179], v[136:139], v[24:27]
ds_read_b128 v[160:163], v10 offset:43008
ds_read_b128 v[164:167], v10 offset:44032
v_mfma_f32_16x16x32_bf16 v[28:31], v[176:179], v[140:143], v[28:31]
ds_read_b128 v[168:171], v10 offset:45056
ds_read_b128 v[172:175], v10 offset:46080
v_mfma_f32_16x16x32_bf16 v[32:35], v[176:179], v[144:147], v[32:35]
v_mfma_f32_16x16x32_bf16 v[36:39], v[176:179], v[148:151], v[36:39]
s_waitcnt vmcnt(15)
v_mfma_f32_16x16x32_bf16 v[116:119], v[180:183], v[208:211], v[116:119]
v_mfma_f32_16x16x32_bf16 v[40:43], v[180:183], v[128:131], v[40:43]
s_barrier
v_mfma_f32_16x16x32_bf16 v[44:47], v[180:183], v[132:135], v[44:47]
s_add_u32 m0, s46, 0
s_add_u32 s48, s43, 14336
v_mfma_f32_16x16x32_bf16 v[48:51], v[180:183], v[136:139], v[48:51]
buffer_load_dwordx4 v2, s[16:19], s48 offen lds
v_mfma_f32_16x16x32_bf16 v[52:55], v[180:183], v[140:143], v[52:55]
buffer_load_dwordx4 v12, s[16:19], s48 offen offset:1024 lds
v_mfma_f32_16x16x32_bf16 v[56:59], v[180:183], v[144:147], v[56:59]
buffer_load_dwordx4 v13, s[16:19], s48 offen offset:2048 lds
v_mfma_f32_16x16x32_bf16 v[60:63], v[180:183], v[148:151], v[60:63]
s_add_u32 m0, s47, 0
s_add_u32 s49, s44, 114688
v_mfma_f32_16x16x32_bf16 v[120:123], v[184:187], v[208:211], v[120:123]
buffer_load_dwordx4 v3, s[20:23], s49 offen lds
v_mfma_f32_16x16x32_bf16 v[64:67], v[184:187], v[128:131], v[64:67]
buffer_load_dwordx4 v3, s[20:23], s49 offen offset:1024 lds
v_mfma_f32_16x16x32_bf16 v[68:71], v[184:187], v[132:135], v[68:71]
v_mfma_f32_16x16x32_bf16 v[72:75], v[184:187], v[136:139], v[72:75]
v_mfma_f32_16x16x32_bf16 v[76:79], v[184:187], v[140:143], v[76:79]
v_mfma_f32_16x16x32_bf16 v[80:83], v[184:187], v[144:147], v[80:83]
v_mfma_f32_16x16x32_bf16 v[84:87], v[184:187], v[148:151], v[84:87]
v_mfma_f32_16x16x32_bf16 v[124:127], v[188:191], v[208:211], v[124:127]
v_mfma_f32_16x16x32_bf16 v[88:91], v[188:191], v[128:131], v[88:91]
v_mfma_f32_16x16x32_bf16 v[92:95], v[188:191], v[132:135], v[92:95]
v_mfma_f32_16x16x32_bf16 v[96:99], v[188:191], v[136:139], v[96:99]
v_mfma_f32_16x16x32_bf16 v[100:103], v[188:191], v[140:143], v[100:103]
v_mfma_f32_16x16x32_bf16 v[104:107], v[188:191], v[144:147], v[104:107]
v_mfma_f32_16x16x32_bf16 v[108:111], v[188:191], v[148:151], v[108:111]
s_waitcnt lgkmcnt(0)
v_mfma_f32_16x16x32_bf16 v[112:115], v[192:195], v[208:211], v[112:115]
ds_read_b128 v[176:179], v7 offset:0
ds_read_b128 v[180:183], v7 offset:1024
v_mfma_f32_16x16x32_bf16 v[16:19], v[192:195], v[152:155], v[16:19]
ds_read_b128 v[184:187], v7 offset:4096
ds_read_b128 v[188:191], v7 offset:5120
v_mfma_f32_16x16x32_bf16 v[20:23], v[192:195], v[156:159], v[20:23]
ds_read_b128 v[128:131], v11 offset:0
ds_read_b128 v[132:135], v11 offset:1024
v_mfma_f32_16x16x32_bf16 v[24:27], v[192:195], v[160:163], v[24:27]
ds_read_b128 v[136:139], v11 offset:2048
ds_read_b128 v[140:143], v11 offset:3072
v_mfma_f32_16x16x32_bf16 v[28:31], v[192:195], v[164:167], v[28:31]
ds_read_b128 v[144:147], v11 offset:4096
ds_read_b128 v[148:151], v11 offset:5120
v_mfma_f32_16x16x32_bf16 v[32:35], v[192:195], v[168:171], v[32:35]
v_mfma_f32_16x16x32_bf16 v[36:39], v[192:195], v[172:175], v[36:39]
s_waitcnt vmcnt(15)
v_mfma_f32_16x16x32_bf16 v[116:119], v[196:199], v[208:211], v[116:119]
v_mfma_f32_16x16x32_bf16 v[40:43], v[196:199], v[152:155], v[40:43]
s_barrier
v_mfma_f32_16x16x32_bf16 v[44:47], v[196:199], v[156:159], v[44:47]
s_add_u32 m0, s46, 20480
s_add_u32 s48, s43, 15360
v_mfma_f32_16x16x32_bf16 v[48:51], v[196:199], v[160:163], v[48:51]
buffer_load_dwordx4 v2, s[16:19], s48 offen lds
v_mfma_f32_16x16x32_bf16 v[52:55], v[196:199], v[164:167], v[52:55]
buffer_load_dwordx4 v12, s[16:19], s48 offen offset:1024 lds
v_mfma_f32_16x16x32_bf16 v[56:59], v[196:199], v[168:171], v[56:59]
buffer_load_dwordx4 v13, s[16:19], s48 offen offset:2048 lds
v_mfma_f32_16x16x32_bf16 v[60:63], v[196:199], v[172:175], v[60:63]
s_add_u32 m0, s47, 20480
s_add_u32 s49, s44, 122880
v_mfma_f32_16x16x32_bf16 v[120:123], v[200:203], v[208:211], v[120:123]
buffer_load_dwordx4 v3, s[20:23], s49 offen lds
v_mfma_f32_16x16x32_bf16 v[64:67], v[200:203], v[152:155], v[64:67]
buffer_load_dwordx4 v3, s[20:23], s49 offen offset:1024 lds
v_mfma_f32_16x16x32_bf16 v[68:71], v[200:203], v[156:159], v[68:71]
v_mfma_f32_16x16x32_bf16 v[72:75], v[200:203], v[160:163], v[72:75]
v_mfma_f32_16x16x32_bf16 v[76:79], v[200:203], v[164:167], v[76:79]
v_mfma_f32_16x16x32_bf16 v[80:83], v[200:203], v[168:171], v[80:83]
v_mfma_f32_16x16x32_bf16 v[84:87], v[200:203], v[172:175], v[84:87]
v_mfma_f32_16x16x32_bf16 v[124:127], v[204:207], v[208:211], v[124:127]
v_mfma_f32_16x16x32_bf16 v[88:91], v[204:207], v[152:155], v[88:91]
v_mfma_f32_16x16x32_bf16 v[92:95], v[204:207], v[156:159], v[92:95]
v_mfma_f32_16x16x32_bf16 v[96:99], v[204:207], v[160:163], v[96:99]
v_mfma_f32_16x16x32_bf16 v[100:103], v[204:207], v[164:167], v[100:103]
v_mfma_f32_16x16x32_bf16 v[104:107], v[204:207], v[168:171], v[104:107]
v_mfma_f32_16x16x32_bf16 v[108:111], v[204:207], v[172:175], v[108:111]
s_waitcnt lgkmcnt(0)
v_mfma_f32_16x16x32_bf16 v[112:115], v[176:179], v[208:211], v[112:115]
ds_read_b128 v[192:195], v7 offset:20480
ds_read_b128 v[196:199], v7 offset:21504
v_mfma_f32_16x16x32_bf16 v[16:19], v[176:179], v[128:131], v[16:19]
ds_read_b128 v[200:203], v7 offset:24576
ds_read_b128 v[204:207], v7 offset:25600
v_mfma_f32_16x16x32_bf16 v[20:23], v[176:179], v[132:135], v[20:23]
ds_read_b128 v[152:155], v11 offset:20480
ds_read_b128 v[156:159], v11 offset:21504
v_mfma_f32_16x16x32_bf16 v[24:27], v[176:179], v[136:139], v[24:27]
ds_read_b128 v[160:163], v11 offset:22528
ds_read_b128 v[164:167], v11 offset:23552
v_mfma_f32_16x16x32_bf16 v[28:31], v[176:179], v[140:143], v[28:31]
ds_read_b128 v[168:171], v11 offset:24576
ds_read_b128 v[172:175], v11 offset:25600
v_mfma_f32_16x16x32_bf16 v[32:35], v[176:179], v[144:147], v[32:35]
v_mfma_f32_16x16x32_bf16 v[36:39], v[176:179], v[148:151], v[36:39]
s_waitcnt vmcnt(15)
v_mfma_f32_16x16x32_bf16 v[116:119], v[180:183], v[208:211], v[116:119]
v_mfma_f32_16x16x32_bf16 v[40:43], v[180:183], v[128:131], v[40:43]
s_barrier
v_mfma_f32_16x16x32_bf16 v[44:47], v[180:183], v[132:135], v[44:47]
v_mfma_f32_16x16x32_bf16 v[48:51], v[180:183], v[136:139], v[48:51]
buffer_load_dwordx4 a[0:3], v5, s[56:59], s78 offen offset:0
v_mfma_f32_16x16x32_bf16 v[52:55], v[180:183], v[140:143], v[52:55]
buffer_load_dwordx4 a[4:7], v5, s[56:59], s78 offen offset:1024
v_mfma_f32_16x16x32_bf16 v[56:59], v[180:183], v[144:147], v[56:59]
buffer_load_dwordx4 a[8:11], v5, s[56:59], s78 offen offset:2048
v_mfma_f32_16x16x32_bf16 v[60:63], v[180:183], v[148:151], v[60:63]
buffer_load_dwordx4 a[12:15], v5, s[56:59], s78 offen offset:3072
v_mfma_f32_16x16x32_bf16 v[120:123], v[184:187], v[208:211], v[120:123]
s_add_u32 s78, s78, 4096
v_mfma_f32_16x16x32_bf16 v[64:67], v[184:187], v[128:131], v[64:67]
buffer_load_dwordx4 a[16:19], v5, s[56:59], s78 offen offset:0
v_mfma_f32_16x16x32_bf16 v[68:71], v[184:187], v[132:135], v[68:71]
buffer_load_dwordx4 a[20:23], v5, s[56:59], s78 offen offset:1024
v_mfma_f32_16x16x32_bf16 v[72:75], v[184:187], v[136:139], v[72:75]
buffer_load_dwordx4 a[24:27], v5, s[56:59], s78 offen offset:2048
v_mfma_f32_16x16x32_bf16 v[76:79], v[184:187], v[140:143], v[76:79]
buffer_load_dwordx4 a[28:31], v5, s[56:59], s78 offen offset:3072
v_mfma_f32_16x16x32_bf16 v[80:83], v[184:187], v[144:147], v[80:83]
s_add_u32 s78, s78, 4096
v_mfma_f32_16x16x32_bf16 v[84:87], v[184:187], v[148:151], v[84:87]
v_mfma_f32_16x16x32_bf16 v[124:127], v[188:191], v[208:211], v[124:127]
v_mfma_f32_16x16x32_bf16 v[88:91], v[188:191], v[128:131], v[88:91]
v_mfma_f32_16x16x32_bf16 v[92:95], v[188:191], v[132:135], v[92:95]
v_mfma_f32_16x16x32_bf16 v[96:99], v[188:191], v[136:139], v[96:99]
v_mfma_f32_16x16x32_bf16 v[100:103], v[188:191], v[140:143], v[100:103]
v_mfma_f32_16x16x32_bf16 v[104:107], v[188:191], v[144:147], v[104:107]
v_mfma_f32_16x16x32_bf16 v[108:111], v[188:191], v[148:151], v[108:111]
s_waitcnt lgkmcnt(0)
v_mfma_f32_16x16x32_bf16 v[112:115], v[192:195], v[208:211], v[112:115]
ds_read_b128 v[176:179], v7 offset:40960
ds_read_b128 v[180:183], v7 offset:41984
v_mfma_f32_16x16x32_bf16 v[16:19], v[192:195], v[152:155], v[16:19]
ds_read_b128 v[184:187], v7 offset:45056
ds_read_b128 v[188:191], v7 offset:46080
v_mfma_f32_16x16x32_bf16 v[20:23], v[192:195], v[156:159], v[20:23]
ds_read_b128 v[128:131], v11 offset:40960
ds_read_b128 v[132:135], v11 offset:41984
v_mfma_f32_16x16x32_bf16 v[24:27], v[192:195], v[160:163], v[24:27]
ds_read_b128 v[136:139], v11 offset:43008
ds_read_b128 v[140:143], v11 offset:44032
v_mfma_f32_16x16x32_bf16 v[28:31], v[192:195], v[164:167], v[28:31]
ds_read_b128 v[144:147], v11 offset:45056
ds_read_b128 v[148:151], v11 offset:46080
v_mfma_f32_16x16x32_bf16 v[32:35], v[192:195], v[168:171], v[32:35]
v_mfma_f32_16x16x32_bf16 v[36:39], v[192:195], v[172:175], v[36:39]
s_waitcnt vmcnt(18)
v_mfma_f32_16x16x32_bf16 v[116:119], v[196:199], v[208:211], v[116:119]
v_mfma_f32_16x16x32_bf16 v[40:43], v[196:199], v[152:155], v[40:43]
s_barrier
v_mfma_f32_16x16x32_bf16 v[44:47], v[196:199], v[156:159], v[44:47]
v_mfma_f32_16x16x32_bf16 v[48:51], v[196:199], v[160:163], v[48:51]
buffer_load_dwordx4 a[32:35], v5, s[56:59], s78 offen offset:0
v_mfma_f32_16x16x32_bf16 v[52:55], v[196:199], v[164:167], v[52:55]
buffer_load_dwordx4 a[36:39], v5, s[56:59], s78 offen offset:1024
v_mfma_f32_16x16x32_bf16 v[56:59], v[196:199], v[168:171], v[56:59]
buffer_load_dwordx4 a[40:43], v5, s[56:59], s78 offen offset:2048
v_mfma_f32_16x16x32_bf16 v[60:63], v[196:199], v[172:175], v[60:63]
buffer_load_dwordx4 a[44:47], v5, s[56:59], s78 offen offset:3072
v_mfma_f32_16x16x32_bf16 v[120:123], v[200:203], v[208:211], v[120:123]
s_add_u32 s78, s78, 4096
v_mfma_f32_16x16x32_bf16 v[64:67], v[200:203], v[152:155], v[64:67]
buffer_load_dwordx4 a[48:51], v5, s[56:59], s78 offen offset:0
v_mfma_f32_16x16x32_bf16 v[68:71], v[200:203], v[156:159], v[68:71]
buffer_load_dwordx4 a[52:55], v5, s[56:59], s78 offen offset:1024
v_mfma_f32_16x16x32_bf16 v[72:75], v[200:203], v[160:163], v[72:75]
buffer_load_dwordx4 a[56:59], v5, s[56:59], s78 offen offset:2048
v_mfma_f32_16x16x32_bf16 v[76:79], v[200:203], v[164:167], v[76:79]
buffer_load_dwordx4 a[60:63], v5, s[56:59], s78 offen offset:3072
v_mfma_f32_16x16x32_bf16 v[80:83], v[200:203], v[168:171], v[80:83]
s_add_u32 s78, s78, 4096
v_mfma_f32_16x16x32_bf16 v[84:87], v[200:203], v[172:175], v[84:87]
v_mfma_f32_16x16x32_bf16 v[124:127], v[204:207], v[208:211], v[124:127]
v_mfma_f32_16x16x32_bf16 v[88:91], v[204:207], v[152:155], v[88:91]
v_mfma_f32_16x16x32_bf16 v[92:95], v[204:207], v[156:159], v[92:95]
v_mfma_f32_16x16x32_bf16 v[96:99], v[204:207], v[160:163], v[96:99]
v_mfma_f32_16x16x32_bf16 v[100:103], v[204:207], v[164:167], v[100:103]
v_mfma_f32_16x16x32_bf16 v[104:107], v[204:207], v[168:171], v[104:107]
v_mfma_f32_16x16x32_bf16 v[108:111], v[204:207], v[172:175], v[108:111]
s_waitcnt lgkmcnt(0)
v_mfma_f32_16x16x32_bf16 v[112:115], v[176:179], v[208:211], v[112:115]
ds_read_b128 v[192:195], v15 offset:0
ds_read_b128 v[196:199], v15 offset:1024
v_mfma_f32_16x16x32_bf16 v[16:19], v[176:179], v[128:131], v[16:19]
ds_read_b128 v[200:203], v15 offset:4096
ds_read_b128 v[204:207], v15 offset:5120
v_mfma_f32_16x16x32_bf16 v[20:23], v[176:179], v[132:135], v[20:23]
ds_read_b128 v[152:155], v14 offset:0
ds_read_b128 v[156:159], v14 offset:1024
v_mfma_f32_16x16x32_bf16 v[24:27], v[176:179], v[136:139], v[24:27]
ds_read_b128 v[160:163], v14 offset:2048
ds_read_b128 v[164:167], v14 offset:3072
v_mfma_f32_16x16x32_bf16 v[28:31], v[176:179], v[140:143], v[28:31]
ds_read_b128 v[168:171], v14 offset:4096
ds_read_b128 v[172:175], v14 offset:5120
v_mfma_f32_16x16x32_bf16 v[32:35], v[176:179], v[144:147], v[32:35]
v_mfma_f32_16x16x32_bf16 v[36:39], v[176:179], v[148:151], v[36:39]
s_waitcnt vmcnt(21)
v_mfma_f32_16x16x32_bf16 v[116:119], v[180:183], v[208:211], v[116:119]
v_mfma_f32_16x16x32_bf16 v[40:43], v[180:183], v[128:131], v[40:43]
s_barrier
v_mfma_f32_16x16x32_bf16 v[44:47], v[180:183], v[132:135], v[44:47]
v_mfma_f32_16x16x32_bf16 v[48:51], v[180:183], v[136:139], v[48:51]
buffer_load_dwordx4 a[64:67], v5, s[56:59], s78 offen offset:0
v_mfma_f32_16x16x32_bf16 v[52:55], v[180:183], v[140:143], v[52:55]
buffer_load_dwordx4 a[68:71], v5, s[56:59], s78 offen offset:1024
v_mfma_f32_16x16x32_bf16 v[56:59], v[180:183], v[144:147], v[56:59]
buffer_load_dwordx4 a[72:75], v5, s[56:59], s78 offen offset:2048
v_mfma_f32_16x16x32_bf16 v[60:63], v[180:183], v[148:151], v[60:63]
buffer_load_dwordx4 a[76:79], v5, s[56:59], s78 offen offset:3072
v_mfma_f32_16x16x32_bf16 v[120:123], v[184:187], v[208:211], v[120:123]
s_add_u32 s78, s78, 4096
v_mfma_f32_16x16x32_bf16 v[64:67], v[184:187], v[128:131], v[64:67]
buffer_load_dwordx4 a[80:83], v5, s[56:59], s78 offen offset:0
v_mfma_f32_16x16x32_bf16 v[68:71], v[184:187], v[132:135], v[68:71]
buffer_load_dwordx4 a[84:87], v5, s[56:59], s78 offen offset:1024
v_mfma_f32_16x16x32_bf16 v[72:75], v[184:187], v[136:139], v[72:75]
buffer_load_dwordx4 a[88:91], v5, s[56:59], s78 offen offset:2048
v_mfma_f32_16x16x32_bf16 v[76:79], v[184:187], v[140:143], v[76:79]
buffer_load_dwordx4 a[92:95], v5, s[56:59], s78 offen offset:3072
v_mfma_f32_16x16x32_bf16 v[80:83], v[184:187], v[144:147], v[80:83]
s_add_u32 s78, s78, 4096
v_mfma_f32_16x16x32_bf16 v[84:87], v[184:187], v[148:151], v[84:87]
v_mfma_f32_16x16x32_bf16 v[124:127], v[188:191], v[208:211], v[124:127]
v_mfma_f32_16x16x32_bf16 v[88:91], v[188:191], v[128:131], v[88:91]
v_mfma_f32_16x16x32_bf16 v[92:95], v[188:191], v[132:135], v[92:95]
v_mfma_f32_16x16x32_bf16 v[96:99], v[188:191], v[136:139], v[96:99]
v_mfma_f32_16x16x32_bf16 v[100:103], v[188:191], v[140:143], v[100:103]
v_mfma_f32_16x16x32_bf16 v[104:107], v[188:191], v[144:147], v[104:107]
v_mfma_f32_16x16x32_bf16 v[108:111], v[188:191], v[148:151], v[108:111]
s_waitcnt lgkmcnt(0)
v_mfma_f32_16x16x32_bf16 v[112:115], v[192:195], v[208:211], v[112:115]
ds_read_b128 v[176:179], v6 offset:0
ds_read_b128 v[180:183], v6 offset:1024
v_mfma_f32_16x16x32_bf16 v[16:19], v[192:195], v[152:155], v[16:19]
ds_read_b128 v[184:187], v6 offset:4096
ds_read_b128 v[188:191], v6 offset:5120
v_mfma_f32_16x16x32_bf16 v[20:23], v[192:195], v[156:159], v[20:23]
ds_read_b128 v[128:131], v10 offset:0
ds_read_b128 v[132:135], v10 offset:1024
v_mfma_f32_16x16x32_bf16 v[24:27], v[192:195], v[160:163], v[24:27]
ds_read_b128 v[136:139], v10 offset:2048
ds_read_b128 v[140:143], v10 offset:3072
v_mfma_f32_16x16x32_bf16 v[28:31], v[192:195], v[164:167], v[28:31]
ds_read_b128 v[144:147], v10 offset:4096
ds_read_b128 v[148:151], v10 offset:5120
v_mfma_f32_16x16x32_bf16 v[32:35], v[192:195], v[168:171], v[32:35]
v_mfma_f32_16x16x32_bf16 v[36:39], v[192:195], v[172:175], v[36:39]
s_waitcnt vmcnt(24)
v_mfma_f32_16x16x32_bf16 v[116:119], v[196:199], v[208:211], v[116:119]
v_mfma_f32_16x16x32_bf16 v[40:43], v[196:199], v[152:155], v[40:43]
s_barrier
v_mfma_f32_16x16x32_bf16 v[44:47], v[196:199], v[156:159], v[44:47]
v_mfma_f32_16x16x32_bf16 v[48:51], v[196:199], v[160:163], v[48:51]
buffer_load_dwordx4 a[96:99], v5, s[56:59], s78 offen offset:0
v_mfma_f32_16x16x32_bf16 v[52:55], v[196:199], v[164:167], v[52:55]
buffer_load_dwordx4 a[100:103], v5, s[56:59], s78 offen offset:1024
v_mfma_f32_16x16x32_bf16 v[56:59], v[196:199], v[168:171], v[56:59]
buffer_load_dwordx4 a[104:107], v5, s[56:59], s78 offen offset:2048
v_mfma_f32_16x16x32_bf16 v[60:63], v[196:199], v[172:175], v[60:63]
buffer_load_dwordx4 a[108:111], v5, s[56:59], s78 offen offset:3072
v_mfma_f32_16x16x32_bf16 v[120:123], v[200:203], v[208:211], v[120:123]
s_add_u32 s78, s78, 4096
v_mfma_f32_16x16x32_bf16 v[64:67], v[200:203], v[152:155], v[64:67]
buffer_load_dwordx4 a[112:115], v5, s[56:59], s78 offen offset:0
v_mfma_f32_16x16x32_bf16 v[68:71], v[200:203], v[156:159], v[68:71]
buffer_load_dwordx4 a[116:119], v5, s[56:59], s78 offen offset:1024
v_mfma_f32_16x16x32_bf16 v[72:75], v[200:203], v[160:163], v[72:75]
buffer_load_dwordx4 a[120:123], v5, s[56:59], s78 offen offset:2048
v_mfma_f32_16x16x32_bf16 v[76:79], v[200:203], v[164:167], v[76:79]
buffer_load_dwordx4 a[124:127], v5, s[56:59], s78 offen offset:3072
v_mfma_f32_16x16x32_bf16 v[80:83], v[200:203], v[168:171], v[80:83]
s_add_u32 s78, s78, 4096
v_mfma_f32_16x16x32_bf16 v[84:87], v[200:203], v[172:175], v[84:87]
v_mfma_f32_16x16x32_bf16 v[124:127], v[204:207], v[208:211], v[124:127]
v_mfma_f32_16x16x32_bf16 v[88:91], v[204:207], v[152:155], v[88:91]
v_mfma_f32_16x16x32_bf16 v[92:95], v[204:207], v[156:159], v[92:95]
v_mfma_f32_16x16x32_bf16 v[96:99], v[204:207], v[160:163], v[96:99]
v_mfma_f32_16x16x32_bf16 v[100:103], v[204:207], v[164:167], v[100:103]
v_mfma_f32_16x16x32_bf16 v[104:107], v[204:207], v[168:171], v[104:107]
v_mfma_f32_16x16x32_bf16 v[108:111], v[204:207], v[172:175], v[108:111]
s_waitcnt lgkmcnt(0)
v_mfma_f32_16x16x32_bf16 v[112:115], v[176:179], v[208:211], v[112:115]
ds_read_b128 v[192:195], v6 offset:20480
ds_read_b128 v[196:199], v6 offset:21504
v_mfma_f32_16x16x32_bf16 v[16:19], v[176:179], v[128:131], v[16:19]
ds_read_b128 v[200:203], v6 offset:24576
ds_read_b128 v[204:207], v6 offset:25600
v_mfma_f32_16x16x32_bf16 v[20:23], v[176:179], v[132:135], v[20:23]
ds_read_b128 v[152:155], v10 offset:20480
ds_read_b128 v[156:159], v10 offset:21504
v_mfma_f32_16x16x32_bf16 v[24:27], v[176:179], v[136:139], v[24:27]
ds_read_b128 v[160:163], v10 offset:22528
ds_read_b128 v[164:167], v10 offset:23552
v_mfma_f32_16x16x32_bf16 v[28:31], v[176:179], v[140:143], v[28:31]
ds_read_b128 v[168:171], v10 offset:24576
ds_read_b128 v[172:175], v10 offset:25600
v_mfma_f32_16x16x32_bf16 v[32:35], v[176:179], v[144:147], v[32:35]
v_mfma_f32_16x16x32_bf16 v[36:39], v[176:179], v[148:151], v[36:39]
buffer_load_dwordx4 a[128:131], v5, s[56:59], s78 offen offset:0
v_mfma_f32_16x16x32_bf16 v[116:119], v[180:183], v[208:211], v[116:119]
buffer_load_dwordx4 a[132:135], v5, s[56:59], s78 offen offset:1024
v_mfma_f32_16x16x32_bf16 v[40:43], v[180:183], v[128:131], v[40:43]
buffer_load_dwordx4 a[136:139], v5, s[56:59], s78 offen offset:2048
v_mfma_f32_16x16x32_bf16 v[44:47], v[180:183], v[132:135], v[44:47]
buffer_load_dwordx4 a[140:143], v5, s[56:59], s78 offen offset:3072
v_mfma_f32_16x16x32_bf16 v[48:51], v[180:183], v[136:139], v[48:51]
s_add_u32 s78, s78, 4096
v_mfma_f32_16x16x32_bf16 v[52:55], v[180:183], v[140:143], v[52:55]
buffer_load_dwordx4 a[144:147], v5, s[56:59], s78 offen offset:0
v_mfma_f32_16x16x32_bf16 v[56:59], v[180:183], v[144:147], v[56:59]
buffer_load_dwordx4 a[148:151], v5, s[56:59], s78 offen offset:1024
v_mfma_f32_16x16x32_bf16 v[60:63], v[180:183], v[148:151], v[60:63]
buffer_load_dwordx4 a[152:155], v5, s[56:59], s78 offen offset:2048
v_mfma_f32_16x16x32_bf16 v[120:123], v[184:187], v[208:211], v[120:123]
buffer_load_dwordx4 a[156:159], v5, s[56:59], s78 offen offset:3072
v_mfma_f32_16x16x32_bf16 v[64:67], v[184:187], v[128:131], v[64:67]
s_add_u32 s78, s78, 4096
v_mfma_f32_16x16x32_bf16 v[68:71], v[184:187], v[132:135], v[68:71]
v_mfma_f32_16x16x32_bf16 v[72:75], v[184:187], v[136:139], v[72:75]
v_mfma_f32_16x16x32_bf16 v[76:79], v[184:187], v[140:143], v[76:79]
v_mfma_f32_16x16x32_bf16 v[80:83], v[184:187], v[144:147], v[80:83]
v_mfma_f32_16x16x32_bf16 v[84:87], v[184:187], v[148:151], v[84:87]
v_mfma_f32_16x16x32_bf16 v[124:127], v[188:191], v[208:211], v[124:127]
v_mfma_f32_16x16x32_bf16 v[88:91], v[188:191], v[128:131], v[88:91]
v_mfma_f32_16x16x32_bf16 v[92:95], v[188:191], v[132:135], v[92:95]
v_mfma_f32_16x16x32_bf16 v[96:99], v[188:191], v[136:139], v[96:99]
v_mfma_f32_16x16x32_bf16 v[100:103], v[188:191], v[140:143], v[100:103]
v_mfma_f32_16x16x32_bf16 v[104:107], v[188:191], v[144:147], v[104:107]
v_mfma_f32_16x16x32_bf16 v[108:111], v[188:191], v[148:151], v[108:111]
s_waitcnt lgkmcnt(0)
v_mfma_f32_16x16x32_bf16 v[112:115], v[192:195], v[208:211], v[112:115]
v_mfma_f32_16x16x32_bf16 v[16:19], v[192:195], v[152:155], v[16:19]
v_mfma_f32_16x16x32_bf16 v[20:23], v[192:195], v[156:159], v[20:23]
buffer_load_dwordx4 a[160:163], v5, s[56:59], s78 offen offset:0
v_mfma_f32_16x16x32_bf16 v[24:27], v[192:195], v[160:163], v[24:27]
buffer_load_dwordx4 a[164:167], v5, s[56:59], s78 offen offset:1024
v_mfma_f32_16x16x32_bf16 v[28:31], v[192:195], v[164:167], v[28:31]
buffer_load_dwordx4 a[168:171], v5, s[56:59], s78 offen offset:2048
v_mfma_f32_16x16x32_bf16 v[32:35], v[192:195], v[168:171], v[32:35]
buffer_load_dwordx4 a[172:175], v5, s[56:59], s78 offen offset:3072
v_mfma_f32_16x16x32_bf16 v[36:39], v[192:195], v[172:175], v[36:39]
s_add_u32 s78, s78, 4096
v_mfma_f32_16x16x32_bf16 v[116:119], v[196:199], v[208:211], v[116:119]
v_mfma_f32_16x16x32_bf16 v[40:43], v[196:199], v[152:155], v[40:43]
v_mfma_f32_16x16x32_bf16 v[44:47], v[196:199], v[156:159], v[44:47]
v_mfma_f32_16x16x32_bf16 v[48:51], v[196:199], v[160:163], v[48:51]
v_mfma_f32_16x16x32_bf16 v[52:55], v[196:199], v[164:167], v[52:55]
v_mfma_f32_16x16x32_bf16 v[56:59], v[196:199], v[168:171], v[56:59]
v_mfma_f32_16x16x32_bf16 v[60:63], v[196:199], v[172:175], v[60:63]
v_mfma_f32_16x16x32_bf16 v[120:123], v[200:203], v[208:211], v[120:123]
v_mfma_f32_16x16x32_bf16 v[64:67], v[200:203], v[152:155], v[64:67]
v_mfma_f32_16x16x32_bf16 v[68:71], v[200:203], v[156:159], v[68:71]
v_mfma_f32_16x16x32_bf16 v[72:75], v[200:203], v[160:163], v[72:75]
v_mfma_f32_16x16x32_bf16 v[76:79], v[200:203], v[164:167], v[76:79]
v_mfma_f32_16x16x32_bf16 v[80:83], v[200:203], v[168:171], v[80:83]
v_mfma_f32_16x16x32_bf16 v[84:87], v[200:203], v[172:175], v[84:87]
v_mfma_f32_16x16x32_bf16 v[124:127], v[204:207], v[208:211], v[124:127]
v_mfma_f32_16x16x32_bf16 v[88:91], v[204:207], v[152:155], v[88:91]
v_mfma_f32_16x16x32_bf16 v[92:95], v[204:207], v[156:159], v[92:95]
v_mfma_f32_16x16x32_bf16 v[96:99], v[204:207], v[160:163], v[96:99]
v_mfma_f32_16x16x32_bf16 v[100:103], v[204:207], v[164:167], v[100:103]
v_mfma_f32_16x16x32_bf16 v[104:107], v[204:207], v[168:171], v[104:107]
v_mfma_f32_16x16x32_bf16 v[108:111], v[204:207], v[172:175], v[108:111]
s_waitcnt vmcnt(0)
v_add_f32 v232, v232, v234
v_add_f32 v233, v233, v235
v_add_f32 v236, v236, v238
v_add_f32 v237, v237, v239
v_add_f32 v240, v240, v242
v_add_f32 v241, v241, v243
v_add_f32 v244, v244, v246
v_add_f32 v245, v245, v247
v_add_f32 v248, v248, v250
v_add_f32 v249, v249, v251
v_add_f32 v252, v252, v254
v_add_f32 v253, v253, v255
v_mov_b32 v234, v232
v_mov_b32 v235, v233
v_mov_b32 v238, v236
v_mov_b32 v239, v237
v_mov_b32 v242, v240
v_mov_b32 v243, v241
v_mov_b32 v246, v244
v_mov_b32 v247, v245
v_mov_b32 v250, v248
v_mov_b32 v251, v249
v_mov_b32 v254, v252
v_mov_b32 v255, v253
s_nop 1
v_permlane16_swap_b32 v232, v234
v_permlane16_swap_b32 v233, v235
v_permlane16_swap_b32 v236, v238
v_permlane16_swap_b32 v237, v239
v_permlane16_swap_b32 v240, v242
v_permlane16_swap_b32 v241, v243
v_permlane16_swap_b32 v244, v246
v_permlane16_swap_b32 v245, v247
v_permlane16_swap_b32 v248, v250
v_permlane16_swap_b32 v249, v251
v_permlane16_swap_b32 v252, v254
v_permlane16_swap_b32 v253, v255
s_nop 1
v_add_f32 v232, v232, v234
v_add_f32 v233, v233, v235
v_add_f32 v236, v236, v238
v_add_f32 v237, v237, v239
v_add_f32 v240, v240, v242
v_add_f32 v241, v241, v243
v_add_f32 v244, v244, v246
v_add_f32 v245, v245, v247
v_add_f32 v248, v248, v250
v_add_f32 v249, v249, v251
v_add_f32 v252, v252, v254
v_add_f32 v253, v253, v255
v_mov_b32 v234, v232
v_mov_b32 v235, v233
v_mov_b32 v238, v236
v_mov_b32 v239, v237
v_mov_b32 v242, v240
v_mov_b32 v243, v241
v_mov_b32 v246, v244
v_mov_b32 v247, v245
v_mov_b32 v250, v248
v_mov_b32 v251, v249
v_mov_b32 v254, v252
v_mov_b32 v255, v253
s_nop 1
v_permlane32_swap_b32 v232, v234
v_permlane32_swap_b32 v233, v235
v_permlane32_swap_b32 v236, v238
v_permlane32_swap_b32 v237, v239
v_permlane32_swap_b32 v240, v242
v_permlane32_swap_b32 v241, v243
v_permlane32_swap_b32 v244, v246
v_permlane32_swap_b32 v245, v247
v_permlane32_swap_b32 v248, v250
v_permlane32_swap_b32 v249, v251
v_permlane32_swap_b32 v252, v254
v_permlane32_swap_b32 v253, v255
s_nop 1
v_add_f32 v232, v232, v234
v_add_f32 v233, v233, v235
v_add_f32 v236, v236, v238
v_add_f32 v237, v237, v239
v_add_f32 v240, v240, v242
v_add_f32 v241, v241, v243
v_add_f32 v244, v244, v246
v_add_f32 v245, v245, v247
v_add_f32 v248, v248, v250
v_add_f32 v249, v249, v251
v_add_f32 v252, v252, v254
v_add_f32 v253, v253, v255
v_mul_f32 v212, 0x3b000000, v232
v_mul_f32 v233, 0x3b000000, v233
v_fma_f32 v233, -v212, v212, v233
v_max_f32 v233, 0, v233
v_add_f32 v233, 0x3727c5ac, v233
v_rcp_f32 v218, v233
v_mul_f32 v213, 0x3b000000, v236
v_mul_f32 v237, 0x3b000000, v237
v_fma_f32 v237, -v213, v213, v237
v_max_f32 v237, 0, v237
v_add_f32 v237, 0x3727c5ac, v237
v_rcp_f32 v219, v237
v_mul_f32 v214, 0x3b000000, v240
v_mul_f32 v241, 0x3b000000, v241
v_fma_f32 v241, -v214, v214, v241
v_max_f32 v241, 0, v241
v_add_f32 v241, 0x3727c5ac, v241
v_rcp_f32 v220, v241
v_mul_f32 v215, 0x3b000000, v244
v_mul_f32 v245, 0x3b000000, v245
v_fma_f32 v245, -v215, v215, v245
v_max_f32 v245, 0, v245
v_add_f32 v245, 0x3727c5ac, v245
v_rcp_f32 v221, v245
v_mul_f32 v216, 0x3b000000, v248
v_mul_f32 v249, 0x3b000000, v249
v_fma_f32 v249, -v216, v216, v249
v_max_f32 v249, 0, v249
v_add_f32 v249, 0x3727c5ac, v249
v_rcp_f32 v222, v249
v_mul_f32 v217, 0x3b000000, v252
v_mul_f32 v253, 0x3b000000, v253
v_fma_f32 v253, -v217, v217, v253
v_max_f32 v253, 0, v253
v_add_f32 v253, 0x3727c5ac, v253
v_rcp_f32 v223, v253
s_nop 0
s_cmp_eq_u32 s38, 21
s_cselect_b32 s39, s42, 0
s_cmp_lg_u32 s39, 0
s_cbranch_scc1 K4_DONE
s_mul_i32 s39, s37, 12
s_mul_i32 s40, s41, 6
s_add_u32 s39, s39, s40
s_mul_i32 s52, s39, 45056
s_lshl_b32 s39, s38, 1
s_add_u32 s39, s39, s42
s_lshl_b32 s39, s39, 10
s_add_u32 s52, s52, s39
v_lshlrev_b32 v224, 4, v1
v_fma_f32 v16, -v212, v112, v16
v_fma_f32 v64, -v212, v120, v64
v_max_f32 v16, 0, v16
v_mul_f32 v64, v64, v218
v_mul_f32 v128, v16, v64
v_fma_f32 v17, -v212, v113, v17
v_fma_f32 v65, -v212, v121, v65
v_max_f32 v17, 0, v17
v_mul_f32 v65, v65, v218
v_mul_f32 v129, v17, v65
v_fma_f32 v18, -v212, v114, v18
v_fma_f32 v66, -v212, v122, v66
v_max_f32 v18, 0, v18
v_mul_f32 v66, v66, v218
v_mul_f32 v130, v18, v66
v_fma_f32 v19, -v212, v115, v19
v_fma_f32 v67, -v212, v123, v67
v_max_f32 v19, 0, v19
v_mul_f32 v67, v67, v218
v_mul_f32 v131, v19, v67
v_fma_f32 v40, -v212, v116, v40
v_fma_f32 v88, -v212, v124, v88
v_max_f32 v40, 0, v40
v_mul_f32 v88, v88, v218
v_mul_f32 v132, v40, v88
v_fma_f32 v41, -v212, v117, v41
v_fma_f32 v89, -v212, v125, v89
v_max_f32 v41, 0, v41
v_mul_f32 v89, v89, v218
v_mul_f32 v133, v41, v89
v_fma_f32 v42, -v212, v118, v42
v_fma_f32 v90, -v212, v126, v90
v_max_f32 v42, 0, v42
v_mul_f32 v90, v90, v218
v_mul_f32 v134, v42, v90
v_fma_f32 v43, -v212, v119, v43
v_fma_f32 v91, -v212, v127, v91
v_max_f32 v43, 0, v43
v_mul_f32 v91, v91, v218
v_mul_f32 v135, v43, v91
v_cvt_pk_bf16_f32 v136, v128, v129
v_cvt_pk_bf16_f32 v137, v130, v131
v_cvt_pk_bf16_f32 v138, v132, v133
v_cvt_pk_bf16_f32 v139, v134, v135
buffer_store_dwordx4 v[136:139], v224, s[28:31], s52 offen sc0 sc1
s_add_u32 s52, s52, 45056
v_fma_f32 v20, -v213, v112, v20
v_fma_f32 v68, -v213, v120, v68
v_max_f32 v20, 0, v20
v_mul_f32 v68, v68, v219
v_mul_f32 v144, v20, v68
v_fma_f32 v21, -v213, v113, v21
v_fma_f32 v69, -v213, v121, v69
v_max_f32 v21, 0, v21
v_mul_f32 v69, v69, v219
v_mul_f32 v145, v21, v69
v_fma_f32 v22, -v213, v114, v22
v_fma_f32 v70, -v213, v122, v70
v_max_f32 v22, 0, v22
v_mul_f32 v70, v70, v219
v_mul_f32 v146, v22, v70
v_fma_f32 v23, -v213, v115, v23
v_fma_f32 v71, -v213, v123, v71
v_max_f32 v23, 0, v23
v_mul_f32 v71, v71, v219
v_mul_f32 v147, v23, v71
v_fma_f32 v44, -v213, v116, v44
v_fma_f32 v92, -v213, v124, v92
v_max_f32 v44, 0, v44
v_mul_f32 v92, v92, v219
v_mul_f32 v148, v44, v92
v_fma_f32 v45, -v213, v117, v45
v_fma_f32 v93, -v213, v125, v93
v_max_f32 v45, 0, v45
v_mul_f32 v93, v93, v219
v_mul_f32 v149, v45, v93
v_fma_f32 v46, -v213, v118, v46
v_fma_f32 v94, -v213, v126, v94
v_max_f32 v46, 0, v46
v_mul_f32 v94, v94, v219
v_mul_f32 v150, v46, v94
v_fma_f32 v47, -v213, v119, v47
v_fma_f32 v95, -v213, v127, v95
v_max_f32 v47, 0, v47
v_mul_f32 v95, v95, v219
v_mul_f32 v151, v47, v95
v_cvt_pk_bf16_f32 v152, v144, v145
v_cvt_pk_bf16_f32 v153, v146, v147
v_cvt_pk_bf16_f32 v154, v148, v149
v_cvt_pk_bf16_f32 v155, v150, v151
buffer_store_dwordx4 v[152:155], v224, s[28:31], s52 offen sc0 sc1
s_add_u32 s52, s52, 45056
v_fma_f32 v24, -v214, v112, v24
v_fma_f32 v72, -v214, v120, v72
v_max_f32 v24, 0, v24
v_mul_f32 v72, v72, v220
v_mul_f32 v128, v24, v72
v_fma_f32 v25, -v214, v113, v25
v_fma_f32 v73, -v214, v121, v73
v_max_f32 v25, 0, v25
v_mul_f32 v73, v73, v220
v_mul_f32 v129, v25, v73
v_fma_f32 v26, -v214, v114, v26
v_fma_f32 v74, -v214, v122, v74
v_max_f32 v26, 0, v26
v_mul_f32 v74, v74, v220
v_mul_f32 v130, v26, v74
v_fma_f32 v27, -v214, v115, v27
v_fma_f32 v75, -v214, v123, v75
v_max_f32 v27, 0, v27
v_mul_f32 v75, v75, v220
v_mul_f32 v131, v27, v75
v_fma_f32 v48, -v214, v116, v48
v_fma_f32 v96, -v214, v124, v96
v_max_f32 v48, 0, v48
v_mul_f32 v96, v96, v220
v_mul_f32 v132, v48, v96
v_fma_f32 v49, -v214, v117, v49
v_fma_f32 v97, -v214, v125, v97
v_max_f32 v49, 0, v49
v_mul_f32 v97, v97, v220
v_mul_f32 v133, v49, v97
v_fma_f32 v50, -v214, v118, v50
v_fma_f32 v98, -v214, v126, v98
v_max_f32 v50, 0, v50
v_mul_f32 v98, v98, v220
v_mul_f32 v134, v50, v98
v_fma_f32 v51, -v214, v119, v51
v_fma_f32 v99, -v214, v127, v99
v_max_f32 v51, 0, v51
v_mul_f32 v99, v99, v220
v_mul_f32 v135, v51, v99
v_cvt_pk_bf16_f32 v136, v128, v129
v_cvt_pk_bf16_f32 v137, v130, v131
v_cvt_pk_bf16_f32 v138, v132, v133
v_cvt_pk_bf16_f32 v139, v134, v135
buffer_store_dwordx4 v[136:139], v224, s[28:31], s52 offen sc0 sc1
s_add_u32 s52, s52, 45056
v_fma_f32 v28, -v215, v112, v28
v_fma_f32 v76, -v215, v120, v76
v_max_f32 v28, 0, v28
v_mul_f32 v76, v76, v221
v_mul_f32 v144, v28, v76
v_fma_f32 v29, -v215, v113, v29
v_fma_f32 v77, -v215, v121, v77
v_max_f32 v29, 0, v29
v_mul_f32 v77, v77, v221
v_mul_f32 v145, v29, v77
v_fma_f32 v30, -v215, v114, v30
v_fma_f32 v78, -v215, v122, v78
v_max_f32 v30, 0, v30
v_mul_f32 v78, v78, v221
v_mul_f32 v146, v30, v78
v_fma_f32 v31, -v215, v115, v31
v_fma_f32 v79, -v215, v123, v79
v_max_f32 v31, 0, v31
v_mul_f32 v79, v79, v221
v_mul_f32 v147, v31, v79
v_fma_f32 v52, -v215, v116, v52
v_fma_f32 v100, -v215, v124, v100
v_max_f32 v52, 0, v52
v_mul_f32 v100, v100, v221
v_mul_f32 v148, v52, v100
v_fma_f32 v53, -v215, v117, v53
v_fma_f32 v101, -v215, v125, v101
v_max_f32 v53, 0, v53
v_mul_f32 v101, v101, v221
v_mul_f32 v149, v53, v101
v_fma_f32 v54, -v215, v118, v54
v_fma_f32 v102, -v215, v126, v102
v_max_f32 v54, 0, v54
v_mul_f32 v102, v102, v221
v_mul_f32 v150, v54, v102
v_fma_f32 v55, -v215, v119, v55
v_fma_f32 v103, -v215, v127, v103
v_max_f32 v55, 0, v55
v_mul_f32 v103, v103, v221
v_mul_f32 v151, v55, v103
v_cvt_pk_bf16_f32 v152, v144, v145
v_cvt_pk_bf16_f32 v153, v146, v147
v_cvt_pk_bf16_f32 v154, v148, v149
v_cvt_pk_bf16_f32 v155, v150, v151
buffer_store_dwordx4 v[152:155], v224, s[28:31], s52 offen sc0 sc1
s_add_u32 s52, s52, 45056
v_fma_f32 v32, -v216, v112, v32
v_fma_f32 v80, -v216, v120, v80
v_max_f32 v32, 0, v32
v_mul_f32 v80, v80, v222
v_mul_f32 v128, v32, v80
v_fma_f32 v33, -v216, v113, v33
v_fma_f32 v81, -v216, v121, v81
v_max_f32 v33, 0, v33
v_mul_f32 v81, v81, v222
v_mul_f32 v129, v33, v81
v_fma_f32 v34, -v216, v114, v34
v_fma_f32 v82, -v216, v122, v82
v_max_f32 v34, 0, v34
v_mul_f32 v82, v82, v222
v_mul_f32 v130, v34, v82
v_fma_f32 v35, -v216, v115, v35
v_fma_f32 v83, -v216, v123, v83
v_max_f32 v35, 0, v35
v_mul_f32 v83, v83, v222
v_mul_f32 v131, v35, v83
v_fma_f32 v56, -v216, v116, v56
v_fma_f32 v104, -v216, v124, v104
v_max_f32 v56, 0, v56
v_mul_f32 v104, v104, v222
v_mul_f32 v132, v56, v104
v_fma_f32 v57, -v216, v117, v57
v_fma_f32 v105, -v216, v125, v105
v_max_f32 v57, 0, v57
v_mul_f32 v105, v105, v222
v_mul_f32 v133, v57, v105
v_fma_f32 v58, -v216, v118, v58
v_fma_f32 v106, -v216, v126, v106
v_max_f32 v58, 0, v58
v_mul_f32 v106, v106, v222
v_mul_f32 v134, v58, v106
v_fma_f32 v59, -v216, v119, v59
v_fma_f32 v107, -v216, v127, v107
v_max_f32 v59, 0, v59
v_mul_f32 v107, v107, v222
v_mul_f32 v135, v59, v107
v_cvt_pk_bf16_f32 v136, v128, v129
v_cvt_pk_bf16_f32 v137, v130, v131
v_cvt_pk_bf16_f32 v138, v132, v133
v_cvt_pk_bf16_f32 v139, v134, v135
buffer_store_dwordx4 v[136:139], v224, s[28:31], s52 offen sc0 sc1
s_add_u32 s52, s52, 45056
v_fma_f32 v36, -v217, v112, v36
v_fma_f32 v84, -v217, v120, v84
v_max_f32 v36, 0, v36
v_mul_f32 v84, v84, v223
v_mul_f32 v144, v36, v84
v_fma_f32 v37, -v217, v113, v37
v_fma_f32 v85, -v217, v121, v85
v_max_f32 v37, 0, v37
v_mul_f32 v85, v85, v223
v_mul_f32 v145, v37, v85
v_fma_f32 v38, -v217, v114, v38
v_fma_f32 v86, -v217, v122, v86
v_max_f32 v38, 0, v38
v_mul_f32 v86, v86, v223
v_mul_f32 v146, v38, v86
v_fma_f32 v39, -v217, v115, v39
v_fma_f32 v87, -v217, v123, v87
v_max_f32 v39, 0, v39
v_mul_f32 v87, v87, v223
v_mul_f32 v147, v39, v87
v_fma_f32 v60, -v217, v116, v60
v_fma_f32 v108, -v217, v124, v108
v_max_f32 v60, 0, v60
v_mul_f32 v108, v108, v223
v_mul_f32 v148, v60, v108
v_fma_f32 v61, -v217, v117, v61
v_fma_f32 v109, -v217, v125, v109
v_max_f32 v61, 0, v61
v_mul_f32 v109, v109, v223
v_mul_f32 v149, v61, v109
v_fma_f32 v62, -v217, v118, v62
v_fma_f32 v110, -v217, v126, v110
v_max_f32 v62, 0, v62
v_mul_f32 v110, v110, v223
v_mul_f32 v150, v62, v110
v_fma_f32 v63, -v217, v119, v63
v_fma_f32 v111, -v217, v127, v111
v_max_f32 v63, 0, v63
v_mul_f32 v111, v111, v223
v_mul_f32 v151, v63, v111
v_cvt_pk_bf16_f32 v152, v144, v145
v_cvt_pk_bf16_f32 v153, v146, v147
v_cvt_pk_bf16_f32 v154, v148, v149
v_cvt_pk_bf16_f32 v155, v150, v151
buffer_store_dwordx4 v[152:155], v224, s[28:31], s52 offen sc0 sc1
s_add_u32 s52, s52, 45056
K4_DONE:
s_waitcnt vmcnt(0)
s_barrier
s_cmp_eq_u32 s36, 0
s_cbranch_scc0 K45_P5
v_cmp_eq_u32 vcc, 0, v1
v_mov_b32 v224, 0x100000
s_mul_i32 s39, s37, 22
s_add_u32 s39, s39, s38
s_lshl_b32 s39, s39, 7
v_mov_b32 v225, s39
v_cndmask_b32 v224, v224, v225, vcc
v_mov_b32 v225, 1
buffer_store_dword v225, v224, s[72:75], 0 offen sc0 sc1
K45_P5:
v_lshlrev_b32 v252, 4, v1
v_add_u32 v253, 45056, v252
v_add_u32 v254, 90112, v252
v_add_u32 v255, 135168, v252
s_mul_i32 s39, s36, 11
s_mul_i32 s40, s77, 44
s_add_u32 s40, s40, s39
s_lshl_b32 s40, s40, 12
s_cmp_eq_u32 s40, s78
s_cbranch_scc0 K45_WOK
buffer_load_dwordx4 a[0:3], v252, s[56:59], s78 offen offset:0
buffer_load_dwordx4 a[4:7], v252, s[56:59], s78 offen offset:1024
buffer_load_dwordx4 a[8:11], v252, s[56:59], s78 offen offset:2048
buffer_load_dwordx4 a[12:15], v252, s[56:59], s78 offen offset:3072
s_add_u32 s78, s78, 4096
buffer_load_dwordx4 a[16:19], v252, s[56:59], s78 offen offset:0
buffer_load_dwordx4 a[20:23], v252, s[56:59], s78 offen offset:1024
buffer_load_dwordx4 a[24:27], v252, s[56:59], s78 offen offset:2048
buffer_load_dwordx4 a[28:31], v252, s[56:59], s78 offen offset:3072
s_add_u32 s78, s78, 4096
buffer_load_dwordx4 a[32:35], v252, s[56:59], s78 offen offset:0
buffer_load_dwordx4 a[36:39], v252, s[56:59], s78 offen offset:1024
buffer_load_dwordx4 a[40:43], v252, s[56:59], s78 offen offset:2048
buffer_load_dwordx4 a[44:47], v252, s[56:59], s78 offen offset:3072
s_add_u32 s78, s78, 4096
buffer_load_dwordx4 a[48:51], v252, s[56:59], s78 offen offset:0
buffer_load_dwordx4 a[52:55], v252, s[56:59], s78 offen offset:1024
buffer_load_dwordx4 a[56:59], v252, s[56:59], s78 offen offset:2048
buffer_load_dwordx4 a[60:63], v252, s[56:59], s78 offen offset:3072
s_add_u32 s78, s78, 4096
buffer_load_dwordx4 a[64:67], v252, s[56:59], s78 offen offset:0
buffer_load_dwordx4 a[68:71], v252, s[56:59], s78 offen offset:1024
buffer_load_dwordx4 a[72:75], v252, s[56:59], s78 offen offset:2048
buffer_load_dwordx4 a[76:79], v252, s[56:59], s78 offen offset:3072
s_add_u32 s78, s78, 4096
buffer_load_dwordx4 a[80:83], v252, s[56:59], s78 offen offset:0
buffer_load_dwordx4 a[84:87], v252, s[56:59], s78 offen offset:1024
buffer_load_dwordx4 a[88:91], v252, s[56:59], s78 offen offset:2048
buffer_load_dwordx4 a[92:95], v252, s[56:59], s78 offen offset:3072
s_add_u32 s78, s78, 4096
buffer_load_dwordx4 a[96:99], v252, s[56:59], s78 offen offset:0
buffer_load_dwordx4 a[100:103], v252, s[56:59], s78 offen offset:1024
buffer_load_dwordx4 a[104:107], v252, s[56:59], s78 offen offset:2048
buffer_load_dwordx4 a[108:111], v252, s[56:59], s78 offen offset:3072
s_add_u32 s78, s78, 4096
buffer_load_dwordx4 a[112:115], v252, s[56:59], s78 offen offset:0
buffer_load_dwordx4 a[116:119], v252, s[56:59], s78 offen offset:1024
buffer_load_dwordx4 a[120:123], v252, s[56:59], s78 offen offset:2048
buffer_load_dwordx4 a[124:127], v252, s[56:59], s78 offen offset:3072
s_add_u32 s78, s78, 4096
buffer_load_dwordx4 a[128:131], v252, s[56:59], s78 offen offset:0
buffer_load_dwordx4 a[132:135], v252, s[56:59], s78 offen offset:1024
buffer_load_dwordx4 a[136:139], v252, s[56:59], s78 offen offset:2048
buffer_load_dwordx4 a[140:143], v252, s[56:59], s78 offen offset:3072
s_add_u32 s78, s78, 4096
buffer_load_dwordx4 a[144:147], v252, s[56:59], s78 offen offset:0
buffer_load_dwordx4 a[148:151], v252, s[56:59], s78 offen offset:1024
buffer_load_dwordx4 a[152:155], v252, s[56:59], s78 offen offset:2048
buffer_load_dwordx4 a[156:159], v252, s[56:59], s78 offen offset:3072
s_add_u32 s78, s78, 4096
buffer_load_dwordx4 a[160:163], v252, s[56:59], s78 offen offset:0
buffer_load_dwordx4 a[164:167], v252, s[56:59], s78 offen offset:1024
buffer_load_dwordx4 a[168:171], v252, s[56:59], s78 offen offset:2048
buffer_load_dwordx4 a[172:175], v252, s[56:59], s78 offen offset:3072
s_add_u32 s78, s78, 4096
K45_WOK:
v_lshrrev_b32 v22, 3, v0
v_and_b32 v23, 7, v0
v_lshlrev_b32 v12, 10, v22
v_lshl_add_u32 v12, v23, 4, v12
s_lshl_b32 s39, s76, 16
s_lshl_b32 s40, s77, 7
s_add_u32 s46, s39, s40
s_add_u32 s47, s46, 32768
buffer_load_dwordx4 v[14:17], v12, s[64:67], s46 offen
buffer_load_dwordx4 v[18:21], v12, s[64:67], s47 offen
s_mul_hi_u32 s39, s76, 1431655766
s_mul_i32 s39, s39, 2816
v_lshlrev_b32 v2, 7, v1
v_add_u32 v2, s39, v2
v_mov_b32 v3, 0x100000
v_cmp_gt_u32 vcc, 22, v1
s_nop 1
v_cndmask_b32 v2, v3, v2, vcc
s_mov_b64 s[42:43], vcc
s_cmp_eq_u32 s36, 0
s_cbranch_scc0 K45_GO
s_mov_b32 s41, 0
K45_POLL:
buffer_load_dword v3, v2, s[72:75], 0 offen sc1
s_waitcnt vmcnt(0)
v_cmp_eq_u32 vcc, 1, v3
s_nop 3
s_cmp_eq_u64 vcc, s[42:43]
s_cbranch_scc1 K45_GO
s_add_u32 s41, s41, 1
s_cmp_ge_u32 s41, 0x40000
s_cbranch_scc1 K45_GO
s_sleep 12
s_branch K45_POLL
K45_GO:
s_waitcnt vmcnt(0)
s_barrier
buffer_load_dwordx4 v[88:91], v252, s[60:63], s79 offen sc1
buffer_load_dwordx4 v[92:95], v253, s[60:63], s79 offen sc1
buffer_load_dwordx4 v[96:99], v254, s[60:63], s79 offen sc1
buffer_load_dwordx4 v[100:103], v255, s[60:63], s79 offen sc1
s_add_u32 s79, s79, 1024
buffer_load_dwordx4 v[104:107], v252, s[60:63], s79 offen sc1
buffer_load_dwordx4 v[108:111], v253, s[60:63], s79 offen sc1
buffer_load_dwordx4 v[112:115], v254, s[60:63], s79 offen sc1
buffer_load_dwordx4 v[116:119], v255, s[60:63], s79 offen sc1
s_add_u32 s79, s79, 1024
buffer_load_dwordx4 v[120:123], v252, s[60:63], s79 offen sc1
buffer_load_dwordx4 v[124:127], v253, s[60:63], s79 offen sc1
buffer_load_dwordx4 v[128:131], v254, s[60:63], s79 offen sc1
buffer_load_dwordx4 v[132:135], v255, s[60:63], s79 offen sc1
s_add_u32 s79, s79, 1024
buffer_load_dwordx4 v[136:139], v252, s[60:63], s79 offen sc1
buffer_load_dwordx4 v[140:143], v253, s[60:63], s79 offen sc1
buffer_load_dwordx4 v[144:147], v254, s[60:63], s79 offen sc1
buffer_load_dwordx4 v[148:151], v255, s[60:63], s79 offen sc1
s_add_u32 s79, s79, 1024
buffer_load_dwordx4 v[152:155], v252, s[60:63], s79 offen sc1
buffer_load_dwordx4 v[156:159], v253, s[60:63], s79 offen sc1
buffer_load_dwordx4 v[160:163], v254, s[60:63], s79 offen sc1
buffer_load_dwordx4 v[164:167], v255, s[60:63], s79 offen sc1
s_add_u32 s79, s79, 1024
buffer_load_dwordx4 v[168:171], v252, s[60:63], s79 offen sc1
buffer_load_dwordx4 v[172:175], v253, s[60:63], s79 offen sc1
buffer_load_dwordx4 v[176:179], v254, s[60:63], s79 offen sc1
buffer_load_dwordx4 v[180:183], v255, s[60:63], s79 offen sc1
s_add_u32 s79, s79, 1024
buffer_load_dwordx4 v[184:187], v252, s[60:63], s79 offen sc1
buffer_load_dwordx4 v[188:191], v253, s[60:63], s79 offen sc1
buffer_load_dwordx4 v[192:195], v254, s[60:63], s79 offen sc1
buffer_load_dwordx4 v[196:199], v255, s[60:63], s79 offen sc1
s_add_u32 s79, s79, 1024
buffer_load_dwordx4 v[200:203], v252, s[60:63], s79 offen sc1
buffer_load_dwordx4 v[204:207], v253, s[60:63], s79 offen sc1
buffer_load_dwordx4 v[208:211], v254, s[60:63], s79 offen sc1
buffer_load_dwordx4 v[212:215], v255, s[60:63], s79 offen sc1
s_add_u32 s79, s79, 1024
buffer_load_dwordx4 v[216:219], v252, s[60:63], s79 offen sc1
buffer_load_dwordx4 v[220:223], v253, s[60:63], s79 offen sc1
buffer_load_dwordx4 v[224:227], v254, s[60:63], s79 offen sc1
buffer_load_dwordx4 v[228:231], v255, s[60:63], s79 offen sc1
s_add_u32 s79, s79, 1024
buffer_load_dwordx4 v[232:235], v252, s[60:63], s79 offen sc1
buffer_load_dwordx4 v[236:239], v253, s[60:63], s79 offen sc1
buffer_load_dwordx4 v[240:243], v254, s[60:63], s79 offen sc1
buffer_load_dwordx4 v[244:247], v255, s[60:63], s79 offen sc1
s_add_u32 s79, s79, 1024
buffer_load_dwordx4 a[176:179], v252, s[60:63], s79 offen sc1
buffer_load_dwordx4 a[180:183], v253, s[60:63], s79 offen sc1
buffer_load_dwordx4 a[184:187], v254, s[60:63], s79 offen sc1
buffer_load_dwordx4 a[188:191], v255, s[60:63], s79 offen sc1
s_add_u32 s79, s79, 1024
s_waitcnt vmcnt(40)
v_mfma_f32_16x16x32_bf16 v[24:27], a[0:3], v[88:91], 0
v_mfma_f32_16x16x32_bf16 v[40:43], a[4:7], v[88:91], 0
v_mfma_f32_16x16x32_bf16 v[56:59], a[8:11], v[88:91], 0
v_mfma_f32_16x16x32_bf16 v[72:75], a[12:15], v[88:91], 0
v_mfma_f32_16x16x32_bf16 v[28:31], a[0:3], v[92:95], 0
v_mfma_f32_16x16x32_bf16 v[44:47], a[4:7], v[92:95], 0
v_mfma_f32_16x16x32_bf16 v[60:63], a[8:11], v[92:95], 0
v_mfma_f32_16x16x32_bf16 v[76:79], a[12:15], v[92:95], 0
v_mfma_f32_16x16x32_bf16 v[32:35], a[0:3], v[96:99], 0
v_mfma_f32_16x16x32_bf16 v[48:51], a[4:7], v[96:99], 0
v_mfma_f32_16x16x32_bf16 v[64:67], a[8:11], v[96:99], 0
v_mfma_f32_16x16x32_bf16 v[80:83], a[12:15], v[96:99], 0
v_mfma_f32_16x16x32_bf16 v[36:39], a[0:3], v[100:103], 0
v_mfma_f32_16x16x32_bf16 v[52:55], a[4:7], v[100:103], 0
v_mfma_f32_16x16x32_bf16 v[68:71], a[8:11], v[100:103], 0
v_mfma_f32_16x16x32_bf16 v[84:87], a[12:15], v[100:103], 0
s_waitcnt vmcnt(36)
v_mfma_f32_16x16x32_bf16 v[24:27], a[16:19], v[104:107], v[24:27]
v_mfma_f32_16x16x32_bf16 v[40:43], a[20:23], v[104:107], v[40:43]
v_mfma_f32_16x16x32_bf16 v[56:59], a[24:27], v[104:107], v[56:59]
v_mfma_f32_16x16x32_bf16 v[72:75], a[28:31], v[104:107], v[72:75]
v_mfma_f32_16x16x32_bf16 v[28:31], a[16:19], v[108:111], v[28:31]
v_mfma_f32_16x16x32_bf16 v[44:47], a[20:23], v[108:111], v[44:47]
v_mfma_f32_16x16x32_bf16 v[60:63], a[24:27], v[108:111], v[60:63]
v_mfma_f32_16x16x32_bf16 v[76:79], a[28:31], v[108:111], v[76:79]
v_mfma_f32_16x16x32_bf16 v[32:35], a[16:19], v[112:115], v[32:35]
v_mfma_f32_16x16x32_bf16 v[48:51], a[20:23], v[112:115], v[48:51]
v_mfma_f32_16x16x32_bf16 v[64:67], a[24:27], v[112:115], v[64:67]
v_mfma_f32_16x16x32_bf16 v[80:83], a[28:31], v[112:115], v[80:83]
v_mfma_f32_16x16x32_bf16 v[36:39], a[16:19], v[116:119], v[36:39]
v_mfma_f32_16x16x32_bf16 v[52:55], a[20:23], v[116:119], v[52:55]
v_mfma_f32_16x16x32_bf16 v[68:71], a[24:27], v[116:119], v[68:71]
v_mfma_f32_16x16x32_bf16 v[84:87], a[28:31], v[116:119], v[84:87]
s_waitcnt vmcnt(32)
v_mfma_f32_16x16x32_bf16 v[24:27], a[32:35], v[120:123], v[24:27]
v_mfma_f32_16x16x32_bf16 v[40:43], a[36:39], v[120:123], v[40:43]
v_mfma_f32_16x16x32_bf16 v[56:59], a[40:43], v[120:123], v[56:59]
v_mfma_f32_16x16x32_bf16 v[72:75], a[44:47], v[120:123], v[72:75]
v_mfma_f32_16x16x32_bf16 v[28:31], a[32:35], v[124:127], v[28:31]
v_mfma_f32_16x16x32_bf16 v[44:47], a[36:39], v[124:127], v[44:47]
v_mfma_f32_16x16x32_bf16 v[60:63], a[40:43], v[124:127], v[60:63]
v_mfma_f32_16x16x32_bf16 v[76:79], a[44:47], v[124:127], v[76:79]
v_mfma_f32_16x16x32_bf16 v[32:35], a[32:35], v[128:131], v[32:35]
v_mfma_f32_16x16x32_bf16 v[48:51], a[36:39], v[128:131], v[48:51]
v_mfma_f32_16x16x32_bf16 v[64:67], a[40:43], v[128:131], v[64:67]
v_mfma_f32_16x16x32_bf16 v[80:83], a[44:47], v[128:131], v[80:83]
v_mfma_f32_16x16x32_bf16 v[36:39], a[32:35], v[132:135], v[36:39]
v_mfma_f32_16x16x32_bf16 v[52:55], a[36:39], v[132:135], v[52:55]
v_mfma_f32_16x16x32_bf16 v[68:71], a[40:43], v[132:135], v[68:71]
v_mfma_f32_16x16x32_bf16 v[84:87], a[44:47], v[132:135], v[84:87]
s_waitcnt vmcnt(28)
v_mfma_f32_16x16x32_bf16 v[24:27], a[48:51], v[136:139], v[24:27]
v_mfma_f32_16x16x32_bf16 v[40:43], a[52:55], v[136:139], v[40:43]
v_mfma_f32_16x16x32_bf16 v[56:59], a[56:59], v[136:139], v[56:59]
v_mfma_f32_16x16x32_bf16 v[72:75], a[60:63], v[136:139], v[72:75]
v_mfma_f32_16x16x32_bf16 v[28:31], a[48:51], v[140:143], v[28:31]
v_mfma_f32_16x16x32_bf16 v[44:47], a[52:55], v[140:143], v[44:47]
v_mfma_f32_16x16x32_bf16 v[60:63], a[56:59], v[140:143], v[60:63]
v_mfma_f32_16x16x32_bf16 v[76:79], a[60:63], v[140:143], v[76:79]
v_mfma_f32_16x16x32_bf16 v[32:35], a[48:51], v[144:147], v[32:35]
v_mfma_f32_16x16x32_bf16 v[48:51], a[52:55], v[144:147], v[48:51]
v_mfma_f32_16x16x32_bf16 v[64:67], a[56:59], v[144:147], v[64:67]
v_mfma_f32_16x16x32_bf16 v[80:83], a[60:63], v[144:147], v[80:83]
v_mfma_f32_16x16x32_bf16 v[36:39], a[48:51], v[148:151], v[36:39]
v_mfma_f32_16x16x32_bf16 v[52:55], a[52:55], v[148:151], v[52:55]
v_mfma_f32_16x16x32_bf16 v[68:71], a[56:59], v[148:151], v[68:71]
v_mfma_f32_16x16x32_bf16 v[84:87], a[60:63], v[148:151], v[84:87]
s_waitcnt vmcnt(24)
v_mfma_f32_16x16x32_bf16 v[24:27], a[64:67], v[152:155], v[24:27]
v_mfma_f32_16x16x32_bf16 v[40:43], a[68:71], v[152:155], v[40:43]
v_mfma_f32_16x16x32_bf16 v[56:59], a[72:75], v[152:155], v[56:59]
v_mfma_f32_16x16x32_bf16 v[72:75], a[76:79], v[152:155], v[72:75]
v_mfma_f32_16x16x32_bf16 v[28:31], a[64:67], v[156:159], v[28:31]
v_mfma_f32_16x16x32_bf16 v[44:47], a[68:71], v[156:159], v[44:47]
v_mfma_f32_16x16x32_bf16 v[60:63], a[72:75], v[156:159], v[60:63]
v_mfma_f32_16x16x32_bf16 v[76:79], a[76:79], v[156:159], v[76:79]
v_mfma_f32_16x16x32_bf16 v[32:35], a[64:67], v[160:163], v[32:35]
v_mfma_f32_16x16x32_bf16 v[48:51], a[68:71], v[160:163], v[48:51]
v_mfma_f32_16x16x32_bf16 v[64:67], a[72:75], v[160:163], v[64:67]
v_mfma_f32_16x16x32_bf16 v[80:83], a[76:79], v[160:163], v[80:83]
v_mfma_f32_16x16x32_bf16 v[36:39], a[64:67], v[164:167], v[36:39]
v_mfma_f32_16x16x32_bf16 v[52:55], a[68:71], v[164:167], v[52:55]
v_mfma_f32_16x16x32_bf16 v[68:71], a[72:75], v[164:167], v[68:71]
v_mfma_f32_16x16x32_bf16 v[84:87], a[76:79], v[164:167], v[84:87]
s_waitcnt vmcnt(20)
v_mfma_f32_16x16x32_bf16 v[24:27], a[80:83], v[168:171], v[24:27]
v_mfma_f32_16x16x32_bf16 v[40:43], a[84:87], v[168:171], v[40:43]
v_mfma_f32_16x16x32_bf16 v[56:59], a[88:91], v[168:171], v[56:59]
v_mfma_f32_16x16x32_bf16 v[72:75], a[92:95], v[168:171], v[72:75]
v_mfma_f32_16x16x32_bf16 v[28:31], a[80:83], v[172:175], v[28:31]
v_mfma_f32_16x16x32_bf16 v[44:47], a[84:87], v[172:175], v[44:47]
v_mfma_f32_16x16x32_bf16 v[60:63], a[88:91], v[172:175], v[60:63]
v_mfma_f32_16x16x32_bf16 v[76:79], a[92:95], v[172:175], v[76:79]
v_mfma_f32_16x16x32_bf16 v[32:35], a[80:83], v[176:179], v[32:35]
v_mfma_f32_16x16x32_bf16 v[48:51], a[84:87], v[176:179], v[48:51]
v_mfma_f32_16x16x32_bf16 v[64:67], a[88:91], v[176:179], v[64:67]
v_mfma_f32_16x16x32_bf16 v[80:83], a[92:95], v[176:179], v[80:83]
v_mfma_f32_16x16x32_bf16 v[36:39], a[80:83], v[180:183], v[36:39]
v_mfma_f32_16x16x32_bf16 v[52:55], a[84:87], v[180:183], v[52:55]
v_mfma_f32_16x16x32_bf16 v[68:71], a[88:91], v[180:183], v[68:71]
v_mfma_f32_16x16x32_bf16 v[84:87], a[92:95], v[180:183], v[84:87]
s_waitcnt vmcnt(16)
v_mfma_f32_16x16x32_bf16 v[24:27], a[96:99], v[184:187], v[24:27]
v_mfma_f32_16x16x32_bf16 v[40:43], a[100:103], v[184:187], v[40:43]
v_mfma_f32_16x16x32_bf16 v[56:59], a[104:107], v[184:187], v[56:59]
v_mfma_f32_16x16x32_bf16 v[72:75], a[108:111], v[184:187], v[72:75]
v_mfma_f32_16x16x32_bf16 v[28:31], a[96:99], v[188:191], v[28:31]
v_mfma_f32_16x16x32_bf16 v[44:47], a[100:103], v[188:191], v[44:47]
v_mfma_f32_16x16x32_bf16 v[60:63], a[104:107], v[188:191], v[60:63]
v_mfma_f32_16x16x32_bf16 v[76:79], a[108:111], v[188:191], v[76:79]
v_mfma_f32_16x16x32_bf16 v[32:35], a[96:99], v[192:195], v[32:35]
v_mfma_f32_16x16x32_bf16 v[48:51], a[100:103], v[192:195], v[48:51]
v_mfma_f32_16x16x32_bf16 v[64:67], a[104:107], v[192:195], v[64:67]
v_mfma_f32_16x16x32_bf16 v[80:83], a[108:111], v[192:195], v[80:83]
v_mfma_f32_16x16x32_bf16 v[36:39], a[96:99], v[196:199], v[36:39]
v_mfma_f32_16x16x32_bf16 v[52:55], a[100:103], v[196:199], v[52:55]
v_mfma_f32_16x16x32_bf16 v[68:71], a[104:107], v[196:199], v[68:71]
v_mfma_f32_16x16x32_bf16 v[84:87], a[108:111], v[196:199], v[84:87]
s_waitcnt vmcnt(12)
v_mfma_f32_16x16x32_bf16 v[24:27], a[112:115], v[200:203], v[24:27]
v_mfma_f32_16x16x32_bf16 v[40:43], a[116:119], v[200:203], v[40:43]
v_mfma_f32_16x16x32_bf16 v[56:59], a[120:123], v[200:203], v[56:59]
v_mfma_f32_16x16x32_bf16 v[72:75], a[124:127], v[200:203], v[72:75]
v_mfma_f32_16x16x32_bf16 v[28:31], a[112:115], v[204:207], v[28:31]
v_mfma_f32_16x16x32_bf16 v[44:47], a[116:119], v[204:207], v[44:47]
v_mfma_f32_16x16x32_bf16 v[60:63], a[120:123], v[204:207], v[60:63]
v_mfma_f32_16x16x32_bf16 v[76:79], a[124:127], v[204:207], v[76:79]
v_mfma_f32_16x16x32_bf16 v[32:35], a[112:115], v[208:211], v[32:35]
v_mfma_f32_16x16x32_bf16 v[48:51], a[116:119], v[208:211], v[48:51]
v_mfma_f32_16x16x32_bf16 v[64:67], a[120:123], v[208:211], v[64:67]
v_mfma_f32_16x16x32_bf16 v[80:83], a[124:127], v[208:211], v[80:83]
v_mfma_f32_16x16x32_bf16 v[36:39], a[112:115], v[212:215], v[36:39]
v_mfma_f32_16x16x32_bf16 v[52:55], a[116:119], v[212:215], v[52:55]
v_mfma_f32_16x16x32_bf16 v[68:71], a[120:123], v[212:215], v[68:71]
v_mfma_f32_16x16x32_bf16 v[84:87], a[124:127], v[212:215], v[84:87]
s_waitcnt vmcnt(8)
v_mfma_f32_16x16x32_bf16 v[24:27], a[128:131], v[216:219], v[24:27]
v_mfma_f32_16x16x32_bf16 v[40:43], a[132:135], v[216:219], v[40:43]
v_mfma_f32_16x16x32_bf16 v[56:59], a[136:139], v[216:219], v[56:59]
v_mfma_f32_16x16x32_bf16 v[72:75], a[140:143], v[216:219], v[72:75]
v_mfma_f32_16x16x32_bf16 v[28:31], a[128:131], v[220:223], v[28:31]
v_mfma_f32_16x16x32_bf16 v[44:47], a[132:135], v[220:223], v[44:47]
v_mfma_f32_16x16x32_bf16 v[60:63], a[136:139], v[220:223], v[60:63]
v_mfma_f32_16x16x32_bf16 v[76:79], a[140:143], v[220:223], v[76:79]
v_mfma_f32_16x16x32_bf16 v[32:35], a[128:131], v[224:227], v[32:35]
v_mfma_f32_16x16x32_bf16 v[48:51], a[132:135], v[224:227], v[48:51]
v_mfma_f32_16x16x32_bf16 v[64:67], a[136:139], v[224:227], v[64:67]
v_mfma_f32_16x16x32_bf16 v[80:83], a[140:143], v[224:227], v[80:83]
v_mfma_f32_16x16x32_bf16 v[36:39], a[128:131], v[228:231], v[36:39]
v_mfma_f32_16x16x32_bf16 v[52:55], a[132:135], v[228:231], v[52:55]
v_mfma_f32_16x16x32_bf16 v[68:71], a[136:139], v[228:231], v[68:71]
v_mfma_f32_16x16x32_bf16 v[84:87], a[140:143], v[228:231], v[84:87]
s_waitcnt vmcnt(4)
v_mfma_f32_16x16x32_bf16 v[24:27], a[144:147], v[232:235], v[24:27]
v_mfma_f32_16x16x32_bf16 v[40:43], a[148:151], v[232:235], v[40:43]
v_mfma_f32_16x16x32_bf16 v[56:59], a[152:155], v[232:235], v[56:59]
v_mfma_f32_16x16x32_bf16 v[72:75], a[156:159], v[232:235], v[72:75]
v_mfma_f32_16x16x32_bf16 v[28:31], a[144:147], v[236:239], v[28:31]
v_mfma_f32_16x16x32_bf16 v[44:47], a[148:151], v[236:239], v[44:47]
v_mfma_f32_16x16x32_bf16 v[60:63], a[152:155], v[236:239], v[60:63]
v_mfma_f32_16x16x32_bf16 v[76:79], a[156:159], v[236:239], v[76:79]
v_mfma_f32_16x16x32_bf16 v[32:35], a[144:147], v[240:243], v[32:35]
v_mfma_f32_16x16x32_bf16 v[48:51], a[148:151], v[240:243], v[48:51]
v_mfma_f32_16x16x32_bf16 v[64:67], a[152:155], v[240:243], v[64:67]
v_mfma_f32_16x16x32_bf16 v[80:83], a[156:159], v[240:243], v[80:83]
v_mfma_f32_16x16x32_bf16 v[36:39], a[144:147], v[244:247], v[36:39]
v_mfma_f32_16x16x32_bf16 v[52:55], a[148:151], v[244:247], v[52:55]
v_mfma_f32_16x16x32_bf16 v[68:71], a[152:155], v[244:247], v[68:71]
v_mfma_f32_16x16x32_bf16 v[84:87], a[156:159], v[244:247], v[84:87]
s_cmp_eq_u32 s36, 3
s_cbranch_scc1 K45_SKIP
s_waitcnt vmcnt(0)
v_mfma_f32_16x16x32_bf16 v[24:27], a[160:163], a[176:179], v[24:27]
v_mfma_f32_16x16x32_bf16 v[40:43], a[164:167], a[176:179], v[40:43]
v_mfma_f32_16x16x32_bf16 v[56:59], a[168:171], a[176:179], v[56:59]
v_mfma_f32_16x16x32_bf16 v[72:75], a[172:175], a[176:179], v[72:75]
v_mfma_f32_16x16x32_bf16 v[28:31], a[160:163], a[180:183], v[28:31]
v_mfma_f32_16x16x32_bf16 v[44:47], a[164:167], a[180:183], v[44:47]
v_mfma_f32_16x16x32_bf16 v[60:63], a[168:171], a[180:183], v[60:63]
v_mfma_f32_16x16x32_bf16 v[76:79], a[172:175], a[180:183], v[76:79]
v_mfma_f32_16x16x32_bf16 v[32:35], a[160:163], a[184:187], v[32:35]
v_mfma_f32_16x16x32_bf16 v[48:51], a[164:167], a[184:187], v[48:51]
v_mfma_f32_16x16x32_bf16 v[64:67], a[168:171], a[184:187], v[64:67]
v_mfma_f32_16x16x32_bf16 v[80:83], a[172:175], a[184:187], v[80:83]
v_mfma_f32_16x16x32_bf16 v[36:39], a[160:163], a[188:191], v[36:39]
v_mfma_f32_16x16x32_bf16 v[52:55], a[164:167], a[188:191], v[52:55]
v_mfma_f32_16x16x32_bf16 v[68:71], a[168:171], a[188:191], v[68:71]
v_mfma_f32_16x16x32_bf16 v[84:87], a[172:175], a[188:191], v[84:87]
K45_SKIP:
s_nop 7
v_mov_b32 v88, v22
v_mov_b32 v89, v23
v_lshlrev_b32 v92, 10, v22
v_lshl_add_u32 v92, v23, 4, v92
v_and_b32 v93, 15, v1
v_lshrrev_b32 v94, 4, v1
s_mul_i32 s39, s36, 17408
v_mul_u32_u24 v93, 272, v93
v_lshl_add_u32 v93, v94, 4, v93
v_add_u32 v93, s39, v93
ds_write_b128 v93, v[24:27] offset:0
ds_write_b128 v93, v[40:43] offset:64
ds_write_b128 v93, v[56:59] offset:128
ds_write_b128 v93, v[72:75] offset:192
ds_write_b128 v93, v[28:31] offset:4352
ds_write_b128 v93, v[44:47] offset:4416
ds_write_b128 v93, v[60:63] offset:4480
ds_write_b128 v93, v[76:79] offset:4544
ds_write_b128 v93, v[32:35] offset:8704
ds_write_b128 v93, v[48:51] offset:8768
ds_write_b128 v93, v[64:67] offset:8832
ds_write_b128 v93, v[80:83] offset:8896
ds_write_b128 v93, v[36:39] offset:13056
ds_write_b128 v93, v[52:55] offset:13120
ds_write_b128 v93, v[68:71] offset:13184
ds_write_b128 v93, v[84:87] offset:13248
s_waitcnt lgkmcnt(0)
s_barrier
v_mul_u32_u24 v93, 272, v88
v_lshl_add_u32 v93, v89, 5, v93
ds_read_b128 v[24:27], v93 offset:0
ds_read_b128 v[28:31], v93 offset:16
ds_read_b128 v[32:35], v93 offset:17408
ds_read_b128 v[36:39], v93 offset:17424
ds_read_b128 v[40:43], v93 offset:34816
ds_read_b128 v[44:47], v93 offset:34832
ds_read_b128 v[48:51], v93 offset:52224
ds_read_b128 v[52:55], v93 offset:52240
ds_read_b128 v[56:59], v93 offset:8704
ds_read_b128 v[60:63], v93 offset:8720
ds_read_b128 v[64:67], v93 offset:26112
ds_read_b128 v[68:71], v93 offset:26128
ds_read_b128 v[72:75], v93 offset:43520
ds_read_b128 v[76:79], v93 offset:43536
ds_read_b128 v[80:83], v93 offset:60928
ds_read_b128 v[84:87], v93 offset:60944
s_waitcnt lgkmcnt(8)
v_add_f32 v24, v24, v32
v_add_f32 v25, v25, v33
v_add_f32 v26, v26, v34
v_add_f32 v27, v27, v35
v_add_f32 v28, v28, v36
v_add_f32 v29, v29, v37
v_add_f32 v30, v30, v38
v_add_f32 v31, v31, v39
v_add_f32 v24, v24, v40
v_add_f32 v25, v25, v41
v_add_f32 v26, v26, v42
v_add_f32 v27, v27, v43
v_add_f32 v28, v28, v44
v_add_f32 v29, v29, v45
v_add_f32 v30, v30, v46
v_add_f32 v31, v31, v47
v_add_f32 v24, v24, v48
v_add_f32 v25, v25, v49
v_add_f32 v26, v26, v50
v_add_f32 v27, v27, v51
v_add_f32 v28, v28, v52
v_add_f32 v29, v29, v53
v_add_f32 v30, v30, v54
v_add_f32 v31, v31, v55
v_lshlrev_b32 v98, 16, v14
v_and_b32 v99, 0xffff0000, v14
v_add_f32 v24, v24, v98
v_add_f32 v25, v25, v99
v_lshlrev_b32 v98, 16, v15
v_and_b32 v99, 0xffff0000, v15
v_add_f32 v26, v26, v98
v_add_f32 v27, v27, v99
v_lshlrev_b32 v98, 16, v16
v_and_b32 v99, 0xffff0000, v16
v_add_f32 v28, v28, v98
v_add_f32 v29, v29, v99
v_lshlrev_b32 v98, 16, v17
v_and_b32 v99, 0xffff0000, v17
v_add_f32 v30, v30, v98
v_add_f32 v31, v31, v99
v_cvt_pk_bf16_f32 v32, v24, v25
v_cvt_pk_bf16_f32 v33, v26, v27
v_cvt_pk_bf16_f32 v34, v28, v29
v_cvt_pk_bf16_f32 v35, v30, v31
buffer_store_dwordx4 v[32:35], v92, s[68:71], s46 offen
s_waitcnt lgkmcnt(0)
v_add_f32 v56, v56, v64
v_add_f32 v57, v57, v65
v_add_f32 v58, v58, v66
v_add_f32 v59, v59, v67
v_add_f32 v60, v60, v68
v_add_f32 v61, v61, v69
v_add_f32 v62, v62, v70
v_add_f32 v63, v63, v71
v_add_f32 v56, v56, v72
v_add_f32 v57, v57, v73
v_add_f32 v58, v58, v74
v_add_f32 v59, v59, v75
v_add_f32 v60, v60, v76
v_add_f32 v61, v61, v77
v_add_f32 v62, v62, v78
v_add_f32 v63, v63, v79
v_add_f32 v56, v56, v80
v_add_f32 v57, v57, v81
v_add_f32 v58, v58, v82
v_add_f32 v59, v59, v83
v_add_f32 v60, v60, v84
v_add_f32 v61, v61, v85
v_add_f32 v62, v62, v86
v_add_f32 v63, v63, v87
v_lshlrev_b32 v98, 16, v18
v_and_b32 v99, 0xffff0000, v18
v_add_f32 v56, v56, v98
v_add_f32 v57, v57, v99
v_lshlrev_b32 v98, 16, v19
v_and_b32 v99, 0xffff0000, v19
v_add_f32 v58, v58, v98
v_add_f32 v59, v59, v99
v_lshlrev_b32 v98, 16, v20
v_and_b32 v99, 0xffff0000, v20
v_add_f32 v60, v60, v98
v_add_f32 v61, v61, v99
v_lshlrev_b32 v98, 16, v21
v_and_b32 v99, 0xffff0000, v21
v_add_f32 v62, v62, v98
v_add_f32 v63, v63, v99
v_cvt_pk_bf16_f32 v64, v56, v57
v_cvt_pk_bf16_f32 v65, v58, v59
v_cvt_pk_bf16_f32 v66, v60, v61
v_cvt_pk_bf16_f32 v67, v62, v63
buffer_store_dwordx4 v[64:67], v92, s[68:71], s47 offen
K5_END:
s_endpgm
TEXT_END:
s_endpgm
.section .rodata,"a"
.p2align 6
.amdhsa_kernel k1_kernel
  .amdhsa_next_free_vgpr 512
  .amdhsa_next_free_sgpr 100
  .amdhsa_accum_offset 256
  .amdhsa_group_segment_fixed_size 0
  .amdhsa_kernarg_size 104
  .amdhsa_user_sgpr_count 2
  .amdhsa_user_sgpr_kernarg_segment_ptr 1
  .amdhsa_system_sgpr_workgroup_id_x 1
  .amdhsa_float_denorm_mode_32 3
.end_amdhsa_kernel
.section .rodata,"a"
.p2align 6
.amdhsa_kernel k2_kernel
  .amdhsa_next_free_vgpr 512
  .amdhsa_next_free_sgpr 100
  .amdhsa_accum_offset 256
  .amdhsa_group_segment_fixed_size 0
  .amdhsa_kernarg_size 104
  .amdhsa_user_sgpr_count 2
  .amdhsa_user_sgpr_kernarg_segment_ptr 1
  .amdhsa_system_sgpr_workgroup_id_x 1
  .amdhsa_float_denorm_mode_32 3
.end_amdhsa_kernel
.section .rodata,"a"
.p2align 6
.amdhsa_kernel k3_kernel
  .amdhsa_next_free_vgpr 512
  .amdhsa_next_free_sgpr 100
  .amdhsa_accum_offset 256
  .amdhsa_group_segment_fixed_size 0
  .amdhsa_kernarg_size 104
  .amdhsa_user_sgpr_count 2
  .amdhsa_user_sgpr_kernarg_segment_ptr 1
  .amdhsa_system_sgpr_workgroup_id_x 1
  .amdhsa_float_denorm_mode_32 3
.end_amdhsa_kernel
.section .rodata,"a"
.p2align 6
.amdhsa_kernel k45_kernel
  .amdhsa_next_free_vgpr 512
  .amdhsa_next_free_sgpr 100
  .amdhsa_accum_offset 256
  .amdhsa_group_segment_fixed_size 0
  .amdhsa_kernarg_size 104
  .amdhsa_user_sgpr_count 2
  .amdhsa_user_sgpr_kernarg_segment_ptr 1
  .amdhsa_system_sgpr_workgroup_id_x 1
  .amdhsa_float_denorm_mode_32 3
.end_amdhsa_kernel
```
